```python
import torch

def _softmax(x, axis=-1):
    return torch.softmax(x, dim=axis)
def _gelu(x):
    return torch.nn.functional.gelu(x, approximate="tanh")
def _silu(x):
    return torch.nn.functional.silu(x)
def _sigmoid(x):
    return torch.sigmoid(x)
def _layernorm(x, axis=-1, eps=1e-5):
    m = x.mean(dim=axis, keepdim=True)
    v = x.var(dim=axis, keepdim=True, unbiased=False)
    return (x - m) / torch.sqrt(v + eps)
def _scatter_add(tgt, idx, src, axis=0):
    return tgt.clone().index_add_(axis, idx, src)
def _segment_sum(src, seg, n):
    out = torch.zeros((n,) + src.shape[1:], dtype=src.dtype)
    return out.index_add_(0, seg, src)
def _pad(x, pw):
    flat = tuple(v for pair in reversed(pw) for v in pair)
    return torch.nn.functional.pad(x, flat)

kernel_name = 'gated_mix__sliding_block__dense_activation_relu__prompt'

def setup_inputs():

    _w = (lambda a: (lambda t: t.to(torch.bfloat16) if t.is_floating_point() else t)(torch.as_tensor(a)))
    def _A_setup():
        B, S, D = 1, 2048, 640
        return {
            "x": _w((lambda *s: torch.randn(*s, dtype=torch.bfloat16) * 0.05)(B, S, D)),
            "wqkv": _w((lambda *s: torch.randn(*s, dtype=torch.bfloat16) * 0.8)(D, 3 * D)),
            "wo": _w((lambda *s: torch.randn(*s, dtype=torch.bfloat16) * 0.05)(D, D)),
        }
    _A_in = _A_setup()

    def _B_setup():
        B, S, D, Dff = 1, 2048, 640, 1728
        return {
            "x": _w((lambda *s: torch.randn(*s, dtype=torch.bfloat16) * 0.05)(B, S, D)),
            "w1": _w((lambda *s: torch.randn(*s, dtype=torch.bfloat16) * 0.1)(D, Dff)),
            "w2": _w((lambda *s: torch.randn(*s, dtype=torch.bfloat16) * 0.1)(Dff, D)),
        }
    _B_in = _B_setup()

    return {
        "A_x": _A_in["x"],
        "A_wqkv": _A_in["wqkv"],
        "A_wo": _A_in["wo"],
        "B_x": _B_in["x"],
        "B_w1": _B_in["w1"],
        "B_w2": _B_in["w2"],
        "gate_w": _w((lambda *s: torch.randn(*s, dtype=torch.bfloat16) * 0.05)(640) * 16.0),
    }

def reference(A_x, A_wqkv, A_wo, B_x, B_w1, B_w2, gate_w):
    def _A_ref(x, wqkv, wo):
        B, S, D = x.shape
        H = 32; Dh = D // H; W = 256
        qkv = (lambda x, *d: x.permute(*d))((x @ wqkv).reshape(B, S, 3, H, Dh), 2, 0, 3, 1, 4)
        q, k, v = qkv[0], qkv[1], qkv[2]
        scores = torch.einsum("bhqd,bhkd->bhqk", q, k) * (Dh ** -0.5)
        idx = torch.arange(S)
        mask = (idx[:, None] - idx[None, :] >= 0) & (idx[:, None] - idx[None, :] < W)
        scores = torch.where(mask[None, None], scores, -1e9)
        p = _softmax(scores, axis=-1)
        o = torch.einsum("bhqk,bhkd->bhqd", p, v)
        return (lambda x, *d: x.permute(*d))(o, 0, 2, 1, 3).reshape(B, S, D) @ wo

    def _B_ref(x, w1, w2):
        h = torch.einsum("bsd,df->bsf", x, w1)
        zero = torch.zeros_like(h)
        h = torch.maximum(h, zero)
        return torch.einsum("bsf,fd->bsd", h, w2)

    x = A_x
    g = _sigmoid((x * gate_w).sum(-1, keepdims=True))
    a = _A_ref(x, A_wqkv, A_wo)
    b = _B_ref(x, B_w1, B_w2)
    return g * a + (1 - g) * b
```

```asm
; @launch grid=(256,1,1) block=(256,1,1) lds=163840
.amdgcn_target "amdgcn-amd-amdhsa--gfx950"
.text
.globl gated_mix__sliding_block__dense_activation_relu__prompt_kernel
.p2align 8
.type gated_mix__sliding_block__dense_activation_relu__prompt_kernel,@function
gated_mix__sliding_block__dense_activation_relu__prompt_kernel:
    s_cmp_ge_u32 s2, 256
 s_cbranch_scc1 L_end
 s_load_dwordx2 s[4:5], s[0:1], 0
 s_load_dwordx2 s[8:9], s[0:1], 8
 s_load_dwordx2 s[12:13], s[0:1], 32
 s_load_dwordx2 s[16:17], s[0:1], 72
 s_load_dwordx2 s[20:21], s[0:1], 56
 s_load_dwordx2 s[24:25], s[0:1], 64
 s_getpc_b64 s[46:47]
L_pc:
 s_cmp_lt_u32 s2, 240
 s_cbranch_scc1 L_nopf
 s_bfe_u32 s40, s2, 0x10003
 v_lshl_add_u32 v248, v0, 1, s40
 v_lshlrev_b32 v248, 7, v248
 v_min_u32 v248, L_cold-L_pc, v248
 global_load_dword v224, v248, s[46:47]
L_nopf:
 v_lshrrev_b32 v248, 6, v0
 v_and_b32 v255, 63, v0
 v_readfirstlane_b32 s3, v248
 s_bfe_u32 s40, s2, 0x20001
 s_mul_i32 s40, s40, 30
 s_lshr_b32 s41, s2, 3
 s_add_u32 s40, s40, s41
 s_lshr_b32 s34, s40, 3
 s_and_b32 s40, s40, 7
 s_and_b32 s41, s2, 1
 s_lshl3_add_u32 s40, s41, s40
 s_add_u32 s45, s40, s34
 s_and_b32 s45, s45, 1
 s_lshr_b32 s43, s2, 1
 s_lshl1_add_u32 s43, s2, s43
 s_and_b32 s43, s43, 3
 s_mul_i32 s43, s43, 2
 s_add_u32 s45, s45, s43
 s_mov_b32 s80, 0x85634120
 s_mov_b32 s81, 0x97
 s_cmp_eq_u32 s45, 1
 s_cselect_b32 s80, 0x67452301, s80
 s_cselect_b32 s81, 0x89, s81
 s_cmp_eq_u32 s45, 2
 s_cselect_b32 s80, 0x85634120, s80
 s_cselect_b32 s81, 0x97, s81
 s_cmp_eq_u32 s45, 3
 s_cselect_b32 s80, 0x67452301, s80
 s_cselect_b32 s81, 0x89, s81
 s_cmp_eq_u32 s45, 4
 s_cselect_b32 s80, 0x30189675, s80
 s_cselect_b32 s81, 0x42, s81
 s_cmp_eq_u32 s45, 5
 s_cselect_b32 s80, 0x12907856, s80
 s_cselect_b32 s81, 0x34, s81
 s_cmp_eq_u32 s45, 6
 s_cselect_b32 s80, 0x30189675, s80
 s_cselect_b32 s81, 0x42, s81
 s_cmp_eq_u32 s45, 7
 s_cselect_b32 s80, 0x12907856, s80
 s_cselect_b32 s81, 0x34, s81
 s_lshl2_add_u32 s40, s40, s3
 s_mul_i32 s40, s40, 40960
 s_lshl_b32 s44, s34, 8
 s_movk_i32 s42, 1280
 s_movk_i32 s43, 18432
 v_lshrrev_b32 v249, 4, v255
 v_and_b32 v250, 7, v255
 v_xor_b32 v250, v250, v249
 v_lshl_add_u32 v250, v250, 4, s40
 v_lshrrev_b32 v248, 3, v255
 v_mad_u32_u24 v0, v248, s42, v250
 v_xad_u32 v2, v0, 64, s43
 v_add_u32 v1, 9216, v0
 v_add_u32 v3, 9216, v2
 v_lshlrev_b32 v250, 2, v249
 v_and_b32 v251, 15, v255
 v_xor_b32 v250, v250, v251
 v_lshl_add_u32 v250, v250, 4, s44
 v_lshl_add_u32 v249, s3, 4, v249
 s_movk_i32 s42, 3840
 v_mad_u32_u24 v4, v249, s42, v250
 s_movk_i32 s43, 28672
 v_xad_u32 v6, v4, 16, s43
 v_add_u32 v5, 14336, v4
 v_add_u32 v7, 14336, v6
 s_lshl_b32 s86, s3, 12
 s_lshl2_add_u32 s35, s86, 81920
 s_mov_b32 s6, 2621440
 s_mov_b32 s7, 0x20000
 s_mov_b32 s10, 2457600
 s_mov_b32 s11, 0x20000
 s_lshl2_add_u32 s40, s2, s3
 s_mul_i32 s40, s40, 192
L_pc2:
 s_add_u32 s46, s46, wave_table@rel32@lo+(L_pc2+4-L_pc)
 s_addc_u32 s47, s47, wave_table@rel32@hi+(L_pc2+12-L_pc)
 s_add_u32 s46, s46, s40
 s_addc_u32 s47, s47, 0
 s_waitcnt lgkmcnt(0)
 s_cmp_ge_u32 s2, 240
 s_cbranch_scc1 L_spare
 s_load_dwordx2 s[32:33], s[0:1], 16
 s_load_dwordx4 s[36:39], s[0:1], 40
 s_load_dwordx16 s[48:63], s[46:47], 0
 s_load_dwordx16 s[64:79], s[46:47], 64
 s_load_dword s87, s[46:47], 128
 s_add_u32 m0, s35, 0
 s_bfe_u32 s45, s80, 0x40000
 s_mul_i32 s45, s45, 128
 buffer_load_dwordx4 v0, s[4:7], s45 offen offset:0 lds
 buffer_load_dwordx4 v1, s[4:7], s45 offen offset:1024 lds
 buffer_load_dwordx4 v2, s[4:7], s45 offen offset:2048 lds
 buffer_load_dwordx4 v3, s[4:7], s45 offen offset:3072 lds
 s_add_u32 m0, s86, 0
 s_bfe_u32 s45, s80, 0x40000
 s_mul_i32 s45, s45, 245760
 buffer_load_dwordx4 v4, s[8:11], s45 offen offset:0 lds
 buffer_load_dwordx4 v5, s[8:11], s45 offen offset:1024 lds
 buffer_load_dwordx4 v6, s[8:11], s45 offen offset:2048 lds
 buffer_load_dwordx4 v7, s[8:11], s45 offen offset:3072 lds
 s_mov_b32 s14, 2211840
 s_mov_b32 s15, 0x20000
 s_mov_b32 s18, 26060800
 s_mov_b32 s19, 0x20000
 s_mov_b32 s22, 2621440
 s_mov_b32 s23, 0x20000
 s_mov_b32 s26, 256
 s_mov_b32 s27, 0x20000
 s_mov_b32 s31, 0x20000
 v_lshlrev_b32 v254, 4, v255
 v_mov_b32 v237, 0
 v_lshrrev_b32 v236, 5, v255
 v_lshl_add_u32 v236, v236, 26, v254
 s_mov_b32 s94, 0xfffff
 s_mov_b32 s95, 0xfffff
 s_mov_b32 s96, 0x10000
 s_mov_b32 s97, 0x20000
 s_movk_i32 s42, 3456
 v_and_b32 v15, 255, v250
 v_mad_u32_u24 v8, v249, s42, v15
 s_movk_i32 s43, 25600
 v_xad_u32 v10, v8, 16, s43
 v_add_u32 v9, 12800, v8
 v_add_u32 v11, 12800, v10
 v_and_b32 v246, 8, v255
 v_and_b32 v248, 15, v255
 v_add_u32 v246, v246, v248
 v_lshrrev_b32 v247, 4, v255
 s_and_b32 s40, s3, 2
 s_lshl_b32 s40, s40, 14
 s_add_u32 s40, s40, 81920
 v_bfe_u32 v249, v255, 1, 3
 v_xor_b32 v249, v249, v247
 v_lshl_add_u32 v249, v249, 4, s40
 v_lshl_add_u32 v12, v246, 7, v249
 v_xor_b32 v13, 64, v12
 s_and_b32 s41, s3, 1
 s_lshl_b32 s40, s41, 3
 v_and_b32 v248, 14, v255
 v_and_or_b32 v248, v247, 1, v248
 v_xor_b32 v248, s40, v248
 v_and_b32 v249, 1, v255
 v_lshl_add_u32 v248, v248, 1, v249
 v_bfe_u32 v249, v255, 2, 2
 v_lshl_add_u32 v249, v247, 3, v249
 v_lshlrev_b32 v249, 8, v249
 v_lshl_add_u32 v16, v248, 3, v249
 v_xor_b32 v17, 16, v16
 v_xor_b32 v18, 64, v16
 v_xor_b32 v19, 80, v16
 v_add_u32 v20, 0x10000, v16
 v_add_u32 v21, 0x10000, v17
 v_add_u32 v22, 0x10000, v18
 v_add_u32 v23, 0x10000, v19
 v_lshlrev_b32 v248, 4, v246
 v_lshl_add_u32 v226, v247, 9, v248
 s_cmp_ge_u32 s34, 10
 s_cbranch_scc1 L_st1v_1
 v_lshrrev_b32 v248, 5, v255
 v_mul_u32_u24 v248, 64512, v248
 v_add_u32 v24, v248, v226
 v_add_u32 v25, 128, v24
 v_add_u32 v26, 131072, v24
 v_add_u32 v27, 131200, v24
 s_branch L_st1d_2
L_st1v_1:
 s_lshl1_add_u32 s41, s34, s41
 s_lshl_b32 s41, s41, 6
 s_sub_u32 s41, s41, 1280
 v_add_u32 v248, s41, v246
 v_mul_u32_u24 v250, 640, v247
 s_mov_b32 s42, 163200
 v_mul_u32_u24 v251, 1639, v248
 v_lshrrev_b32 v251, 16, v251
 v_lshl_add_u32 v249, v248, 4, v250
 v_mad_u32_u24 v24, v251, s42, v249
 v_add_u32 v248, 8, v248
 v_mul_u32_u24 v251, 1639, v248
 v_lshrrev_b32 v251, 16, v251
 v_lshl_add_u32 v249, v248, 4, v250
 v_mad_u32_u24 v25, v251, s42, v249
 v_add_u32 v248, 24, v248
 v_mul_u32_u24 v251, 1639, v248
 v_lshrrev_b32 v251, 16, v251
 v_lshl_add_u32 v249, v248, 4, v250
 v_mad_u32_u24 v26, v251, s42, v249
 v_add_u32 v248, 8, v248
 v_mul_u32_u24 v251, 1639, v248
 v_lshrrev_b32 v251, 16, v251
 v_lshl_add_u32 v249, v248, 4, v250
 v_mad_u32_u24 v27, v251, s42, v249
L_st1d_2:
 s_add_u32 m0, s35, 4096
 s_bfe_u32 s45, s80, 0x40004
 s_mul_i32 s45, s45, 128
 buffer_load_dwordx4 v0, s[4:7], s45 offen offset:0 lds
 buffer_load_dwordx4 v1, s[4:7], s45 offen offset:1024 lds
 buffer_load_dwordx4 v2, s[4:7], s45 offen offset:2048 lds
 buffer_load_dwordx4 v3, s[4:7], s45 offen offset:3072 lds
 s_and_b32 s40, s3, 1
 s_mul_i32 s40, s40, 160
 v_add_u32 v248, s40, v255
 v_mul_u32_u24 v249, 820, v248
 v_lshrrev_b32 v249, 16, v249
 v_lshlrev_b32 v249, 2, v249
 v_xor_b32 v249, v248, v249
 v_lshlrev_b32 v76, 4, v249
 v_add_u32 v248, 64, v248
 v_mul_u32_u24 v249, 820, v248
 v_lshrrev_b32 v249, 16, v249
 v_lshlrev_b32 v249, 2, v249
 v_xor_b32 v249, v248, v249
 v_lshlrev_b32 v77, 4, v249
 v_add_u32 v248, 64, v248
 v_mul_u32_u24 v249, 820, v248
 v_lshrrev_b32 v249, 16, v249
 v_lshlrev_b32 v249, 2, v249
 v_xor_b32 v249, v248, v249
 v_lshlrev_b32 v78, 4, v249
 v_lshrrev_b32 v248, 4, v255
 v_and_b32 v249, 3, v255
 v_bfe_u32 v247, v255, 2, 2
 v_lshlrev_b32 v251, 3, v247
 v_mul_u32_u24 v247, 1280, v247
 v_add_u32 v247, 147456, v247
 s_lshl_b32 s40, s3, 5
 v_and_b32 v246, 1, v248
 v_lshl_add_u32 v250, v249, 1, v246
 v_lshrrev_b32 v64, 5, v255
 v_lshl_add_u32 v250, v64, 3, v250
 v_add_u32 v250, s40, v250
 v_xor_b32 v64, v250, v251
 v_lshl_add_u32 v79, v64, 3, v247
 v_add_u32 v250, 16, v250
 v_xor_b32 v64, v250, v251
 v_lshl_add_u32 v80, v64, 3, v247
 v_lshl_add_u32 v250, v246, 2, v249
 s_lshl3_add_u32 s40, s3, 0x80
 v_add_u32 v250, s40, v250
 v_xor_b32 v250, v250, v251
 v_lshl_add_u32 v81, v250, 3, v247
 v_mul_u32_u24 v248, 768, v248
 v_add_u32 v82, v248, v254
 v_add_u32 v83, 378880, v82
 s_mov_b32 s40, 378624
 v_mad_u32_u24 v248, v246, s40, v236
 v_add_u32 v84, 4096, v248
 s_add_u32 m0, s86, 16384
 s_bfe_u32 s45, s80, 0x40004
 s_mul_i32 s45, s45, 245760
 buffer_load_dwordx4 v4, s[8:11], s45 offen offset:0 lds
 buffer_load_dwordx4 v5, s[8:11], s45 offen offset:1024 lds
 buffer_load_dwordx4 v6, s[8:11], s45 offen offset:2048 lds
 buffer_load_dwordx4 v7, s[8:11], s45 offen offset:3072 lds
 s_waitcnt lgkmcnt(0)
 s_lshr_b32 s100, s58, 28
 s_bitcmp1_b32 s58, 1
 s_cselect_b64 s[28:29], s[32:33], s[36:37]
 s_mov_b32 s30, 819200
 s_cselect_b32 s30, s30, 2211840
 s_mul_i32 s45, s3, 2560
 s_add_u32 m0, s45, 147456
 s_nop 0
 buffer_load_dwordx4 v76, s[28:31], s57 offen nt lds
 s_add_u32 m0, s45, 148480
 s_nop 0
 buffer_load_dwordx4 v77, s[28:31], s57 offen nt lds
 s_add_u32 m0, s45, 149504
 s_mov_b32 exec_hi, 0
 buffer_load_dwordx4 v78, s[28:31], s57 offen nt lds
 s_mov_b32 exec_hi, -1
 s_cmp_eq_u32 s3, 1
 s_cselect_b32 s41, s54, s53
 s_lshr_b32 s42, s79, 2
 s_lshl_b32 s42, s42, 7
 s_add_u32 s42, s42, 20684800
 s_or_b32 s43, s53, 1920
 s_cmp_eq_u32 s3, 2
 s_cselect_b32 s42, s42, s43
 s_cmp_eq_u32 s100, 14
 s_cselect_b32 s42, s42, 67108864
 s_cmp_lt_u32 s3, 2
 s_cselect_b32 s41, s41, s42
 s_andn2_b32 s41, s41, 127
 v_lshl_add_u32 v248, v255, 2, 0
 s_mov_b32 exec_hi, 0
 buffer_store_dword v237, v248, s[16:19], s41 offen sc1
 s_mov_b32 exec_hi, -1
 s_waitcnt vmcnt(12) lgkmcnt(0)
 s_barrier
 ds_read_b64_tr_b16 v[32:33], v16 offset:0
 ds_read_b64_tr_b16 v[34:35], v16 offset:1024
 ds_read_b64_tr_b16 v[36:37], v16 offset:8192
 ds_read_b64_tr_b16 v[38:39], v16 offset:9216
 ds_read_b64_tr_b16 v[40:41], v17 offset:0
 ds_read_b64_tr_b16 v[42:43], v17 offset:1024
 ds_read_b128 a[0:3], v12 offset:0
 ds_read_b128 a[16:19], v13 offset:0
 ds_read_b128 a[4:7], v12 offset:1024
 ds_read_b128 a[20:23], v13 offset:1024
 ds_read_b128 a[8:11], v12 offset:16384
 ds_read_b128 a[24:27], v13 offset:16384
 ds_read_b128 a[12:15], v12 offset:17408
 ds_read_b128 a[28:31], v13 offset:17408
 s_cmp_ge_u32 s34, 10
 s_cbranch_scc1 L_p1v
 s_waitcnt lgkmcnt(4)
 v_mfma_f32_16x16x32_bf16 v[128:131], v[32:35], a[0:3], 0
 ds_read_b64_tr_b16 v[44:45], v17 offset:8192
 ds_read_b64_tr_b16 v[46:47], v17 offset:9216
 s_lshl_b32 s40, s100, 8
 v_mfma_f32_16x16x32_bf16 v[128:131], v[36:39], a[16:19], v[128:131]
 s_add_u32 m0, s35, 8192
 s_bfe_u32 s0, s80, 0x40008
 s_mul_i32 s0, s0, 128
 buffer_load_dwordx4 v0, s[4:7], s0 offen offset:0 lds
 v_add_u32 v15, s40, v15
 v_mfma_f32_16x16x32_bf16 v[144:147], v[36:39], a[20:23], 0
 v_cmp_le_u32 vcc, 3456, v15
 v_mov_b32 v248, s40
 v_mov_b32 v15, 0x1000000
 v_mfma_f32_16x16x32_bf16 v[144:147], v[32:35], a[4:7], v[144:147]
 v_cndmask_b32 v248, v248, v15, vcc
 v_add_u32 v8, v248, v8
 s_waitcnt lgkmcnt(2)
 v_mfma_f32_16x16x32_bf16 v[136:139], v[32:35], a[8:11], 0
 ds_read_b64_tr_b16 v[48:49], v18 offset:0
 ds_read_b64_tr_b16 v[50:51], v18 offset:1024
 v_add_u32 v9, v248, v9
 v_mfma_f32_16x16x32_bf16 v[136:139], v[36:39], a[24:27], v[136:139]
 buffer_load_dwordx4 v1, s[4:7], s0 offen offset:1024 lds
 v_add_u32 v10, v248, v10
 v_mfma_f32_16x16x32_bf16 v[152:155], v[36:39], a[28:31], 0
 ds_read_b64_tr_b16 v[52:53], v18 offset:8192
 ds_read_b64_tr_b16 v[54:55], v18 offset:9216
 v_add_u32 v11, v248, v11
 v_mfma_f32_16x16x32_bf16 v[152:155], v[32:35], a[12:15], v[152:155]
 buffer_load_dwordx4 v2, s[4:7], s0 offen offset:2048 lds
 v_mfma_f32_16x16x32_bf16 v[156:159], v[40:43], a[12:15], 0
 v_and_b32 v248, 31, v255
 v_lshrrev_b32 v249, 5, v255
 v_lshlrev_b32 v227, 2, v248
 s_waitcnt lgkmcnt(4)
 v_mfma_f32_16x16x32_bf16 v[156:159], v[44:47], a[28:31], v[156:159]
 buffer_load_dwordx4 v3, s[4:7], s0 offen offset:3072 lds
 s_lshl_b32 s41, s3, 10
 v_mfma_f32_16x16x32_bf16 v[140:143], v[44:47], a[24:27], 0
 ds_read_b64_tr_b16 v[56:57], v19 offset:0
 ds_read_b64_tr_b16 v[58:59], v19 offset:1024
 s_add_u32 s42, s41, 81920
 v_mfma_f32_16x16x32_bf16 v[140:143], v[40:43], a[8:11], v[140:143]
 s_add_u32 m0, s86, 32768
 s_bfe_u32 s0, s80, 0x40008
 s_mul_i32 s0, s0, 245760
 buffer_load_dwordx4 v4, s[8:11], s0 offen offset:0 lds
 v_add_u32 v241, s42, v254
 v_mfma_f32_16x16x32_bf16 v[148:151], v[40:43], a[4:7], 0
 ds_read_b64_tr_b16 v[60:61], v19 offset:8192
 ds_read_b64_tr_b16 v[62:63], v19 offset:9216
 s_mul_i32 s41, s41, 3
 v_mfma_f32_16x16x32_bf16 v[148:151], v[44:47], a[20:23], v[148:151]
 buffer_load_dwordx4 v5, s[8:11], s0 offen offset:1024 lds
 s_add_u32 s41, s41, 118784
 v_mfma_f32_16x16x32_bf16 v[132:135], v[44:47], a[16:19], 0
 v_lshl_add_u32 v250, v249, 7, v254
 v_add_u32 v240, s41, v250
 v_lshlrev_b32 v250, 2, v249
 v_mfma_f32_16x16x32_bf16 v[132:135], v[40:43], a[0:3], v[132:135]
 v_sub_u32 v250, v248, v250
 v_cvt_f32_i32 v250, v250
 s_waitcnt lgkmcnt(4)
 v_mfma_f32_16x16x32_bf16 v[160:163], v[48:51], a[0:3], 0
 v_mov_b32 v251, 0x71800000
 v_fmaak_f32 v208, v250, v251, 0x71000000
 v_min_f32 v192, 0, v208
 v_mfma_f32_16x16x32_bf16 v[160:163], v[52:55], a[16:19], v[160:163]
 buffer_load_dwordx4 v6, s[8:11], s0 offen offset:2048 lds
 v_min_f32 v208, -v208, 0
 v_mfma_f32_16x16x32_bf16 v[176:179], v[52:55], a[20:23], 0
 v_fmaak_f32 v209, v250, v251, 0xf1000000
 v_min_f32 v193, 0, v209
 v_min_f32 v209, -v209, 0
 v_mfma_f32_16x16x32_bf16 v[176:179], v[48:51], a[4:7], v[176:179]
 buffer_load_dwordx4 v7, s[8:11], s0 offen offset:3072 lds
 v_fmaak_f32 v210, v250, v251, 0xf1c00000
 v_mfma_f32_16x16x32_bf16 v[168:171], v[48:51], a[8:11], 0
 v_min_f32 v194, 0, v210
 v_min_f32 v210, -v210, 0
 v_fmaak_f32 v211, v250, v251, 0xf2200000
 v_mfma_f32_16x16x32_bf16 v[168:171], v[52:55], a[24:27], v[168:171]
 s_waitcnt vmcnt(12) lgkmcnt(0)
 s_barrier
 v_min_f32 v195, 0, v211
 v_mfma_f32_16x16x32_bf16 v[184:187], v[52:55], a[28:31], 0
 ds_read_b64_tr_b16 v[32:33], v16 offset:16384
 ds_read_b64_tr_b16 v[34:35], v16 offset:17408
 v_min_f32 v211, -v211, 0
 v_mfma_f32_16x16x32_bf16 v[184:187], v[48:51], a[12:15], v[184:187]
 ds_read_b64_tr_b16 v[36:37], v16 offset:24576
 ds_read_b64_tr_b16 v[38:39], v16 offset:25600
 v_fmaak_f32 v212, v250, v251, 0xf2f00000
 v_mfma_f32_16x16x32_bf16 v[188:191], v[56:59], a[12:15], 0
 ds_read_b128 a[32:35], v12 offset:4096
 ds_read_b128 a[48:51], v13 offset:4096
 v_min_f32 v196, 0, v212
 v_mfma_f32_16x16x32_bf16 v[188:191], v[60:63], a[28:31], v[188:191]
 ds_read_b128 a[36:39], v12 offset:5120
 ds_read_b128 a[52:55], v13 offset:5120
 s_add_u32 m0, s35, 12288
 s_bfe_u32 s0, s80, 0x4000c
 s_mul_i32 s0, s0, 128
 buffer_load_dwordx4 v0, s[4:7], s0 offen offset:0 lds
 v_mfma_f32_16x16x32_bf16 v[172:175], v[60:63], a[24:27], 0
 ds_read_b128 a[40:43], v12 offset:20480
 ds_read_b128 a[56:59], v13 offset:20480
 v_min_f32 v212, -v212, 0
 v_mfma_f32_16x16x32_bf16 v[172:175], v[56:59], a[8:11], v[172:175]
 ds_read_b128 a[44:47], v12 offset:21504
 ds_read_b128 a[60:63], v13 offset:21504
 v_fmaak_f32 v213, v250, v251, 0xf3080000
 v_mfma_f32_16x16x32_bf16 v[180:183], v[56:59], a[4:7], 0
 buffer_load_dwordx4 v1, s[4:7], s0 offen offset:1024 lds
 v_min_f32 v197, 0, v213
 v_mfma_f32_16x16x32_bf16 v[180:183], v[60:63], a[20:23], v[180:183]
 buffer_load_dwordx4 v2, s[4:7], s0 offen offset:2048 lds
 v_min_f32 v213, -v213, 0
 v_mfma_f32_16x16x32_bf16 v[164:167], v[60:63], a[16:19], 0
 ds_read_b64_tr_b16 v[40:41], v17 offset:16384
 ds_read_b64_tr_b16 v[42:43], v17 offset:17408
 v_fmaak_f32 v214, v250, v251, 0xf3180000
 v_mfma_f32_16x16x32_bf16 v[164:167], v[56:59], a[0:3], v[164:167]
 v_min_f32 v198, 0, v214
 v_min_f32 v214, -v214, 0
 s_waitcnt lgkmcnt(6)
 v_mfma_f32_16x16x32_bf16 v[128:131], v[32:35], a[32:35], v[128:131]
 ds_read_b64_tr_b16 v[44:45], v17 offset:24576
 ds_read_b64_tr_b16 v[46:47], v17 offset:25600
 v_fmaak_f32 v215, v250, v251, 0xf3280000
 v_mfma_f32_16x16x32_bf16 v[128:131], v[36:39], a[48:51], v[128:131]
 buffer_load_dwordx4 v3, s[4:7], s0 offen offset:3072 lds
 v_min_f32 v199, 0, v215
 v_mfma_f32_16x16x32_bf16 v[144:147], v[36:39], a[52:55], v[144:147]
 v_min_f32 v215, -v215, 0
 v_fmaak_f32 v216, v250, v251, 0xf3780000
 v_min_f32 v200, 0, v216
 v_mfma_f32_16x16x32_bf16 v[144:147], v[32:35], a[36:39], v[144:147]
 v_min_f32 v216, -v216, 0
 v_fmaak_f32 v217, v250, v251, 0xf3840000
 s_waitcnt lgkmcnt(4)
 v_mfma_f32_16x16x32_bf16 v[136:139], v[32:35], a[40:43], v[136:139]
 ds_read_b64_tr_b16 v[48:49], v18 offset:16384
 ds_read_b64_tr_b16 v[50:51], v18 offset:17408
 v_min_f32 v201, 0, v217
 v_mfma_f32_16x16x32_bf16 v[136:139], v[36:39], a[56:59], v[136:139]
 s_add_u32 m0, s86, 49152
 s_bfe_u32 s0, s80, 0x4000c
 s_mul_i32 s0, s0, 245760
 buffer_load_dwordx4 v4, s[8:11], s0 offen offset:0 lds
 v_min_f32 v217, -v217, 0
 v_mfma_f32_16x16x32_bf16 v[152:155], v[36:39], a[60:63], v[152:155]
 ds_read_b64_tr_b16 v[52:53], v18 offset:24576
 ds_read_b64_tr_b16 v[54:55], v18 offset:25600
 v_fmaak_f32 v218, v250, v251, 0xf38c0000
 v_mfma_f32_16x16x32_bf16 v[152:155], v[32:35], a[44:47], v[152:155]
 v_min_f32 v202, 0, v218
 v_min_f32 v218, -v218, 0
 s_waitcnt lgkmcnt(4)
 v_mfma_f32_16x16x32_bf16 v[156:159], v[40:43], a[44:47], v[156:159]
 v_fmaak_f32 v219, v250, v251, 0xf3940000
 v_min_f32 v203, 0, v219
 v_min_f32 v219, -v219, 0
 v_mfma_f32_16x16x32_bf16 v[156:159], v[44:47], a[60:63], v[156:159]
 buffer_load_dwordx4 v5, s[8:11], s0 offen offset:1024 lds
 v_fmaak_f32 v220, v250, v251, 0xf3bc0000
 v_mfma_f32_16x16x32_bf16 v[140:143], v[44:47], a[56:59], v[140:143]
 ds_read_b64_tr_b16 v[56:57], v19 offset:16384
 ds_read_b64_tr_b16 v[58:59], v19 offset:17408
 v_min_f32 v204, 0, v220
 v_mfma_f32_16x16x32_bf16 v[140:143], v[40:43], a[40:43], v[140:143]
 buffer_load_dwordx4 v6, s[8:11], s0 offen offset:2048 lds
 v_min_f32 v220, -v220, 0
 v_mfma_f32_16x16x32_bf16 v[148:151], v[40:43], a[36:39], v[148:151]
 ds_read_b64_tr_b16 v[60:61], v19 offset:24576
 ds_read_b64_tr_b16 v[62:63], v19 offset:25600
 v_fmaak_f32 v221, v250, v251, 0xf3c40000
 v_mfma_f32_16x16x32_bf16 v[148:151], v[44:47], a[52:55], v[148:151]
 v_min_f32 v205, 0, v221
 v_min_f32 v221, -v221, 0
 v_fmaak_f32 v222, v250, v251, 0xf3cc0000
 v_mfma_f32_16x16x32_bf16 v[132:135], v[44:47], a[48:51], v[132:135]
 v_min_f32 v206, 0, v222
 v_min_f32 v222, -v222, 0
 v_fmaak_f32 v223, v250, v251, 0xf3d40000
 v_mfma_f32_16x16x32_bf16 v[132:135], v[40:43], a[32:35], v[132:135]
 v_min_f32 v207, 0, v223
 v_min_f32 v223, -v223, 0
 s_waitcnt lgkmcnt(4)
 v_mfma_f32_16x16x32_bf16 v[160:163], v[48:51], a[32:35], v[160:163]
 v_lshrrev_b32 v249, 4, v255
 v_lshl_add_u32 v239, v249, 8, v254
 v_add_u32 v232, s69, v239
 v_mfma_f32_16x16x32_bf16 v[160:163], v[52:55], a[48:51], v[160:163]
 buffer_load_dwordx4 v7, s[8:11], s0 offen offset:3072 lds
 v_add_u32 v233, s70, v239
 v_mfma_f32_16x16x32_bf16 v[176:179], v[52:55], a[52:55], v[176:179]
 v_add_u32 v234, s71, v239
 v_add_u32 v235, s72, v239
 v_add_u32 v228, s61, v254
 v_mfma_f32_16x16x32_bf16 v[176:179], v[48:51], a[36:39], v[176:179]
 v_add_u32 v229, s62, v254
 v_add_u32 v230, s63, v254
 v_add_u32 v231, s60, v254
 v_mfma_f32_16x16x32_bf16 v[168:171], v[48:51], a[40:43], v[168:171]
 v_lshl_add_u32 v227, s59, 8, v227
 v_add_u32 v227, 20594688, v227
 v_min_u32 v248, 59, v255
 v_mfma_f32_16x16x32_bf16 v[168:171], v[52:55], a[56:59], v[168:171]
 s_waitcnt vmcnt(8) lgkmcnt(0)
 s_barrier
 v_mfma_f32_16x16x32_bf16 v[184:187], v[52:55], a[60:63], v[184:187]
 ds_read_b64_tr_b16 v[32:33], v16 offset:32768
 ds_read_b64_tr_b16 v[34:35], v16 offset:33792
 v_mfma_f32_16x16x32_bf16 v[184:187], v[48:51], a[44:47], v[184:187]
 ds_read_b64_tr_b16 v[36:37], v16 offset:40960
 ds_read_b64_tr_b16 v[38:39], v16 offset:41984
 v_mfma_f32_16x16x32_bf16 v[188:191], v[56:59], a[44:47], v[188:191]
 ds_read_b128 a[64:67], v12 offset:8192
 ds_read_b128 a[80:83], v13 offset:8192
 v_mfma_f32_16x16x32_bf16 v[188:191], v[60:63], a[60:63], v[188:191]
 ds_read_b128 a[68:71], v12 offset:9216
 ds_read_b128 a[84:87], v13 offset:9216
 s_add_u32 m0, s35, 0
 s_bfe_u32 s0, s80, 0x40010
 s_mul_i32 s0, s0, 128
 buffer_load_dwordx4 v0, s[4:7], s0 offen offset:0 lds
 v_mfma_f32_16x16x32_bf16 v[172:175], v[60:63], a[56:59], v[172:175]
 ds_read_b128 a[72:75], v12 offset:24576
 ds_read_b128 a[88:91], v13 offset:24576
 v_mfma_f32_16x16x32_bf16 v[172:175], v[56:59], a[40:43], v[172:175]
 ds_read_b128 a[76:79], v12 offset:25600
 ds_read_b128 a[92:95], v13 offset:25600
 v_mfma_f32_16x16x32_bf16 v[180:183], v[56:59], a[36:39], v[180:183]
 buffer_load_dwordx4 v1, s[4:7], s0 offen offset:1024 lds
 v_mfma_f32_16x16x32_bf16 v[180:183], v[60:63], a[52:55], v[180:183]
 buffer_load_dwordx4 v2, s[4:7], s0 offen offset:2048 lds
 v_mfma_f32_16x16x32_bf16 v[164:167], v[60:63], a[48:51], v[164:167]
 ds_read_b64_tr_b16 v[40:41], v17 offset:32768
 ds_read_b64_tr_b16 v[42:43], v17 offset:33792
 v_mfma_f32_16x16x32_bf16 v[164:167], v[56:59], a[32:35], v[164:167]
 v_and_b32 v249, 3, v248
 s_waitcnt lgkmcnt(6)
 v_mfma_f32_16x16x32_bf16 v[128:131], v[32:35], a[64:67], v[128:131]
 ds_read_b64_tr_b16 v[44:45], v17 offset:40960
 ds_read_b64_tr_b16 v[46:47], v17 offset:41984
 v_mfma_f32_16x16x32_bf16 v[128:131], v[36:39], a[80:83], v[128:131]
 buffer_load_dwordx4 v3, s[4:7], s0 offen offset:3072 lds
 v_mfma_f32_16x16x32_bf16 v[144:147], v[36:39], a[84:87], v[144:147]
 v_lshl_add_u32 v249, v249, 3, s76
 v_lshrrev_b32 v248, 2, v248
 v_mfma_f32_16x16x32_bf16 v[144:147], v[32:35], a[68:71], v[144:147]
 v_lshl_add_u32 v249, v248, 7, v249
 s_waitcnt lgkmcnt(4)
 v_mfma_f32_16x16x32_bf16 v[136:139], v[32:35], a[72:75], v[136:139]
 ds_read_b64_tr_b16 v[48:49], v18 offset:32768
 ds_read_b64_tr_b16 v[50:51], v18 offset:33792
 v_mfma_f32_16x16x32_bf16 v[136:139], v[36:39], a[88:91], v[136:139]
 s_add_u32 m0, s86, 65536
 s_bfe_u32 s0, s80, 0x40010
 s_mul_i32 s0, s0, 245760
 buffer_load_dwordx4 v4, s[8:11], s0 offen offset:0 lds
 v_mfma_f32_16x16x32_bf16 v[152:155], v[36:39], a[92:95], v[152:155]
 ds_read_b64_tr_b16 v[52:53], v18 offset:40960
 ds_read_b64_tr_b16 v[54:55], v18 offset:41984
 v_mfma_f32_16x16x32_bf16 v[152:155], v[32:35], a[76:79], v[152:155]
 s_mul_i32 s40, s3, -1152
 s_waitcnt lgkmcnt(4)
 v_mfma_f32_16x16x32_bf16 v[156:159], v[40:43], a[76:79], v[156:159]
 s_add_u32 s40, s40, 4608
 v_cmp_lt_u32 vcc, 47, v255
 v_mfma_f32_16x16x32_bf16 v[156:159], v[44:47], a[92:95], v[156:159]
 buffer_load_dwordx4 v5, s[8:11], s0 offen offset:1024 lds
 v_mfma_f32_16x16x32_bf16 v[140:143], v[44:47], a[88:91], v[140:143]
 ds_read_b64_tr_b16 v[56:57], v19 offset:32768
 ds_read_b64_tr_b16 v[58:59], v19 offset:33792
 v_mfma_f32_16x16x32_bf16 v[140:143], v[40:43], a[72:75], v[140:143]
 buffer_load_dwordx4 v6, s[8:11], s0 offen offset:2048 lds
 v_mfma_f32_16x16x32_bf16 v[148:151], v[40:43], a[68:71], v[148:151]
 ds_read_b64_tr_b16 v[60:61], v19 offset:40960
 ds_read_b64_tr_b16 v[62:63], v19 offset:41984
 v_mfma_f32_16x16x32_bf16 v[148:151], v[44:47], a[84:87], v[148:151]
 v_add_u32 v248, s40, v249
 v_cndmask_b32 v244, v249, v248, vcc
 v_mfma_f32_16x16x32_bf16 v[132:135], v[44:47], a[80:83], v[132:135]
 v_lshrrev_b32 v248, 1, v255
 v_min_u32 v248, 4, v248
 v_mfma_f32_16x16x32_bf16 v[132:135], v[40:43], a[64:67], v[132:135]
 ds_read_b64_tr_b16 v[64:65], v79 offset:0
 ds_read_b64_tr_b16 v[66:67], v79 offset:5120
 s_waitcnt lgkmcnt(6)
 v_mfma_f32_16x16x32_bf16 v[160:163], v[48:51], a[64:67], v[160:163]
 ds_read_b64_tr_b16 v[68:69], v80 offset:0
 ds_read_b64_tr_b16 v[70:71], v80 offset:5120
 v_mfma_f32_16x16x32_bf16 v[160:163], v[52:55], a[80:83], v[160:163]
 ds_read_b64_tr_b16 v[72:73], v81 offset:0
 ds_read_b64_tr_b16 v[74:75], v81 offset:5120
 v_mfma_f32_16x16x32_bf16 v[176:179], v[52:55], a[84:87], v[176:179]
 buffer_load_dwordx4 v7, s[8:11], s0 offen offset:3072 lds
 v_mfma_f32_16x16x32_bf16 v[176:179], v[48:51], a[68:71], v[176:179]
 v_and_b32 v249, 1, v255
 v_lshl_add_u32 v249, v249, 3, s74
 v_mfma_f32_16x16x32_bf16 v[168:171], v[48:51], a[72:75], v[168:171]
 v_lshl_add_u32 v243, v248, 7, v249
 v_writelane_b32 v243, s75, 63
 v_mfma_f32_16x16x32_bf16 v[168:171], v[52:55], a[88:91], v[168:171]
 s_waitcnt vmcnt(8) lgkmcnt(0)
 s_barrier
 v_mfma_f32_16x16x32_bf16 v[184:187], v[52:55], a[92:95], v[184:187]
 ds_read_b64_tr_b16 v[32:33], v16 offset:49152
 ds_read_b64_tr_b16 v[34:35], v16 offset:50176
 v_mfma_f32_16x16x32_bf16 v[184:187], v[48:51], a[76:79], v[184:187]
 ds_read_b64_tr_b16 v[36:37], v16 offset:57344
 ds_read_b64_tr_b16 v[38:39], v16 offset:58368
 v_mfma_f32_16x16x32_bf16 v[188:191], v[56:59], a[76:79], v[188:191]
 ds_read_b128 a[96:99], v12 offset:12288
 ds_read_b128 a[112:115], v13 offset:12288
 v_mfma_f32_16x16x32_bf16 v[188:191], v[60:63], a[92:95], v[188:191]
 ds_read_b128 a[100:103], v12 offset:13312
 ds_read_b128 a[116:119], v13 offset:13312
 s_add_u32 m0, s35, 4096
 s_bfe_u32 s0, s80, 0x40014
 s_mul_i32 s0, s0, 128
 buffer_load_dwordx4 v0, s[4:7], s0 offen offset:0 lds
 v_mfma_f32_16x16x32_bf16 v[172:175], v[60:63], a[88:91], v[172:175]
 ds_read_b128 a[104:107], v12 offset:28672
 ds_read_b128 a[120:123], v13 offset:28672
 v_mfma_f32_16x16x32_bf16 v[172:175], v[56:59], a[72:75], v[172:175]
 ds_read_b128 a[108:111], v12 offset:29696
 ds_read_b128 a[124:127], v13 offset:29696
 v_mfma_f32_16x16x32_bf16 v[180:183], v[56:59], a[68:71], v[180:183]
 buffer_load_dwordx4 v1, s[4:7], s0 offen offset:1024 lds
 v_mfma_f32_16x16x32_bf16 v[180:183], v[60:63], a[84:87], v[180:183]
 buffer_store_dwordx4 v[64:67], v82, s[16:19], s55 offen sc1
 v_mfma_f32_16x16x32_bf16 v[164:167], v[60:63], a[80:83], v[164:167]
 ds_read_b64_tr_b16 v[40:41], v17 offset:49152
 ds_read_b64_tr_b16 v[42:43], v17 offset:50176
 v_mfma_f32_16x16x32_bf16 v[164:167], v[56:59], a[64:67], v[164:167]
 s_bfe_u32 s40, s58, 0x1a0002
 s_waitcnt lgkmcnt(6)
 v_mfma_f32_16x16x32_bf16 v[128:131], v[32:35], a[96:99], v[128:131]
 ds_read_b64_tr_b16 v[44:45], v17 offset:57344
 ds_read_b64_tr_b16 v[46:47], v17 offset:58368
 buffer_load_dwordx4 v2, s[4:7], s0 offen offset:2048 lds
 v_mfma_f32_16x16x32_bf16 v[128:131], v[36:39], a[112:115], v[128:131]
 buffer_load_dwordx4 v3, s[4:7], s0 offen offset:3072 lds
 v_mfma_f32_16x16x32_bf16 v[144:147], v[36:39], a[116:119], v[144:147]
 v_writelane_b32 v243, s40, 62
 s_lshr_b32 s40, s59, 2
 v_mfma_f32_16x16x32_bf16 v[144:147], v[32:35], a[100:103], v[144:147]
 s_sub_u32 s40, s40, 2
 s_waitcnt lgkmcnt(4)
 v_mfma_f32_16x16x32_bf16 v[136:139], v[32:35], a[104:107], v[136:139]
 ds_read_b64_tr_b16 v[48:49], v18 offset:49152
 ds_read_b64_tr_b16 v[50:51], v18 offset:50176
 v_mfma_f32_16x16x32_bf16 v[136:139], v[36:39], a[120:123], v[136:139]
 s_add_u32 m0, s86, 0
 s_bfe_u32 s0, s80, 0x40014
 s_mul_i32 s0, s0, 245760
 buffer_load_dwordx4 v4, s[8:11], s0 offen offset:0 lds
 v_mfma_f32_16x16x32_bf16 v[152:155], v[36:39], a[124:127], v[152:155]
 ds_read_b64_tr_b16 v[52:53], v18 offset:57344
 ds_read_b64_tr_b16 v[54:55], v18 offset:58368
 v_mfma_f32_16x16x32_bf16 v[152:155], v[32:35], a[108:111], v[152:155]
 v_lshrrev_b32 v248, 4, v255
 s_waitcnt lgkmcnt(4)
 v_mfma_f32_16x16x32_bf16 v[156:159], v[40:43], a[108:111], v[156:159]
 v_min_u32 v248, 2, v248
 v_add_u32 v248, s40, v248
 v_mfma_f32_16x16x32_bf16 v[156:159], v[44:47], a[124:127], v[156:159]
 buffer_load_dwordx4 v5, s[8:11], s0 offen offset:1024 lds
 v_mfma_f32_16x16x32_bf16 v[140:143], v[44:47], a[120:123], v[140:143]
 ds_read_b64_tr_b16 v[56:57], v19 offset:49152
 ds_read_b64_tr_b16 v[58:59], v19 offset:50176
 v_mfma_f32_16x16x32_bf16 v[140:143], v[40:43], a[104:107], v[140:143]
 buffer_store_dwordx4 v[68:71], v83, s[16:19], s55 offen sc1
 v_mfma_f32_16x16x32_bf16 v[148:151], v[40:43], a[100:103], v[148:151]
 ds_read_b64_tr_b16 v[60:61], v19 offset:57344
 ds_read_b64_tr_b16 v[62:63], v19 offset:58368
 v_mfma_f32_16x16x32_bf16 v[148:151], v[44:47], a[116:119], v[148:151]
 buffer_load_dwordx4 v6, s[8:11], s0 offen offset:2048 lds
 v_mfma_f32_16x16x32_bf16 v[132:135], v[44:47], a[112:115], v[132:135]
 v_max_i32 v248, 0, v248
 v_and_b32 v249, 3, v255
 v_mfma_f32_16x16x32_bf16 v[132:135], v[40:43], a[96:99], v[132:135]
 v_lshl_add_u32 v249, v249, 3, s77
 s_waitcnt lgkmcnt(4)
 v_mfma_f32_16x16x32_bf16 v[160:163], v[48:51], a[96:99], v[160:163]
 v_lshl_add_u32 v248, v248, 11, v249
 v_bfe_u32 v249, v255, 2, 1
 v_mfma_f32_16x16x32_bf16 v[160:163], v[52:55], a[112:115], v[160:163]
 buffer_load_dwordx4 v7, s[8:11], s0 offen offset:3072 lds
 v_mfma_f32_16x16x32_bf16 v[176:179], v[52:55], a[116:119], v[176:179]
 v_mad_u32_u24 v248, v249, s78, v248
 v_cmp_gt_u32 vcc, 48, v255
 v_mfma_f32_16x16x32_bf16 v[176:179], v[48:51], a[100:103], v[176:179]
 v_bfe_u32 v249, v255, 3, 1
 v_add_u32 v249, 1, v249
 v_mfma_f32_16x16x32_bf16 v[168:171], v[48:51], a[104:107], v[168:171]
 v_mul_u32_u24 v249, 640, v249
 v_cndmask_b32 v249, 0, v249, vcc
 v_mfma_f32_16x16x32_bf16 v[168:171], v[52:55], a[120:123], v[168:171]
 s_waitcnt vmcnt(10) lgkmcnt(0)
 s_barrier
 v_mfma_f32_16x16x32_bf16 v[184:187], v[52:55], a[124:127], v[184:187]
 ds_read_b64_tr_b16 v[32:33], v20 offset:0
 ds_read_b64_tr_b16 v[34:35], v20 offset:1024
 v_mfma_f32_16x16x32_bf16 v[184:187], v[48:51], a[108:111], v[184:187]
 ds_read_b64_tr_b16 v[36:37], v20 offset:8192
 ds_read_b64_tr_b16 v[38:39], v20 offset:9216
 buffer_store_dwordx4 v[72:75], v84, s[16:19], s55 offen sc1
 v_mfma_f32_16x16x32_bf16 v[188:191], v[56:59], a[108:111], v[188:191]
 ds_read_b128 a[128:131], v12 offset:0
 ds_read_b128 a[144:147], v13 offset:0
 v_mfma_f32_16x16x32_bf16 v[188:191], v[60:63], a[124:127], v[188:191]
 ds_read_b128 a[132:135], v12 offset:1024
 ds_read_b128 a[148:151], v13 offset:1024
 s_add_u32 m0, s35, 8192
 s_bfe_u32 s0, s80, 0x40018
 s_mul_i32 s0, s0, 128
 buffer_load_dwordx4 v0, s[4:7], s0 offen offset:0 lds
 v_mfma_f32_16x16x32_bf16 v[172:175], v[60:63], a[120:123], v[172:175]
 ds_read_b128 a[136:139], v12 offset:16384
 ds_read_b128 a[152:155], v13 offset:16384
 v_mfma_f32_16x16x32_bf16 v[172:175], v[56:59], a[104:107], v[172:175]
 ds_read_b128 a[140:143], v12 offset:17408
 ds_read_b128 a[156:159], v13 offset:17408
 buffer_load_dwordx2 v[252:253], v237, s[24:27], 0 offen sc1
 v_mfma_f32_16x16x32_bf16 v[180:183], v[56:59], a[100:103], v[180:183]
 buffer_load_dwordx4 v1, s[4:7], s0 offen offset:1024 lds
 v_mfma_f32_16x16x32_bf16 v[180:183], v[60:63], a[116:119], v[180:183]
 buffer_load_dwordx4 v2, s[4:7], s0 offen offset:2048 lds
 v_mfma_f32_16x16x32_bf16 v[164:167], v[60:63], a[112:115], v[164:167]
 ds_read_b64_tr_b16 v[40:41], v21 offset:0
 ds_read_b64_tr_b16 v[42:43], v21 offset:1024
 v_mfma_f32_16x16x32_bf16 v[164:167], v[56:59], a[96:99], v[164:167]
 v_add_u32 v245, v248, v249
 s_waitcnt lgkmcnt(6)
 v_mfma_f32_16x16x32_bf16 v[128:131], v[32:35], a[128:131], v[128:131]
 ds_read_b64_tr_b16 v[44:45], v21 offset:8192
 ds_read_b64_tr_b16 v[46:47], v21 offset:9216
 v_mfma_f32_16x16x32_bf16 v[128:131], v[36:39], a[144:147], v[128:131]
 buffer_load_dwordx4 v3, s[4:7], s0 offen offset:3072 lds
 v_mfma_f32_16x16x32_bf16 v[144:147], v[36:39], a[148:151], v[144:147]
 v_mfma_f32_16x16x32_bf16 v[144:147], v[32:35], a[132:135], v[144:147]
 s_waitcnt lgkmcnt(4)
 v_mfma_f32_16x16x32_bf16 v[136:139], v[32:35], a[136:139], v[136:139]
 ds_read_b64_tr_b16 v[48:49], v22 offset:0
 ds_read_b64_tr_b16 v[50:51], v22 offset:1024
 v_mfma_f32_16x16x32_bf16 v[136:139], v[36:39], a[152:155], v[136:139]
 s_add_u32 m0, s86, 16384
 s_bfe_u32 s0, s80, 0x40018
 s_mul_i32 s0, s0, 245760
 buffer_load_dwordx4 v4, s[8:11], s0 offen offset:0 lds
 v_mfma_f32_16x16x32_bf16 v[152:155], v[36:39], a[156:159], v[152:155]
 ds_read_b64_tr_b16 v[52:53], v22 offset:8192
 ds_read_b64_tr_b16 v[54:55], v22 offset:9216
 v_mfma_f32_16x16x32_bf16 v[152:155], v[32:35], a[140:143], v[152:155]
 s_waitcnt lgkmcnt(4)
 v_mfma_f32_16x16x32_bf16 v[156:159], v[40:43], a[140:143], v[156:159]
 v_mfma_f32_16x16x32_bf16 v[156:159], v[44:47], a[156:159], v[156:159]
 buffer_load_dwordx4 v5, s[8:11], s0 offen offset:1024 lds
 v_mfma_f32_16x16x32_bf16 v[140:143], v[44:47], a[152:155], v[140:143]
 ds_read_b64_tr_b16 v[56:57], v23 offset:0
 ds_read_b64_tr_b16 v[58:59], v23 offset:1024
 v_mfma_f32_16x16x32_bf16 v[140:143], v[40:43], a[136:139], v[140:143]
 buffer_load_dwordx4 v6, s[8:11], s0 offen offset:2048 lds
 v_mfma_f32_16x16x32_bf16 v[148:151], v[40:43], a[132:135], v[148:151]
 ds_read_b64_tr_b16 v[60:61], v23 offset:8192
 ds_read_b64_tr_b16 v[62:63], v23 offset:9216
 v_mfma_f32_16x16x32_bf16 v[148:151], v[44:47], a[148:151], v[148:151]
 v_mfma_f32_16x16x32_bf16 v[132:135], v[44:47], a[144:147], v[132:135]
 v_mfma_f32_16x16x32_bf16 v[132:135], v[40:43], a[128:131], v[132:135]
 s_waitcnt lgkmcnt(4)
 v_mfma_f32_16x16x32_bf16 v[160:163], v[48:51], a[128:131], v[160:163]
 v_mfma_f32_16x16x32_bf16 v[160:163], v[52:55], a[144:147], v[160:163]
 buffer_load_dwordx4 v7, s[8:11], s0 offen offset:3072 lds
 v_mfma_f32_16x16x32_bf16 v[176:179], v[52:55], a[148:151], v[176:179]
 v_mfma_f32_16x16x32_bf16 v[176:179], v[48:51], a[132:135], v[176:179]
 v_mfma_f32_16x16x32_bf16 v[168:171], v[48:51], a[136:139], v[168:171]
 v_mfma_f32_16x16x32_bf16 v[168:171], v[52:55], a[152:155], v[168:171]
 s_waitcnt vmcnt(10) lgkmcnt(0)
 s_barrier
 v_mfma_f32_16x16x32_bf16 v[184:187], v[52:55], a[156:159], v[184:187]
 ds_read_b64_tr_b16 v[32:33], v16 offset:0
 ds_read_b64_tr_b16 v[34:35], v16 offset:1024
 v_mfma_f32_16x16x32_bf16 v[184:187], v[48:51], a[140:143], v[184:187]
 ds_read_b64_tr_b16 v[36:37], v16 offset:8192
 ds_read_b64_tr_b16 v[38:39], v16 offset:9216
 v_mfma_f32_16x16x32_bf16 v[188:191], v[56:59], a[140:143], v[188:191]
 ds_read_b128 a[224:227], v12 offset:4096
 ds_read_b128 a[240:243], v13 offset:4096
 v_mfma_f32_16x16x32_bf16 v[188:191], v[60:63], a[156:159], v[188:191]
 ds_read_b128 a[228:231], v12 offset:5120
 ds_read_b128 a[244:247], v13 offset:5120
 s_add_u32 m0, s35, 12288
 s_bfe_u32 s0, s80, 0x4001c
 s_mul_i32 s0, s0, 128
 buffer_load_dwordx4 v0, s[4:7], s0 offen offset:0 lds
 v_mfma_f32_16x16x32_bf16 v[172:175], v[60:63], a[152:155], v[172:175]
 ds_read_b128 a[232:235], v12 offset:20480
 ds_read_b128 a[248:251], v13 offset:20480
 v_mfma_f32_16x16x32_bf16 v[172:175], v[56:59], a[136:139], v[172:175]
 ds_read_b128 a[236:239], v12 offset:21504
 ds_read_b128 a[252:255], v13 offset:21504
 v_mfma_f32_16x16x32_bf16 v[180:183], v[56:59], a[132:135], v[180:183]
 buffer_load_dwordx4 v1, s[4:7], s0 offen offset:1024 lds
 v_mfma_f32_16x16x32_bf16 v[180:183], v[60:63], a[148:151], v[180:183]
 buffer_load_dwordx4 v2, s[4:7], s0 offen offset:2048 lds
 v_mfma_f32_16x16x32_bf16 v[164:167], v[60:63], a[144:147], v[164:167]
 ds_read_b64_tr_b16 v[40:41], v17 offset:0
 ds_read_b64_tr_b16 v[42:43], v17 offset:1024
 v_mfma_f32_16x16x32_bf16 v[164:167], v[56:59], a[128:131], v[164:167]
 s_waitcnt lgkmcnt(6)
 v_mfma_f32_16x16x32_bf16 v[128:131], v[32:35], a[224:227], v[128:131]
 ds_read_b64_tr_b16 v[44:45], v17 offset:8192
 ds_read_b64_tr_b16 v[46:47], v17 offset:9216
 v_mfma_f32_16x16x32_bf16 v[128:131], v[36:39], a[240:243], v[128:131]
 buffer_load_dwordx4 v3, s[4:7], s0 offen offset:3072 lds
 v_mfma_f32_16x16x32_bf16 v[144:147], v[36:39], a[244:247], v[144:147]
 v_mfma_f32_16x16x32_bf16 v[144:147], v[32:35], a[228:231], v[144:147]
 s_waitcnt lgkmcnt(4)
 v_mfma_f32_16x16x32_bf16 v[136:139], v[32:35], a[232:235], v[136:139]
 ds_read_b64_tr_b16 v[48:49], v18 offset:0
 ds_read_b64_tr_b16 v[50:51], v18 offset:1024
 v_mfma_f32_16x16x32_bf16 v[136:139], v[36:39], a[248:251], v[136:139]
 s_add_u32 m0, s86, 32768
 s_bfe_u32 s0, s80, 0x4001c
 s_mul_i32 s0, s0, 245760
 buffer_load_dwordx4 v4, s[8:11], s0 offen offset:0 lds
 v_mfma_f32_16x16x32_bf16 v[152:155], v[36:39], a[252:255], v[152:155]
 ds_read_b64_tr_b16 v[52:53], v18 offset:8192
 ds_read_b64_tr_b16 v[54:55], v18 offset:9216
 v_mfma_f32_16x16x32_bf16 v[152:155], v[32:35], a[236:239], v[152:155]
 s_waitcnt lgkmcnt(4)
 v_mfma_f32_16x16x32_bf16 v[156:159], v[40:43], a[236:239], v[156:159]
 v_mfma_f32_16x16x32_bf16 v[156:159], v[44:47], a[252:255], v[156:159]
 buffer_load_dwordx4 v5, s[8:11], s0 offen offset:1024 lds
 v_mfma_f32_16x16x32_bf16 v[140:143], v[44:47], a[248:251], v[140:143]
 ds_read_b64_tr_b16 v[56:57], v19 offset:0
 ds_read_b64_tr_b16 v[58:59], v19 offset:1024
 v_mfma_f32_16x16x32_bf16 v[140:143], v[40:43], a[232:235], v[140:143]
 buffer_load_dwordx4 v6, s[8:11], s0 offen offset:2048 lds
 v_mfma_f32_16x16x32_bf16 v[148:151], v[40:43], a[228:231], v[148:151]
 ds_read_b64_tr_b16 v[60:61], v19 offset:8192
 ds_read_b64_tr_b16 v[62:63], v19 offset:9216
 v_mfma_f32_16x16x32_bf16 v[148:151], v[44:47], a[244:247], v[148:151]
 v_mfma_f32_16x16x32_bf16 v[132:135], v[44:47], a[240:243], v[132:135]
 v_mfma_f32_16x16x32_bf16 v[132:135], v[40:43], a[224:227], v[132:135]
 s_waitcnt lgkmcnt(4)
 v_mfma_f32_16x16x32_bf16 v[160:163], v[48:51], a[224:227], v[160:163]
 v_mfma_f32_16x16x32_bf16 v[160:163], v[52:55], a[240:243], v[160:163]
 buffer_load_dwordx4 v7, s[8:11], s0 offen offset:3072 lds
 v_mfma_f32_16x16x32_bf16 v[176:179], v[52:55], a[244:247], v[176:179]
 v_mfma_f32_16x16x32_bf16 v[176:179], v[48:51], a[228:231], v[176:179]
 v_mfma_f32_16x16x32_bf16 v[168:171], v[48:51], a[232:235], v[168:171]
 v_mfma_f32_16x16x32_bf16 v[168:171], v[52:55], a[248:251], v[168:171]
 s_waitcnt vmcnt(15)
 v_readfirstlane_b32 s90, v252
 v_readfirstlane_b32 s91, v253
 s_cmp_eq_u32 s90, 0
 s_cbranch_scc1 L_nonce_3
L_nonce_ok_4:
 s_waitcnt vmcnt(8) lgkmcnt(0)
 s_barrier
 v_mfma_f32_16x16x32_bf16 v[184:187], v[52:55], a[252:255], v[184:187]
 ds_read_b64_tr_b16 v[32:33], v16 offset:16384
 ds_read_b64_tr_b16 v[34:35], v16 offset:17408
 v_mfma_f32_16x16x32_bf16 v[184:187], v[48:51], a[236:239], v[184:187]
 ds_read_b64_tr_b16 v[36:37], v16 offset:24576
 ds_read_b64_tr_b16 v[38:39], v16 offset:25600
 v_mfma_f32_16x16x32_bf16 v[188:191], v[56:59], a[236:239], v[188:191]
 ds_read_b128 a[160:163], v12 offset:8192
 ds_read_b128 a[176:179], v13 offset:8192
 v_mfma_f32_16x16x32_bf16 v[188:191], v[60:63], a[252:255], v[188:191]
 ds_read_b128 a[164:167], v12 offset:9216
 ds_read_b128 a[180:183], v13 offset:9216
 s_add_u32 m0, s35, 0
 s_bfe_u32 s0, s81, 0x40000
 s_mul_i32 s0, s0, 128
 buffer_load_dwordx4 v0, s[4:7], s0 offen offset:0 lds
 v_mfma_f32_16x16x32_bf16 v[172:175], v[60:63], a[248:251], v[172:175]
 ds_read_b128 a[168:171], v12 offset:24576
 ds_read_b128 a[184:187], v13 offset:24576
 s_mov_b64 exec, 1
 buffer_store_dwordx2 v[252:253], v237, s[16:19], s56 offen offset:0 sc1
 s_mov_b64 exec, -1
 v_mfma_f32_16x16x32_bf16 v[172:175], v[56:59], a[232:235], v[172:175]
 ds_read_b128 a[172:175], v12 offset:25600
 ds_read_b128 a[188:191], v13 offset:25600
 v_mfma_f32_16x16x32_bf16 v[180:183], v[56:59], a[228:231], v[180:183]
 buffer_load_dwordx4 v1, s[4:7], s0 offen offset:1024 lds
 v_mfma_f32_16x16x32_bf16 v[180:183], v[60:63], a[244:247], v[180:183]
 buffer_load_dwordx4 v2, s[4:7], s0 offen offset:2048 lds
 v_mfma_f32_16x16x32_bf16 v[164:167], v[60:63], a[240:243], v[164:167]
 ds_read_b64_tr_b16 v[40:41], v17 offset:16384
 ds_read_b64_tr_b16 v[42:43], v17 offset:17408
 v_mfma_f32_16x16x32_bf16 v[164:167], v[56:59], a[224:227], v[164:167]
 s_waitcnt lgkmcnt(6)
 v_mfma_f32_16x16x32_bf16 v[128:131], v[32:35], a[160:163], v[128:131]
 ds_read_b64_tr_b16 v[44:45], v17 offset:24576
 ds_read_b64_tr_b16 v[46:47], v17 offset:25600
 v_mfma_f32_16x16x32_bf16 v[128:131], v[36:39], a[176:179], v[128:131]
 buffer_load_dwordx4 v3, s[4:7], s0 offen offset:3072 lds
 v_mfma_f32_16x16x32_bf16 v[144:147], v[36:39], a[180:183], v[144:147]
 v_mfma_f32_16x16x32_bf16 v[144:147], v[32:35], a[164:167], v[144:147]
 s_waitcnt lgkmcnt(4)
 v_mfma_f32_16x16x32_bf16 v[136:139], v[32:35], a[168:171], v[136:139]
 ds_read_b64_tr_b16 v[48:49], v18 offset:16384
 ds_read_b64_tr_b16 v[50:51], v18 offset:17408
 v_mfma_f32_16x16x32_bf16 v[136:139], v[36:39], a[184:187], v[136:139]
 s_add_u32 m0, s86, 49152
 s_bfe_u32 s0, s81, 0x40000
 s_mul_i32 s0, s0, 245760
 buffer_load_dwordx4 v4, s[8:11], s0 offen offset:0 lds
 v_mfma_f32_16x16x32_bf16 v[152:155], v[36:39], a[188:191], v[152:155]
 ds_read_b64_tr_b16 v[52:53], v18 offset:24576
 ds_read_b64_tr_b16 v[54:55], v18 offset:25600
 v_mfma_f32_16x16x32_bf16 v[152:155], v[32:35], a[172:175], v[152:155]
 s_waitcnt lgkmcnt(4)
 v_mfma_f32_16x16x32_bf16 v[156:159], v[40:43], a[172:175], v[156:159]
 v_mfma_f32_16x16x32_bf16 v[156:159], v[44:47], a[188:191], v[156:159]
 buffer_load_dwordx4 v5, s[8:11], s0 offen offset:1024 lds
 v_mfma_f32_16x16x32_bf16 v[140:143], v[44:47], a[184:187], v[140:143]
 ds_read_b64_tr_b16 v[56:57], v19 offset:16384
 ds_read_b64_tr_b16 v[58:59], v19 offset:17408
 v_mfma_f32_16x16x32_bf16 v[140:143], v[40:43], a[168:171], v[140:143]
 buffer_load_dwordx4 v6, s[8:11], s0 offen offset:2048 lds
 v_mfma_f32_16x16x32_bf16 v[148:151], v[40:43], a[164:167], v[148:151]
 ds_read_b64_tr_b16 v[60:61], v19 offset:24576
 ds_read_b64_tr_b16 v[62:63], v19 offset:25600
 v_mfma_f32_16x16x32_bf16 v[148:151], v[44:47], a[180:183], v[148:151]
 v_mfma_f32_16x16x32_bf16 v[132:135], v[44:47], a[176:179], v[132:135]
 v_mfma_f32_16x16x32_bf16 v[132:135], v[40:43], a[160:163], v[132:135]
 s_waitcnt lgkmcnt(4)
 v_mfma_f32_16x16x32_bf16 v[160:163], v[48:51], a[160:163], v[160:163]
 v_mfma_f32_16x16x32_bf16 v[160:163], v[52:55], a[176:179], v[160:163]
 buffer_load_dwordx4 v7, s[8:11], s0 offen offset:3072 lds
 v_mfma_f32_16x16x32_bf16 v[176:179], v[52:55], a[180:183], v[176:179]
 v_mfma_f32_16x16x32_bf16 v[176:179], v[48:51], a[164:167], v[176:179]
 v_mfma_f32_16x16x32_bf16 v[168:171], v[48:51], a[168:171], v[168:171]
 v_mfma_f32_16x16x32_bf16 v[168:171], v[52:55], a[184:187], v[168:171]
 s_waitcnt vmcnt(9) lgkmcnt(0)
 s_barrier
 v_mfma_f32_16x16x32_bf16 v[184:187], v[52:55], a[188:191], v[184:187]
 ds_read_b64_tr_b16 v[32:33], v16 offset:32768
 ds_read_b64_tr_b16 v[34:35], v16 offset:33792
 v_mfma_f32_16x16x32_bf16 v[184:187], v[48:51], a[172:175], v[184:187]
 ds_read_b64_tr_b16 v[36:37], v16 offset:40960
 ds_read_b64_tr_b16 v[38:39], v16 offset:41984
 v_mfma_f32_16x16x32_bf16 v[188:191], v[56:59], a[172:175], v[188:191]
 ds_read_b128 a[224:227], v12 offset:12288
 ds_read_b128 a[240:243], v13 offset:12288
 v_mfma_f32_16x16x32_bf16 v[188:191], v[60:63], a[188:191], v[188:191]
 ds_read_b128 a[228:231], v12 offset:13312
 ds_read_b128 a[244:247], v13 offset:13312
 s_add_u32 m0, s35, 8192
 s_bfe_u32 s0, s81, 0x40004
 s_mul_i32 s0, s0, 128
 buffer_load_dwordx4 v0, s[4:7], s0 offen offset:0 lds
 v_mfma_f32_16x16x32_bf16 v[172:175], v[60:63], a[184:187], v[172:175]
 ds_read_b128 a[232:235], v12 offset:28672
 ds_read_b128 a[248:251], v13 offset:28672
 v_mfma_f32_16x16x32_bf16 v[172:175], v[56:59], a[168:171], v[172:175]
 ds_read_b128 a[236:239], v12 offset:29696
 ds_read_b128 a[252:255], v13 offset:29696
 v_mfma_f32_16x16x32_bf16 v[180:183], v[56:59], a[164:167], v[180:183]
 buffer_load_dwordx4 v1, s[4:7], s0 offen offset:1024 lds
 v_mfma_f32_16x16x32_bf16 v[180:183], v[60:63], a[180:183], v[180:183]
 buffer_load_dwordx4 v2, s[4:7], s0 offen offset:2048 lds
 v_mfma_f32_16x16x32_bf16 v[164:167], v[60:63], a[176:179], v[164:167]
 ds_read_b64_tr_b16 v[40:41], v17 offset:32768
 ds_read_b64_tr_b16 v[42:43], v17 offset:33792
 v_mfma_f32_16x16x32_bf16 v[164:167], v[56:59], a[160:163], v[164:167]
 s_waitcnt lgkmcnt(6)
 v_mfma_f32_16x16x32_bf16 v[128:131], v[32:35], a[224:227], v[128:131]
 ds_read_b64_tr_b16 v[44:45], v17 offset:40960
 ds_read_b64_tr_b16 v[46:47], v17 offset:41984
 v_mfma_f32_16x16x32_bf16 v[128:131], v[36:39], a[240:243], v[128:131]
 buffer_load_dwordx4 v3, s[4:7], s0 offen offset:3072 lds
 v_mfma_f32_16x16x32_bf16 v[144:147], v[36:39], a[244:247], v[144:147]
 v_mfma_f32_16x16x32_bf16 v[144:147], v[32:35], a[228:231], v[144:147]
 s_waitcnt lgkmcnt(4)
 v_mfma_f32_16x16x32_bf16 v[136:139], v[32:35], a[232:235], v[136:139]
 ds_read_b64_tr_b16 v[48:49], v18 offset:32768
 ds_read_b64_tr_b16 v[50:51], v18 offset:33792
 v_mfma_f32_16x16x32_bf16 v[136:139], v[36:39], a[248:251], v[136:139]
 s_add_u32 m0, s86, 65536
 s_bfe_u32 s0, s81, 0x40004
 s_mul_i32 s0, s0, 245760
 buffer_load_dwordx4 v4, s[8:11], s0 offen offset:0 lds
 v_mfma_f32_16x16x32_bf16 v[152:155], v[36:39], a[252:255], v[152:155]
 ds_read_b64_tr_b16 v[52:53], v18 offset:40960
 ds_read_b64_tr_b16 v[54:55], v18 offset:41984
 v_mfma_f32_16x16x32_bf16 v[152:155], v[32:35], a[236:239], v[152:155]
 s_waitcnt lgkmcnt(4)
 v_mfma_f32_16x16x32_bf16 v[156:159], v[40:43], a[236:239], v[156:159]
 v_mfma_f32_16x16x32_bf16 v[156:159], v[44:47], a[252:255], v[156:159]
 buffer_load_dwordx4 v5, s[8:11], s0 offen offset:1024 lds
 v_mfma_f32_16x16x32_bf16 v[140:143], v[44:47], a[248:251], v[140:143]
 ds_read_b64_tr_b16 v[56:57], v19 offset:32768
 ds_read_b64_tr_b16 v[58:59], v19 offset:33792
 v_mfma_f32_16x16x32_bf16 v[140:143], v[40:43], a[232:235], v[140:143]
 buffer_load_dwordx4 v6, s[8:11], s0 offen offset:2048 lds
 v_mfma_f32_16x16x32_bf16 v[148:151], v[40:43], a[228:231], v[148:151]
 ds_read_b64_tr_b16 v[60:61], v19 offset:40960
 ds_read_b64_tr_b16 v[62:63], v19 offset:41984
 v_mfma_f32_16x16x32_bf16 v[148:151], v[44:47], a[244:247], v[148:151]
 v_mfma_f32_16x16x32_bf16 v[132:135], v[44:47], a[240:243], v[132:135]
 v_mfma_f32_16x16x32_bf16 v[132:135], v[40:43], a[224:227], v[132:135]
 s_waitcnt lgkmcnt(4)
 v_mfma_f32_16x16x32_bf16 v[160:163], v[48:51], a[224:227], v[160:163]
 v_mfma_f32_16x16x32_bf16 v[160:163], v[52:55], a[240:243], v[160:163]
 buffer_load_dwordx4 v7, s[8:11], s0 offen offset:3072 lds
 v_mfma_f32_16x16x32_bf16 v[176:179], v[52:55], a[244:247], v[176:179]
 v_mfma_f32_16x16x32_bf16 v[176:179], v[48:51], a[228:231], v[176:179]
 s_mov_b64 s[28:29], s[38:39]
 s_cmp_eq_u32 s100, 14
 s_cselect_b32 s30, 1280, 0
 s_lshr_b32 s45, s86, 1
 s_add_u32 m0, s45, 155648
 s_nop 0
 buffer_load_dwordx4 v254, s[28:31], 0 offen offset:0 lds
 buffer_load_dwordx4 v254, s[28:31], 0 offen offset:1024 lds
 v_mfma_f32_16x16x32_bf16 v[168:171], v[48:51], a[232:235], v[168:171]
 v_mfma_f32_16x16x32_bf16 v[168:171], v[52:55], a[248:251], v[168:171]
 s_waitcnt vmcnt(10) lgkmcnt(0)
 s_barrier
 v_mfma_f32_16x16x32_bf16 v[184:187], v[52:55], a[252:255], v[184:187]
 ds_read_b64_tr_b16 v[32:33], v16 offset:49152
 ds_read_b64_tr_b16 v[34:35], v16 offset:50176
 v_mfma_f32_16x16x32_bf16 v[184:187], v[48:51], a[236:239], v[184:187]
 ds_read_b64_tr_b16 v[36:37], v16 offset:57344
 ds_read_b64_tr_b16 v[38:39], v16 offset:58368
 v_mfma_f32_16x16x32_bf16 v[188:191], v[56:59], a[236:239], v[188:191]
 ds_read_b128 a[192:195], v12 offset:0
 ds_read_b128 a[208:211], v13 offset:0
 v_mfma_f32_16x16x32_bf16 v[188:191], v[60:63], a[252:255], v[188:191]
 ds_read_b128 a[196:199], v12 offset:1024
 ds_read_b128 a[212:215], v13 offset:1024
 s_add_u32 m0, s86, 0
 s_bfe_u32 s0, s81, 0x40004
 s_mul_i32 s0, s0, 221184
 buffer_load_dwordx4 v8, s[12:15], s0 offen offset:0 lds
 v_mfma_f32_16x16x32_bf16 v[172:175], v[60:63], a[248:251], v[172:175]
 ds_read_b128 a[200:203], v12 offset:16384
 ds_read_b128 a[216:219], v13 offset:16384
 v_mfma_f32_16x16x32_bf16 v[172:175], v[56:59], a[232:235], v[172:175]
 ds_read_b128 a[204:207], v12 offset:17408
 ds_read_b128 a[220:223], v13 offset:17408
 v_mfma_f32_16x16x32_bf16 v[180:183], v[56:59], a[228:231], v[180:183]
 v_mfma_f32_16x16x32_bf16 v[180:183], v[60:63], a[244:247], v[180:183]
 buffer_load_dwordx4 v9, s[12:15], s0 offen offset:1024 lds
 v_mfma_f32_16x16x32_bf16 v[164:167], v[60:63], a[240:243], v[164:167]
 ds_read_b64_tr_b16 v[40:41], v17 offset:49152
 ds_read_b64_tr_b16 v[42:43], v17 offset:50176
 v_mfma_f32_16x16x32_bf16 v[164:167], v[56:59], a[224:227], v[164:167]
 s_waitcnt lgkmcnt(6)
 v_mfma_f32_16x16x32_bf16 v[128:131], v[32:35], a[192:195], v[128:131]
 ds_read_b64_tr_b16 v[44:45], v17 offset:57344
 ds_read_b64_tr_b16 v[46:47], v17 offset:58368
 v_mfma_f32_16x16x32_bf16 v[128:131], v[36:39], a[208:211], v[128:131]
 v_mfma_f32_16x16x32_bf16 v[144:147], v[36:39], a[212:215], v[144:147]
 v_mfma_f32_16x16x32_bf16 v[144:147], v[32:35], a[196:199], v[144:147]
 s_waitcnt lgkmcnt(4)
 v_mfma_f32_16x16x32_bf16 v[136:139], v[32:35], a[200:203], v[136:139]
 ds_read_b64_tr_b16 v[48:49], v18 offset:49152
 ds_read_b64_tr_b16 v[50:51], v18 offset:50176
 v_mfma_f32_16x16x32_bf16 v[136:139], v[36:39], a[216:219], v[136:139]
 buffer_load_dwordx4 v10, s[12:15], s0 offen offset:2048 lds
 v_mfma_f32_16x16x32_bf16 v[152:155], v[36:39], a[220:223], v[152:155]
 ds_read_b64_tr_b16 v[52:53], v18 offset:57344
 ds_read_b64_tr_b16 v[54:55], v18 offset:58368
 v_mfma_f32_16x16x32_bf16 v[152:155], v[32:35], a[204:207], v[152:155]
 s_waitcnt lgkmcnt(4)
 v_mfma_f32_16x16x32_bf16 v[156:159], v[40:43], a[204:207], v[156:159]
 v_mfma_f32_16x16x32_bf16 v[156:159], v[44:47], a[220:223], v[156:159]
 v_mfma_f32_16x16x32_bf16 v[140:143], v[44:47], a[216:219], v[140:143]
 ds_read_b64_tr_b16 v[56:57], v19 offset:49152
 ds_read_b64_tr_b16 v[58:59], v19 offset:50176
 v_mfma_f32_16x16x32_bf16 v[140:143], v[40:43], a[200:203], v[140:143]
 buffer_load_dwordx4 v11, s[12:15], s0 offen offset:3072 lds
 v_mfma_f32_16x16x32_bf16 v[148:151], v[40:43], a[196:199], v[148:151]
 ds_read_b64_tr_b16 v[60:61], v19 offset:57344
 ds_read_b64_tr_b16 v[62:63], v19 offset:58368
 v_mfma_f32_16x16x32_bf16 v[148:151], v[44:47], a[212:215], v[148:151]
 v_mfma_f32_16x16x32_bf16 v[132:135], v[44:47], a[208:211], v[132:135]
 v_mfma_f32_16x16x32_bf16 v[132:135], v[40:43], a[192:195], v[132:135]
 s_waitcnt lgkmcnt(4)
 v_mfma_f32_16x16x32_bf16 v[160:163], v[48:51], a[192:195], v[160:163]
 v_mfma_f32_16x16x32_bf16 v[160:163], v[52:55], a[208:211], v[160:163]
 s_add_u32 m0, s86, 16384
 s_bfe_u32 s0, s80, 0x40000
 s_mul_i32 s0, s0, 221184
 buffer_load_dwordx4 v8, s[12:15], s0 offen offset:0 lds
 v_mfma_f32_16x16x32_bf16 v[176:179], v[52:55], a[212:215], v[176:179]
 v_mfma_f32_16x16x32_bf16 v[176:179], v[48:51], a[196:199], v[176:179]
 v_mfma_f32_16x16x32_bf16 v[168:171], v[48:51], a[200:203], v[168:171]
 v_mfma_f32_16x16x32_bf16 v[168:171], v[52:55], a[216:219], v[168:171]
 s_waitcnt vmcnt(7) lgkmcnt(0)
 s_barrier
 v_mfma_f32_16x16x32_bf16 v[184:187], v[52:55], a[220:223], v[184:187]
 ds_read_b64_tr_b16 v[32:33], v20 offset:0
 ds_read_b64_tr_b16 v[34:35], v20 offset:1024
 v_mfma_f32_16x16x32_bf16 v[184:187], v[48:51], a[204:207], v[184:187]
 ds_read_b64_tr_b16 v[36:37], v20 offset:8192
 ds_read_b64_tr_b16 v[38:39], v20 offset:9216
 v_mfma_f32_16x16x32_bf16 v[188:191], v[56:59], a[204:207], v[188:191]
 ds_read_b128 a[224:227], v12 offset:8192
 ds_read_b128 a[240:243], v13 offset:8192
 v_mfma_f32_16x16x32_bf16 v[188:191], v[60:63], a[220:223], v[188:191]
 ds_read_b128 a[228:231], v12 offset:9216
 ds_read_b128 a[244:247], v13 offset:9216
 v_mfma_f32_16x16x32_bf16 v[172:175], v[60:63], a[216:219], v[172:175]
 ds_read_b128 a[232:235], v12 offset:24576
 ds_read_b128 a[248:251], v13 offset:24576
 v_mfma_f32_16x16x32_bf16 v[172:175], v[56:59], a[200:203], v[172:175]
 ds_read_b128 a[236:239], v12 offset:25600
 ds_read_b128 a[252:255], v13 offset:25600
 v_mfma_f32_16x16x32_bf16 v[180:183], v[56:59], a[196:199], v[180:183]
 v_mfma_f32_16x16x32_bf16 v[180:183], v[60:63], a[212:215], v[180:183]
 buffer_load_dwordx4 v9, s[12:15], s0 offen offset:1024 lds
 v_mfma_f32_16x16x32_bf16 v[164:167], v[60:63], a[208:211], v[164:167]
 ds_read_b64_tr_b16 v[40:41], v21 offset:0
 ds_read_b64_tr_b16 v[42:43], v21 offset:1024
 v_mfma_f32_16x16x32_bf16 v[164:167], v[56:59], a[192:195], v[164:167]
 s_waitcnt lgkmcnt(6)
 v_mfma_f32_16x16x32_bf16 v[128:131], v[32:35], a[224:227], v[128:131]
 ds_read_b64_tr_b16 v[44:45], v21 offset:8192
 ds_read_b64_tr_b16 v[46:47], v21 offset:9216
 v_mfma_f32_16x16x32_bf16 v[128:131], v[36:39], a[240:243], v[128:131]
 buffer_load_dwordx4 v10, s[12:15], s0 offen offset:2048 lds
 v_mfma_f32_16x16x32_bf16 v[144:147], v[36:39], a[244:247], v[144:147]
 v_mfma_f32_16x16x32_bf16 v[144:147], v[32:35], a[228:231], v[144:147]
 s_waitcnt lgkmcnt(4)
 v_mfma_f32_16x16x32_bf16 v[136:139], v[32:35], a[232:235], v[136:139]
 ds_read_b64_tr_b16 v[48:49], v22 offset:0
 ds_read_b64_tr_b16 v[50:51], v22 offset:1024
 v_mfma_f32_16x16x32_bf16 v[136:139], v[36:39], a[248:251], v[136:139]
 buffer_load_dwordx4 v11, s[12:15], s0 offen offset:3072 lds
 v_mfma_f32_16x16x32_bf16 v[152:155], v[36:39], a[252:255], v[152:155]
 ds_read_b64_tr_b16 v[52:53], v22 offset:8192
 ds_read_b64_tr_b16 v[54:55], v22 offset:9216
 v_mfma_f32_16x16x32_bf16 v[152:155], v[32:35], a[236:239], v[152:155]
 s_waitcnt lgkmcnt(4)
 v_mfma_f32_16x16x32_bf16 v[156:159], v[40:43], a[236:239], v[156:159]
 v_mfma_f32_16x16x32_bf16 v[156:159], v[44:47], a[252:255], v[156:159]
 s_add_u32 m0, s86, 32768
 s_bfe_u32 s0, s80, 0x40004
 s_mul_i32 s0, s0, 221184
 buffer_load_dwordx4 v8, s[12:15], s0 offen offset:0 lds
 v_mfma_f32_16x16x32_bf16 v[140:143], v[44:47], a[248:251], v[140:143]
 ds_read_b64_tr_b16 v[56:57], v23 offset:0
 ds_read_b64_tr_b16 v[58:59], v23 offset:1024
 v_mfma_f32_16x16x32_bf16 v[140:143], v[40:43], a[232:235], v[140:143]
 buffer_load_dwordx4 v9, s[12:15], s0 offen offset:1024 lds
 v_mfma_f32_16x16x32_bf16 v[148:151], v[40:43], a[228:231], v[148:151]
 ds_read_b64_tr_b16 v[60:61], v23 offset:8192
 ds_read_b64_tr_b16 v[62:63], v23 offset:9216
 v_mfma_f32_16x16x32_bf16 v[148:151], v[44:47], a[244:247], v[148:151]
 v_mfma_f32_16x16x32_bf16 v[132:135], v[44:47], a[240:243], v[132:135]
 v_mfma_f32_16x16x32_bf16 v[132:135], v[40:43], a[224:227], v[132:135]
 s_waitcnt lgkmcnt(4)
 v_mfma_f32_16x16x32_bf16 v[160:163], v[48:51], a[224:227], v[160:163]
 v_mfma_f32_16x16x32_bf16 v[160:163], v[52:55], a[240:243], v[160:163]
 buffer_load_dwordx4 v10, s[12:15], s0 offen offset:2048 lds
 v_mfma_f32_16x16x32_bf16 v[176:179], v[52:55], a[244:247], v[176:179]
 v_mfma_f32_16x16x32_bf16 v[176:179], v[48:51], a[228:231], v[176:179]
 buffer_load_dwordx4 v11, s[12:15], s0 offen offset:3072 lds
 v_mfma_f32_16x16x32_bf16 v[168:171], v[48:51], a[232:235], v[168:171]
 v_mfma_f32_16x16x32_bf16 v[168:171], v[52:55], a[248:251], v[168:171]
 s_waitcnt vmcnt(8) lgkmcnt(0)
 s_barrier
 v_mfma_f32_16x16x32_bf16 v[184:187], v[52:55], a[252:255], v[184:187]
 ds_read_b64_tr_b16 v[32:33], v16 offset:0
 ds_read_b64_tr_b16 v[34:35], v16 offset:1024
 v_mfma_f32_16x16x32_bf16 v[184:187], v[48:51], a[236:239], v[184:187]
 ds_read_b64_tr_b16 v[36:37], v16 offset:8192
 ds_read_b64_tr_b16 v[38:39], v16 offset:9216
 v_mfma_f32_16x16x32_bf16 v[188:191], v[56:59], a[236:239], v[188:191]
 v_mfma_f32_16x16x32_bf16 v[188:191], v[60:63], a[252:255], v[188:191]
 s_add_u32 m0, s86, 49152
 s_bfe_u32 s0, s80, 0x40014
 s_mul_i32 s0, s0, 221184
 buffer_load_dwordx4 v8, s[12:15], s0 offen offset:0 lds
 v_mfma_f32_16x16x32_bf16 v[172:175], v[60:63], a[248:251], v[172:175]
 v_mfma_f32_16x16x32_bf16 v[172:175], v[56:59], a[232:235], v[172:175]
 v_mfma_f32_16x16x32_bf16 v[180:183], v[56:59], a[228:231], v[180:183]
 v_mfma_f32_16x16x32_bf16 v[180:183], v[60:63], a[244:247], v[180:183]
 buffer_load_dwordx4 v9, s[12:15], s0 offen offset:1024 lds
 v_mfma_f32_16x16x32_bf16 v[164:167], v[60:63], a[240:243], v[164:167]
 ds_read_b64_tr_b16 v[40:41], v17 offset:0
 ds_read_b64_tr_b16 v[42:43], v17 offset:1024
 v_mfma_f32_16x16x32_bf16 v[164:167], v[56:59], a[224:227], v[164:167]
 s_branch L_p2
L_p1v:
 s_waitcnt lgkmcnt(4)
 v_mfma_f32_16x16x32_bf16 v[128:131], a[0:3], v[32:35], 0
 ds_read_b64_tr_b16 v[44:45], v17 offset:8192
 ds_read_b64_tr_b16 v[46:47], v17 offset:9216
 s_lshl_b32 s40, s100, 8
 v_mfma_f32_16x16x32_bf16 v[128:131], a[16:19], v[36:39], v[128:131]
 s_add_u32 m0, s35, 8192
 s_bfe_u32 s0, s80, 0x40008
 s_mul_i32 s0, s0, 128
 buffer_load_dwordx4 v0, s[4:7], s0 offen offset:0 lds
 v_add_u32 v15, s40, v15
 v_mfma_f32_16x16x32_bf16 v[132:135], a[20:23], v[36:39], 0
 v_cmp_le_u32 vcc, 3456, v15
 v_mov_b32 v248, s40
 v_mov_b32 v15, 0x1000000
 v_mfma_f32_16x16x32_bf16 v[132:135], a[4:7], v[32:35], v[132:135]
 v_cndmask_b32 v248, v248, v15, vcc
 v_add_u32 v8, v248, v8
 s_waitcnt lgkmcnt(2)
 v_mfma_f32_16x16x32_bf16 v[136:139], a[8:11], v[32:35], 0
 ds_read_b64_tr_b16 v[48:49], v18 offset:0
 ds_read_b64_tr_b16 v[50:51], v18 offset:1024
 v_add_u32 v9, v248, v9
 v_mfma_f32_16x16x32_bf16 v[136:139], a[24:27], v[36:39], v[136:139]
 buffer_load_dwordx4 v1, s[4:7], s0 offen offset:1024 lds
 v_add_u32 v10, v248, v10
 v_mfma_f32_16x16x32_bf16 v[140:143], a[28:31], v[36:39], 0
 ds_read_b64_tr_b16 v[52:53], v18 offset:8192
 ds_read_b64_tr_b16 v[54:55], v18 offset:9216
 v_add_u32 v11, v248, v11
 v_mfma_f32_16x16x32_bf16 v[140:143], a[12:15], v[32:35], v[140:143]
 buffer_load_dwordx4 v2, s[4:7], s0 offen offset:2048 lds
 v_mfma_f32_16x16x32_bf16 v[156:159], a[12:15], v[40:43], 0
 v_and_b32 v248, 31, v255
 v_lshrrev_b32 v249, 5, v255
 v_lshlrev_b32 v227, 2, v248
 s_waitcnt lgkmcnt(4)
 v_mfma_f32_16x16x32_bf16 v[156:159], a[28:31], v[44:47], v[156:159]
 buffer_load_dwordx4 v3, s[4:7], s0 offen offset:3072 lds
 s_lshl_b32 s41, s3, 10
 v_mfma_f32_16x16x32_bf16 v[152:155], a[24:27], v[44:47], 0
 ds_read_b64_tr_b16 v[56:57], v19 offset:0
 ds_read_b64_tr_b16 v[58:59], v19 offset:1024
 s_add_u32 s42, s41, 81920
 v_mfma_f32_16x16x32_bf16 v[152:155], a[8:11], v[40:43], v[152:155]
 s_add_u32 m0, s86, 32768
 s_bfe_u32 s0, s80, 0x40008
 s_mul_i32 s0, s0, 245760
 buffer_load_dwordx4 v4, s[8:11], s0 offen offset:0 lds
 v_add_u32 v241, s42, v254
 v_mfma_f32_16x16x32_bf16 v[148:151], a[4:7], v[40:43], 0
 ds_read_b64_tr_b16 v[60:61], v19 offset:8192
 ds_read_b64_tr_b16 v[62:63], v19 offset:9216
 s_mul_i32 s41, s41, 3
 v_mfma_f32_16x16x32_bf16 v[148:151], a[20:23], v[44:47], v[148:151]
 buffer_load_dwordx4 v5, s[8:11], s0 offen offset:1024 lds
 s_add_u32 s41, s41, 118784
 v_mfma_f32_16x16x32_bf16 v[144:147], a[16:19], v[44:47], 0
 v_lshl_add_u32 v250, v249, 7, v254
 v_add_u32 v240, s41, v250
 v_lshlrev_b32 v250, 2, v249
 v_mfma_f32_16x16x32_bf16 v[144:147], a[0:3], v[40:43], v[144:147]
 v_sub_u32 v250, v248, v250
 v_cvt_f32_i32 v250, v250
 s_waitcnt lgkmcnt(4)
 v_mfma_f32_16x16x32_bf16 v[160:163], a[0:3], v[48:51], 0
 v_mov_b32 v251, 0x71800000
 v_fmaak_f32 v208, v250, v251, 0x71000000
 v_min_f32 v192, 0, v208
 v_mfma_f32_16x16x32_bf16 v[160:163], a[16:19], v[52:55], v[160:163]
 buffer_load_dwordx4 v6, s[8:11], s0 offen offset:2048 lds
 v_min_f32 v208, -v208, 0
 v_mfma_f32_16x16x32_bf16 v[164:167], a[20:23], v[52:55], 0
 v_fmaak_f32 v209, v250, v251, 0xf1000000
 v_min_f32 v193, 0, v209
 v_min_f32 v209, -v209, 0
 v_mfma_f32_16x16x32_bf16 v[164:167], a[4:7], v[48:51], v[164:167]
 buffer_load_dwordx4 v7, s[8:11], s0 offen offset:3072 lds
 v_fmaak_f32 v210, v250, v251, 0xf1c00000
 v_mfma_f32_16x16x32_bf16 v[168:171], a[8:11], v[48:51], 0
 v_min_f32 v194, 0, v210
 v_min_f32 v210, -v210, 0
 v_fmaak_f32 v211, v250, v251, 0xf2200000
 v_mfma_f32_16x16x32_bf16 v[168:171], a[24:27], v[52:55], v[168:171]
 s_waitcnt vmcnt(12) lgkmcnt(0)
 s_barrier
 v_min_f32 v195, 0, v211
 v_mfma_f32_16x16x32_bf16 v[172:175], a[28:31], v[52:55], 0
 ds_read_b64_tr_b16 v[32:33], v16 offset:16384
 ds_read_b64_tr_b16 v[34:35], v16 offset:17408
 v_min_f32 v211, -v211, 0
 v_mfma_f32_16x16x32_bf16 v[172:175], a[12:15], v[48:51], v[172:175]
 ds_read_b64_tr_b16 v[36:37], v16 offset:24576
 ds_read_b64_tr_b16 v[38:39], v16 offset:25600
 v_fmaak_f32 v212, v250, v251, 0xf2f00000
 v_mfma_f32_16x16x32_bf16 v[188:191], a[12:15], v[56:59], 0
 ds_read_b128 a[32:35], v12 offset:4096
 ds_read_b128 a[48:51], v13 offset:4096
 v_min_f32 v196, 0, v212
 v_mfma_f32_16x16x32_bf16 v[188:191], a[28:31], v[60:63], v[188:191]
 ds_read_b128 a[36:39], v12 offset:5120
 ds_read_b128 a[52:55], v13 offset:5120
 s_add_u32 m0, s35, 12288
 s_bfe_u32 s0, s80, 0x4000c
 s_mul_i32 s0, s0, 128
 buffer_load_dwordx4 v0, s[4:7], s0 offen offset:0 lds
 v_mfma_f32_16x16x32_bf16 v[184:187], a[24:27], v[60:63], 0
 ds_read_b128 a[40:43], v12 offset:20480
 ds_read_b128 a[56:59], v13 offset:20480
 v_min_f32 v212, -v212, 0
 v_mfma_f32_16x16x32_bf16 v[184:187], a[8:11], v[56:59], v[184:187]
 ds_read_b128 a[44:47], v12 offset:21504
 ds_read_b128 a[60:63], v13 offset:21504
 v_fmaak_f32 v213, v250, v251, 0xf3080000
 v_mfma_f32_16x16x32_bf16 v[180:183], a[4:7], v[56:59], 0
 buffer_load_dwordx4 v1, s[4:7], s0 offen offset:1024 lds
 v_min_f32 v197, 0, v213
 v_mfma_f32_16x16x32_bf16 v[180:183], a[20:23], v[60:63], v[180:183]
 buffer_load_dwordx4 v2, s[4:7], s0 offen offset:2048 lds
 v_min_f32 v213, -v213, 0
 v_mfma_f32_16x16x32_bf16 v[176:179], a[16:19], v[60:63], 0
 ds_read_b64_tr_b16 v[40:41], v17 offset:16384
 ds_read_b64_tr_b16 v[42:43], v17 offset:17408
 v_fmaak_f32 v214, v250, v251, 0xf3180000
 v_mfma_f32_16x16x32_bf16 v[176:179], a[0:3], v[56:59], v[176:179]
 v_min_f32 v198, 0, v214
 v_min_f32 v214, -v214, 0
 s_waitcnt lgkmcnt(6)
 v_mfma_f32_16x16x32_bf16 v[128:131], a[32:35], v[32:35], v[128:131]
 ds_read_b64_tr_b16 v[44:45], v17 offset:24576
 ds_read_b64_tr_b16 v[46:47], v17 offset:25600
 v_fmaak_f32 v215, v250, v251, 0xf3280000
 v_mfma_f32_16x16x32_bf16 v[128:131], a[48:51], v[36:39], v[128:131]
 buffer_load_dwordx4 v3, s[4:7], s0 offen offset:3072 lds
 v_min_f32 v199, 0, v215
 v_mfma_f32_16x16x32_bf16 v[132:135], a[52:55], v[36:39], v[132:135]
 v_min_f32 v215, -v215, 0
 v_fmaak_f32 v216, v250, v251, 0xf3780000
 v_min_f32 v200, 0, v216
 v_mfma_f32_16x16x32_bf16 v[132:135], a[36:39], v[32:35], v[132:135]
 v_min_f32 v216, -v216, 0
 v_fmaak_f32 v217, v250, v251, 0xf3840000
 s_waitcnt lgkmcnt(4)
 v_mfma_f32_16x16x32_bf16 v[136:139], a[40:43], v[32:35], v[136:139]
 ds_read_b64_tr_b16 v[48:49], v18 offset:16384
 ds_read_b64_tr_b16 v[50:51], v18 offset:17408
 v_min_f32 v201, 0, v217
 v_mfma_f32_16x16x32_bf16 v[136:139], a[56:59], v[36:39], v[136:139]
 s_add_u32 m0, s86, 49152
 s_bfe_u32 s0, s80, 0x4000c
 s_mul_i32 s0, s0, 245760
 buffer_load_dwordx4 v4, s[8:11], s0 offen offset:0 lds
 v_min_f32 v217, -v217, 0
 v_mfma_f32_16x16x32_bf16 v[140:143], a[60:63], v[36:39], v[140:143]
 ds_read_b64_tr_b16 v[52:53], v18 offset:24576
 ds_read_b64_tr_b16 v[54:55], v18 offset:25600
 v_fmaak_f32 v218, v250, v251, 0xf38c0000
 v_mfma_f32_16x16x32_bf16 v[140:143], a[44:47], v[32:35], v[140:143]
 v_min_f32 v202, 0, v218
 v_min_f32 v218, -v218, 0
 s_waitcnt lgkmcnt(4)
 v_mfma_f32_16x16x32_bf16 v[156:159], a[44:47], v[40:43], v[156:159]
 v_fmaak_f32 v219, v250, v251, 0xf3940000
 v_min_f32 v203, 0, v219
 v_min_f32 v219, -v219, 0
 v_mfma_f32_16x16x32_bf16 v[156:159], a[60:63], v[44:47], v[156:159]
 buffer_load_dwordx4 v5, s[8:11], s0 offen offset:1024 lds
 v_fmaak_f32 v220, v250, v251, 0xf3bc0000
 v_mfma_f32_16x16x32_bf16 v[152:155], a[56:59], v[44:47], v[152:155]
 ds_read_b64_tr_b16 v[56:57], v19 offset:16384
 ds_read_b64_tr_b16 v[58:59], v19 offset:17408
 v_min_f32 v204, 0, v220
 v_mfma_f32_16x16x32_bf16 v[152:155], a[40:43], v[40:43], v[152:155]
 buffer_load_dwordx4 v6, s[8:11], s0 offen offset:2048 lds
 v_min_f32 v220, -v220, 0
 v_mfma_f32_16x16x32_bf16 v[148:151], a[36:39], v[40:43], v[148:151]
 ds_read_b64_tr_b16 v[60:61], v19 offset:24576
 ds_read_b64_tr_b16 v[62:63], v19 offset:25600
 v_fmaak_f32 v221, v250, v251, 0xf3c40000
 v_mfma_f32_16x16x32_bf16 v[148:151], a[52:55], v[44:47], v[148:151]
 v_min_f32 v205, 0, v221
 v_min_f32 v221, -v221, 0
 v_fmaak_f32 v222, v250, v251, 0xf3cc0000
 v_mfma_f32_16x16x32_bf16 v[144:147], a[48:51], v[44:47], v[144:147]
 v_min_f32 v206, 0, v222
 v_min_f32 v222, -v222, 0
 v_fmaak_f32 v223, v250, v251, 0xf3d40000
 v_mfma_f32_16x16x32_bf16 v[144:147], a[32:35], v[40:43], v[144:147]
 v_min_f32 v207, 0, v223
 v_min_f32 v223, -v223, 0
 s_waitcnt lgkmcnt(4)
 v_mfma_f32_16x16x32_bf16 v[160:163], a[32:35], v[48:51], v[160:163]
 v_lshrrev_b32 v249, 4, v255
 v_lshl_add_u32 v239, v249, 8, v254
 v_add_u32 v232, s69, v239
 v_mfma_f32_16x16x32_bf16 v[160:163], a[48:51], v[52:55], v[160:163]
 buffer_load_dwordx4 v7, s[8:11], s0 offen offset:3072 lds
 v_add_u32 v233, s70, v239
 v_mfma_f32_16x16x32_bf16 v[164:167], a[52:55], v[52:55], v[164:167]
 v_add_u32 v234, s71, v239
 v_add_u32 v235, s72, v239
 v_add_u32 v228, s61, v254
 v_mfma_f32_16x16x32_bf16 v[164:167], a[36:39], v[48:51], v[164:167]
 v_add_u32 v229, s62, v254
 v_add_u32 v230, s63, v254
 v_add_u32 v231, s60, v254
 v_mfma_f32_16x16x32_bf16 v[168:171], a[40:43], v[48:51], v[168:171]
 v_lshl_add_u32 v227, s59, 8, v227
 v_add_u32 v227, 20594688, v227
 v_min_u32 v248, 59, v255
 v_mfma_f32_16x16x32_bf16 v[168:171], a[56:59], v[52:55], v[168:171]
 s_waitcnt vmcnt(8) lgkmcnt(0)
 s_barrier
 v_mfma_f32_16x16x32_bf16 v[172:175], a[60:63], v[52:55], v[172:175]
 ds_read_b64_tr_b16 v[32:33], v16 offset:32768
 ds_read_b64_tr_b16 v[34:35], v16 offset:33792
 v_mfma_f32_16x16x32_bf16 v[172:175], a[44:47], v[48:51], v[172:175]
 ds_read_b64_tr_b16 v[36:37], v16 offset:40960
 ds_read_b64_tr_b16 v[38:39], v16 offset:41984
 v_mfma_f32_16x16x32_bf16 v[188:191], a[44:47], v[56:59], v[188:191]
 ds_read_b128 a[64:67], v12 offset:8192
 ds_read_b128 a[80:83], v13 offset:8192
 v_mfma_f32_16x16x32_bf16 v[188:191], a[60:63], v[60:63], v[188:191]
 ds_read_b128 a[68:71], v12 offset:9216
 ds_read_b128 a[84:87], v13 offset:9216
 s_add_u32 m0, s35, 0
 s_bfe_u32 s0, s80, 0x40010
 s_mul_i32 s0, s0, 128
 buffer_load_dwordx4 v0, s[4:7], s0 offen offset:0 lds
 v_mfma_f32_16x16x32_bf16 v[184:187], a[56:59], v[60:63], v[184:187]
 ds_read_b128 a[72:75], v12 offset:24576
 ds_read_b128 a[88:91], v13 offset:24576
 v_mfma_f32_16x16x32_bf16 v[184:187], a[40:43], v[56:59], v[184:187]
 ds_read_b128 a[76:79], v12 offset:25600
 ds_read_b128 a[92:95], v13 offset:25600
 v_mfma_f32_16x16x32_bf16 v[180:183], a[36:39], v[56:59], v[180:183]
 buffer_load_dwordx4 v1, s[4:7], s0 offen offset:1024 lds
 v_mfma_f32_16x16x32_bf16 v[180:183], a[52:55], v[60:63], v[180:183]
 buffer_load_dwordx4 v2, s[4:7], s0 offen offset:2048 lds
 v_mfma_f32_16x16x32_bf16 v[176:179], a[48:51], v[60:63], v[176:179]
 ds_read_b64_tr_b16 v[40:41], v17 offset:32768
 ds_read_b64_tr_b16 v[42:43], v17 offset:33792
 v_mfma_f32_16x16x32_bf16 v[176:179], a[32:35], v[56:59], v[176:179]
 v_and_b32 v249, 3, v248
 s_waitcnt lgkmcnt(6)
 v_mfma_f32_16x16x32_bf16 v[128:131], a[64:67], v[32:35], v[128:131]
 ds_read_b64_tr_b16 v[44:45], v17 offset:40960
 ds_read_b64_tr_b16 v[46:47], v17 offset:41984
 v_mfma_f32_16x16x32_bf16 v[128:131], a[80:83], v[36:39], v[128:131]
 buffer_load_dwordx4 v3, s[4:7], s0 offen offset:3072 lds
 v_mfma_f32_16x16x32_bf16 v[132:135], a[84:87], v[36:39], v[132:135]
 v_lshl_add_u32 v249, v249, 3, s76
 v_lshrrev_b32 v248, 2, v248
 v_mfma_f32_16x16x32_bf16 v[132:135], a[68:71], v[32:35], v[132:135]
 v_lshl_add_u32 v249, v248, 7, v249
 s_waitcnt lgkmcnt(4)
 v_mfma_f32_16x16x32_bf16 v[136:139], a[72:75], v[32:35], v[136:139]
 ds_read_b64_tr_b16 v[48:49], v18 offset:32768
 ds_read_b64_tr_b16 v[50:51], v18 offset:33792
 v_mfma_f32_16x16x32_bf16 v[136:139], a[88:91], v[36:39], v[136:139]
 s_add_u32 m0, s86, 65536
 s_bfe_u32 s0, s80, 0x40010
 s_mul_i32 s0, s0, 245760
 buffer_load_dwordx4 v4, s[8:11], s0 offen offset:0 lds
 v_mfma_f32_16x16x32_bf16 v[140:143], a[92:95], v[36:39], v[140:143]
 ds_read_b64_tr_b16 v[52:53], v18 offset:40960
 ds_read_b64_tr_b16 v[54:55], v18 offset:41984
 v_mfma_f32_16x16x32_bf16 v[140:143], a[76:79], v[32:35], v[140:143]
 s_mul_i32 s40, s3, -1152
 s_waitcnt lgkmcnt(4)
 v_mfma_f32_16x16x32_bf16 v[156:159], a[76:79], v[40:43], v[156:159]
 s_add_u32 s40, s40, 4608
 v_cmp_lt_u32 vcc, 47, v255
 v_mfma_f32_16x16x32_bf16 v[156:159], a[92:95], v[44:47], v[156:159]
 buffer_load_dwordx4 v5, s[8:11], s0 offen offset:1024 lds
 v_mfma_f32_16x16x32_bf16 v[152:155], a[88:91], v[44:47], v[152:155]
 ds_read_b64_tr_b16 v[56:57], v19 offset:32768
 ds_read_b64_tr_b16 v[58:59], v19 offset:33792
 v_mfma_f32_16x16x32_bf16 v[152:155], a[72:75], v[40:43], v[152:155]
 buffer_load_dwordx4 v6, s[8:11], s0 offen offset:2048 lds
 v_mfma_f32_16x16x32_bf16 v[148:151], a[68:71], v[40:43], v[148:151]
 ds_read_b64_tr_b16 v[60:61], v19 offset:40960
 ds_read_b64_tr_b16 v[62:63], v19 offset:41984
 v_mfma_f32_16x16x32_bf16 v[148:151], a[84:87], v[44:47], v[148:151]
 v_add_u32 v248, s40, v249
 v_cndmask_b32 v244, v249, v248, vcc
 v_mfma_f32_16x16x32_bf16 v[144:147], a[80:83], v[44:47], v[144:147]
 v_lshrrev_b32 v248, 1, v255
 v_min_u32 v248, 4, v248
 v_mfma_f32_16x16x32_bf16 v[144:147], a[64:67], v[40:43], v[144:147]
 ds_read_b64_tr_b16 v[64:65], v79 offset:0
 ds_read_b64_tr_b16 v[66:67], v79 offset:5120
 s_waitcnt lgkmcnt(6)
 v_mfma_f32_16x16x32_bf16 v[160:163], a[64:67], v[48:51], v[160:163]
 ds_read_b64_tr_b16 v[68:69], v80 offset:0
 ds_read_b64_tr_b16 v[70:71], v80 offset:5120
 v_mfma_f32_16x16x32_bf16 v[160:163], a[80:83], v[52:55], v[160:163]
 ds_read_b64_tr_b16 v[72:73], v81 offset:0
 ds_read_b64_tr_b16 v[74:75], v81 offset:5120
 v_mfma_f32_16x16x32_bf16 v[164:167], a[84:87], v[52:55], v[164:167]
 buffer_load_dwordx4 v7, s[8:11], s0 offen offset:3072 lds
 v_mfma_f32_16x16x32_bf16 v[164:167], a[68:71], v[48:51], v[164:167]
 v_and_b32 v249, 1, v255
 v_lshl_add_u32 v249, v249, 3, s74
 v_mfma_f32_16x16x32_bf16 v[168:171], a[72:75], v[48:51], v[168:171]
 v_lshl_add_u32 v243, v248, 7, v249
 v_writelane_b32 v243, s75, 63
 v_mfma_f32_16x16x32_bf16 v[168:171], a[88:91], v[52:55], v[168:171]
 s_waitcnt vmcnt(8) lgkmcnt(0)
 s_barrier
 v_mfma_f32_16x16x32_bf16 v[172:175], a[92:95], v[52:55], v[172:175]
 ds_read_b64_tr_b16 v[32:33], v16 offset:49152
 ds_read_b64_tr_b16 v[34:35], v16 offset:50176
 v_mfma_f32_16x16x32_bf16 v[172:175], a[76:79], v[48:51], v[172:175]
 ds_read_b64_tr_b16 v[36:37], v16 offset:57344
 ds_read_b64_tr_b16 v[38:39], v16 offset:58368
 v_mfma_f32_16x16x32_bf16 v[188:191], a[76:79], v[56:59], v[188:191]
 ds_read_b128 a[96:99], v12 offset:12288
 ds_read_b128 a[112:115], v13 offset:12288
 v_mfma_f32_16x16x32_bf16 v[188:191], a[92:95], v[60:63], v[188:191]
 ds_read_b128 a[100:103], v12 offset:13312
 ds_read_b128 a[116:119], v13 offset:13312
 s_add_u32 m0, s35, 4096
 s_bfe_u32 s0, s80, 0x40014
 s_mul_i32 s0, s0, 128
 buffer_load_dwordx4 v0, s[4:7], s0 offen offset:0 lds
 v_mfma_f32_16x16x32_bf16 v[184:187], a[88:91], v[60:63], v[184:187]
 ds_read_b128 a[104:107], v12 offset:28672
 ds_read_b128 a[120:123], v13 offset:28672
 v_mfma_f32_16x16x32_bf16 v[184:187], a[72:75], v[56:59], v[184:187]
 ds_read_b128 a[108:111], v12 offset:29696
 ds_read_b128 a[124:127], v13 offset:29696
 v_mfma_f32_16x16x32_bf16 v[180:183], a[68:71], v[56:59], v[180:183]
 buffer_load_dwordx4 v1, s[4:7], s0 offen offset:1024 lds
 v_mfma_f32_16x16x32_bf16 v[180:183], a[84:87], v[60:63], v[180:183]
 buffer_store_dwordx4 v[64:67], v82, s[16:19], s55 offen sc1
 v_mfma_f32_16x16x32_bf16 v[176:179], a[80:83], v[60:63], v[176:179]
 ds_read_b64_tr_b16 v[40:41], v17 offset:49152
 ds_read_b64_tr_b16 v[42:43], v17 offset:50176
 v_mfma_f32_16x16x32_bf16 v[176:179], a[64:67], v[56:59], v[176:179]
 s_bfe_u32 s40, s58, 0x1a0002
 s_waitcnt lgkmcnt(6)
 v_mfma_f32_16x16x32_bf16 v[128:131], a[96:99], v[32:35], v[128:131]
 ds_read_b64_tr_b16 v[44:45], v17 offset:57344
 ds_read_b64_tr_b16 v[46:47], v17 offset:58368
 buffer_load_dwordx4 v2, s[4:7], s0 offen offset:2048 lds
 v_mfma_f32_16x16x32_bf16 v[128:131], a[112:115], v[36:39], v[128:131]
 buffer_load_dwordx4 v3, s[4:7], s0 offen offset:3072 lds
 v_mfma_f32_16x16x32_bf16 v[132:135], a[116:119], v[36:39], v[132:135]
 v_writelane_b32 v243, s40, 62
 s_lshr_b32 s40, s59, 2
 v_mfma_f32_16x16x32_bf16 v[132:135], a[100:103], v[32:35], v[132:135]
 s_sub_u32 s40, s40, 2
 s_waitcnt lgkmcnt(4)
 v_mfma_f32_16x16x32_bf16 v[136:139], a[104:107], v[32:35], v[136:139]
 ds_read_b64_tr_b16 v[48:49], v18 offset:49152
 ds_read_b64_tr_b16 v[50:51], v18 offset:50176
 v_mfma_f32_16x16x32_bf16 v[136:139], a[120:123], v[36:39], v[136:139]
 s_add_u32 m0, s86, 0
 s_bfe_u32 s0, s80, 0x40014
 s_mul_i32 s0, s0, 245760
 buffer_load_dwordx4 v4, s[8:11], s0 offen offset:0 lds
 v_mfma_f32_16x16x32_bf16 v[140:143], a[124:127], v[36:39], v[140:143]
 ds_read_b64_tr_b16 v[52:53], v18 offset:57344
 ds_read_b64_tr_b16 v[54:55], v18 offset:58368
 v_mfma_f32_16x16x32_bf16 v[140:143], a[108:111], v[32:35], v[140:143]
 v_lshrrev_b32 v248, 4, v255
 s_waitcnt lgkmcnt(4)
 v_mfma_f32_16x16x32_bf16 v[156:159], a[108:111], v[40:43], v[156:159]
 v_min_u32 v248, 2, v248
 v_add_u32 v248, s40, v248
 v_mfma_f32_16x16x32_bf16 v[156:159], a[124:127], v[44:47], v[156:159]
 buffer_load_dwordx4 v5, s[8:11], s0 offen offset:1024 lds
 v_mfma_f32_16x16x32_bf16 v[152:155], a[120:123], v[44:47], v[152:155]
 ds_read_b64_tr_b16 v[56:57], v19 offset:49152
 ds_read_b64_tr_b16 v[58:59], v19 offset:50176
 v_mfma_f32_16x16x32_bf16 v[152:155], a[104:107], v[40:43], v[152:155]
 buffer_store_dwordx4 v[68:71], v83, s[16:19], s55 offen sc1
 v_mfma_f32_16x16x32_bf16 v[148:151], a[100:103], v[40:43], v[148:151]
 ds_read_b64_tr_b16 v[60:61], v19 offset:57344
 ds_read_b64_tr_b16 v[62:63], v19 offset:58368
 v_mfma_f32_16x16x32_bf16 v[148:151], a[116:119], v[44:47], v[148:151]
 buffer_load_dwordx4 v6, s[8:11], s0 offen offset:2048 lds
 v_mfma_f32_16x16x32_bf16 v[144:147], a[112:115], v[44:47], v[144:147]
 v_max_i32 v248, 0, v248
 v_and_b32 v249, 3, v255
 v_mfma_f32_16x16x32_bf16 v[144:147], a[96:99], v[40:43], v[144:147]
 v_lshl_add_u32 v249, v249, 3, s77
 s_waitcnt lgkmcnt(4)
 v_mfma_f32_16x16x32_bf16 v[160:163], a[96:99], v[48:51], v[160:163]
 v_lshl_add_u32 v248, v248, 11, v249
 v_bfe_u32 v249, v255, 2, 1
 v_mfma_f32_16x16x32_bf16 v[160:163], a[112:115], v[52:55], v[160:163]
 buffer_load_dwordx4 v7, s[8:11], s0 offen offset:3072 lds
 v_mfma_f32_16x16x32_bf16 v[164:167], a[116:119], v[52:55], v[164:167]
 v_mad_u32_u24 v248, v249, s78, v248
 v_cmp_gt_u32 vcc, 48, v255
 v_mfma_f32_16x16x32_bf16 v[164:167], a[100:103], v[48:51], v[164:167]
 v_bfe_u32 v249, v255, 3, 1
 v_add_u32 v249, 1, v249
 v_mfma_f32_16x16x32_bf16 v[168:171], a[104:107], v[48:51], v[168:171]
 v_mul_u32_u24 v249, 640, v249
 v_cndmask_b32 v249, 0, v249, vcc
 v_mfma_f32_16x16x32_bf16 v[168:171], a[120:123], v[52:55], v[168:171]
 s_waitcnt vmcnt(10) lgkmcnt(0)
 s_barrier
 v_mfma_f32_16x16x32_bf16 v[172:175], a[124:127], v[52:55], v[172:175]
 ds_read_b64_tr_b16 v[32:33], v20 offset:0
 ds_read_b64_tr_b16 v[34:35], v20 offset:1024
 v_mfma_f32_16x16x32_bf16 v[172:175], a[108:111], v[48:51], v[172:175]
 ds_read_b64_tr_b16 v[36:37], v20 offset:8192
 ds_read_b64_tr_b16 v[38:39], v20 offset:9216
 buffer_store_dwordx4 v[72:75], v84, s[16:19], s55 offen sc1
 v_mfma_f32_16x16x32_bf16 v[188:191], a[108:111], v[56:59], v[188:191]
 ds_read_b128 a[128:131], v12 offset:0
 ds_read_b128 a[144:147], v13 offset:0
 v_mfma_f32_16x16x32_bf16 v[188:191], a[124:127], v[60:63], v[188:191]
 ds_read_b128 a[132:135], v12 offset:1024
 ds_read_b128 a[148:151], v13 offset:1024
 s_add_u32 m0, s35, 8192
 s_bfe_u32 s0, s80, 0x40018
 s_mul_i32 s0, s0, 128
 buffer_load_dwordx4 v0, s[4:7], s0 offen offset:0 lds
 v_mfma_f32_16x16x32_bf16 v[184:187], a[120:123], v[60:63], v[184:187]
 ds_read_b128 a[136:139], v12 offset:16384
 ds_read_b128 a[152:155], v13 offset:16384
 v_mfma_f32_16x16x32_bf16 v[184:187], a[104:107], v[56:59], v[184:187]
 ds_read_b128 a[140:143], v12 offset:17408
 ds_read_b128 a[156:159], v13 offset:17408
 buffer_load_dwordx2 v[252:253], v237, s[24:27], 0 offen sc1
 v_mfma_f32_16x16x32_bf16 v[180:183], a[100:103], v[56:59], v[180:183]
 buffer_load_dwordx4 v1, s[4:7], s0 offen offset:1024 lds
 v_mfma_f32_16x16x32_bf16 v[180:183], a[116:119], v[60:63], v[180:183]
 buffer_load_dwordx4 v2, s[4:7], s0 offen offset:2048 lds
 v_mfma_f32_16x16x32_bf16 v[176:179], a[112:115], v[60:63], v[176:179]
 ds_read_b64_tr_b16 v[40:41], v21 offset:0
 ds_read_b64_tr_b16 v[42:43], v21 offset:1024
 v_mfma_f32_16x16x32_bf16 v[176:179], a[96:99], v[56:59], v[176:179]
 v_add_u32 v245, v248, v249
 s_waitcnt lgkmcnt(6)
 v_mfma_f32_16x16x32_bf16 v[128:131], a[128:131], v[32:35], v[128:131]
 ds_read_b64_tr_b16 v[44:45], v21 offset:8192
 ds_read_b64_tr_b16 v[46:47], v21 offset:9216
 v_mfma_f32_16x16x32_bf16 v[128:131], a[144:147], v[36:39], v[128:131]
 buffer_load_dwordx4 v3, s[4:7], s0 offen offset:3072 lds
 v_mfma_f32_16x16x32_bf16 v[132:135], a[148:151], v[36:39], v[132:135]
 v_mfma_f32_16x16x32_bf16 v[132:135], a[132:135], v[32:35], v[132:135]
 s_waitcnt lgkmcnt(4)
 v_mfma_f32_16x16x32_bf16 v[136:139], a[136:139], v[32:35], v[136:139]
 ds_read_b64_tr_b16 v[48:49], v22 offset:0
 ds_read_b64_tr_b16 v[50:51], v22 offset:1024
 v_mfma_f32_16x16x32_bf16 v[136:139], a[152:155], v[36:39], v[136:139]
 s_add_u32 m0, s86, 16384
 s_bfe_u32 s0, s80, 0x40018
 s_mul_i32 s0, s0, 245760
 buffer_load_dwordx4 v4, s[8:11], s0 offen offset:0 lds
 v_mfma_f32_16x16x32_bf16 v[140:143], a[156:159], v[36:39], v[140:143]
 ds_read_b64_tr_b16 v[52:53], v22 offset:8192
 ds_read_b64_tr_b16 v[54:55], v22 offset:9216
 v_mfma_f32_16x16x32_bf16 v[140:143], a[140:143], v[32:35], v[140:143]
 s_waitcnt lgkmcnt(4)
 v_mfma_f32_16x16x32_bf16 v[156:159], a[140:143], v[40:43], v[156:159]
 v_mfma_f32_16x16x32_bf16 v[156:159], a[156:159], v[44:47], v[156:159]
 buffer_load_dwordx4 v5, s[8:11], s0 offen offset:1024 lds
 v_mfma_f32_16x16x32_bf16 v[152:155], a[152:155], v[44:47], v[152:155]
 ds_read_b64_tr_b16 v[56:57], v23 offset:0
 ds_read_b64_tr_b16 v[58:59], v23 offset:1024
 v_mfma_f32_16x16x32_bf16 v[152:155], a[136:139], v[40:43], v[152:155]
 buffer_load_dwordx4 v6, s[8:11], s0 offen offset:2048 lds
 v_mfma_f32_16x16x32_bf16 v[148:151], a[132:135], v[40:43], v[148:151]
 ds_read_b64_tr_b16 v[60:61], v23 offset:8192
 ds_read_b64_tr_b16 v[62:63], v23 offset:9216
 v_mfma_f32_16x16x32_bf16 v[148:151], a[148:151], v[44:47], v[148:151]
 v_mfma_f32_16x16x32_bf16 v[144:147], a[144:147], v[44:47], v[144:147]
 v_mfma_f32_16x16x32_bf16 v[144:147], a[128:131], v[40:43], v[144:147]
 s_waitcnt lgkmcnt(4)
 v_mfma_f32_16x16x32_bf16 v[160:163], a[128:131], v[48:51], v[160:163]
 v_mfma_f32_16x16x32_bf16 v[160:163], a[144:147], v[52:55], v[160:163]
 buffer_load_dwordx4 v7, s[8:11], s0 offen offset:3072 lds
 v_mfma_f32_16x16x32_bf16 v[164:167], a[148:151], v[52:55], v[164:167]
 v_mfma_f32_16x16x32_bf16 v[164:167], a[132:135], v[48:51], v[164:167]
 v_mfma_f32_16x16x32_bf16 v[168:171], a[136:139], v[48:51], v[168:171]
 v_mfma_f32_16x16x32_bf16 v[168:171], a[152:155], v[52:55], v[168:171]
 s_waitcnt vmcnt(10) lgkmcnt(0)
 s_barrier
 v_mfma_f32_16x16x32_bf16 v[172:175], a[156:159], v[52:55], v[172:175]
 ds_read_b64_tr_b16 v[32:33], v16 offset:0
 ds_read_b64_tr_b16 v[34:35], v16 offset:1024
 v_mfma_f32_16x16x32_bf16 v[172:175], a[140:143], v[48:51], v[172:175]
 ds_read_b64_tr_b16 v[36:37], v16 offset:8192
 ds_read_b64_tr_b16 v[38:39], v16 offset:9216
 v_mfma_f32_16x16x32_bf16 v[188:191], a[140:143], v[56:59], v[188:191]
 ds_read_b128 a[224:227], v12 offset:4096
 ds_read_b128 a[240:243], v13 offset:4096
 v_mfma_f32_16x16x32_bf16 v[188:191], a[156:159], v[60:63], v[188:191]
 ds_read_b128 a[228:231], v12 offset:5120
 ds_read_b128 a[244:247], v13 offset:5120
 s_add_u32 m0, s35, 12288
 s_bfe_u32 s0, s80, 0x4001c
 s_mul_i32 s0, s0, 128
 buffer_load_dwordx4 v0, s[4:7], s0 offen offset:0 lds
 v_mfma_f32_16x16x32_bf16 v[184:187], a[152:155], v[60:63], v[184:187]
 ds_read_b128 a[232:235], v12 offset:20480
 ds_read_b128 a[248:251], v13 offset:20480
 v_mfma_f32_16x16x32_bf16 v[184:187], a[136:139], v[56:59], v[184:187]
 ds_read_b128 a[236:239], v12 offset:21504
 ds_read_b128 a[252:255], v13 offset:21504
 v_mfma_f32_16x16x32_bf16 v[180:183], a[132:135], v[56:59], v[180:183]
 buffer_load_dwordx4 v1, s[4:7], s0 offen offset:1024 lds
 v_mfma_f32_16x16x32_bf16 v[180:183], a[148:151], v[60:63], v[180:183]
 buffer_load_dwordx4 v2, s[4:7], s0 offen offset:2048 lds
 v_mfma_f32_16x16x32_bf16 v[176:179], a[144:147], v[60:63], v[176:179]
 ds_read_b64_tr_b16 v[40:41], v17 offset:0
 ds_read_b64_tr_b16 v[42:43], v17 offset:1024
 v_mfma_f32_16x16x32_bf16 v[176:179], a[128:131], v[56:59], v[176:179]
 s_waitcnt lgkmcnt(6)
 v_mfma_f32_16x16x32_bf16 v[128:131], a[224:227], v[32:35], v[128:131]
 ds_read_b64_tr_b16 v[44:45], v17 offset:8192
 ds_read_b64_tr_b16 v[46:47], v17 offset:9216
 v_mfma_f32_16x16x32_bf16 v[128:131], a[240:243], v[36:39], v[128:131]
 buffer_load_dwordx4 v3, s[4:7], s0 offen offset:3072 lds
 v_mfma_f32_16x16x32_bf16 v[132:135], a[244:247], v[36:39], v[132:135]
 v_mfma_f32_16x16x32_bf16 v[132:135], a[228:231], v[32:35], v[132:135]
 s_waitcnt lgkmcnt(4)
 v_mfma_f32_16x16x32_bf16 v[136:139], a[232:235], v[32:35], v[136:139]
 ds_read_b64_tr_b16 v[48:49], v18 offset:0
 ds_read_b64_tr_b16 v[50:51], v18 offset:1024
 v_mfma_f32_16x16x32_bf16 v[136:139], a[248:251], v[36:39], v[136:139]
 s_add_u32 m0, s86, 32768
 s_bfe_u32 s0, s80, 0x4001c
 s_mul_i32 s0, s0, 245760
 buffer_load_dwordx4 v4, s[8:11], s0 offen offset:0 lds
 v_mfma_f32_16x16x32_bf16 v[140:143], a[252:255], v[36:39], v[140:143]
 ds_read_b64_tr_b16 v[52:53], v18 offset:8192
 ds_read_b64_tr_b16 v[54:55], v18 offset:9216
 v_mfma_f32_16x16x32_bf16 v[140:143], a[236:239], v[32:35], v[140:143]
 s_waitcnt lgkmcnt(4)
 v_mfma_f32_16x16x32_bf16 v[156:159], a[236:239], v[40:43], v[156:159]
 v_mfma_f32_16x16x32_bf16 v[156:159], a[252:255], v[44:47], v[156:159]
 buffer_load_dwordx4 v5, s[8:11], s0 offen offset:1024 lds
 v_mfma_f32_16x16x32_bf16 v[152:155], a[248:251], v[44:47], v[152:155]
 ds_read_b64_tr_b16 v[56:57], v19 offset:0
 ds_read_b64_tr_b16 v[58:59], v19 offset:1024
 v_mfma_f32_16x16x32_bf16 v[152:155], a[232:235], v[40:43], v[152:155]
 buffer_load_dwordx4 v6, s[8:11], s0 offen offset:2048 lds
 v_mfma_f32_16x16x32_bf16 v[148:151], a[228:231], v[40:43], v[148:151]
 ds_read_b64_tr_b16 v[60:61], v19 offset:8192
 ds_read_b64_tr_b16 v[62:63], v19 offset:9216
 v_mfma_f32_16x16x32_bf16 v[148:151], a[244:247], v[44:47], v[148:151]
 v_mfma_f32_16x16x32_bf16 v[144:147], a[240:243], v[44:47], v[144:147]
 v_mfma_f32_16x16x32_bf16 v[144:147], a[224:227], v[40:43], v[144:147]
 s_waitcnt lgkmcnt(4)
 v_mfma_f32_16x16x32_bf16 v[160:163], a[224:227], v[48:51], v[160:163]
 v_mfma_f32_16x16x32_bf16 v[160:163], a[240:243], v[52:55], v[160:163]
 buffer_load_dwordx4 v7, s[8:11], s0 offen offset:3072 lds
 v_mfma_f32_16x16x32_bf16 v[164:167], a[244:247], v[52:55], v[164:167]
 v_mfma_f32_16x16x32_bf16 v[164:167], a[228:231], v[48:51], v[164:167]
 v_mfma_f32_16x16x32_bf16 v[168:171], a[232:235], v[48:51], v[168:171]
 v_mfma_f32_16x16x32_bf16 v[168:171], a[248:251], v[52:55], v[168:171]
 s_waitcnt vmcnt(15)
 v_readfirstlane_b32 s90, v252
 v_readfirstlane_b32 s91, v253
 s_cmp_eq_u32 s90, 0
 s_cbranch_scc1 L_nonce_5
L_nonce_ok_6:
 s_waitcnt vmcnt(8) lgkmcnt(0)
 s_barrier
 v_mfma_f32_16x16x32_bf16 v[172:175], a[252:255], v[52:55], v[172:175]
 ds_read_b64_tr_b16 v[32:33], v16 offset:16384
 ds_read_b64_tr_b16 v[34:35], v16 offset:17408
 v_mfma_f32_16x16x32_bf16 v[172:175], a[236:239], v[48:51], v[172:175]
 ds_read_b64_tr_b16 v[36:37], v16 offset:24576
 ds_read_b64_tr_b16 v[38:39], v16 offset:25600
 v_mfma_f32_16x16x32_bf16 v[188:191], a[236:239], v[56:59], v[188:191]
 ds_read_b128 a[160:163], v12 offset:8192
 ds_read_b128 a[176:179], v13 offset:8192
 v_mfma_f32_16x16x32_bf16 v[188:191], a[252:255], v[60:63], v[188:191]
 ds_read_b128 a[164:167], v12 offset:9216
 ds_read_b128 a[180:183], v13 offset:9216
 s_add_u32 m0, s35, 0
 s_bfe_u32 s0, s81, 0x40000
 s_mul_i32 s0, s0, 128
 buffer_load_dwordx4 v0, s[4:7], s0 offen offset:0 lds
 v_mfma_f32_16x16x32_bf16 v[184:187], a[248:251], v[60:63], v[184:187]
 ds_read_b128 a[168:171], v12 offset:24576
 ds_read_b128 a[184:187], v13 offset:24576
 s_mov_b64 exec, 1
 buffer_store_dwordx2 v[252:253], v237, s[16:19], s56 offen offset:0 sc1
 s_mov_b64 exec, -1
 v_mfma_f32_16x16x32_bf16 v[184:187], a[232:235], v[56:59], v[184:187]
 ds_read_b128 a[172:175], v12 offset:25600
 ds_read_b128 a[188:191], v13 offset:25600
 v_mfma_f32_16x16x32_bf16 v[180:183], a[228:231], v[56:59], v[180:183]
 buffer_load_dwordx4 v1, s[4:7], s0 offen offset:1024 lds
 v_mfma_f32_16x16x32_bf16 v[180:183], a[244:247], v[60:63], v[180:183]
 buffer_load_dwordx4 v2, s[4:7], s0 offen offset:2048 lds
 v_mfma_f32_16x16x32_bf16 v[176:179], a[240:243], v[60:63], v[176:179]
 ds_read_b64_tr_b16 v[40:41], v17 offset:16384
 ds_read_b64_tr_b16 v[42:43], v17 offset:17408
 v_mfma_f32_16x16x32_bf16 v[176:179], a[224:227], v[56:59], v[176:179]
 s_waitcnt lgkmcnt(6)
 v_mfma_f32_16x16x32_bf16 v[128:131], a[160:163], v[32:35], v[128:131]
 ds_read_b64_tr_b16 v[44:45], v17 offset:24576
 ds_read_b64_tr_b16 v[46:47], v17 offset:25600
 v_mfma_f32_16x16x32_bf16 v[128:131], a[176:179], v[36:39], v[128:131]
 buffer_load_dwordx4 v3, s[4:7], s0 offen offset:3072 lds
 v_mfma_f32_16x16x32_bf16 v[132:135], a[180:183], v[36:39], v[132:135]
 v_mfma_f32_16x16x32_bf16 v[132:135], a[164:167], v[32:35], v[132:135]
 s_waitcnt lgkmcnt(4)
 v_mfma_f32_16x16x32_bf16 v[136:139], a[168:171], v[32:35], v[136:139]
 ds_read_b64_tr_b16 v[48:49], v18 offset:16384
 ds_read_b64_tr_b16 v[50:51], v18 offset:17408
 v_mfma_f32_16x16x32_bf16 v[136:139], a[184:187], v[36:39], v[136:139]
 s_add_u32 m0, s86, 49152
 s_bfe_u32 s0, s81, 0x40000
 s_mul_i32 s0, s0, 245760
 buffer_load_dwordx4 v4, s[8:11], s0 offen offset:0 lds
 v_mfma_f32_16x16x32_bf16 v[140:143], a[188:191], v[36:39], v[140:143]
 ds_read_b64_tr_b16 v[52:53], v18 offset:24576
 ds_read_b64_tr_b16 v[54:55], v18 offset:25600
 v_mfma_f32_16x16x32_bf16 v[140:143], a[172:175], v[32:35], v[140:143]
 s_waitcnt lgkmcnt(4)
 v_mfma_f32_16x16x32_bf16 v[156:159], a[172:175], v[40:43], v[156:159]
 v_mfma_f32_16x16x32_bf16 v[156:159], a[188:191], v[44:47], v[156:159]
 buffer_load_dwordx4 v5, s[8:11], s0 offen offset:1024 lds
 v_mfma_f32_16x16x32_bf16 v[152:155], a[184:187], v[44:47], v[152:155]
 ds_read_b64_tr_b16 v[56:57], v19 offset:16384
 ds_read_b64_tr_b16 v[58:59], v19 offset:17408
 v_mfma_f32_16x16x32_bf16 v[152:155], a[168:171], v[40:43], v[152:155]
 buffer_load_dwordx4 v6, s[8:11], s0 offen offset:2048 lds
 v_mfma_f32_16x16x32_bf16 v[148:151], a[164:167], v[40:43], v[148:151]
 ds_read_b64_tr_b16 v[60:61], v19 offset:24576
 ds_read_b64_tr_b16 v[62:63], v19 offset:25600
 v_mfma_f32_16x16x32_bf16 v[148:151], a[180:183], v[44:47], v[148:151]
 v_mfma_f32_16x16x32_bf16 v[144:147], a[176:179], v[44:47], v[144:147]
 v_mfma_f32_16x16x32_bf16 v[144:147], a[160:163], v[40:43], v[144:147]
 s_waitcnt lgkmcnt(4)
 v_mfma_f32_16x16x32_bf16 v[160:163], a[160:163], v[48:51], v[160:163]
 v_mfma_f32_16x16x32_bf16 v[160:163], a[176:179], v[52:55], v[160:163]
 buffer_load_dwordx4 v7, s[8:11], s0 offen offset:3072 lds
 v_mfma_f32_16x16x32_bf16 v[164:167], a[180:183], v[52:55], v[164:167]
 v_mfma_f32_16x16x32_bf16 v[164:167], a[164:167], v[48:51], v[164:167]
 v_mfma_f32_16x16x32_bf16 v[168:171], a[168:171], v[48:51], v[168:171]
 v_mfma_f32_16x16x32_bf16 v[168:171], a[184:187], v[52:55], v[168:171]
 s_waitcnt vmcnt(9) lgkmcnt(0)
 s_barrier
 v_mfma_f32_16x16x32_bf16 v[172:175], a[188:191], v[52:55], v[172:175]
 ds_read_b64_tr_b16 v[32:33], v16 offset:32768
 ds_read_b64_tr_b16 v[34:35], v16 offset:33792
 v_mfma_f32_16x16x32_bf16 v[172:175], a[172:175], v[48:51], v[172:175]
 ds_read_b64_tr_b16 v[36:37], v16 offset:40960
 ds_read_b64_tr_b16 v[38:39], v16 offset:41984
 v_mfma_f32_16x16x32_bf16 v[188:191], a[172:175], v[56:59], v[188:191]
 ds_read_b128 a[224:227], v12 offset:12288
 ds_read_b128 a[240:243], v13 offset:12288
 v_mfma_f32_16x16x32_bf16 v[188:191], a[188:191], v[60:63], v[188:191]
 ds_read_b128 a[228:231], v12 offset:13312
 ds_read_b128 a[244:247], v13 offset:13312
 s_add_u32 m0, s35, 8192
 s_bfe_u32 s0, s81, 0x40004
 s_mul_i32 s0, s0, 128
 buffer_load_dwordx4 v0, s[4:7], s0 offen offset:0 lds
 v_mfma_f32_16x16x32_bf16 v[184:187], a[184:187], v[60:63], v[184:187]
 ds_read_b128 a[232:235], v12 offset:28672
 ds_read_b128 a[248:251], v13 offset:28672
 v_mfma_f32_16x16x32_bf16 v[184:187], a[168:171], v[56:59], v[184:187]
 ds_read_b128 a[236:239], v12 offset:29696
 ds_read_b128 a[252:255], v13 offset:29696
 v_mfma_f32_16x16x32_bf16 v[180:183], a[164:167], v[56:59], v[180:183]
 buffer_load_dwordx4 v1, s[4:7], s0 offen offset:1024 lds
 v_mfma_f32_16x16x32_bf16 v[180:183], a[180:183], v[60:63], v[180:183]
 buffer_load_dwordx4 v2, s[4:7], s0 offen offset:2048 lds
 v_mfma_f32_16x16x32_bf16 v[176:179], a[176:179], v[60:63], v[176:179]
 ds_read_b64_tr_b16 v[40:41], v17 offset:32768
 ds_read_b64_tr_b16 v[42:43], v17 offset:33792
 v_mfma_f32_16x16x32_bf16 v[176:179], a[160:163], v[56:59], v[176:179]
 s_waitcnt lgkmcnt(6)
 v_mfma_f32_16x16x32_bf16 v[128:131], a[224:227], v[32:35], v[128:131]
 ds_read_b64_tr_b16 v[44:45], v17 offset:40960
 ds_read_b64_tr_b16 v[46:47], v17 offset:41984
 v_mfma_f32_16x16x32_bf16 v[128:131], a[240:243], v[36:39], v[128:131]
 buffer_load_dwordx4 v3, s[4:7], s0 offen offset:3072 lds
 v_mfma_f32_16x16x32_bf16 v[132:135], a[244:247], v[36:39], v[132:135]
 v_mfma_f32_16x16x32_bf16 v[132:135], a[228:231], v[32:35], v[132:135]
 s_waitcnt lgkmcnt(4)
 v_mfma_f32_16x16x32_bf16 v[136:139], a[232:235], v[32:35], v[136:139]
 ds_read_b64_tr_b16 v[48:49], v18 offset:32768
 ds_read_b64_tr_b16 v[50:51], v18 offset:33792
 v_mfma_f32_16x16x32_bf16 v[136:139], a[248:251], v[36:39], v[136:139]
 s_add_u32 m0, s86, 65536
 s_bfe_u32 s0, s81, 0x40004
 s_mul_i32 s0, s0, 245760
 buffer_load_dwordx4 v4, s[8:11], s0 offen offset:0 lds
 v_mfma_f32_16x16x32_bf16 v[140:143], a[252:255], v[36:39], v[140:143]
 ds_read_b64_tr_b16 v[52:53], v18 offset:40960
 ds_read_b64_tr_b16 v[54:55], v18 offset:41984
 v_mfma_f32_16x16x32_bf16 v[140:143], a[236:239], v[32:35], v[140:143]
 s_waitcnt lgkmcnt(4)
 v_mfma_f32_16x16x32_bf16 v[156:159], a[236:239], v[40:43], v[156:159]
 v_mfma_f32_16x16x32_bf16 v[156:159], a[252:255], v[44:47], v[156:159]
 buffer_load_dwordx4 v5, s[8:11], s0 offen offset:1024 lds
 v_mfma_f32_16x16x32_bf16 v[152:155], a[248:251], v[44:47], v[152:155]
 ds_read_b64_tr_b16 v[56:57], v19 offset:32768
 ds_read_b64_tr_b16 v[58:59], v19 offset:33792
 v_mfma_f32_16x16x32_bf16 v[152:155], a[232:235], v[40:43], v[152:155]
 buffer_load_dwordx4 v6, s[8:11], s0 offen offset:2048 lds
 v_mfma_f32_16x16x32_bf16 v[148:151], a[228:231], v[40:43], v[148:151]
 ds_read_b64_tr_b16 v[60:61], v19 offset:40960
 ds_read_b64_tr_b16 v[62:63], v19 offset:41984
 v_mfma_f32_16x16x32_bf16 v[148:151], a[244:247], v[44:47], v[148:151]
 v_mfma_f32_16x16x32_bf16 v[144:147], a[240:243], v[44:47], v[144:147]
 v_mfma_f32_16x16x32_bf16 v[144:147], a[224:227], v[40:43], v[144:147]
 s_waitcnt lgkmcnt(4)
 v_mfma_f32_16x16x32_bf16 v[160:163], a[224:227], v[48:51], v[160:163]
 v_mfma_f32_16x16x32_bf16 v[160:163], a[240:243], v[52:55], v[160:163]
 buffer_load_dwordx4 v7, s[8:11], s0 offen offset:3072 lds
 v_mfma_f32_16x16x32_bf16 v[164:167], a[244:247], v[52:55], v[164:167]
 v_mfma_f32_16x16x32_bf16 v[164:167], a[228:231], v[48:51], v[164:167]
 s_mov_b64 s[28:29], s[38:39]
 s_cmp_eq_u32 s100, 14
 s_cselect_b32 s30, 1280, 0
 s_lshr_b32 s45, s86, 1
 s_add_u32 m0, s45, 155648
 s_nop 0
 buffer_load_dwordx4 v254, s[28:31], 0 offen offset:0 lds
 buffer_load_dwordx4 v254, s[28:31], 0 offen offset:1024 lds
 v_mfma_f32_16x16x32_bf16 v[168:171], a[232:235], v[48:51], v[168:171]
 v_mfma_f32_16x16x32_bf16 v[168:171], a[248:251], v[52:55], v[168:171]
 s_waitcnt vmcnt(10) lgkmcnt(0)
 s_barrier
 v_mfma_f32_16x16x32_bf16 v[172:175], a[252:255], v[52:55], v[172:175]
 ds_read_b64_tr_b16 v[32:33], v16 offset:49152
 ds_read_b64_tr_b16 v[34:35], v16 offset:50176
 v_mfma_f32_16x16x32_bf16 v[172:175], a[236:239], v[48:51], v[172:175]
 ds_read_b64_tr_b16 v[36:37], v16 offset:57344
 ds_read_b64_tr_b16 v[38:39], v16 offset:58368
 v_mfma_f32_16x16x32_bf16 v[188:191], a[236:239], v[56:59], v[188:191]
 ds_read_b128 a[192:195], v12 offset:0
 ds_read_b128 a[208:211], v13 offset:0
 v_mfma_f32_16x16x32_bf16 v[188:191], a[252:255], v[60:63], v[188:191]
 ds_read_b128 a[196:199], v12 offset:1024
 ds_read_b128 a[212:215], v13 offset:1024
 s_add_u32 m0, s86, 0
 s_bfe_u32 s0, s81, 0x40004
 s_mul_i32 s0, s0, 221184
 buffer_load_dwordx4 v8, s[12:15], s0 offen offset:0 lds
 v_mfma_f32_16x16x32_bf16 v[184:187], a[248:251], v[60:63], v[184:187]
 ds_read_b128 a[200:203], v12 offset:16384
 ds_read_b128 a[216:219], v13 offset:16384
 v_mfma_f32_16x16x32_bf16 v[184:187], a[232:235], v[56:59], v[184:187]
 ds_read_b128 a[204:207], v12 offset:17408
 ds_read_b128 a[220:223], v13 offset:17408
 v_mfma_f32_16x16x32_bf16 v[180:183], a[228:231], v[56:59], v[180:183]
 v_mfma_f32_16x16x32_bf16 v[180:183], a[244:247], v[60:63], v[180:183]
 buffer_load_dwordx4 v9, s[12:15], s0 offen offset:1024 lds
 v_mfma_f32_16x16x32_bf16 v[176:179], a[240:243], v[60:63], v[176:179]
 ds_read_b64_tr_b16 v[40:41], v17 offset:49152
 ds_read_b64_tr_b16 v[42:43], v17 offset:50176
 v_mfma_f32_16x16x32_bf16 v[176:179], a[224:227], v[56:59], v[176:179]
 s_waitcnt lgkmcnt(6)
 v_mfma_f32_16x16x32_bf16 v[128:131], a[192:195], v[32:35], v[128:131]
 ds_read_b64_tr_b16 v[44:45], v17 offset:57344
 ds_read_b64_tr_b16 v[46:47], v17 offset:58368
 v_mfma_f32_16x16x32_bf16 v[128:131], a[208:211], v[36:39], v[128:131]
 v_mfma_f32_16x16x32_bf16 v[132:135], a[212:215], v[36:39], v[132:135]
 v_mfma_f32_16x16x32_bf16 v[132:135], a[196:199], v[32:35], v[132:135]
 s_waitcnt lgkmcnt(4)
 v_mfma_f32_16x16x32_bf16 v[136:139], a[200:203], v[32:35], v[136:139]
 ds_read_b64_tr_b16 v[48:49], v18 offset:49152
 ds_read_b64_tr_b16 v[50:51], v18 offset:50176
 v_mfma_f32_16x16x32_bf16 v[136:139], a[216:219], v[36:39], v[136:139]
 buffer_load_dwordx4 v10, s[12:15], s0 offen offset:2048 lds
 v_mfma_f32_16x16x32_bf16 v[140:143], a[220:223], v[36:39], v[140:143]
 ds_read_b64_tr_b16 v[52:53], v18 offset:57344
 ds_read_b64_tr_b16 v[54:55], v18 offset:58368
 v_mfma_f32_16x16x32_bf16 v[140:143], a[204:207], v[32:35], v[140:143]
 s_waitcnt lgkmcnt(4)
 v_mfma_f32_16x16x32_bf16 v[156:159], a[204:207], v[40:43], v[156:159]
 v_mfma_f32_16x16x32_bf16 v[156:159], a[220:223], v[44:47], v[156:159]
 v_mfma_f32_16x16x32_bf16 v[152:155], a[216:219], v[44:47], v[152:155]
 ds_read_b64_tr_b16 v[56:57], v19 offset:49152
 ds_read_b64_tr_b16 v[58:59], v19 offset:50176
 v_mfma_f32_16x16x32_bf16 v[152:155], a[200:203], v[40:43], v[152:155]
 buffer_load_dwordx4 v11, s[12:15], s0 offen offset:3072 lds
 v_mfma_f32_16x16x32_bf16 v[148:151], a[196:199], v[40:43], v[148:151]
 ds_read_b64_tr_b16 v[60:61], v19 offset:57344
 ds_read_b64_tr_b16 v[62:63], v19 offset:58368
 v_mfma_f32_16x16x32_bf16 v[148:151], a[212:215], v[44:47], v[148:151]
 v_mfma_f32_16x16x32_bf16 v[144:147], a[208:211], v[44:47], v[144:147]
 v_mfma_f32_16x16x32_bf16 v[144:147], a[192:195], v[40:43], v[144:147]
 s_waitcnt lgkmcnt(4)
 v_mfma_f32_16x16x32_bf16 v[160:163], a[192:195], v[48:51], v[160:163]
 v_mfma_f32_16x16x32_bf16 v[160:163], a[208:211], v[52:55], v[160:163]
 s_add_u32 m0, s86, 16384
 s_bfe_u32 s0, s80, 0x40000
 s_mul_i32 s0, s0, 221184
 buffer_load_dwordx4 v8, s[12:15], s0 offen offset:0 lds
 v_mfma_f32_16x16x32_bf16 v[164:167], a[212:215], v[52:55], v[164:167]
 v_mfma_f32_16x16x32_bf16 v[164:167], a[196:199], v[48:51], v[164:167]
 v_mfma_f32_16x16x32_bf16 v[168:171], a[200:203], v[48:51], v[168:171]
 v_mfma_f32_16x16x32_bf16 v[168:171], a[216:219], v[52:55], v[168:171]
 s_waitcnt vmcnt(7) lgkmcnt(0)
 s_barrier
 v_mfma_f32_16x16x32_bf16 v[172:175], a[220:223], v[52:55], v[172:175]
 ds_read_b64_tr_b16 v[32:33], v20 offset:0
 ds_read_b64_tr_b16 v[34:35], v20 offset:1024
 v_mfma_f32_16x16x32_bf16 v[172:175], a[204:207], v[48:51], v[172:175]
 ds_read_b64_tr_b16 v[36:37], v20 offset:8192
 ds_read_b64_tr_b16 v[38:39], v20 offset:9216
 v_mfma_f32_16x16x32_bf16 v[188:191], a[204:207], v[56:59], v[188:191]
 ds_read_b128 a[224:227], v12 offset:8192
 ds_read_b128 a[240:243], v13 offset:8192
 v_mfma_f32_16x16x32_bf16 v[188:191], a[220:223], v[60:63], v[188:191]
 ds_read_b128 a[228:231], v12 offset:9216
 ds_read_b128 a[244:247], v13 offset:9216
 v_mfma_f32_16x16x32_bf16 v[184:187], a[216:219], v[60:63], v[184:187]
 ds_read_b128 a[232:235], v12 offset:24576
 ds_read_b128 a[248:251], v13 offset:24576
 v_mfma_f32_16x16x32_bf16 v[184:187], a[200:203], v[56:59], v[184:187]
 ds_read_b128 a[236:239], v12 offset:25600
 ds_read_b128 a[252:255], v13 offset:25600
 v_mfma_f32_16x16x32_bf16 v[180:183], a[196:199], v[56:59], v[180:183]
 v_mfma_f32_16x16x32_bf16 v[180:183], a[212:215], v[60:63], v[180:183]
 buffer_load_dwordx4 v9, s[12:15], s0 offen offset:1024 lds
 v_mfma_f32_16x16x32_bf16 v[176:179], a[208:211], v[60:63], v[176:179]
 ds_read_b64_tr_b16 v[40:41], v21 offset:0
 ds_read_b64_tr_b16 v[42:43], v21 offset:1024
 v_mfma_f32_16x16x32_bf16 v[176:179], a[192:195], v[56:59], v[176:179]
 s_waitcnt lgkmcnt(6)
 v_mfma_f32_16x16x32_bf16 v[128:131], a[224:227], v[32:35], v[128:131]
 ds_read_b64_tr_b16 v[44:45], v21 offset:8192
 ds_read_b64_tr_b16 v[46:47], v21 offset:9216
 v_mfma_f32_16x16x32_bf16 v[128:131], a[240:243], v[36:39], v[128:131]
 buffer_load_dwordx4 v10, s[12:15], s0 offen offset:2048 lds
 v_mfma_f32_16x16x32_bf16 v[132:135], a[244:247], v[36:39], v[132:135]
 v_mfma_f32_16x16x32_bf16 v[132:135], a[228:231], v[32:35], v[132:135]
 s_waitcnt lgkmcnt(4)
 v_mfma_f32_16x16x32_bf16 v[136:139], a[232:235], v[32:35], v[136:139]
 ds_read_b64_tr_b16 v[48:49], v22 offset:0
 ds_read_b64_tr_b16 v[50:51], v22 offset:1024
 v_mfma_f32_16x16x32_bf16 v[136:139], a[248:251], v[36:39], v[136:139]
 buffer_load_dwordx4 v11, s[12:15], s0 offen offset:3072 lds
 v_mfma_f32_16x16x32_bf16 v[140:143], a[252:255], v[36:39], v[140:143]
 ds_read_b64_tr_b16 v[52:53], v22 offset:8192
 ds_read_b64_tr_b16 v[54:55], v22 offset:9216
 v_mfma_f32_16x16x32_bf16 v[140:143], a[236:239], v[32:35], v[140:143]
 s_waitcnt lgkmcnt(4)
 v_mfma_f32_16x16x32_bf16 v[156:159], a[236:239], v[40:43], v[156:159]
 v_mfma_f32_16x16x32_bf16 v[156:159], a[252:255], v[44:47], v[156:159]
 s_add_u32 m0, s86, 32768
 s_bfe_u32 s0, s80, 0x40004
 s_mul_i32 s0, s0, 221184
 buffer_load_dwordx4 v8, s[12:15], s0 offen offset:0 lds
 v_mfma_f32_16x16x32_bf16 v[152:155], a[248:251], v[44:47], v[152:155]
 ds_read_b64_tr_b16 v[56:57], v23 offset:0
 ds_read_b64_tr_b16 v[58:59], v23 offset:1024
 v_mfma_f32_16x16x32_bf16 v[152:155], a[232:235], v[40:43], v[152:155]
 buffer_load_dwordx4 v9, s[12:15], s0 offen offset:1024 lds
 v_mfma_f32_16x16x32_bf16 v[148:151], a[228:231], v[40:43], v[148:151]
 ds_read_b64_tr_b16 v[60:61], v23 offset:8192
 ds_read_b64_tr_b16 v[62:63], v23 offset:9216
 v_mfma_f32_16x16x32_bf16 v[148:151], a[244:247], v[44:47], v[148:151]
 v_mfma_f32_16x16x32_bf16 v[144:147], a[240:243], v[44:47], v[144:147]
 v_mfma_f32_16x16x32_bf16 v[144:147], a[224:227], v[40:43], v[144:147]
 s_waitcnt lgkmcnt(4)
 v_mfma_f32_16x16x32_bf16 v[160:163], a[224:227], v[48:51], v[160:163]
 v_mfma_f32_16x16x32_bf16 v[160:163], a[240:243], v[52:55], v[160:163]
 buffer_load_dwordx4 v10, s[12:15], s0 offen offset:2048 lds
 v_mfma_f32_16x16x32_bf16 v[164:167], a[244:247], v[52:55], v[164:167]
 v_mfma_f32_16x16x32_bf16 v[164:167], a[228:231], v[48:51], v[164:167]
 buffer_load_dwordx4 v11, s[12:15], s0 offen offset:3072 lds
 v_mfma_f32_16x16x32_bf16 v[168:171], a[232:235], v[48:51], v[168:171]
 v_mfma_f32_16x16x32_bf16 v[168:171], a[248:251], v[52:55], v[168:171]
 s_waitcnt vmcnt(8) lgkmcnt(0)
 s_barrier
 v_mfma_f32_16x16x32_bf16 v[172:175], a[252:255], v[52:55], v[172:175]
 ds_read_b64_tr_b16 v[32:33], v16 offset:0
 ds_read_b64_tr_b16 v[34:35], v16 offset:1024
 v_mfma_f32_16x16x32_bf16 v[172:175], a[236:239], v[48:51], v[172:175]
 ds_read_b64_tr_b16 v[36:37], v16 offset:8192
 ds_read_b64_tr_b16 v[38:39], v16 offset:9216
 v_mfma_f32_16x16x32_bf16 v[188:191], a[236:239], v[56:59], v[188:191]
 v_mfma_f32_16x16x32_bf16 v[188:191], a[252:255], v[60:63], v[188:191]
 s_add_u32 m0, s86, 49152
 s_bfe_u32 s0, s80, 0x40014
 s_mul_i32 s0, s0, 221184
 buffer_load_dwordx4 v8, s[12:15], s0 offen offset:0 lds
 v_mfma_f32_16x16x32_bf16 v[184:187], a[248:251], v[60:63], v[184:187]
 v_mfma_f32_16x16x32_bf16 v[184:187], a[232:235], v[56:59], v[184:187]
 v_mfma_f32_16x16x32_bf16 v[180:183], a[228:231], v[56:59], v[180:183]
 v_mfma_f32_16x16x32_bf16 v[180:183], a[244:247], v[60:63], v[180:183]
 buffer_load_dwordx4 v9, s[12:15], s0 offen offset:1024 lds
 v_mfma_f32_16x16x32_bf16 v[176:179], a[240:243], v[60:63], v[176:179]
 ds_read_b64_tr_b16 v[40:41], v17 offset:0
 ds_read_b64_tr_b16 v[42:43], v17 offset:1024
 v_mfma_f32_16x16x32_bf16 v[176:179], a[224:227], v[56:59], v[176:179]
L_p2:
 s_cmp_eq_u32 s100, 14
 s_cbranch_scc1 L_gate
 s_waitcnt lgkmcnt(2)
 v_mfma_f32_16x16x32_bf16 v[64:67], v[32:35], a[224:227], 0
 ds_read_b64_tr_b16 v[44:45], v17 offset:8192
 ds_read_b64_tr_b16 v[46:47], v17 offset:9216
 v_mfma_f32_16x16x32_bf16 v[64:67], v[36:39], a[240:243], v[64:67]
 buffer_load_dwordx4 v10, s[12:15], s0 offen offset:2048 lds
 v_mul_f32 v128, s52, v128
 v_mfma_f32_16x16x32_bf16 v[80:83], v[36:39], a[244:247], 0
 v_mul_f32 v129, s52, v129
 v_mul_f32 v130, s52, v130
 v_mul_f32 v131, s52, v131
 v_mfma_f32_16x16x32_bf16 v[80:83], v[32:35], a[228:231], v[80:83]
 v_mul_f32 v132, s52, v132
 v_mul_f32 v133, s52, v133
 v_mfma_f32_16x16x32_bf16 v[72:75], v[32:35], a[232:235], 0
 ds_read_b64_tr_b16 v[48:49], v18 offset:0
 ds_read_b64_tr_b16 v[50:51], v18 offset:1024
 v_mul_f32 v134, s52, v134
 v_mfma_f32_16x16x32_bf16 v[72:75], v[36:39], a[248:251], v[72:75]
 buffer_load_dwordx4 v11, s[12:15], s0 offen offset:3072 lds
 v_mul_f32 v135, s52, v135
 v_mfma_f32_16x16x32_bf16 v[88:91], v[36:39], a[252:255], 0
 ds_read_b64_tr_b16 v[52:53], v18 offset:8192
 ds_read_b64_tr_b16 v[54:55], v18 offset:9216
 v_cvt_pk_bf16_f32 v128, v128, v129
 v_mfma_f32_16x16x32_bf16 v[88:91], v[32:35], a[236:239], v[88:91]
 v_cvt_pk_bf16_f32 v129, v130, v131
 s_waitcnt lgkmcnt(4)
 v_mfma_f32_16x16x32_bf16 v[92:95], v[40:43], a[236:239], 0
 v_cvt_pk_bf16_f32 v130, v132, v133
 v_cvt_pk_bf16_f32 v131, v134, v135
 v_mfma_f32_16x16x32_bf16 v[92:95], v[44:47], a[252:255], v[92:95]
 buffer_store_dwordx4 v[128:131], v24, s[16:19], s48 offen sc1
 v_mul_f32 v136, s52, v136
 v_mfma_f32_16x16x32_bf16 v[76:79], v[44:47], a[248:251], 0
 ds_read_b64_tr_b16 v[56:57], v19 offset:0
 ds_read_b64_tr_b16 v[58:59], v19 offset:1024
 v_mul_f32 v137, s52, v137
 v_mfma_f32_16x16x32_bf16 v[76:79], v[40:43], a[232:235], v[76:79]
 v_mul_f32 v138, s52, v138
 v_mul_f32 v139, s52, v139
 v_mul_f32 v140, s52, v140
 v_mfma_f32_16x16x32_bf16 v[84:87], v[40:43], a[228:231], 0
 ds_read_b64_tr_b16 v[60:61], v19 offset:8192
 ds_read_b64_tr_b16 v[62:63], v19 offset:9216
 v_mfma_f32_16x16x32_bf16 v[84:87], v[44:47], a[244:247], v[84:87]
 v_mul_f32 v141, s52, v141
 v_mul_f32 v142, s52, v142
 v_mfma_f32_16x16x32_bf16 v[68:71], v[44:47], a[240:243], 0
 v_mul_f32 v143, s52, v143
 v_cvt_pk_bf16_f32 v136, v136, v137
 v_mfma_f32_16x16x32_bf16 v[68:71], v[40:43], a[224:227], v[68:71]
 v_cvt_pk_bf16_f32 v137, v138, v139
 s_waitcnt lgkmcnt(4)
 v_mfma_f32_16x16x32_bf16 v[96:99], v[48:51], a[224:227], 0
 v_cvt_pk_bf16_f32 v138, v140, v141
 v_cvt_pk_bf16_f32 v139, v142, v143
 v_mfma_f32_16x16x32_bf16 v[96:99], v[52:55], a[240:243], v[96:99]
 buffer_store_dwordx4 v[136:139], v24, s[16:19], s49 offen sc1
 v_mul_f32 v144, s52, v144
 v_mfma_f32_16x16x32_bf16 v[112:115], v[52:55], a[244:247], 0
 v_mul_f32 v145, s52, v145
 v_mul_f32 v146, s52, v146
 v_mul_f32 v147, s52, v147
 v_mfma_f32_16x16x32_bf16 v[112:115], v[48:51], a[228:231], v[112:115]
 v_mul_f32 v148, s52, v148
 v_mul_f32 v149, s52, v149
 v_mul_f32 v150, s52, v150
 v_mfma_f32_16x16x32_bf16 v[104:107], v[48:51], a[232:235], 0
 v_mul_f32 v151, s52, v151
 v_cvt_pk_bf16_f32 v144, v144, v145
 v_cvt_pk_bf16_f32 v145, v146, v147
 v_mfma_f32_16x16x32_bf16 v[104:107], v[52:55], a[248:251], v[104:107]
 s_waitcnt vmcnt(10) lgkmcnt(0)
 s_barrier
 v_mfma_f32_16x16x32_bf16 v[120:123], v[52:55], a[252:255], 0
 ds_read_b64_tr_b16 v[32:33], v16 offset:16384
 ds_read_b64_tr_b16 v[34:35], v16 offset:17408
 v_mfma_f32_16x16x32_bf16 v[120:123], v[48:51], a[236:239], v[120:123]
 ds_read_b64_tr_b16 v[36:37], v16 offset:24576
 ds_read_b64_tr_b16 v[38:39], v16 offset:25600
 v_mfma_f32_16x16x32_bf16 v[124:127], v[56:59], a[236:239], 0
 v_cvt_pk_bf16_f32 v146, v148, v149
 v_cvt_pk_bf16_f32 v147, v150, v151
 v_mfma_f32_16x16x32_bf16 v[124:127], v[60:63], a[252:255], v[124:127]
 buffer_store_dwordx4 v[144:147], v25, s[16:19], s48 offen sc1
 v_mul_f32 v152, s52, v152
 v_mfma_f32_16x16x32_bf16 v[108:111], v[60:63], a[248:251], 0
 v_mul_f32 v153, s52, v153
 v_mul_f32 v154, s52, v154
 v_mul_f32 v155, s52, v155
 v_mfma_f32_16x16x32_bf16 v[108:111], v[56:59], a[232:235], v[108:111]
 v_mul_f32 v156, s52, v156
 v_mul_f32 v157, s52, v157
 v_mul_f32 v158, s52, v158
 v_mfma_f32_16x16x32_bf16 v[116:119], v[56:59], a[228:231], 0
 v_mul_f32 v159, s52, v159
 v_cvt_pk_bf16_f32 v152, v152, v153
 v_mfma_f32_16x16x32_bf16 v[116:119], v[60:63], a[244:247], v[116:119]
 v_cvt_pk_bf16_f32 v153, v154, v155
 v_cvt_pk_bf16_f32 v154, v156, v157
 v_mfma_f32_16x16x32_bf16 v[100:103], v[60:63], a[240:243], 0
 ds_read_b64_tr_b16 v[40:41], v17 offset:16384
 ds_read_b64_tr_b16 v[42:43], v17 offset:17408
 v_mfma_f32_16x16x32_bf16 v[100:103], v[56:59], a[224:227], v[100:103]
 v_cvt_pk_bf16_f32 v155, v158, v159
 s_waitcnt lgkmcnt(2)
 v_mfma_f32_16x16x32_bf16 v[64:67], v[32:35], a[0:3], v[64:67]
 ds_read_b64_tr_b16 v[44:45], v17 offset:24576
 ds_read_b64_tr_b16 v[46:47], v17 offset:25600
 v_mfma_f32_16x16x32_bf16 v[64:67], v[36:39], a[16:19], v[64:67]
 buffer_store_dwordx4 v[152:155], v25, s[16:19], s49 offen sc1
 v_mul_f32 v160, s52, v160
 v_mfma_f32_16x16x32_bf16 v[80:83], v[36:39], a[20:23], v[80:83]
 v_mul_f32 v161, s52, v161
 v_mul_f32 v162, s52, v162
 v_mul_f32 v163, s52, v163
 v_mfma_f32_16x16x32_bf16 v[80:83], v[32:35], a[4:7], v[80:83]
 v_mul_f32 v164, s52, v164
 v_mul_f32 v165, s52, v165
 v_mfma_f32_16x16x32_bf16 v[72:75], v[32:35], a[8:11], v[72:75]
 ds_read_b64_tr_b16 v[48:49], v18 offset:16384
 ds_read_b64_tr_b16 v[50:51], v18 offset:17408
 v_mul_f32 v166, s52, v166
 v_mfma_f32_16x16x32_bf16 v[72:75], v[36:39], a[24:27], v[72:75]
 v_mul_f32 v167, s52, v167
 v_cvt_pk_bf16_f32 v160, v160, v161
 v_mfma_f32_16x16x32_bf16 v[88:91], v[36:39], a[28:31], v[88:91]
 ds_read_b64_tr_b16 v[52:53], v18 offset:24576
 ds_read_b64_tr_b16 v[54:55], v18 offset:25600
 v_mfma_f32_16x16x32_bf16 v[88:91], v[32:35], a[12:15], v[88:91]
 v_cvt_pk_bf16_f32 v161, v162, v163
 s_waitcnt lgkmcnt(4)
 v_mfma_f32_16x16x32_bf16 v[92:95], v[40:43], a[12:15], v[92:95]
 v_cvt_pk_bf16_f32 v162, v164, v165
 v_cvt_pk_bf16_f32 v163, v166, v167
 v_mfma_f32_16x16x32_bf16 v[92:95], v[44:47], a[28:31], v[92:95]
 buffer_store_dwordx4 v[160:163], v26, s[16:19], s48 offen sc1
 v_mul_f32 v168, s52, v168
 v_mfma_f32_16x16x32_bf16 v[76:79], v[44:47], a[24:27], v[76:79]
 ds_read_b64_tr_b16 v[56:57], v19 offset:16384
 ds_read_b64_tr_b16 v[58:59], v19 offset:17408
 v_mul_f32 v169, s52, v169
 v_mfma_f32_16x16x32_bf16 v[76:79], v[40:43], a[8:11], v[76:79]
 v_mul_f32 v170, s52, v170
 v_mul_f32 v171, s52, v171
 v_mul_f32 v172, s52, v172
 v_mfma_f32_16x16x32_bf16 v[84:87], v[40:43], a[4:7], v[84:87]
 ds_read_b64_tr_b16 v[60:61], v19 offset:24576
 ds_read_b64_tr_b16 v[62:63], v19 offset:25600
 v_mfma_f32_16x16x32_bf16 v[84:87], v[44:47], a[20:23], v[84:87]
 v_mul_f32 v173, s52, v173
 v_mul_f32 v174, s52, v174
 v_mfma_f32_16x16x32_bf16 v[68:71], v[44:47], a[16:19], v[68:71]
 v_mul_f32 v175, s52, v175
 v_cvt_pk_bf16_f32 v168, v168, v169
 v_mfma_f32_16x16x32_bf16 v[68:71], v[40:43], a[0:3], v[68:71]
 v_cvt_pk_bf16_f32 v169, v170, v171
 s_waitcnt lgkmcnt(4)
 v_mfma_f32_16x16x32_bf16 v[96:99], v[48:51], a[0:3], v[96:99]
 v_cvt_pk_bf16_f32 v170, v172, v173
 v_cvt_pk_bf16_f32 v171, v174, v175
 v_mfma_f32_16x16x32_bf16 v[96:99], v[52:55], a[16:19], v[96:99]
 buffer_store_dwordx4 v[168:171], v26, s[16:19], s49 offen sc1
 v_mul_f32 v176, s52, v176
 v_mfma_f32_16x16x32_bf16 v[112:115], v[52:55], a[20:23], v[112:115]
 v_mul_f32 v177, s52, v177
 v_mul_f32 v178, s52, v178
 v_mul_f32 v179, s52, v179
 v_mfma_f32_16x16x32_bf16 v[112:115], v[48:51], a[4:7], v[112:115]
 v_mul_f32 v180, s52, v180
 v_mul_f32 v181, s52, v181
 v_mul_f32 v182, s52, v182
 v_mfma_f32_16x16x32_bf16 v[104:107], v[48:51], a[8:11], v[104:107]
 v_mul_f32 v183, s52, v183
 v_cvt_pk_bf16_f32 v176, v176, v177
 v_cvt_pk_bf16_f32 v177, v178, v179
 v_mfma_f32_16x16x32_bf16 v[104:107], v[52:55], a[24:27], v[104:107]
 s_waitcnt vmcnt(10) lgkmcnt(0)
 s_barrier
 v_mfma_f32_16x16x32_bf16 v[120:123], v[52:55], a[28:31], v[120:123]
 ds_read_b64_tr_b16 v[32:33], v16 offset:32768
 ds_read_b64_tr_b16 v[34:35], v16 offset:33792
 v_mfma_f32_16x16x32_bf16 v[120:123], v[48:51], a[12:15], v[120:123]
 ds_read_b64_tr_b16 v[36:37], v16 offset:40960
 ds_read_b64_tr_b16 v[38:39], v16 offset:41984
 v_mfma_f32_16x16x32_bf16 v[124:127], v[56:59], a[12:15], v[124:127]
 v_cvt_pk_bf16_f32 v178, v180, v181
 v_cvt_pk_bf16_f32 v179, v182, v183
 v_mfma_f32_16x16x32_bf16 v[124:127], v[60:63], a[28:31], v[124:127]
 s_add_u32 m0, s86, 65536
 s_bfe_u32 s0, s80, 0x40008
 s_mul_i32 s0, s0, 221184
 buffer_load_dwordx4 v8, s[12:15], s0 offen offset:0 lds
 v_mul_f32 v184, s52, v184
 v_mfma_f32_16x16x32_bf16 v[108:111], v[60:63], a[24:27], v[108:111]
 v_mul_f32 v185, s52, v185
 v_mul_f32 v186, s52, v186
 v_mul_f32 v187, s52, v187
 v_mfma_f32_16x16x32_bf16 v[108:111], v[56:59], a[8:11], v[108:111]
 buffer_store_dwordx4 v[176:179], v27, s[16:19], s48 offen sc1
 v_mul_f32 v188, s52, v188
 v_mfma_f32_16x16x32_bf16 v[116:119], v[56:59], a[4:7], v[116:119]
 v_mul_f32 v189, s52, v189
 v_mul_f32 v190, s52, v190
 v_mul_f32 v191, s52, v191
 v_mfma_f32_16x16x32_bf16 v[116:119], v[60:63], a[20:23], v[116:119]
 buffer_load_dwordx4 v9, s[12:15], s0 offen offset:1024 lds
 v_cvt_pk_bf16_f32 v184, v184, v185
 v_mfma_f32_16x16x32_bf16 v[100:103], v[60:63], a[16:19], v[100:103]
 ds_read_b64_tr_b16 v[40:41], v17 offset:32768
 ds_read_b64_tr_b16 v[42:43], v17 offset:33792
 v_cvt_pk_bf16_f32 v185, v186, v187
 v_mfma_f32_16x16x32_bf16 v[100:103], v[56:59], a[0:3], v[100:103]
 v_cvt_pk_bf16_f32 v186, v188, v189
 v_cvt_pk_bf16_f32 v187, v190, v191
 s_waitcnt lgkmcnt(2)
 v_mfma_f32_16x16x32_bf16 v[64:67], v[32:35], a[32:35], v[64:67]
 ds_read_b64_tr_b16 v[44:45], v17 offset:40960
 ds_read_b64_tr_b16 v[46:47], v17 offset:41984
 v_mfma_f32_16x16x32_bf16 v[64:67], v[36:39], a[48:51], v[64:67]
 buffer_store_dwordx4 v[184:187], v27, s[16:19], s49 offen sc1
 v_mfma_f32_16x16x32_bf16 v[80:83], v[36:39], a[52:55], v[80:83]
 ds_read_b128 a[224:227], v12 offset:4096
 ds_read_b128 a[240:243], v13 offset:4096
 v_mfma_f32_16x16x32_bf16 v[80:83], v[32:35], a[36:39], v[80:83]
 v_mfma_f32_16x16x32_bf16 v[72:75], v[32:35], a[40:43], v[72:75]
 ds_read_b64_tr_b16 v[48:49], v18 offset:32768
 ds_read_b64_tr_b16 v[50:51], v18 offset:33792
 v_mfma_f32_16x16x32_bf16 v[72:75], v[36:39], a[56:59], v[72:75]
 buffer_load_dwordx4 v10, s[12:15], s0 offen offset:2048 lds
 v_mfma_f32_16x16x32_bf16 v[88:91], v[36:39], a[60:63], v[88:91]
 ds_read_b64_tr_b16 v[52:53], v18 offset:40960
 ds_read_b64_tr_b16 v[54:55], v18 offset:41984
 v_mfma_f32_16x16x32_bf16 v[88:91], v[32:35], a[44:47], v[88:91]
 s_waitcnt lgkmcnt(6)
 v_mfma_f32_16x16x32_bf16 v[92:95], v[40:43], a[44:47], v[92:95]
 ds_read_b128 a[228:231], v12 offset:5120
 ds_read_b128 a[244:247], v13 offset:5120
 v_mfma_f32_16x16x32_bf16 v[92:95], v[44:47], a[60:63], v[92:95]
 s_mov_b32 s92, 0x11000000
 s_mov_b32 s93, 0x11000000
 v_mov_b32 v160, 0x3f803f80
 v_cndmask_b32 v160, 0, v160, s[92:93]
 v_mfma_f32_16x16x32_bf16 v[76:79], v[44:47], a[56:59], v[76:79]
 ds_read_b64_tr_b16 v[56:57], v19 offset:32768
 ds_read_b64_tr_b16 v[58:59], v19 offset:33792
 v_mfma_f32_16x16x32_bf16 v[76:79], v[40:43], a[40:43], v[76:79]
 buffer_load_dwordx4 v11, s[12:15], s0 offen offset:3072 lds
 v_mfma_f32_16x16x32_bf16 v[84:87], v[40:43], a[36:39], v[84:87]
 ds_read_b64_tr_b16 v[60:61], v19 offset:40960
 ds_read_b64_tr_b16 v[62:63], v19 offset:41984
 v_mfma_f32_16x16x32_bf16 v[84:87], v[44:47], a[52:55], v[84:87]
 v_mov_b32 v161, v160
 v_mov_b32 v162, v160
 v_mfma_f32_16x16x32_bf16 v[68:71], v[44:47], a[48:51], v[68:71]
 ds_read_b128 a[232:235], v12 offset:20480
 ds_read_b128 a[248:251], v13 offset:20480
 v_mfma_f32_16x16x32_bf16 v[68:71], v[40:43], a[32:35], v[68:71]
 v_mov_b32 v163, v160
 s_waitcnt lgkmcnt(8)
 v_mfma_f32_16x16x32_bf16 v[96:99], v[48:51], a[32:35], v[96:99]
 ds_read_b128 a[236:239], v12 offset:21504
 ds_read_b128 a[252:255], v13 offset:21504
 v_mfma_f32_16x16x32_bf16 v[96:99], v[52:55], a[48:51], v[96:99]
 v_mov_b32 v164, v160
 v_mov_b32 v165, v160
 v_mfma_f32_16x16x32_bf16 v[112:115], v[52:55], a[52:55], v[112:115]
 v_mov_b32 v166, v160
 v_mov_b32 v167, v160
 v_mfma_f32_16x16x32_bf16 v[112:115], v[48:51], a[36:39], v[112:115]
 v_mfma_f32_16x16x32_bf16 v[104:107], v[48:51], a[40:43], v[104:107]
 v_mfma_f32_16x16x32_bf16 v[104:107], v[52:55], a[56:59], v[104:107]
 s_waitcnt vmcnt(12) lgkmcnt(0)
 s_barrier
 v_mfma_f32_16x16x32_bf16 v[120:123], v[52:55], a[60:63], v[120:123]
 ds_read_b64_tr_b16 v[32:33], v16 offset:49152
 ds_read_b64_tr_b16 v[34:35], v16 offset:50176
 v_mfma_f32_16x16x32_bf16 v[120:123], v[48:51], a[44:47], v[120:123]
 ds_read_b64_tr_b16 v[36:37], v16 offset:57344
 ds_read_b64_tr_b16 v[38:39], v16 offset:58368
 v_mfma_f32_16x16x32_bf16 v[124:127], v[56:59], a[44:47], v[124:127]
 v_mfma_f32_16x16x32_bf16 v[124:127], v[60:63], a[60:63], v[124:127]
 s_add_u32 m0, s86, 0
 s_bfe_u32 s0, s80, 0x4001c
 s_mul_i32 s0, s0, 221184
 buffer_load_dwordx4 v8, s[12:15], s0 offen offset:0 lds
 v_mfma_f32_16x16x32_bf16 v[108:111], v[60:63], a[56:59], v[108:111]
 v_mfma_f32_16x16x32_bf16 v[108:111], v[56:59], a[40:43], v[108:111]
 buffer_load_dwordx4 v9, s[12:15], s0 offen offset:1024 lds
 v_mfma_f32_16x16x32_bf16 v[116:119], v[56:59], a[36:39], v[116:119]
 v_mfma_f32_16x16x32_bf16 v[116:119], v[60:63], a[52:55], v[116:119]
 v_mfma_f32_16x16x32_bf16 v[100:103], v[60:63], a[48:51], v[100:103]
 ds_read_b64_tr_b16 v[40:41], v17 offset:49152
 ds_read_b64_tr_b16 v[42:43], v17 offset:50176
 v_mfma_f32_16x16x32_bf16 v[100:103], v[56:59], a[32:35], v[100:103]
 s_waitcnt lgkmcnt(2)
 v_mfma_f32_16x16x32_bf16 v[64:67], v[32:35], a[224:227], v[64:67]
 ds_read_b64_tr_b16 v[44:45], v17 offset:57344
 ds_read_b64_tr_b16 v[46:47], v17 offset:58368
 v_mfma_f32_16x16x32_bf16 v[64:67], v[36:39], a[240:243], v[64:67]
 buffer_load_dwordx4 v10, s[12:15], s0 offen offset:2048 lds
 v_mfma_f32_16x16x32_bf16 v[80:83], v[36:39], a[244:247], v[80:83]
 v_mfma_f32_16x16x32_bf16 v[80:83], v[32:35], a[228:231], v[80:83]
 v_mfma_f32_16x16x32_bf16 v[72:75], v[32:35], a[232:235], v[72:75]
 ds_read_b64_tr_b16 v[48:49], v18 offset:49152
 ds_read_b64_tr_b16 v[50:51], v18 offset:50176
 v_mfma_f32_16x16x32_bf16 v[72:75], v[36:39], a[248:251], v[72:75]
 buffer_load_dwordx4 v11, s[12:15], s0 offen offset:3072 lds
 v_mfma_f32_16x16x32_bf16 v[88:91], v[36:39], a[252:255], v[88:91]
 ds_read_b64_tr_b16 v[52:53], v18 offset:57344
 ds_read_b64_tr_b16 v[54:55], v18 offset:58368
 v_mfma_f32_16x16x32_bf16 v[88:91], v[32:35], a[236:239], v[88:91]
 s_waitcnt lgkmcnt(4)
 v_mfma_f32_16x16x32_bf16 v[92:95], v[40:43], a[236:239], v[92:95]
 v_mfma_f32_16x16x32_bf16 v[92:95], v[44:47], a[252:255], v[92:95]
 s_add_u32 m0, s86, 16384
 s_bfe_u32 s0, s80, 0x4000c
 s_mul_i32 s0, s0, 221184
 buffer_load_dwordx4 v8, s[12:15], s0 offen offset:0 lds
 v_mfma_f32_16x16x32_bf16 v[76:79], v[44:47], a[248:251], v[76:79]
 ds_read_b64_tr_b16 v[56:57], v19 offset:49152
 ds_read_b64_tr_b16 v[58:59], v19 offset:50176
 v_mfma_f32_16x16x32_bf16 v[76:79], v[40:43], a[232:235], v[76:79]
 v_mfma_f32_16x16x32_bf16 v[84:87], v[40:43], a[228:231], v[84:87]
 ds_read_b64_tr_b16 v[60:61], v19 offset:57344
 ds_read_b64_tr_b16 v[62:63], v19 offset:58368
 v_mfma_f32_16x16x32_bf16 v[84:87], v[44:47], a[244:247], v[84:87]
 buffer_load_dwordx4 v9, s[12:15], s0 offen offset:1024 lds
 v_mfma_f32_16x16x32_bf16 v[68:71], v[44:47], a[240:243], v[68:71]
 v_mfma_f32_16x16x32_bf16 v[68:71], v[40:43], a[224:227], v[68:71]
 s_waitcnt lgkmcnt(4)
 v_mfma_f32_16x16x32_bf16 v[96:99], v[48:51], a[224:227], v[96:99]
 v_mfma_f32_16x16x32_bf16 v[96:99], v[52:55], a[240:243], v[96:99]
 s_waitcnt vmcnt(8)
 s_mov_b64 exec, 1
 buffer_store_dwordx2 v[252:253], v237, s[16:19], s53 offen offset:0 sc1
 s_mov_b64 exec, -1
 v_mfma_f32_16x16x32_bf16 v[112:115], v[52:55], a[244:247], v[112:115]
 v_mfma_f32_16x16x32_bf16 v[112:115], v[48:51], a[228:231], v[112:115]
 buffer_load_dwordx4 v10, s[12:15], s0 offen offset:2048 lds
 v_mfma_f32_16x16x32_bf16 v[104:107], v[48:51], a[232:235], v[104:107]
 v_mfma_f32_16x16x32_bf16 v[104:107], v[52:55], a[248:251], v[104:107]
 s_waitcnt vmcnt(8) lgkmcnt(0)
 s_barrier
 v_mfma_f32_16x16x32_bf16 v[120:123], v[52:55], a[252:255], v[120:123]
 ds_read_b64_tr_b16 v[32:33], v20 offset:0
 ds_read_b64_tr_b16 v[34:35], v20 offset:1024
 v_mfma_f32_16x16x32_bf16 v[120:123], v[48:51], a[236:239], v[120:123]
 ds_read_b64_tr_b16 v[36:37], v20 offset:8192
 ds_read_b64_tr_b16 v[38:39], v20 offset:9216
 v_mfma_f32_16x16x32_bf16 v[124:127], v[56:59], a[236:239], v[124:127]
 v_mfma_f32_16x16x32_bf16 v[124:127], v[60:63], a[252:255], v[124:127]
 buffer_load_dwordx4 v11, s[12:15], s0 offen offset:3072 lds
 v_mfma_f32_16x16x32_bf16 v[108:111], v[60:63], a[248:251], v[108:111]
 v_mfma_f32_16x16x32_bf16 v[108:111], v[56:59], a[232:235], v[108:111]
 v_mfma_f32_16x16x32_bf16 v[116:119], v[56:59], a[228:231], v[116:119]
 v_mfma_f32_16x16x32_bf16 v[116:119], v[60:63], a[244:247], v[116:119]
 buffer_load_dwordx2 v[246:247], v244, s[16:19], 0 offen sc1
 v_mfma_f32_16x16x32_bf16 v[100:103], v[60:63], a[240:243], v[100:103]
 ds_read_b64_tr_b16 v[40:41], v21 offset:0
 ds_read_b64_tr_b16 v[42:43], v21 offset:1024
 v_mfma_f32_16x16x32_bf16 v[100:103], v[56:59], a[224:227], v[100:103]
 s_waitcnt lgkmcnt(2)
 v_mfma_f32_16x16x32_bf16 v[64:67], v[32:35], a[64:67], v[64:67]
 ds_read_b64_tr_b16 v[44:45], v21 offset:8192
 ds_read_b64_tr_b16 v[46:47], v21 offset:9216
 v_mfma_f32_16x16x32_bf16 v[64:67], v[36:39], a[80:83], v[64:67]
 s_add_u32 m0, s86, 32768
 s_bfe_u32 s0, s80, 0x40010
 s_mul_i32 s0, s0, 221184
 buffer_load_dwordx4 v8, s[12:15], s0 offen offset:0 lds
 v_mfma_f32_16x16x32_bf16 v[80:83], v[36:39], a[84:87], v[80:83]
 ds_read_b128 a[224:227], v12 offset:12288
 ds_read_b128 a[240:243], v13 offset:12288
 v_mfma_f32_16x16x32_bf16 v[80:83], v[32:35], a[68:71], v[80:83]
 v_mfma_f32_16x16x32_bf16 v[72:75], v[32:35], a[72:75], v[72:75]
 ds_read_b64_tr_b16 v[48:49], v22 offset:0
 ds_read_b64_tr_b16 v[50:51], v22 offset:1024
 v_mfma_f32_16x16x32_bf16 v[72:75], v[36:39], a[88:91], v[72:75]
 buffer_load_dwordx4 v9, s[12:15], s0 offen offset:1024 lds
 v_mfma_f32_16x16x32_bf16 v[88:91], v[36:39], a[92:95], v[88:91]
 ds_read_b64_tr_b16 v[52:53], v22 offset:8192
 ds_read_b64_tr_b16 v[54:55], v22 offset:9216
 v_mfma_f32_16x16x32_bf16 v[88:91], v[32:35], a[76:79], v[88:91]
 s_waitcnt lgkmcnt(6)
 v_mfma_f32_16x16x32_bf16 v[92:95], v[40:43], a[76:79], v[92:95]
 ds_read_b128 a[228:231], v12 offset:13312
 ds_read_b128 a[244:247], v13 offset:13312
 v_mfma_f32_16x16x32_bf16 v[92:95], v[44:47], a[92:95], v[92:95]
 buffer_load_dwordx4 v10, s[12:15], s0 offen offset:2048 lds
 v_mfma_f32_16x16x32_bf16 v[76:79], v[44:47], a[88:91], v[76:79]
 ds_read_b64_tr_b16 v[56:57], v23 offset:0
 ds_read_b64_tr_b16 v[58:59], v23 offset:1024
 v_mfma_f32_16x16x32_bf16 v[76:79], v[40:43], a[72:75], v[76:79]
 buffer_load_dwordx4 v11, s[12:15], s0 offen offset:3072 lds
 v_mfma_f32_16x16x32_bf16 v[84:87], v[40:43], a[68:71], v[84:87]
 ds_read_b64_tr_b16 v[60:61], v23 offset:8192
 ds_read_b64_tr_b16 v[62:63], v23 offset:9216
 v_mfma_f32_16x16x32_bf16 v[84:87], v[44:47], a[84:87], v[84:87]
 v_mfma_f32_16x16x32_bf16 v[68:71], v[44:47], a[80:83], v[68:71]
 ds_read_b128 a[232:235], v12 offset:28672
 ds_read_b128 a[248:251], v13 offset:28672
 v_mfma_f32_16x16x32_bf16 v[68:71], v[40:43], a[64:67], v[68:71]
 s_waitcnt lgkmcnt(8)
 v_mfma_f32_16x16x32_bf16 v[96:99], v[48:51], a[64:67], v[96:99]
 ds_read_b128 a[236:239], v12 offset:29696
 ds_read_b128 a[252:255], v13 offset:29696
 v_mfma_f32_16x16x32_bf16 v[96:99], v[52:55], a[80:83], v[96:99]
 s_add_u32 m0, s86, 49152
 s_bfe_u32 s0, s80, 0x40018
 s_mul_i32 s0, s0, 221184
 buffer_load_dwordx4 v8, s[12:15], s0 offen offset:0 lds
 v_mfma_f32_16x16x32_bf16 v[112:115], v[52:55], a[84:87], v[112:115]
 v_mfma_f32_16x16x32_bf16 v[112:115], v[48:51], a[68:71], v[112:115]
 v_mfma_f32_16x16x32_bf16 v[104:107], v[48:51], a[72:75], v[104:107]
 v_mfma_f32_16x16x32_bf16 v[104:107], v[52:55], a[88:91], v[104:107]
 s_waitcnt vmcnt(11) lgkmcnt(0)
 s_barrier
 v_mfma_f32_16x16x32_bf16 v[120:123], v[52:55], a[92:95], v[120:123]
 ds_read_b64_tr_b16 v[32:33], v16 offset:0
 ds_read_b64_tr_b16 v[34:35], v16 offset:1024
 v_mfma_f32_16x16x32_bf16 v[120:123], v[48:51], a[76:79], v[120:123]
 ds_read_b64_tr_b16 v[36:37], v16 offset:8192
 ds_read_b64_tr_b16 v[38:39], v16 offset:9216
 v_mfma_f32_16x16x32_bf16 v[124:127], v[56:59], a[76:79], v[124:127]
 v_mfma_f32_16x16x32_bf16 v[124:127], v[60:63], a[92:95], v[124:127]
 buffer_load_dwordx4 v9, s[12:15], s0 offen offset:1024 lds
 v_mfma_f32_16x16x32_bf16 v[108:111], v[60:63], a[88:91], v[108:111]
 v_mfma_f32_16x16x32_bf16 v[108:111], v[56:59], a[72:75], v[108:111]
 buffer_load_dwordx4 v10, s[12:15], s0 offen offset:2048 lds
 v_mfma_f32_16x16x32_bf16 v[116:119], v[56:59], a[68:71], v[116:119]
 v_mfma_f32_16x16x32_bf16 v[116:119], v[60:63], a[84:87], v[116:119]
 buffer_load_dwordx4 v11, s[12:15], s0 offen offset:3072 lds
 v_mfma_f32_16x16x32_bf16 v[100:103], v[60:63], a[80:83], v[100:103]
 ds_read_b64_tr_b16 v[40:41], v17 offset:0
 ds_read_b64_tr_b16 v[42:43], v17 offset:1024
 v_mfma_f32_16x16x32_bf16 v[100:103], v[56:59], a[64:67], v[100:103]
 s_waitcnt lgkmcnt(2)
 v_mfma_f32_16x16x32_bf16 v[64:67], v[32:35], a[224:227], v[64:67]
 ds_read_b64_tr_b16 v[44:45], v17 offset:8192
 ds_read_b64_tr_b16 v[46:47], v17 offset:9216
 s_waitcnt vmcnt(8)
 v_cmp_ne_u64 vcc, s[90:91], v[246:247]
 s_nop 0
 s_cbranch_vccnz L_poll_7
L_poll_ok_8:
 v_mfma_f32_16x16x32_bf16 v[64:67], v[36:39], a[240:243], v[64:67]
 v_add_u32 v242, s73, v254
 global_load_dwordx4 a[0:3], v242, s[16:17] offset:-2048 sc1
 v_mfma_f32_16x16x32_bf16 v[80:83], v[36:39], a[244:247], v[80:83]
 v_mfma_f32_16x16x32_bf16 v[80:83], v[32:35], a[228:231], v[80:83]
 v_mfma_f32_16x16x32_bf16 v[72:75], v[32:35], a[232:235], v[72:75]
 ds_read_b64_tr_b16 v[48:49], v18 offset:0
 ds_read_b64_tr_b16 v[50:51], v18 offset:1024
 v_mfma_f32_16x16x32_bf16 v[72:75], v[36:39], a[248:251], v[72:75]
 global_load_dwordx4 a[4:7], v242, s[16:17] offset:-1024 sc1
 v_mfma_f32_16x16x32_bf16 v[88:91], v[36:39], a[252:255], v[88:91]
 ds_read_b64_tr_b16 v[52:53], v18 offset:8192
 ds_read_b64_tr_b16 v[54:55], v18 offset:9216
 v_mfma_f32_16x16x32_bf16 v[88:91], v[32:35], a[236:239], v[88:91]
 s_waitcnt lgkmcnt(4)
 v_mfma_f32_16x16x32_bf16 v[92:95], v[40:43], a[236:239], v[92:95]
 v_mfma_f32_16x16x32_bf16 v[92:95], v[44:47], a[252:255], v[92:95]
 global_load_dwordx4 a[8:11], v242, s[16:17] offset:0 sc1
 v_mfma_f32_16x16x32_bf16 v[76:79], v[44:47], a[248:251], v[76:79]
 ds_read_b64_tr_b16 v[56:57], v19 offset:0
 ds_read_b64_tr_b16 v[58:59], v19 offset:1024
 v_mfma_f32_16x16x32_bf16 v[76:79], v[40:43], a[232:235], v[76:79]
 v_mfma_f32_16x16x32_bf16 v[84:87], v[40:43], a[228:231], v[84:87]
 ds_read_b64_tr_b16 v[60:61], v19 offset:8192
 ds_read_b64_tr_b16 v[62:63], v19 offset:9216
 v_mfma_f32_16x16x32_bf16 v[84:87], v[44:47], a[244:247], v[84:87]
 global_load_dwordx4 a[12:15], v242, s[16:17] offset:1024 sc1
 v_mfma_f32_16x16x32_bf16 v[68:71], v[44:47], a[240:243], v[68:71]
 v_mfma_f32_16x16x32_bf16 v[68:71], v[40:43], a[224:227], v[68:71]
 s_waitcnt lgkmcnt(4)
 v_mfma_f32_16x16x32_bf16 v[96:99], v[48:51], a[224:227], v[96:99]
 v_mfma_f32_16x16x32_bf16 v[96:99], v[52:55], a[240:243], v[96:99]
 global_load_dwordx4 a[16:19], v242, s[16:17] offset:2048 sc1
 v_mfma_f32_16x16x32_bf16 v[112:115], v[52:55], a[244:247], v[112:115]
 v_mfma_f32_16x16x32_bf16 v[112:115], v[48:51], a[228:231], v[112:115]
 v_mfma_f32_16x16x32_bf16 v[104:107], v[48:51], a[232:235], v[104:107]
 v_mfma_f32_16x16x32_bf16 v[104:107], v[52:55], a[248:251], v[104:107]
 s_waitcnt lgkmcnt(0)
 s_barrier
 v_mfma_f32_16x16x32_bf16 v[120:123], v[52:55], a[252:255], v[120:123]
 ds_read_b64_tr_b16 v[32:33], v16 offset:16384
 ds_read_b64_tr_b16 v[34:35], v16 offset:17408
 v_mfma_f32_16x16x32_bf16 v[120:123], v[48:51], a[236:239], v[120:123]
 ds_read_b64_tr_b16 v[36:37], v16 offset:24576
 ds_read_b64_tr_b16 v[38:39], v16 offset:25600
 v_add_u32 v242, 5120, v242
 global_load_dwordx4 a[20:23], v242, s[16:17] offset:-2048 sc1
 v_mfma_f32_16x16x32_bf16 v[124:127], v[56:59], a[236:239], v[124:127]
 v_mfma_f32_16x16x32_bf16 v[124:127], v[60:63], a[252:255], v[124:127]
 global_load_dwordx4 a[24:27], v242, s[16:17] offset:-1024 sc1
 v_mfma_f32_16x16x32_bf16 v[108:111], v[60:63], a[248:251], v[108:111]
 v_mfma_f32_16x16x32_bf16 v[108:111], v[56:59], a[232:235], v[108:111]
 v_mfma_f32_16x16x32_bf16 v[116:119], v[56:59], a[228:231], v[116:119]
 v_mfma_f32_16x16x32_bf16 v[116:119], v[60:63], a[244:247], v[116:119]
 global_load_dwordx4 a[28:31], v242, s[16:17] offset:0 sc1
 v_mfma_f32_16x16x32_bf16 v[100:103], v[60:63], a[240:243], v[100:103]
 ds_read_b64_tr_b16 v[40:41], v17 offset:16384
 ds_read_b64_tr_b16 v[42:43], v17 offset:17408
 v_mfma_f32_16x16x32_bf16 v[100:103], v[56:59], a[224:227], v[100:103]
 s_waitcnt lgkmcnt(2)
 v_mfma_f32_16x16x32_bf16 v[64:67], v[32:35], a[96:99], v[64:67]
 ds_read_b64_tr_b16 v[44:45], v17 offset:24576
 ds_read_b64_tr_b16 v[46:47], v17 offset:25600
 v_mfma_f32_16x16x32_bf16 v[64:67], v[36:39], a[112:115], v[64:67]
 global_load_dwordx4 a[32:35], v242, s[16:17] offset:1024 sc1
 v_mfma_f32_16x16x32_bf16 v[80:83], v[36:39], a[116:119], v[80:83]
 v_mfma_f32_16x16x32_bf16 v[80:83], v[32:35], a[100:103], v[80:83]
 v_mfma_f32_16x16x32_bf16 v[72:75], v[32:35], a[104:107], v[72:75]
 ds_read_b64_tr_b16 v[48:49], v18 offset:16384
 ds_read_b64_tr_b16 v[50:51], v18 offset:17408
 v_mfma_f32_16x16x32_bf16 v[72:75], v[36:39], a[120:123], v[72:75]
 global_load_dwordx4 a[36:39], v242, s[16:17] offset:2048 sc1
 v_mfma_f32_16x16x32_bf16 v[88:91], v[36:39], a[124:127], v[88:91]
 ds_read_b64_tr_b16 v[52:53], v18 offset:24576
 ds_read_b64_tr_b16 v[54:55], v18 offset:25600
 v_mfma_f32_16x16x32_bf16 v[88:91], v[32:35], a[108:111], v[88:91]
 s_waitcnt lgkmcnt(4)
 v_mfma_f32_16x16x32_bf16 v[92:95], v[40:43], a[108:111], v[92:95]
 v_mfma_f32_16x16x32_bf16 v[92:95], v[44:47], a[124:127], v[92:95]
 v_add_u32 v242, 5120, v242
 global_load_dwordx4 a[40:43], v242, s[16:17] offset:-2048 sc1
 v_mfma_f32_16x16x32_bf16 v[76:79], v[44:47], a[120:123], v[76:79]
 ds_read_b64_tr_b16 v[56:57], v19 offset:16384
 ds_read_b64_tr_b16 v[58:59], v19 offset:17408
 v_mfma_f32_16x16x32_bf16 v[76:79], v[40:43], a[104:107], v[76:79]
 v_mfma_f32_16x16x32_bf16 v[84:87], v[40:43], a[100:103], v[84:87]
 ds_read_b64_tr_b16 v[60:61], v19 offset:24576
 ds_read_b64_tr_b16 v[62:63], v19 offset:25600
 v_mfma_f32_16x16x32_bf16 v[84:87], v[44:47], a[116:119], v[84:87]
 global_load_dwordx4 a[44:47], v242, s[16:17] offset:-1024 sc1
 v_mfma_f32_16x16x32_bf16 v[68:71], v[44:47], a[112:115], v[68:71]
 v_mfma_f32_16x16x32_bf16 v[68:71], v[40:43], a[96:99], v[68:71]
 s_waitcnt lgkmcnt(4)
 v_mfma_f32_16x16x32_bf16 v[96:99], v[48:51], a[96:99], v[96:99]
 v_mfma_f32_16x16x32_bf16 v[96:99], v[52:55], a[112:115], v[96:99]
 buffer_load_dwordx2 v[246:247], v245, s[16:19], 0 offen sc1
 v_mfma_f32_16x16x32_bf16 v[112:115], v[52:55], a[116:119], v[112:115]
 v_mfma_f32_16x16x32_bf16 v[112:115], v[48:51], a[100:103], v[112:115]
 global_load_dwordx4 a[48:51], v242, s[16:17] offset:0 sc1
 v_mfma_f32_16x16x32_bf16 v[104:107], v[48:51], a[104:107], v[104:107]
 v_mfma_f32_16x16x32_bf16 v[104:107], v[52:55], a[120:123], v[104:107]
 s_waitcnt vmcnt(18) lgkmcnt(0)
 s_barrier
 v_mfma_f32_16x16x32_bf16 v[120:123], v[52:55], a[124:127], v[120:123]
 ds_read_b64_tr_b16 v[32:33], v16 offset:32768
 ds_read_b64_tr_b16 v[34:35], v16 offset:33792
 v_mfma_f32_16x16x32_bf16 v[120:123], v[48:51], a[108:111], v[120:123]
 ds_read_b64_tr_b16 v[36:37], v16 offset:40960
 ds_read_b64_tr_b16 v[38:39], v16 offset:41984
 global_load_dwordx4 a[52:55], v242, s[16:17] offset:1024 sc1
 v_mfma_f32_16x16x32_bf16 v[124:127], v[56:59], a[108:111], v[124:127]
 v_mfma_f32_16x16x32_bf16 v[124:127], v[60:63], a[124:127], v[124:127]
 s_add_u32 m0, s86, 65536
 s_bfe_u32 s0, s81, 0x40000
 s_mul_i32 s0, s0, 221184
 buffer_load_dwordx4 v8, s[12:15], s0 offen offset:0 lds
 v_mfma_f32_16x16x32_bf16 v[108:111], v[60:63], a[120:123], v[108:111]
 v_mfma_f32_16x16x32_bf16 v[108:111], v[56:59], a[104:107], v[108:111]
 global_load_dwordx4 a[56:59], v242, s[16:17] offset:2048 sc1
 v_mfma_f32_16x16x32_bf16 v[116:119], v[56:59], a[100:103], v[116:119]
 v_mfma_f32_16x16x32_bf16 v[116:119], v[60:63], a[116:119], v[116:119]
 v_add_u32 v242, 5120, v242
 global_load_dwordx4 a[60:63], v242, s[16:17] offset:-2048 sc1
 v_mfma_f32_16x16x32_bf16 v[100:103], v[60:63], a[112:115], v[100:103]
 ds_read_b64_tr_b16 v[40:41], v17 offset:32768
 ds_read_b64_tr_b16 v[42:43], v17 offset:33792
 v_mfma_f32_16x16x32_bf16 v[100:103], v[56:59], a[96:99], v[100:103]
 s_waitcnt lgkmcnt(2)
 v_mfma_f32_16x16x32_bf16 v[64:67], v[32:35], a[128:131], v[64:67]
 ds_read_b64_tr_b16 v[44:45], v17 offset:40960
 ds_read_b64_tr_b16 v[46:47], v17 offset:41984
 buffer_load_dwordx4 v9, s[12:15], s0 offen offset:1024 lds
 v_mfma_f32_16x16x32_bf16 v[64:67], v[36:39], a[144:147], v[64:67]
 global_load_dwordx4 a[64:67], v242, s[16:17] offset:-1024 sc1
 v_mfma_f32_16x16x32_bf16 v[80:83], v[36:39], a[148:151], v[80:83]
 v_mfma_f32_16x16x32_bf16 v[80:83], v[32:35], a[132:135], v[80:83]
 v_mfma_f32_16x16x32_bf16 v[72:75], v[32:35], a[136:139], v[72:75]
 ds_read_b64_tr_b16 v[48:49], v18 offset:32768
 ds_read_b64_tr_b16 v[50:51], v18 offset:33792
 v_mfma_f32_16x16x32_bf16 v[72:75], v[36:39], a[152:155], v[72:75]
 buffer_load_dwordx4 v10, s[12:15], s0 offen offset:2048 lds
 v_mfma_f32_16x16x32_bf16 v[88:91], v[36:39], a[156:159], v[88:91]
 ds_read_b64_tr_b16 v[52:53], v18 offset:40960
 ds_read_b64_tr_b16 v[54:55], v18 offset:41984
 v_mfma_f32_16x16x32_bf16 v[88:91], v[32:35], a[140:143], v[88:91]
 global_load_dwordx4 a[68:71], v242, s[16:17] offset:0 sc1
 s_waitcnt lgkmcnt(4)
 v_mfma_f32_16x16x32_bf16 v[92:95], v[40:43], a[140:143], v[92:95]
 v_mfma_f32_16x16x32_bf16 v[92:95], v[44:47], a[156:159], v[92:95]
 global_load_dwordx4 a[72:75], v242, s[16:17] offset:1024 sc1
 v_mfma_f32_16x16x32_bf16 v[76:79], v[44:47], a[152:155], v[76:79]
 ds_read_b64_tr_b16 v[56:57], v19 offset:32768
 ds_read_b64_tr_b16 v[58:59], v19 offset:33792
 v_mfma_f32_16x16x32_bf16 v[76:79], v[40:43], a[136:139], v[76:79]
 buffer_load_dwordx4 v11, s[12:15], s0 offen offset:3072 lds
 v_mfma_f32_16x16x32_bf16 v[84:87], v[40:43], a[132:135], v[84:87]
 ds_read_b64_tr_b16 v[60:61], v19 offset:40960
 ds_read_b64_tr_b16 v[62:63], v19 offset:41984
 v_mfma_f32_16x16x32_bf16 v[84:87], v[44:47], a[148:151], v[84:87]
 global_load_dwordx4 a[76:79], v242, s[16:17] offset:2048 sc1
 v_mfma_f32_16x16x32_bf16 v[68:71], v[44:47], a[144:147], v[68:71]
 v_mfma_f32_16x16x32_bf16 v[68:71], v[40:43], a[128:131], v[68:71]
 s_waitcnt lgkmcnt(4)
 v_mfma_f32_16x16x32_bf16 v[96:99], v[48:51], a[128:131], v[96:99]
 s_waitcnt vmcnt(12)
 v_cmp_ne_u64 vcc, s[90:91], v[246:247]
 s_nop 0
 s_cbranch_vccnz L_poll_9
L_poll_ok_10:
 v_mfma_f32_16x16x32_bf16 v[96:99], v[52:55], a[144:147], v[96:99]
 buffer_load_dwordx4 v[128:131], v231, s[16:19], 0 offen sc1
 v_mfma_f32_16x16x32_bf16 v[112:115], v[52:55], a[148:151], v[112:115]
 v_mfma_f32_16x16x32_bf16 v[112:115], v[48:51], a[132:135], v[112:115]
 v_mfma_f32_16x16x32_bf16 v[104:107], v[48:51], a[136:139], v[104:107]
 v_mfma_f32_16x16x32_bf16 v[104:107], v[52:55], a[152:155], v[104:107]
 s_waitcnt lgkmcnt(0)
 s_barrier
 v_mfma_f32_16x16x32_bf16 v[120:123], v[52:55], a[156:159], v[120:123]
 ds_read_b64_tr_b16 v[32:33], v16 offset:49152
 ds_read_b64_tr_b16 v[34:35], v16 offset:50176
 v_mfma_f32_16x16x32_bf16 v[120:123], v[48:51], a[140:143], v[120:123]
 ds_read_b64_tr_b16 v[36:37], v16 offset:57344
 ds_read_b64_tr_b16 v[38:39], v16 offset:58368
 buffer_load_dwordx4 v[132:135], v231, s[16:19], s96 offen sc1
 v_mfma_f32_16x16x32_bf16 v[124:127], v[56:59], a[140:143], v[124:127]
 v_mfma_f32_16x16x32_bf16 v[124:127], v[60:63], a[156:159], v[124:127]
 buffer_load_dwordx4 v[136:139], v231, s[16:19], s97 offen sc1
 v_mfma_f32_16x16x32_bf16 v[108:111], v[60:63], a[152:155], v[108:111]
 v_mfma_f32_16x16x32_bf16 v[108:111], v[56:59], a[136:139], v[108:111]
 s_mul_i32 s45, s3, 3072
 s_add_u32 m0, s45, 81920
 s_nop 0
 buffer_load_dwordx4 v228, s[16:19], 0 offen offset:0 sc1 lds
 v_mfma_f32_16x16x32_bf16 v[116:119], v[56:59], a[132:135], v[116:119]
 v_mfma_f32_16x16x32_bf16 v[116:119], v[60:63], a[148:151], v[116:119]
 v_mfma_f32_16x16x32_bf16 v[100:103], v[60:63], a[144:147], v[100:103]
 ds_read_b64_tr_b16 v[40:41], v17 offset:49152
 ds_read_b64_tr_b16 v[42:43], v17 offset:50176
 v_mfma_f32_16x16x32_bf16 v[100:103], v[56:59], a[128:131], v[100:103]
 s_waitcnt lgkmcnt(2)
 v_mfma_f32_16x16x32_bf16 v[64:67], v[32:35], a[160:163], v[64:67]
 ds_read_b64_tr_b16 v[44:45], v17 offset:57344
 ds_read_b64_tr_b16 v[46:47], v17 offset:58368
 v_mfma_f32_16x16x32_bf16 v[64:67], v[36:39], a[176:179], v[64:67]
 buffer_load_dwordx4 v229, s[16:19], 0 offen offset:1024 sc1 lds
 v_mfma_f32_16x16x32_bf16 v[80:83], v[36:39], a[180:183], v[80:83]
 v_mfma_f32_16x16x32_bf16 v[80:83], v[32:35], a[164:167], v[80:83]
 v_mfma_f32_16x16x32_bf16 v[72:75], v[32:35], a[168:171], v[72:75]
 ds_read_b64_tr_b16 v[48:49], v18 offset:49152
 ds_read_b64_tr_b16 v[50:51], v18 offset:50176
 v_mfma_f32_16x16x32_bf16 v[72:75], v[36:39], a[184:187], v[72:75]
 buffer_load_dwordx4 v230, s[16:19], 0 offen offset:2048 sc1 lds
 v_mfma_f32_16x16x32_bf16 v[88:91], v[36:39], a[188:191], v[88:91]
 ds_read_b64_tr_b16 v[52:53], v18 offset:57344
 ds_read_b64_tr_b16 v[54:55], v18 offset:58368
 v_mfma_f32_16x16x32_bf16 v[88:91], v[32:35], a[172:175], v[88:91]
 s_waitcnt lgkmcnt(4)
 v_mfma_f32_16x16x32_bf16 v[92:95], v[40:43], a[172:175], v[92:95]
 v_mfma_f32_16x16x32_bf16 v[92:95], v[44:47], a[188:191], v[92:95]
 s_add_u32 m0, s45, 94208
 s_nop 0
 buffer_load_dwordx4 v228, s[16:19], s96 offen offset:0 sc1 lds
 v_mfma_f32_16x16x32_bf16 v[76:79], v[44:47], a[184:187], v[76:79]
 ds_read_b64_tr_b16 v[56:57], v19 offset:49152
 ds_read_b64_tr_b16 v[58:59], v19 offset:50176
 v_mfma_f32_16x16x32_bf16 v[76:79], v[40:43], a[168:171], v[76:79]
 buffer_load_dwordx4 v229, s[16:19], s96 offen offset:1024 sc1 lds
 v_mfma_f32_16x16x32_bf16 v[84:87], v[40:43], a[164:167], v[84:87]
 ds_read_b64_tr_b16 v[60:61], v19 offset:57344
 ds_read_b64_tr_b16 v[62:63], v19 offset:58368
 v_mfma_f32_16x16x32_bf16 v[84:87], v[44:47], a[180:183], v[84:87]
 buffer_load_dwordx4 v230, s[16:19], s96 offen offset:2048 sc1 lds
 v_mfma_f32_16x16x32_bf16 v[68:71], v[44:47], a[176:179], v[68:71]
 v_mfma_f32_16x16x32_bf16 v[68:71], v[40:43], a[160:163], v[68:71]
 s_waitcnt lgkmcnt(4)
 v_mfma_f32_16x16x32_bf16 v[96:99], v[48:51], a[160:163], v[96:99]
 v_mfma_f32_16x16x32_bf16 v[96:99], v[52:55], a[176:179], v[96:99]
 s_add_u32 m0, s45, 106496
 s_nop 0
 buffer_load_dwordx4 v228, s[16:19], s97 offen offset:0 sc1 lds
 v_mfma_f32_16x16x32_bf16 v[112:115], v[52:55], a[180:183], v[112:115]
 v_mfma_f32_16x16x32_bf16 v[112:115], v[48:51], a[164:167], v[112:115]
 v_mfma_f32_16x16x32_bf16 v[104:107], v[48:51], a[168:171], v[104:107]
 v_mfma_f32_16x16x32_bf16 v[104:107], v[52:55], a[184:187], v[104:107]
 s_waitcnt vmcnt(11) lgkmcnt(0)
 s_barrier
 v_mfma_f32_16x16x32_bf16 v[120:123], v[52:55], a[188:191], v[120:123]
 ds_read_b64_tr_b16 v[32:33], v20 offset:0
 ds_read_b64_tr_b16 v[34:35], v20 offset:1024
 v_mfma_f32_16x16x32_bf16 v[120:123], v[48:51], a[172:175], v[120:123]
 ds_read_b64_tr_b16 v[36:37], v20 offset:8192
 ds_read_b64_tr_b16 v[38:39], v20 offset:9216
 buffer_load_dwordx4 v229, s[16:19], s97 offen offset:1024 sc1 lds
 v_mfma_f32_16x16x32_bf16 v[124:127], v[56:59], a[172:175], v[124:127]
 v_mfma_f32_16x16x32_bf16 v[124:127], v[60:63], a[188:191], v[124:127]
 buffer_load_dwordx4 v230, s[16:19], s97 offen offset:2048 sc1 lds
 v_mfma_f32_16x16x32_bf16 v[108:111], v[60:63], a[184:187], v[108:111]
 v_mfma_f32_16x16x32_bf16 v[108:111], v[56:59], a[168:171], v[108:111]
 s_mul_i32 s45, s3, 9216
 s_add_u32 m0, s45, 118784
 s_nop 0
 buffer_load_dwordx4 v254, s[16:19], s64 offen offset:0 sc1 lds
 v_mfma_f32_16x16x32_bf16 v[116:119], v[56:59], a[164:167], v[116:119]
 s_bitcmp1_b32 s58, 0
 s_cselect_b64 s[92:93], 0, -1
 s_cselect_b32 s83, -1, 0
 s_cselect_b32 s84, -1, 0
 s_mov_b32 s82, -1
 s_mov_b32 s85, 0
 v_mfma_f32_16x16x32_bf16 v[116:119], v[60:63], a[180:183], v[116:119]
 s_waitcnt vmcnt(10)
 v_cndmask_b32 v144, 0, v128, s[92:93]
 v_cndmask_b32 v145, 0, v129, s[92:93]
 v_mfma_f32_16x16x32_bf16 v[100:103], v[60:63], a[176:179], v[100:103]
 ds_read_b64_tr_b16 v[40:41], v21 offset:0
 ds_read_b64_tr_b16 v[42:43], v21 offset:1024
 v_mov_b32 v146, v130
 v_mfma_f32_16x16x32_bf16 v[100:103], v[56:59], a[160:163], v[100:103]
 v_mov_b32 v147, v131
 v_cndmask_b32 v148, 0, v132, s[82:83]
 s_waitcnt lgkmcnt(2)
 v_mfma_f32_16x16x32_bf16 v[64:67], v[32:35], a[192:195], v[64:67]
 ds_read_b64_tr_b16 v[44:45], v21 offset:8192
 ds_read_b64_tr_b16 v[46:47], v21 offset:9216
 v_mfma_f32_16x16x32_bf16 v[64:67], v[36:39], a[208:211], v[64:67]
 buffer_load_dwordx4 v254, s[16:19], s64 offen offset:1024 sc1 lds
 v_mfma_f32_16x16x32_bf16 v[80:83], v[36:39], a[212:215], v[80:83]
 v_cndmask_b32 v149, 0, v133, s[82:83]
 v_cndmask_b32 v150, 0, v134, s[84:85]
 v_mfma_f32_16x16x32_bf16 v[80:83], v[32:35], a[196:199], v[80:83]
 v_cndmask_b32 v151, 0, v135, s[84:85]
 v_mfma_f32_16x16x32_bf16 v[72:75], v[32:35], a[200:203], v[72:75]
 ds_read_b64_tr_b16 v[48:49], v22 offset:0
 ds_read_b64_tr_b16 v[50:51], v22 offset:1024
 v_mfma_f32_16x16x32_bf16 v[72:75], v[36:39], a[216:219], v[72:75]
 buffer_load_dwordx4 v236, s[16:19], s64 offen offset:2048 sc1 lds
 v_mfma_f32_16x16x32_bf16 v[88:91], v[36:39], a[220:223], v[88:91]
 ds_read_b64_tr_b16 v[52:53], v22 offset:8192
 ds_read_b64_tr_b16 v[54:55], v22 offset:9216
 v_mfma_f32_16x16x32_bf16 v[88:91], v[32:35], a[204:207], v[88:91]
 v_cndmask_b32 v152, v132, 0, s[82:83]
 s_waitcnt lgkmcnt(4)
 v_mfma_f32_16x16x32_bf16 v[92:95], v[40:43], a[204:207], v[92:95]
 s_add_u32 m0, s45, 121856
 s_nop 0
 buffer_load_dwordx4 v254, s[16:19], s65 offen offset:0 sc1 lds
 v_mfma_f32_16x16x32_bf16 v[92:95], v[44:47], a[220:223], v[92:95]
 buffer_load_dwordx4 v254, s[16:19], s65 offen offset:1024 sc1 lds
 v_mfma_f32_16x16x32_bf16 v[76:79], v[44:47], a[216:219], v[76:79]
 ds_read_b64_tr_b16 v[56:57], v23 offset:0
 ds_read_b64_tr_b16 v[58:59], v23 offset:1024
 v_mfma_f32_16x16x32_bf16 v[76:79], v[40:43], a[200:203], v[76:79]
 v_cndmask_b32 v153, v133, 0, s[82:83]
 v_cndmask_b32 v154, v134, 0, s[84:85]
 v_mfma_f32_16x16x32_bf16 v[84:87], v[40:43], a[196:199], v[84:87]
 ds_read_b64_tr_b16 v[60:61], v23 offset:8192
 ds_read_b64_tr_b16 v[62:63], v23 offset:9216
 v_mfma_f32_16x16x32_bf16 v[84:87], v[44:47], a[212:215], v[84:87]
 buffer_load_dwordx4 v236, s[16:19], s65 offen offset:2048 sc1 lds
 v_mfma_f32_16x16x32_bf16 v[68:71], v[44:47], a[208:211], v[68:71]
 v_cndmask_b32 v155, v135, 0, s[84:85]
 v_mov_b32 v156, v136
 v_mfma_f32_16x16x32_bf16 v[68:71], v[40:43], a[192:195], v[68:71]
 v_mov_b32 v157, v137
 s_waitcnt lgkmcnt(4)
 v_mfma_f32_16x16x32_bf16 v[96:99], v[48:51], a[192:195], v[96:99]
 v_cndmask_b32 v158, v138, 0, s[92:93]
 v_cndmask_b32 v159, v139, 0, s[92:93]
 v_mfma_f32_16x16x32_bf16 v[96:99], v[52:55], a[208:211], v[96:99]
 s_add_u32 m0, s45, 124928
 s_nop 0
 buffer_load_dwordx4 v254, s[16:19], s66 offen offset:0 sc1 lds
 v_mfma_f32_16x16x32_bf16 v[112:115], v[52:55], a[212:215], v[112:115]
 v_cvt_pk_bf16_f32 v64, v64, v65
 v_cvt_pk_bf16_f32 v65, v66, v67
 v_mfma_f32_16x16x32_bf16 v[112:115], v[48:51], a[196:199], v[112:115]
 buffer_load_dwordx4 v254, s[16:19], s66 offen offset:1024 sc1 lds
 v_mfma_f32_16x16x32_bf16 v[104:107], v[48:51], a[200:203], v[104:107]
 v_cvt_pk_bf16_f32 v66, v68, v69
 v_cvt_pk_bf16_f32 v67, v70, v71
 v_mfma_f32_16x16x32_bf16 v[104:107], v[52:55], a[216:219], v[104:107]
 v_pk_max_i16 v64, v64, 0
 v_pk_max_i16 v65, v65, 0
 v_mfma_f32_16x16x32_bf16 v[120:123], v[52:55], a[220:223], v[120:123]
 v_pk_max_i16 v66, v66, 0
 v_pk_max_i16 v67, v67, 0
 v_mfma_f32_16x16x32_bf16 v[120:123], v[48:51], a[204:207], v[120:123]
 buffer_load_dwordx4 v236, s[16:19], s66 offen offset:2048 sc1 lds
 s_waitcnt lgkmcnt(0)
 v_mfma_f32_16x16x32_bf16 v[124:127], v[56:59], a[204:207], v[124:127]
 v_cvt_pk_bf16_f32 v72, v72, v73
 v_cvt_pk_bf16_f32 v73, v74, v75
 v_mfma_f32_16x16x32_bf16 v[124:127], v[60:63], a[220:223], v[124:127]
 v_cvt_pk_bf16_f32 v74, v76, v77
 v_cvt_pk_bf16_f32 v75, v78, v79
 v_mfma_f32_16x16x32_bf16 v[108:111], v[60:63], a[216:219], v[108:111]
 v_pk_max_i16 v72, v72, 0
 v_pk_max_i16 v73, v73, 0
 v_mfma_f32_16x16x32_bf16 v[108:111], v[56:59], a[200:203], v[108:111]
 v_pk_max_i16 v74, v74, 0
 v_pk_max_i16 v75, v75, 0
 v_mfma_f32_16x16x32_bf16 v[116:119], v[56:59], a[196:199], v[116:119]
 v_cvt_pk_bf16_f32 v80, v80, v81
 v_cvt_pk_bf16_f32 v81, v82, v83
 v_mfma_f32_16x16x32_bf16 v[116:119], v[60:63], a[212:215], v[116:119]
 v_cvt_pk_bf16_f32 v82, v84, v85
 v_cvt_pk_bf16_f32 v83, v86, v87
 v_mfma_f32_16x16x32_bf16 v[100:103], v[60:63], a[208:211], v[100:103]
 v_pk_max_i16 v80, v80, 0
 v_pk_max_i16 v81, v81, 0
 v_mfma_f32_16x16x32_bf16 v[100:103], v[56:59], a[192:195], v[100:103]
 v_pk_max_i16 v82, v82, 0
 v_pk_max_i16 v83, v83, 0
L_att:
 s_waitcnt vmcnt(9)
 s_barrier
 ds_read_b128 v[168:171], v241 offset:0
 ds_read_b128 v[172:175], v241 offset:12288
 v_cvt_pk_bf16_f32 v88, v88, v89
 v_cvt_pk_bf16_f32 v89, v90, v91
 v_cvt_pk_bf16_f32 v90, v92, v93
 v_cvt_pk_bf16_f32 v91, v94, v95
 v_pk_max_i16 v88, v88, 0
 v_pk_max_i16 v89, v89, 0
 v_pk_max_i16 v90, v90, 0
 v_pk_max_i16 v91, v91, 0
 v_cvt_pk_bf16_f32 v96, v96, v97
 v_cvt_pk_bf16_f32 v97, v98, v99
 v_cvt_pk_bf16_f32 v98, v100, v101
 v_cvt_pk_bf16_f32 v99, v102, v103
 v_pk_max_i16 v96, v96, 0
 v_pk_max_i16 v97, v97, 0
 v_pk_max_i16 v98, v98, 0
 v_pk_max_i16 v99, v99, 0
 v_cvt_pk_bf16_f32 v104, v104, v105
 v_cvt_pk_bf16_f32 v105, v106, v107
 v_cvt_pk_bf16_f32 v106, v108, v109
 v_cvt_pk_bf16_f32 v107, v110, v111
 v_pk_max_i16 v104, v104, 0
 v_pk_max_i16 v105, v105, 0
 v_pk_max_i16 v106, v106, 0
 v_pk_max_i16 v107, v107, 0
 v_cvt_pk_bf16_f32 v112, v112, v113
 v_cvt_pk_bf16_f32 v113, v114, v115
 v_cvt_pk_bf16_f32 v114, v116, v117
 v_cvt_pk_bf16_f32 v115, v118, v119
 v_pk_max_i16 v112, v112, 0
 v_pk_max_i16 v113, v113, 0
 v_pk_max_i16 v114, v114, 0
 v_pk_max_i16 v115, v115, 0
 v_cvt_pk_bf16_f32 v120, v120, v121
 v_cvt_pk_bf16_f32 v121, v122, v123
 v_cvt_pk_bf16_f32 v122, v124, v125
 v_cvt_pk_bf16_f32 v123, v126, v127
 v_pk_max_i16 v120, v120, 0
 v_pk_max_i16 v121, v121, 0
 v_pk_max_i16 v122, v122, 0
 v_pk_max_i16 v123, v123, 0
 buffer_store_dwordx4 v[64:67], v226, s[16:19], s50 offen offset:0 sc1
 s_cmp_lt_u32 s59, 8
 s_cbranch_scc1 L_att_lo
 s_waitcnt lgkmcnt(0)
 v_mfma_f32_32x32x16_bf16 v[0:15], v[168:171], v[144:147], v[208:223]
 v_mfma_f32_32x32x16_bf16 v[0:15], v[172:175], v[148:151], v[0:15]
 ds_read_b128 v[168:171], v241 offset:1024
 ds_read_b128 v[172:175], v241 offset:13312
 s_waitcnt lgkmcnt(0)
 v_mfma_f32_32x32x16_bf16 v[16:31], v[168:171], v[144:147], 0
 buffer_store_dwordx4 v[72:75], v226, s[16:19], s51 offen offset:0 sc1
 s_nop 6
 v_exp_f32 v0, v0
 v_exp_f32 v1, v1
 v_exp_f32 v2, v2
 v_exp_f32 v3, v3
 v_mfma_f32_32x32x16_bf16 v[16:31], v[172:175], v[148:151], v[16:31]
 ds_read_b128 v[168:171], v241 offset:2048
 ds_read_b128 v[172:175], v241 offset:14336
 buffer_store_dwordx4 v[80:83], v226, s[16:19], s50 offen offset:128 sc1
 v_exp_f32 v4, v4
 v_exp_f32 v5, v5
 v_exp_f32 v6, v6
 v_exp_f32 v7, v7
 v_cvt_pk_bf16_f32 v0, v0, v1
 v_cvt_pk_bf16_f32 v1, v2, v3
 buffer_store_dwordx4 v[88:91], v226, s[16:19], s51 offen offset:128 sc1
 v_exp_f32 v8, v8
 v_exp_f32 v9, v9
 v_exp_f32 v10, v10
 v_exp_f32 v11, v11
 v_cvt_pk_bf16_f32 v2, v4, v5
 v_cvt_pk_bf16_f32 v3, v6, v7
 buffer_store_dwordx4 v[96:99], v226, s[16:19], s50 offen offset:2048 sc1
 v_exp_f32 v12, v12
 v_exp_f32 v13, v13
 v_exp_f32 v14, v14
 v_exp_f32 v15, v15
 v_cvt_pk_bf16_f32 v4, v8, v9
 v_cvt_pk_bf16_f32 v5, v10, v11
 v_cvt_pk_bf16_f32 v6, v12, v13
 v_cvt_pk_bf16_f32 v7, v14, v15
 s_waitcnt vmcnt(5)
 s_barrier
 s_mov_b64 exec, s[94:95]
 ds_read_b128 v[160:163], v240 offset:0
 ds_read_b128 v[164:167], v240 offset:1280
 s_mov_b64 exec, -1
 s_waitcnt lgkmcnt(2)
 v_mfma_f32_32x32x16_bf16 v[176:191], v[168:171], v[144:147], 0
 buffer_store_dwordx4 v[104:107], v226, s[16:19], s51 offen offset:2048 sc1
 v_exp_f32 v16, v16
 v_exp_f32 v17, v17
 v_exp_f32 v18, v18
 v_exp_f32 v19, v19
 v_mfma_f32_32x32x16_bf16 v[176:191], v[172:175], v[148:151], v[176:191]
 s_waitcnt lgkmcnt(0)
 ds_read_b128 v[168:171], v241 offset:3072
 ds_read_b128 v[172:175], v241 offset:15360
 buffer_store_dwordx4 v[112:115], v226, s[16:19], s50 offen offset:2176 sc1
 v_exp_f32 v20, v20
 v_exp_f32 v21, v21
 v_exp_f32 v22, v22
 v_exp_f32 v23, v23
 v_cvt_pk_bf16_f32 v16, v16, v17
 v_cvt_pk_bf16_f32 v17, v18, v19
 v_mfma_f32_32x32x16_bf16 v[32:47], v[160:163], v[0:3], 0
 buffer_store_dwordx4 v[120:123], v226, s[16:19], s51 offen offset:2176 sc1
 v_exp_f32 v24, v24
 v_exp_f32 v25, v25
 v_exp_f32 v26, v26
 v_exp_f32 v27, v27
 v_cvt_pk_bf16_f32 v18, v20, v21
 v_cvt_pk_bf16_f32 v19, v22, v23
 v_mfma_f32_32x32x16_bf16 v[32:47], v[164:167], v[4:7], v[32:47]
 s_mov_b64 exec, s[94:95]
 ds_read_b128 v[160:163], v240 offset:3072
 ds_read_b128 v[164:167], v240 offset:4352
 s_mov_b64 exec, -1
 v_add_u32 v242, 5120, v242
 global_load_dwordx4 a[80:83], v242, s[16:17] offset:-2048 sc1
 v_exp_f32 v28, v28
 v_exp_f32 v29, v29
 v_exp_f32 v30, v30
 v_exp_f32 v31, v31
 v_cvt_pk_bf16_f32 v20, v24, v25
 v_cvt_pk_bf16_f32 v21, v26, v27
 v_cvt_pk_bf16_f32 v22, v28, v29
 v_cvt_pk_bf16_f32 v23, v30, v31
 s_waitcnt lgkmcnt(2)
 v_mfma_f32_32x32x16_bf16 v[0:15], v[168:171], v[144:147], 0
 global_load_dwordx4 a[84:87], v242, s[16:17] offset:-1024 sc1
 v_exp_f32 v176, v176
 v_exp_f32 v177, v177
 v_exp_f32 v178, v178
 v_exp_f32 v179, v179
 v_mfma_f32_32x32x16_bf16 v[0:15], v[172:175], v[148:151], v[0:15]
 s_waitcnt lgkmcnt(0)
 ds_read_b128 v[168:171], v241 offset:4096
 ds_read_b128 v[172:175], v241 offset:16384
 global_load_dwordx4 a[88:91], v242, s[16:17] offset:0 sc1
 v_exp_f32 v180, v180
 v_exp_f32 v181, v181
 v_exp_f32 v182, v182
 v_exp_f32 v183, v183
 v_cvt_pk_bf16_f32 v176, v176, v177
 v_cvt_pk_bf16_f32 v177, v178, v179
 v_mfma_f32_32x32x16_bf16 v[32:47], v[160:163], v[16:19], v[32:47]
 global_load_dwordx4 a[92:95], v242, s[16:17] offset:1024 sc1
 v_exp_f32 v184, v184
 v_exp_f32 v185, v185
 v_exp_f32 v186, v186
 v_exp_f32 v187, v187
 v_cvt_pk_bf16_f32 v178, v180, v181
 v_cvt_pk_bf16_f32 v179, v182, v183
 v_mfma_f32_32x32x16_bf16 v[32:47], v[164:167], v[20:23], v[32:47]
 s_mov_b64 exec, s[94:95]
 ds_read_b128 v[160:163], v240 offset:6144
 ds_read_b128 v[164:167], v240 offset:7424
 s_mov_b64 exec, -1
 global_load_dwordx4 a[96:99], v242, s[16:17] offset:2048 sc1
 v_exp_f32 v188, v188
 v_exp_f32 v189, v189
 v_exp_f32 v190, v190
 v_exp_f32 v191, v191
 v_cvt_pk_bf16_f32 v180, v184, v185
 v_cvt_pk_bf16_f32 v181, v186, v187
 v_cvt_pk_bf16_f32 v182, v188, v189
 v_cvt_pk_bf16_f32 v183, v190, v191
 s_waitcnt lgkmcnt(2)
 v_mfma_f32_32x32x16_bf16 v[16:31], v[168:171], v[144:147], 0
 v_add_u32 v242, 5120, v242
 global_load_dwordx4 a[100:103], v242, s[16:17] offset:-2048 sc1
 v_exp_f32 v0, v0
 v_exp_f32 v1, v1
 v_exp_f32 v2, v2
 v_exp_f32 v3, v3
 v_mfma_f32_32x32x16_bf16 v[16:31], v[172:175], v[148:151], v[16:31]
 s_waitcnt lgkmcnt(0)
 ds_read_b128 v[168:171], v241 offset:5120
 ds_read_b128 v[172:175], v241 offset:17408
 global_load_dwordx4 a[104:107], v242, s[16:17] offset:-1024 sc1
 v_exp_f32 v4, v4
 v_exp_f32 v5, v5
 v_exp_f32 v6, v6
 v_exp_f32 v7, v7
 v_cvt_pk_bf16_f32 v0, v0, v1
 v_cvt_pk_bf16_f32 v1, v2, v3
 v_mfma_f32_32x32x16_bf16 v[32:47], v[160:163], v[176:179], v[32:47]
 global_load_dwordx4 a[108:111], v242, s[16:17] offset:0 sc1
 v_exp_f32 v8, v8
 v_exp_f32 v9, v9
 v_exp_f32 v10, v10
 v_exp_f32 v11, v11
 v_cvt_pk_bf16_f32 v2, v4, v5
 v_cvt_pk_bf16_f32 v3, v6, v7
 v_mfma_f32_32x32x16_bf16 v[32:47], v[164:167], v[180:183], v[32:47]
 s_mov_b64 exec, s[94:95]
 ds_read_b128 v[160:163], v240 offset:9216
 ds_read_b128 v[164:167], v240 offset:10496
 s_mov_b64 exec, -1
 global_load_dwordx4 a[112:115], v242, s[16:17] offset:1024 sc1
 v_exp_f32 v12, v12
 v_exp_f32 v13, v13
 v_exp_f32 v14, v14
 v_exp_f32 v15, v15
 v_cvt_pk_bf16_f32 v4, v8, v9
 v_cvt_pk_bf16_f32 v5, v10, v11
 v_cvt_pk_bf16_f32 v6, v12, v13
 v_cvt_pk_bf16_f32 v7, v14, v15
 s_waitcnt lgkmcnt(2)
 v_mfma_f32_32x32x16_bf16 v[176:191], v[168:171], v[144:147], 0
 global_load_dwordx4 a[116:119], v242, s[16:17] offset:2048 sc1
 v_exp_f32 v16, v16
 v_exp_f32 v17, v17
 v_exp_f32 v18, v18
 v_exp_f32 v19, v19
 v_mfma_f32_32x32x16_bf16 v[176:191], v[172:175], v[148:151], v[176:191]
 s_waitcnt lgkmcnt(0)
 ds_read_b128 v[168:171], v241 offset:6144
 ds_read_b128 v[172:175], v241 offset:18432
 v_add_u32 v242, 5120, v242
 global_load_dwordx4 a[120:123], v242, s[16:17] offset:-2048 sc1
 v_exp_f32 v20, v20
 v_exp_f32 v21, v21
 v_exp_f32 v22, v22
 v_exp_f32 v23, v23
 v_cvt_pk_bf16_f32 v16, v16, v17
 v_cvt_pk_bf16_f32 v17, v18, v19
 v_mfma_f32_32x32x16_bf16 v[32:47], v[160:163], v[0:3], v[32:47]
 global_load_dwordx4 a[124:127], v242, s[16:17] offset:-1024 sc1
 v_exp_f32 v24, v24
 v_exp_f32 v25, v25
 v_exp_f32 v26, v26
 v_exp_f32 v27, v27
 v_cvt_pk_bf16_f32 v18, v20, v21
 v_cvt_pk_bf16_f32 v19, v22, v23
 v_mfma_f32_32x32x16_bf16 v[32:47], v[164:167], v[4:7], v[32:47]
 s_mov_b64 exec, s[94:95]
 ds_read_b128 v[160:163], v240 offset:12288
 ds_read_b128 v[164:167], v240 offset:13568
 s_mov_b64 exec, -1
 global_load_dwordx4 a[128:131], v242, s[16:17] offset:0 sc1
 v_exp_f32 v28, v28
 v_exp_f32 v29, v29
 v_exp_f32 v30, v30
 v_exp_f32 v31, v31
 v_cvt_pk_bf16_f32 v20, v24, v25
 v_cvt_pk_bf16_f32 v21, v26, v27
 v_cvt_pk_bf16_f32 v22, v28, v29
 v_cvt_pk_bf16_f32 v23, v30, v31
 s_waitcnt lgkmcnt(2)
 v_mfma_f32_32x32x16_bf16 v[0:15], v[168:171], v[144:147], 0
 global_load_dwordx4 a[132:135], v242, s[16:17] offset:1024 sc1
 v_exp_f32 v176, v176
 v_exp_f32 v177, v177
 v_exp_f32 v178, v178
 v_exp_f32 v179, v179
 v_mfma_f32_32x32x16_bf16 v[0:15], v[172:175], v[148:151], v[0:15]
 s_waitcnt lgkmcnt(0)
 ds_read_b128 v[168:171], v241 offset:7168
 ds_read_b128 v[172:175], v241 offset:19456
 global_load_dwordx4 a[136:139], v242, s[16:17] offset:2048 sc1
 v_exp_f32 v180, v180
 v_exp_f32 v181, v181
 v_exp_f32 v182, v182
 v_exp_f32 v183, v183
 v_cvt_pk_bf16_f32 v176, v176, v177
 v_cvt_pk_bf16_f32 v177, v178, v179
 v_mfma_f32_32x32x16_bf16 v[32:47], v[160:163], v[16:19], v[32:47]
 v_add_u32 v242, 5120, v242
 global_load_dwordx4 a[140:143], v242, s[16:17] offset:-2048 sc1
 v_exp_f32 v184, v184
 v_exp_f32 v185, v185
 v_exp_f32 v186, v186
 v_exp_f32 v187, v187
 v_cvt_pk_bf16_f32 v178, v180, v181
 v_cvt_pk_bf16_f32 v179, v182, v183
 v_mfma_f32_32x32x16_bf16 v[32:47], v[164:167], v[20:23], v[32:47]
 s_mov_b64 exec, s[94:95]
 ds_read_b128 v[160:163], v240 offset:15360
 ds_read_b128 v[164:167], v240 offset:16640
 s_mov_b64 exec, -1
 global_load_dwordx4 a[144:147], v242, s[16:17] offset:-1024 sc1
 v_exp_f32 v188, v188
 v_exp_f32 v189, v189
 v_exp_f32 v190, v190
 v_exp_f32 v191, v191
 v_cvt_pk_bf16_f32 v180, v184, v185
 v_cvt_pk_bf16_f32 v181, v186, v187
 v_cvt_pk_bf16_f32 v182, v188, v189
 v_cvt_pk_bf16_f32 v183, v190, v191
 s_waitcnt lgkmcnt(2)
 v_mfma_f32_32x32x16_bf16 v[16:31], v[168:171], v[144:147], 0
 s_waitcnt vmcnt(17)
 s_mov_b64 exec, 1
 buffer_store_dwordx2 v[252:253], v237, s[16:19], s53 offen offset:32 sc1
 s_mov_b64 exec, -1
 v_exp_f32 v0, v0
 v_exp_f32 v1, v1
 v_exp_f32 v2, v2
 v_exp_f32 v3, v3
 v_mfma_f32_32x32x16_bf16 v[16:31], v[172:175], v[148:151], v[16:31]
 s_waitcnt lgkmcnt(0)
 ds_read_b128 v[168:171], v241 offset:8192
 ds_read_b128 v[172:175], v241 offset:20480
 global_load_dwordx4 a[148:151], v242, s[16:17] offset:0 sc1
 v_exp_f32 v4, v4
 v_exp_f32 v5, v5
 v_exp_f32 v6, v6
 v_exp_f32 v7, v7
 v_cvt_pk_bf16_f32 v0, v0, v1
 v_cvt_pk_bf16_f32 v1, v2, v3
 v_mfma_f32_32x32x16_bf16 v[32:47], v[160:163], v[176:179], v[32:47]
 global_load_dwordx4 a[152:155], v242, s[16:17] offset:1024 sc1
 v_exp_f32 v8, v8
 v_exp_f32 v9, v9
 v_exp_f32 v10, v10
 v_exp_f32 v11, v11
 v_cvt_pk_bf16_f32 v2, v4, v5
 v_cvt_pk_bf16_f32 v3, v6, v7
 v_mfma_f32_32x32x16_bf16 v[32:47], v[164:167], v[180:183], v[32:47]
 s_mov_b64 exec, s[94:95]
 ds_read_b128 v[160:163], v240 offset:18432
 ds_read_b128 v[164:167], v240 offset:19712
 s_mov_b64 exec, -1
 global_load_dwordx4 a[156:159], v242, s[16:17] offset:2048 sc1
 v_exp_f32 v12, v12
 v_exp_f32 v13, v13
 v_exp_f32 v14, v14
 v_exp_f32 v15, v15
 v_cvt_pk_bf16_f32 v4, v8, v9
 v_cvt_pk_bf16_f32 v5, v10, v11
 v_cvt_pk_bf16_f32 v6, v12, v13
 v_cvt_pk_bf16_f32 v7, v14, v15
 s_waitcnt lgkmcnt(2)
 v_mfma_f32_32x32x16_bf16 v[176:191], v[168:171], v[144:147], v[192:207]
 v_add_u32 v242, 5120, v242
 global_load_dwordx4 a[160:163], v242, s[16:17] offset:-2048 sc1
 v_exp_f32 v16, v16
 v_exp_f32 v17, v17
 v_exp_f32 v18, v18
 v_exp_f32 v19, v19
 v_mfma_f32_32x32x16_bf16 v[176:191], v[172:175], v[148:151], v[176:191]
 s_waitcnt lgkmcnt(0)
 ds_read_b128 v[168:171], v241 offset:12288
 ds_read_b128 v[172:175], v241 offset:24576
 global_load_dwordx4 a[164:167], v242, s[16:17] offset:-1024 sc1
 v_exp_f32 v20, v20
 v_exp_f32 v21, v21
 v_exp_f32 v22, v22
 v_exp_f32 v23, v23
 v_cvt_pk_bf16_f32 v16, v16, v17
 v_cvt_pk_bf16_f32 v17, v18, v19
 v_mfma_f32_32x32x16_bf16 v[32:47], v[160:163], v[0:3], v[32:47]
 global_load_dwordx4 a[168:171], v242, s[16:17] offset:0 sc1
 v_exp_f32 v24, v24
 v_exp_f32 v25, v25
 v_exp_f32 v26, v26
 v_exp_f32 v27, v27
 v_cvt_pk_bf16_f32 v18, v20, v21
 v_cvt_pk_bf16_f32 v19, v22, v23
 v_mfma_f32_32x32x16_bf16 v[32:47], v[164:167], v[4:7], v[32:47]
 s_mov_b64 exec, s[94:95]
 ds_read_b128 v[160:163], v240 offset:21504
 ds_read_b128 v[164:167], v240 offset:22784
 s_mov_b64 exec, -1
 global_load_dwordx4 a[172:175], v242, s[16:17] offset:1024 sc1
 v_exp_f32 v28, v28
 v_exp_f32 v29, v29
 v_exp_f32 v30, v30
 v_exp_f32 v31, v31
 v_cvt_pk_bf16_f32 v20, v24, v25
 v_cvt_pk_bf16_f32 v21, v26, v27
 v_cvt_pk_bf16_f32 v22, v28, v29
 v_cvt_pk_bf16_f32 v23, v30, v31
 s_waitcnt lgkmcnt(2)
 v_mfma_f32_32x32x16_bf16 v[0:15], v[168:171], v[152:155], v[208:223]
 global_load_dwordx4 a[176:179], v242, s[16:17] offset:2048 sc1
 v_exp_f32 v176, v176
 v_exp_f32 v177, v177
 v_exp_f32 v178, v178
 v_exp_f32 v179, v179
 v_mfma_f32_32x32x16_bf16 v[0:15], v[172:175], v[156:159], v[0:15]
 s_waitcnt lgkmcnt(0)
 ds_read_b128 v[168:171], v241 offset:13312
 ds_read_b128 v[172:175], v241 offset:25600
 v_add_u32 v242, 5120, v242
 global_load_dwordx4 a[180:183], v242, s[16:17] offset:-2048 sc1
 v_exp_f32 v180, v180
 v_exp_f32 v181, v181
 v_exp_f32 v182, v182
 v_exp_f32 v183, v183
 v_cvt_pk_bf16_f32 v176, v176, v177
 v_cvt_pk_bf16_f32 v177, v178, v179
 v_mfma_f32_32x32x16_bf16 v[32:47], v[160:163], v[16:19], v[32:47]
 global_load_dwordx4 a[184:187], v242, s[16:17] offset:-1024 sc1
 v_exp_f32 v184, v184
 v_exp_f32 v185, v185
 v_exp_f32 v186, v186
 v_exp_f32 v187, v187
 v_cvt_pk_bf16_f32 v178, v180, v181
 v_cvt_pk_bf16_f32 v179, v182, v183
 v_mfma_f32_32x32x16_bf16 v[32:47], v[164:167], v[20:23], v[32:47]
 s_mov_b64 exec, s[94:95]
 ds_read_b128 v[160:163], v240 offset:24576
 ds_read_b128 v[164:167], v240 offset:25856
 s_mov_b64 exec, -1
 global_load_dwordx4 a[188:191], v242, s[16:17] offset:0 sc1
 v_exp_f32 v188, v188
 v_exp_f32 v189, v189
 v_exp_f32 v190, v190
 v_exp_f32 v191, v191
 v_cvt_pk_bf16_f32 v180, v184, v185
 v_cvt_pk_bf16_f32 v181, v186, v187
 v_cvt_pk_bf16_f32 v182, v188, v189
 v_cvt_pk_bf16_f32 v183, v190, v191
 s_waitcnt lgkmcnt(2)
 v_mfma_f32_32x32x16_bf16 v[16:31], v[168:171], v[152:155], 0
 global_load_dwordx4 a[192:195], v242, s[16:17] offset:1024 sc1
 v_exp_f32 v0, v0
 v_exp_f32 v1, v1
 v_exp_f32 v2, v2
 v_exp_f32 v3, v3
 v_mfma_f32_32x32x16_bf16 v[16:31], v[172:175], v[156:159], v[16:31]
 s_waitcnt lgkmcnt(0)
 ds_read_b128 v[168:171], v241 offset:14336
 ds_read_b128 v[172:175], v241 offset:26624
 global_load_dwordx4 a[196:199], v242, s[16:17] offset:2048 sc1
 v_exp_f32 v4, v4
 v_exp_f32 v5, v5
 v_exp_f32 v6, v6
 v_exp_f32 v7, v7
 v_cvt_pk_bf16_f32 v0, v0, v1
 v_cvt_pk_bf16_f32 v1, v2, v3
 v_mfma_f32_32x32x16_bf16 v[32:47], v[160:163], v[176:179], v[32:47]
 v_add_u32 v242, 5120, v242
 global_load_dwordx4 a[200:203], v242, s[16:17] offset:-2048 sc1
 v_exp_f32 v8, v8
 v_exp_f32 v9, v9
 v_exp_f32 v10, v10
 v_exp_f32 v11, v11
 v_cvt_pk_bf16_f32 v2, v4, v5
 v_cvt_pk_bf16_f32 v3, v6, v7
 v_mfma_f32_32x32x16_bf16 v[32:47], v[164:167], v[180:183], v[32:47]
 s_mov_b64 exec, s[94:95]
 ds_read_b128 v[160:163], v240 offset:320
 ds_read_b128 v[164:167], v240 offset:1600
 s_mov_b64 exec, -1
 global_load_dwordx4 a[204:207], v242, s[16:17] offset:-1024 sc1
 v_exp_f32 v12, v12
 v_exp_f32 v13, v13
 v_exp_f32 v14, v14
 v_exp_f32 v15, v15
 v_cvt_pk_bf16_f32 v4, v8, v9
 v_cvt_pk_bf16_f32 v5, v10, v11
 v_cvt_pk_bf16_f32 v6, v12, v13
 v_cvt_pk_bf16_f32 v7, v14, v15
 s_waitcnt lgkmcnt(2)
 v_mfma_f32_32x32x16_bf16 v[176:191], v[168:171], v[152:155], 0
 global_load_dwordx4 a[208:211], v242, s[16:17] offset:0 sc1
 v_exp_f32 v16, v16
 v_exp_f32 v17, v17
 v_exp_f32 v18, v18
 v_exp_f32 v19, v19
 v_mfma_f32_32x32x16_bf16 v[176:191], v[172:175], v[156:159], v[176:191]
 s_waitcnt lgkmcnt(0)
 ds_read_b128 v[168:171], v241 offset:15360
 ds_read_b128 v[172:175], v241 offset:27648
 global_load_dwordx4 a[212:215], v242, s[16:17] offset:1024 sc1
 v_exp_f32 v20, v20
 v_exp_f32 v21, v21
 v_exp_f32 v22, v22
 v_exp_f32 v23, v23
 v_cvt_pk_bf16_f32 v16, v16, v17
 v_cvt_pk_bf16_f32 v17, v18, v19
 v_mfma_f32_32x32x16_bf16 v[48:63], v[160:163], v[0:3], 0
 global_load_dwordx4 a[216:219], v242, s[16:17] offset:2048 sc1
 v_exp_f32 v24, v24
 v_exp_f32 v25, v25
 v_exp_f32 v26, v26
 v_exp_f32 v27, v27
 v_cvt_pk_bf16_f32 v18, v20, v21
 v_cvt_pk_bf16_f32 v19, v22, v23
 v_mfma_f32_32x32x16_bf16 v[48:63], v[164:167], v[4:7], v[48:63]
 s_mov_b64 exec, s[94:95]
 ds_read_b128 v[160:163], v240 offset:3392
 ds_read_b128 v[164:167], v240 offset:4672
 s_mov_b64 exec, -1
 v_add_u32 v242, 5120, v242
 global_load_dwordx4 a[220:223], v242, s[16:17] offset:-2048 sc1
 v_exp_f32 v28, v28
 v_exp_f32 v29, v29
 v_exp_f32 v30, v30
 v_exp_f32 v31, v31
 v_cvt_pk_bf16_f32 v20, v24, v25
 v_cvt_pk_bf16_f32 v21, v26, v27
 v_cvt_pk_bf16_f32 v22, v28, v29
 v_cvt_pk_bf16_f32 v23, v30, v31
 s_waitcnt lgkmcnt(2)
 v_mfma_f32_32x32x16_bf16 v[0:15], v[168:171], v[152:155], 0
 global_load_dwordx4 a[224:227], v242, s[16:17] offset:-1024 sc1
 v_exp_f32 v176, v176
 v_exp_f32 v177, v177
 v_exp_f32 v178, v178
 v_exp_f32 v179, v179
 v_mfma_f32_32x32x16_bf16 v[0:15], v[172:175], v[156:159], v[0:15]
 s_waitcnt lgkmcnt(0)
 ds_read_b128 v[168:171], v241 offset:16384
 ds_read_b128 v[172:175], v241 offset:28672
 global_load_dwordx4 a[228:231], v242, s[16:17] offset:0 sc1
 v_exp_f32 v180, v180
 v_exp_f32 v181, v181
 v_exp_f32 v182, v182
 v_exp_f32 v183, v183
 v_cvt_pk_bf16_f32 v176, v176, v177
 v_cvt_pk_bf16_f32 v177, v178, v179
 v_mfma_f32_32x32x16_bf16 v[48:63], v[160:163], v[16:19], v[48:63]
 global_load_dwordx4 a[232:235], v242, s[16:17] offset:1024 sc1
 v_exp_f32 v184, v184
 v_exp_f32 v185, v185
 v_exp_f32 v186, v186
 v_exp_f32 v187, v187
 v_cvt_pk_bf16_f32 v178, v180, v181
 v_cvt_pk_bf16_f32 v179, v182, v183
 v_mfma_f32_32x32x16_bf16 v[48:63], v[164:167], v[20:23], v[48:63]
 s_mov_b64 exec, s[94:95]
 ds_read_b128 v[160:163], v240 offset:6464
 ds_read_b128 v[164:167], v240 offset:7744
 s_mov_b64 exec, -1
 global_load_dwordx4 a[236:239], v242, s[16:17] offset:2048 sc1
 v_exp_f32 v188, v188
 v_exp_f32 v189, v189
 v_exp_f32 v190, v190
 v_exp_f32 v191, v191
 v_cvt_pk_bf16_f32 v180, v184, v185
 v_cvt_pk_bf16_f32 v181, v186, v187
 v_cvt_pk_bf16_f32 v182, v188, v189
 v_cvt_pk_bf16_f32 v183, v190, v191
 s_waitcnt lgkmcnt(2)
 v_mfma_f32_32x32x16_bf16 v[16:31], v[168:171], v[152:155], 0
 s_mul_i32 s44, s3, 20480
 s_lshl_b32 s42, s3, 3
 s_lshr_b32 s42, 0x1c242d36, s42
 s_and_b32 s42, s42, 0xff
 s_mul_i32 s42, s42, 5120
 s_add_u32 s0, s42, s73
 s_add_u32 m0, s44, 0
 s_add_u32 s0, s0, -2048
 buffer_load_dwordx4 v254, s[16:19], s0 offen offset:0 sc1 lds
 v_exp_f32 v0, v0
 v_exp_f32 v1, v1
 v_exp_f32 v2, v2
 v_exp_f32 v3, v3
 v_mfma_f32_32x32x16_bf16 v[16:31], v[172:175], v[156:159], v[16:31]
 s_waitcnt lgkmcnt(0)
 ds_read_b128 v[168:171], v241 offset:17408
 ds_read_b128 v[172:175], v241 offset:29696
 buffer_load_dwordx4 v254, s[16:19], s0 offen offset:1024 sc1 lds
 v_exp_f32 v4, v4
 v_exp_f32 v5, v5
 v_exp_f32 v6, v6
 v_exp_f32 v7, v7
 v_cvt_pk_bf16_f32 v0, v0, v1
 v_cvt_pk_bf16_f32 v1, v2, v3
 v_mfma_f32_32x32x16_bf16 v[48:63], v[160:163], v[176:179], v[48:63]
 buffer_load_dwordx2 v[246:247], v243, s[16:19], 0 offen sc1
 v_exp_f32 v8, v8
 v_exp_f32 v9, v9
 v_exp_f32 v10, v10
 v_exp_f32 v11, v11
 v_cvt_pk_bf16_f32 v2, v4, v5
 v_cvt_pk_bf16_f32 v3, v6, v7
 v_mfma_f32_32x32x16_bf16 v[48:63], v[164:167], v[180:183], v[48:63]
 s_mov_b64 exec, s[94:95]
 ds_read_b128 v[160:163], v240 offset:9536
 ds_read_b128 v[164:167], v240 offset:10816
 s_mov_b64 exec, -1
 buffer_load_dwordx4 v254, s[16:19], s0 offen offset:2048 sc1 lds
 v_exp_f32 v12, v12
 v_exp_f32 v13, v13
 v_exp_f32 v14, v14
 v_exp_f32 v15, v15
 v_cvt_pk_bf16_f32 v4, v8, v9
 v_cvt_pk_bf16_f32 v5, v10, v11
 v_cvt_pk_bf16_f32 v6, v12, v13
 v_cvt_pk_bf16_f32 v7, v14, v15
 s_waitcnt lgkmcnt(2)
 v_mfma_f32_32x32x16_bf16 v[176:191], v[168:171], v[152:155], 0
 buffer_load_dwordx4 v254, s[16:19], s0 offen offset:3072 sc1 lds
 v_exp_f32 v16, v16
 v_exp_f32 v17, v17
 v_exp_f32 v18, v18
 v_exp_f32 v19, v19
 v_mfma_f32_32x32x16_bf16 v[176:191], v[172:175], v[156:159], v[176:191]
 s_waitcnt lgkmcnt(0)
 ds_read_b128 v[168:171], v241 offset:18432
 ds_read_b128 v[172:175], v241 offset:30720
 s_add_u32 m0, s44, 4096
 s_add_u32 s0, s0, 4096
 buffer_load_dwordx4 v254, s[16:19], s0 offen offset:0 sc1 lds
 v_exp_f32 v20, v20
 v_exp_f32 v21, v21
 v_exp_f32 v22, v22
 v_exp_f32 v23, v23
 v_cvt_pk_bf16_f32 v16, v16, v17
 v_cvt_pk_bf16_f32 v17, v18, v19
 v_mfma_f32_32x32x16_bf16 v[48:63], v[160:163], v[0:3], v[48:63]
 buffer_load_dwordx4 v254, s[16:19], s0 offen offset:1024 sc1 lds
 v_exp_f32 v24, v24
 v_exp_f32 v25, v25
 v_exp_f32 v26, v26
 v_exp_f32 v27, v27
 v_cvt_pk_bf16_f32 v18, v20, v21
 v_cvt_pk_bf16_f32 v19, v22, v23
 v_mfma_f32_32x32x16_bf16 v[48:63], v[164:167], v[4:7], v[48:63]
 s_mov_b64 exec, s[94:95]
 ds_read_b128 v[160:163], v240 offset:12608
 ds_read_b128 v[164:167], v240 offset:13888
 s_mov_b64 exec, -1
 buffer_load_dwordx4 v254, s[16:19], s0 offen offset:2048 sc1 lds
 v_exp_f32 v28, v28
 v_exp_f32 v29, v29
 v_exp_f32 v30, v30
 v_exp_f32 v31, v31
 v_cvt_pk_bf16_f32 v20, v24, v25
 v_cvt_pk_bf16_f32 v21, v26, v27
 v_cvt_pk_bf16_f32 v22, v28, v29
 v_cvt_pk_bf16_f32 v23, v30, v31
 s_waitcnt lgkmcnt(2)
 v_mfma_f32_32x32x16_bf16 v[0:15], v[168:171], v[152:155], 0
 buffer_load_dwordx4 v254, s[16:19], s0 offen offset:3072 sc1 lds
 v_exp_f32 v176, v176
 v_exp_f32 v177, v177
 v_exp_f32 v178, v178
 v_exp_f32 v179, v179
 v_mfma_f32_32x32x16_bf16 v[0:15], v[172:175], v[156:159], v[0:15]
 s_waitcnt lgkmcnt(0)
 ds_read_b128 v[168:171], v241 offset:19456
 ds_read_b128 v[172:175], v241 offset:31744
 s_add_u32 m0, s44, 8192
 s_add_u32 s0, s0, 4096
 buffer_load_dwordx4 v254, s[16:19], s0 offen offset:0 sc1 lds
 v_exp_f32 v180, v180
 v_exp_f32 v181, v181
 v_exp_f32 v182, v182
 v_exp_f32 v183, v183
 v_cvt_pk_bf16_f32 v176, v176, v177
 v_cvt_pk_bf16_f32 v177, v178, v179
 v_mfma_f32_32x32x16_bf16 v[48:63], v[160:163], v[16:19], v[48:63]
 buffer_load_dwordx4 v254, s[16:19], s0 offen offset:1024 sc1 lds
 v_exp_f32 v184, v184
 v_exp_f32 v185, v185
 v_exp_f32 v186, v186
 v_exp_f32 v187, v187
 v_cvt_pk_bf16_f32 v178, v180, v181
 v_cvt_pk_bf16_f32 v179, v182, v183
 v_mfma_f32_32x32x16_bf16 v[48:63], v[164:167], v[20:23], v[48:63]
 s_mov_b64 exec, s[94:95]
 ds_read_b128 v[160:163], v240 offset:15680
 ds_read_b128 v[164:167], v240 offset:16960
 s_mov_b64 exec, -1
 v_exp_f32 v188, v188
 v_exp_f32 v189, v189
 v_exp_f32 v190, v190
 v_exp_f32 v191, v191
 v_cvt_pk_bf16_f32 v180, v184, v185
 v_cvt_pk_bf16_f32 v181, v186, v187
 v_cvt_pk_bf16_f32 v182, v188, v189
 v_cvt_pk_bf16_f32 v183, v190, v191
 s_waitcnt lgkmcnt(2)
 v_mfma_f32_32x32x16_bf16 v[16:31], v[168:171], v[152:155], 0
 v_exp_f32 v0, v0
 v_exp_f32 v1, v1
 v_exp_f32 v2, v2
 v_exp_f32 v3, v3
 v_mfma_f32_32x32x16_bf16 v[16:31], v[172:175], v[156:159], v[16:31]
 s_waitcnt lgkmcnt(0)
 ds_read_b128 v[168:171], v241 offset:20480
 ds_read_b128 v[172:175], v241 offset:32768
 s_waitcnt vmcnt(8)
 v_cmp_ne_u64 vcc, s[90:91], v[246:247]
 s_nop 0
 s_cbranch_vccnz L_poll_11
L_poll_ok_12:
 buffer_load_dword v227, v227, s[16:19], 0 offen sc1
 v_exp_f32 v4, v4
 v_exp_f32 v5, v5
 v_exp_f32 v6, v6
 v_exp_f32 v7, v7
 v_cvt_pk_bf16_f32 v0, v0, v1
 v_cvt_pk_bf16_f32 v1, v2, v3
 v_mfma_f32_32x32x16_bf16 v[48:63], v[160:163], v[176:179], v[48:63]
 buffer_load_dwordx4 v[64:67], v232, s[16:19], 0 offen offset:0 sc1
 v_exp_f32 v8, v8
 v_exp_f32 v9, v9
 v_exp_f32 v10, v10
 v_exp_f32 v11, v11
 v_cvt_pk_bf16_f32 v2, v4, v5
 v_cvt_pk_bf16_f32 v3, v6, v7
 v_mfma_f32_32x32x16_bf16 v[48:63], v[164:167], v[180:183], v[48:63]
 s_mov_b64 exec, s[94:95]
 ds_read_b128 v[160:163], v240 offset:18752
 ds_read_b128 v[164:167], v240 offset:20032
 s_mov_b64 exec, -1
 buffer_load_dwordx4 v[80:83], v232, s[16:19], 0 offen offset:2048 sc1
 v_exp_f32 v12, v12
 v_exp_f32 v13, v13
 v_exp_f32 v14, v14
 v_exp_f32 v15, v15
 v_cvt_pk_bf16_f32 v4, v8, v9
 v_cvt_pk_bf16_f32 v5, v10, v11
 v_cvt_pk_bf16_f32 v6, v12, v13
 v_cvt_pk_bf16_f32 v7, v14, v15
 s_waitcnt lgkmcnt(2)
 v_mfma_f32_32x32x16_bf16 v[176:191], v[168:171], v[152:155], v[192:207]
 buffer_load_dwordx4 v[68:71], v233, s[16:19], 0 offen offset:0 sc1
 v_exp_f32 v16, v16
 v_exp_f32 v17, v17
 v_exp_f32 v18, v18
 v_exp_f32 v19, v19
 v_mfma_f32_32x32x16_bf16 v[176:191], v[172:175], v[156:159], v[176:191]
 s_waitcnt lgkmcnt(0)
 buffer_load_dwordx4 v[84:87], v233, s[16:19], 0 offen offset:2048 sc1
 v_exp_f32 v20, v20
 v_exp_f32 v21, v21
 v_exp_f32 v22, v22
 v_exp_f32 v23, v23
 v_cvt_pk_bf16_f32 v16, v16, v17
 v_cvt_pk_bf16_f32 v17, v18, v19
 v_mfma_f32_32x32x16_bf16 v[48:63], v[160:163], v[0:3], v[48:63]
 buffer_load_dwordx4 v[72:75], v234, s[16:19], 0 offen offset:0 sc1
 v_exp_f32 v24, v24
 v_exp_f32 v25, v25
 v_exp_f32 v26, v26
 v_exp_f32 v27, v27
 v_cvt_pk_bf16_f32 v18, v20, v21
 v_cvt_pk_bf16_f32 v19, v22, v23
 v_mfma_f32_32x32x16_bf16 v[48:63], v[164:167], v[4:7], v[48:63]
 s_mov_b64 exec, s[94:95]
 ds_read_b128 v[160:163], v240 offset:21824
 ds_read_b128 v[164:167], v240 offset:23104
 s_mov_b64 exec, -1
 buffer_load_dwordx4 v[88:91], v234, s[16:19], 0 offen offset:2048 sc1
 v_exp_f32 v28, v28
 v_exp_f32 v29, v29
 v_exp_f32 v30, v30
 v_exp_f32 v31, v31
 v_cvt_pk_bf16_f32 v20, v24, v25
 v_cvt_pk_bf16_f32 v21, v26, v27
 v_cvt_pk_bf16_f32 v22, v28, v29
 v_cvt_pk_bf16_f32 v23, v30, v31
 buffer_load_dwordx4 v[76:79], v235, s[16:19], 0 offen offset:0 sc1
 v_exp_f32 v176, v176
 v_exp_f32 v177, v177
 v_exp_f32 v178, v178
 v_exp_f32 v179, v179
 s_waitcnt lgkmcnt(0)
 buffer_load_dwordx4 v[92:95], v235, s[16:19], 0 offen offset:2048 sc1
 v_exp_f32 v180, v180
 v_exp_f32 v181, v181
 v_exp_f32 v182, v182
 v_exp_f32 v183, v183
 v_cvt_pk_bf16_f32 v176, v176, v177
 v_cvt_pk_bf16_f32 v177, v178, v179
 v_mfma_f32_32x32x16_bf16 v[48:63], v[160:163], v[16:19], v[48:63]
 s_movk_i32 s1, 4096
 buffer_load_dwordx4 v[96:99], v232, s[16:19], s1 offen offset:0 sc1
 v_exp_f32 v184, v184
 v_exp_f32 v185, v185
 v_exp_f32 v186, v186
 v_exp_f32 v187, v187
 v_cvt_pk_bf16_f32 v178, v180, v181
 v_cvt_pk_bf16_f32 v179, v182, v183
 v_mfma_f32_32x32x16_bf16 v[48:63], v[164:167], v[20:23], v[48:63]
 s_mov_b64 exec, s[94:95]
 ds_read_b128 v[160:163], v240 offset:24896
 ds_read_b128 v[164:167], v240 offset:26176
 s_mov_b64 exec, -1
 buffer_load_dwordx4 v[112:115], v232, s[16:19], s1 offen offset:2048 sc1
 v_exp_f32 v188, v188
 v_exp_f32 v189, v189
 v_exp_f32 v190, v190
 v_exp_f32 v191, v191
 v_cvt_pk_bf16_f32 v180, v184, v185
 v_cvt_pk_bf16_f32 v181, v186, v187
 v_cvt_pk_bf16_f32 v182, v188, v189
 v_cvt_pk_bf16_f32 v183, v190, v191
 s_waitcnt lgkmcnt(0)
 v_mfma_f32_32x32x16_bf16 v[48:63], v[160:163], v[176:179], v[48:63]
 v_mfma_f32_32x32x16_bf16 v[48:63], v[164:167], v[180:183], v[48:63]
L_att_join:
 v_subrev_u32 v248, 0x2f800000, v44
 v_cmp_le_u32 vcc, 0x20000000, v248
 buffer_load_dwordx4 v[100:103], v233, s[16:19], s1 offen offset:0 sc1
 buffer_load_dwordx4 v[116:119], v233, s[16:19], s1 offen offset:2048 sc1
 s_cbranch_vccnz L_slow_13
L_slow_ok_14:
 s_nop 6
 v_subrev_u32 v248, 0x2f800000, v60
 v_cmp_le_u32 vcc, 0x20000000, v248
 buffer_load_dwordx4 v[104:107], v234, s[16:19], s1 offen offset:0 sc1
 s_cbranch_vccnz L_slow_15
L_slow_ok_16:
 s_load_dwordx8 s[4:11], s[46:47], 128
 s_load_dwordx4 s[12:15], s[46:47], 160
 s_load_dword s35, s[46:47], 176
 s_waitcnt vmcnt(11)
 v_mfma_f32_16x16x32_bf16 v[144:147], a[0:3], v[64:67], 0
 v_rcp_f32 v250, v44
 v_rcp_f32 v251, v60
 v_mfma_f32_16x16x32_bf16 v[144:147], a[20:23], v[80:83], v[144:147]
 v_mul_f32 v250, v250, v227
 v_mfma_f32_16x16x32_bf16 v[148:151], a[24:27], v[80:83], 0
 v_mul_f32 v251, v251, v227
 v_mul_f32 v32, v32, v250
 v_mfma_f32_16x16x32_bf16 v[148:151], a[4:7], v[64:67], v[148:151]
 buffer_load_dwordx4 v[120:123], v234, s[16:19], s1 offen offset:2048 sc1
 v_mfma_f32_16x16x32_bf16 v[152:155], a[8:11], v[64:67], 0
 v_mul_f32 v33, v33, v250
 v_mul_f32 v34, v34, v250
 v_mfma_f32_16x16x32_bf16 v[152:155], a[28:31], v[80:83], v[152:155]
 v_mul_f32 v35, v35, v250
 v_mul_f32 v36, v36, v250
 v_mfma_f32_16x16x32_bf16 v[156:159], a[32:35], v[80:83], 0
 v_mul_f32 v37, v37, v250
 v_mul_f32 v38, v38, v250
 v_mfma_f32_16x16x32_bf16 v[156:159], a[12:15], v[64:67], v[156:159]
 buffer_load_dwordx4 v[108:111], v235, s[16:19], s1 offen offset:0 sc1
 v_mfma_f32_16x16x32_bf16 v[160:163], a[16:19], v[64:67], 0
 v_mul_f32 v39, v39, v250
 v_cvt_pk_bf16_f32 v0, v32, v33
 v_mfma_f32_16x16x32_bf16 v[160:163], a[36:39], v[80:83], v[160:163]
 v_cvt_pk_bf16_f32 v1, v34, v35
 v_cvt_pk_bf16_f32 v2, v36, v37
 s_waitcnt vmcnt(11)
 v_mfma_f32_16x16x32_bf16 v[180:183], a[36:39], v[84:87], 0
 v_cvt_pk_bf16_f32 v3, v38, v39
 buffer_store_dwordx4 v[0:3], v254, s[16:19], s67 offen offset:0 sc1
 v_mfma_f32_16x16x32_bf16 v[180:183], a[16:19], v[68:71], v[180:183]
 buffer_load_dwordx4 v[124:127], v235, s[16:19], s1 offen offset:2048 sc1
 v_mfma_f32_16x16x32_bf16 v[176:179], a[12:15], v[68:71], 0
 v_mul_f32 v48, v48, v251
 v_mul_f32 v49, v49, v251
 v_mfma_f32_16x16x32_bf16 v[176:179], a[32:35], v[84:87], v[176:179]
 v_mul_f32 v50, v50, v251
 v_mul_f32 v51, v51, v251
 v_mfma_f32_16x16x32_bf16 v[172:175], a[28:31], v[84:87], 0
 v_mul_f32 v52, v52, v251
 v_mul_f32 v53, v53, v251
 v_mfma_f32_16x16x32_bf16 v[172:175], a[8:11], v[68:71], v[172:175]
 s_movk_i32 s1, 8192
 buffer_load_dwordx4 v[128:131], v232, s[16:19], s1 offen offset:0 sc1
 v_mfma_f32_16x16x32_bf16 v[168:171], a[4:7], v[68:71], 0
 v_mul_f32 v54, v54, v251
 v_mul_f32 v55, v55, v251
 v_mfma_f32_16x16x32_bf16 v[168:171], a[24:27], v[84:87], v[168:171]
 v_cvt_pk_bf16_f32 v4, v48, v49
 v_cvt_pk_bf16_f32 v5, v50, v51
 v_mfma_f32_16x16x32_bf16 v[164:167], a[20:23], v[84:87], 0
 v_cvt_pk_bf16_f32 v6, v52, v53
 v_cvt_pk_bf16_f32 v7, v54, v55
 v_mfma_f32_16x16x32_bf16 v[164:167], a[0:3], v[68:71], v[164:167]
 buffer_load_dwordx4 v[16:19], v232, s[16:19], s1 offen offset:2048 sc1
 s_waitcnt vmcnt(13)
 v_mfma_f32_16x16x32_bf16 v[184:187], a[0:3], v[72:75], 0
 buffer_store_dwordx4 v[4:7], v254, s[16:19], s67 offen offset:1024 sc1
 v_mul_f32 v40, v40, v250
 v_mfma_f32_16x16x32_bf16 v[184:187], a[20:23], v[88:91], v[184:187]
 buffer_load_dwordx4 v[132:135], v233, s[16:19], s1 offen offset:0 sc1
 v_mfma_f32_16x16x32_bf16 v[188:191], a[24:27], v[88:91], 0
 v_mul_f32 v41, v41, v250
 v_mul_f32 v42, v42, v250
 v_mfma_f32_16x16x32_bf16 v[188:191], a[4:7], v[72:75], v[188:191]
 v_mul_f32 v43, v43, v250
 v_cvt_pk_bf16_f32 v8, v40, v41
 v_mfma_f32_16x16x32_bf16 v[192:195], a[8:11], v[72:75], 0
 v_cvt_pk_bf16_f32 v9, v42, v43
 v_mul_f32 v56, v56, v251
 v_mfma_f32_16x16x32_bf16 v[192:195], a[28:31], v[88:91], v[192:195]
 buffer_load_dwordx4 v[20:23], v233, s[16:19], s1 offen offset:2048 sc1
 v_mfma_f32_16x16x32_bf16 v[196:199], a[32:35], v[88:91], 0
 v_mul_f32 v57, v57, v251
 v_mul_f32 v58, v58, v251
 v_mfma_f32_16x16x32_bf16 v[196:199], a[12:15], v[72:75], v[196:199]
 v_mul_f32 v59, v59, v251
 v_cvt_pk_bf16_f32 v10, v56, v57
 v_mfma_f32_16x16x32_bf16 v[200:203], a[16:19], v[72:75], 0
 v_cvt_pk_bf16_f32 v11, v58, v59
 buffer_store_dwordx4 v[8:11], v236, s[16:19], s68 offen sc1
 v_mfma_f32_16x16x32_bf16 v[200:203], a[36:39], v[88:91], v[200:203]
 buffer_load_dwordx4 v[136:139], v234, s[16:19], s1 offen offset:0 sc1
 s_waitcnt vmcnt(16)
 v_mfma_f32_16x16x32_bf16 v[220:223], a[36:39], v[92:95], 0
 s_waitcnt lgkmcnt(0)
 v_mfma_f32_16x16x32_bf16 v[220:223], a[16:19], v[76:79], v[220:223]
 s_movk_i32 s96, 4096
 v_mfma_f32_16x16x32_bf16 v[216:219], a[12:15], v[76:79], 0
 s_movk_i32 s97, 8192
 v_mfma_f32_16x16x32_bf16 v[216:219], a[32:35], v[92:95], v[216:219]
 buffer_load_dwordx4 v[24:27], v234, s[16:19], s1 offen offset:2048 sc1
 v_mfma_f32_16x16x32_bf16 v[212:215], a[28:31], v[92:95], 0
 v_add_u32 v228, s4, v239
 v_mfma_f32_16x16x32_bf16 v[212:215], a[8:11], v[76:79], v[212:215]
 v_add_u32 v229, s5, v239
 v_mfma_f32_16x16x32_bf16 v[208:211], a[4:7], v[76:79], 0
 v_add_u32 v230, s6, v239
 v_mfma_f32_16x16x32_bf16 v[208:211], a[24:27], v[92:95], v[208:211]
 buffer_load_dwordx4 v[140:143], v235, s[16:19], s1 offen offset:0 sc1
 v_mfma_f32_16x16x32_bf16 v[204:207], a[20:23], v[92:95], 0
 v_add_u32 v231, s7, v239
 v_mfma_f32_16x16x32_bf16 v[204:207], a[0:3], v[76:79], v[204:207]
 buffer_load_dwordx4 v[28:31], v235, s[16:19], s1 offen offset:2048 sc1
 s_waitcnt vmcnt(17)
 v_mfma_f32_16x16x32_bf16 v[144:147], a[40:43], v[96:99], v[144:147]
 v_and_b32 v248, 15, v255
 v_mfma_f32_16x16x32_bf16 v[144:147], a[60:63], v[112:115], v[144:147]
 v_lshl_add_u32 v244, v248, 2, s10
 v_mfma_f32_16x16x32_bf16 v[148:151], a[64:67], v[112:115], v[148:151]
 buffer_load_dword v244, v244, s[16:19], 0 offen sc1
 v_mfma_f32_16x16x32_bf16 v[148:151], a[44:47], v[96:99], v[148:151]
 s_movk_i32 s1, 12288
 buffer_load_dwordx4 v[48:51], v232, s[16:19], s1 offen offset:0 sc1
 v_mfma_f32_16x16x32_bf16 v[152:155], a[48:51], v[96:99], v[152:155]
 v_add_u32 v224, s12, v254
 v_mfma_f32_16x16x32_bf16 v[152:155], a[68:71], v[112:115], v[152:155]
 v_add_u32 v225, s13, v254
 v_mfma_f32_16x16x32_bf16 v[156:159], a[72:75], v[112:115], v[156:159]
 v_add_u32 v226, s14, v254
 v_mfma_f32_16x16x32_bf16 v[156:159], a[52:55], v[96:99], v[156:159]
 buffer_load_dwordx4 v[32:35], v232, s[16:19], s1 offen offset:2048 sc1
 v_mfma_f32_16x16x32_bf16 v[160:163], a[56:59], v[96:99], v[160:163]
 v_add_u32 v243, s15, v254
 v_mfma_f32_16x16x32_bf16 v[160:163], a[76:79], v[112:115], v[160:163]
 v_lshrrev_b32 v249, 4, v255
 s_waitcnt vmcnt(18)
 v_mfma_f32_16x16x32_bf16 v[180:183], a[76:79], v[116:119], v[180:183]
 v_mul_u32_u24 v248, 1280, v248
 v_mfma_f32_16x16x32_bf16 v[180:183], a[56:59], v[100:103], v[180:183]
 buffer_load_dwordx4 v[52:55], v233, s[16:19], s1 offen offset:0 sc1
 v_mfma_f32_16x16x32_bf16 v[176:179], a[52:55], v[100:103], v[176:179]
 v_add_u32 v248, s11, v248
 v_mfma_f32_16x16x32_bf16 v[176:179], a[72:75], v[116:119], v[176:179]
 v_lshl_add_u32 v240, v249, 4, v248
 v_mfma_f32_16x16x32_bf16 v[172:175], a[68:71], v[116:119], v[172:175]
 v_lshl_add_u32 v241, v249, 3, v248
 v_mfma_f32_16x16x32_bf16 v[172:175], a[48:51], v[100:103], v[172:175]
 buffer_load_dwordx4 v[36:39], v233, s[16:19], s1 offen offset:2048 sc1
 v_mfma_f32_16x16x32_bf16 v[168:171], a[44:47], v[100:103], v[168:171]
 v_lshrrev_b32 v248, 1, v255
 v_mfma_f32_16x16x32_bf16 v[168:171], a[64:67], v[116:119], v[168:171]
 v_min_u32 v248, 3, v248
 v_mfma_f32_16x16x32_bf16 v[164:167], a[60:63], v[116:119], v[164:167]
 v_and_b32 v249, 1, v255
 v_mfma_f32_16x16x32_bf16 v[164:167], a[40:43], v[100:103], v[164:167]
 buffer_load_dwordx4 v[56:59], v234, s[16:19], s1 offen offset:0 sc1
 s_waitcnt vmcnt(19)
 v_mfma_f32_16x16x32_bf16 v[184:187], a[40:43], v[104:107], v[184:187]
 v_lshl_add_u32 v249, v249, 3, s9
 v_mfma_f32_16x16x32_bf16 v[184:187], a[60:63], v[120:123], v[184:187]
 buffer_load_dwordx4 v[40:43], v234, s[16:19], s1 offen offset:2048 sc1
 v_mfma_f32_16x16x32_bf16 v[188:191], a[64:67], v[120:123], v[188:191]
 v_lshl_add_u32 v245, v248, 7, v249
 v_mfma_f32_16x16x32_bf16 v[188:191], a[44:47], v[104:107], v[188:191]
 v_mfma_f32_16x16x32_bf16 v[192:195], a[48:51], v[104:107], v[192:195]
 v_mfma_f32_16x16x32_bf16 v[192:195], a[68:71], v[120:123], v[192:195]
 buffer_load_dwordx4 v[60:63], v235, s[16:19], s1 offen offset:0 sc1
 v_mfma_f32_16x16x32_bf16 v[196:199], a[72:75], v[120:123], v[196:199]
 v_mfma_f32_16x16x32_bf16 v[196:199], a[52:55], v[104:107], v[196:199]
 v_mfma_f32_16x16x32_bf16 v[200:203], a[56:59], v[104:107], v[200:203]
 v_mfma_f32_16x16x32_bf16 v[200:203], a[76:79], v[120:123], v[200:203]
 buffer_load_dwordx4 v[44:47], v235, s[16:19], s1 offen offset:2048 sc1
 s_waitcnt vmcnt(19)
 v_mfma_f32_16x16x32_bf16 v[220:223], a[76:79], v[124:127], v[220:223]
 v_mfma_f32_16x16x32_bf16 v[220:223], a[56:59], v[108:111], v[220:223]
 v_mfma_f32_16x16x32_bf16 v[216:219], a[52:55], v[108:111], v[216:219]
 v_mfma_f32_16x16x32_bf16 v[216:219], a[72:75], v[124:127], v[216:219]
 s_movk_i32 s1, 16384
 buffer_load_dwordx4 v[64:67], v232, s[16:19], s1 offen offset:0 sc1
 v_mfma_f32_16x16x32_bf16 v[212:215], a[68:71], v[124:127], v[212:215]
 v_mfma_f32_16x16x32_bf16 v[212:215], a[48:51], v[108:111], v[212:215]
 v_mfma_f32_16x16x32_bf16 v[208:211], a[44:47], v[108:111], v[208:211]
 v_mfma_f32_16x16x32_bf16 v[208:211], a[64:67], v[124:127], v[208:211]
 buffer_load_dwordx4 v[80:83], v232, s[16:19], s1 offen offset:2048 sc1
 v_mfma_f32_16x16x32_bf16 v[204:207], a[60:63], v[124:127], v[204:207]
 v_mfma_f32_16x16x32_bf16 v[204:207], a[40:43], v[108:111], v[204:207]
 buffer_load_dwordx4 v[68:71], v233, s[16:19], s1 offen offset:0 sc1
 s_waitcnt vmcnt(16)
 s_mov_b64 exec, 1
 buffer_store_dwordx2 v[252:253], v237, s[16:19], s54 offen offset:0 sc1
 s_mov_b64 exec, -1
 v_mfma_f32_16x16x32_bf16 v[144:147], a[80:83], v[128:131], v[144:147]
 ds_read_b128 a[40:43], v243 offset:0
 v_mfma_f32_16x16x32_bf16 v[144:147], a[100:103], v[16:19], v[144:147]
 v_mfma_f32_16x16x32_bf16 v[148:151], a[104:107], v[16:19], v[148:151]
 ds_read_b128 a[44:47], v243 offset:1024
 v_mfma_f32_16x16x32_bf16 v[148:151], a[84:87], v[128:131], v[148:151]
 buffer_load_dwordx4 v[84:87], v233, s[16:19], s1 offen offset:2048 sc1
 v_mfma_f32_16x16x32_bf16 v[152:155], a[88:91], v[128:131], v[152:155]
 ds_read_b128 a[48:51], v243 offset:2048
 v_mfma_f32_16x16x32_bf16 v[152:155], a[108:111], v[16:19], v[152:155]
 v_mfma_f32_16x16x32_bf16 v[156:159], a[112:115], v[16:19], v[156:159]
 ds_read_b128 a[52:55], v243 offset:3072
 v_mfma_f32_16x16x32_bf16 v[156:159], a[92:95], v[128:131], v[156:159]
 buffer_load_dwordx4 v[72:75], v234, s[16:19], s1 offen offset:0 sc1
 v_mfma_f32_16x16x32_bf16 v[160:163], a[96:99], v[128:131], v[160:163]
 ds_read_b128 a[56:59], v243 offset:4096
 v_mfma_f32_16x16x32_bf16 v[160:163], a[116:119], v[16:19], v[160:163]
 v_mfma_f32_16x16x32_bf16 v[180:183], a[116:119], v[20:23], v[180:183]
 ds_read_b128 a[60:63], v243 offset:5120
 v_mfma_f32_16x16x32_bf16 v[180:183], a[96:99], v[132:135], v[180:183]
 buffer_load_dwordx4 v[88:91], v234, s[16:19], s1 offen offset:2048 sc1
 v_mfma_f32_16x16x32_bf16 v[176:179], a[92:95], v[132:135], v[176:179]
 ds_read_b128 a[64:67], v243 offset:6144
 v_mfma_f32_16x16x32_bf16 v[176:179], a[112:115], v[20:23], v[176:179]
 v_mfma_f32_16x16x32_bf16 v[172:175], a[108:111], v[20:23], v[172:175]
 ds_read_b128 a[68:71], v243 offset:7168
 v_mfma_f32_16x16x32_bf16 v[172:175], a[88:91], v[132:135], v[172:175]
 buffer_load_dwordx4 v[76:79], v235, s[16:19], s1 offen offset:0 sc1
 v_mfma_f32_16x16x32_bf16 v[168:171], a[84:87], v[132:135], v[168:171]
 ds_read_b128 a[72:75], v243 offset:8192
 v_mfma_f32_16x16x32_bf16 v[168:171], a[104:107], v[20:23], v[168:171]
 v_mfma_f32_16x16x32_bf16 v[164:167], a[100:103], v[20:23], v[164:167]
 ds_read_b128 a[76:79], v243 offset:9216
 v_mfma_f32_16x16x32_bf16 v[164:167], a[80:83], v[132:135], v[164:167]
 buffer_load_dwordx4 v[92:95], v235, s[16:19], s1 offen offset:2048 sc1
 s_waitcnt vmcnt(20)
 v_mfma_f32_16x16x32_bf16 v[184:187], a[80:83], v[136:139], v[184:187]
 v_mfma_f32_16x16x32_bf16 v[184:187], a[100:103], v[24:27], v[184:187]
 s_movk_i32 s1, 20480
 buffer_load_dwordx4 v[96:99], v232, s[16:19], s1 offen offset:0 sc1
 v_mfma_f32_16x16x32_bf16 v[188:191], a[104:107], v[24:27], v[188:191]
 v_mfma_f32_16x16x32_bf16 v[188:191], a[84:87], v[136:139], v[188:191]
 v_mfma_f32_16x16x32_bf16 v[192:195], a[88:91], v[136:139], v[192:195]
 v_mfma_f32_16x16x32_bf16 v[192:195], a[108:111], v[24:27], v[192:195]
 buffer_load_dwordx4 v[112:115], v232, s[16:19], s1 offen offset:2048 sc1
 v_mfma_f32_16x16x32_bf16 v[196:199], a[112:115], v[24:27], v[196:199]
 v_mfma_f32_16x16x32_bf16 v[196:199], a[92:95], v[136:139], v[196:199]
 v_mfma_f32_16x16x32_bf16 v[200:203], a[96:99], v[136:139], v[200:203]
 v_mfma_f32_16x16x32_bf16 v[200:203], a[116:119], v[24:27], v[200:203]
 buffer_load_dwordx4 v[100:103], v233, s[16:19], s1 offen offset:0 sc1
 s_waitcnt vmcnt(21)
 v_mfma_f32_16x16x32_bf16 v[220:223], a[116:119], v[28:31], v[220:223]
 v_mfma_f32_16x16x32_bf16 v[220:223], a[96:99], v[140:143], v[220:223]
 v_mfma_f32_16x16x32_bf16 v[216:219], a[92:95], v[140:143], v[216:219]
 v_mfma_f32_16x16x32_bf16 v[216:219], a[112:115], v[28:31], v[216:219]
 buffer_load_dwordx4 v[116:119], v233, s[16:19], s1 offen offset:2048 sc1
 v_mfma_f32_16x16x32_bf16 v[212:215], a[108:111], v[28:31], v[212:215]
 v_mfma_f32_16x16x32_bf16 v[212:215], a[88:91], v[140:143], v[212:215]
 v_mfma_f32_16x16x32_bf16 v[208:211], a[84:87], v[140:143], v[208:211]
 v_mfma_f32_16x16x32_bf16 v[208:211], a[104:107], v[28:31], v[208:211]
 buffer_load_dwordx4 v[104:107], v234, s[16:19], s1 offen offset:0 sc1
 v_mfma_f32_16x16x32_bf16 v[204:207], a[100:103], v[28:31], v[204:207]
 v_mfma_f32_16x16x32_bf16 v[204:207], a[80:83], v[140:143], v[204:207]
 buffer_load_dwordx4 v[120:123], v234, s[16:19], s1 offen offset:2048 sc1
 s_waitcnt vmcnt(21)
 v_mfma_f32_16x16x32_bf16 v[144:147], a[120:123], v[48:51], v[144:147]
 v_mfma_f32_16x16x32_bf16 v[144:147], a[140:143], v[32:35], v[144:147]
 v_mfma_f32_16x16x32_bf16 v[148:151], a[144:147], v[32:35], v[148:151]
 v_mfma_f32_16x16x32_bf16 v[148:151], a[124:127], v[48:51], v[148:151]
 buffer_load_dwordx4 v[108:111], v235, s[16:19], s1 offen offset:0 sc1
 v_mfma_f32_16x16x32_bf16 v[152:155], a[128:131], v[48:51], v[152:155]
 v_mfma_f32_16x16x32_bf16 v[152:155], a[148:151], v[32:35], v[152:155]
 v_mfma_f32_16x16x32_bf16 v[156:159], a[152:155], v[32:35], v[156:159]
 v_mfma_f32_16x16x32_bf16 v[156:159], a[132:135], v[48:51], v[156:159]
 buffer_load_dwordx4 v[124:127], v235, s[16:19], s1 offen offset:2048 sc1
 v_mfma_f32_16x16x32_bf16 v[160:163], a[136:139], v[48:51], v[160:163]
 v_mfma_f32_16x16x32_bf16 v[160:163], a[156:159], v[32:35], v[160:163]
 s_waitcnt vmcnt(21)
 v_mfma_f32_16x16x32_bf16 v[180:183], a[156:159], v[36:39], v[180:183]
 v_mfma_f32_16x16x32_bf16 v[180:183], a[136:139], v[52:55], v[180:183]
 v_add_u32 v242, 5120, v242
 global_load_dwordx4 a[0:3], v242, s[16:17] offset:-2048 sc1
 v_mfma_f32_16x16x32_bf16 v[176:179], a[132:135], v[52:55], v[176:179]
 v_mfma_f32_16x16x32_bf16 v[176:179], a[152:155], v[36:39], v[176:179]
 v_mfma_f32_16x16x32_bf16 v[172:175], a[148:151], v[36:39], v[172:175]
 v_mfma_f32_16x16x32_bf16 v[172:175], a[128:131], v[52:55], v[172:175]
 global_load_dwordx4 a[4:7], v242, s[16:17] offset:-1024 sc1
 v_mfma_f32_16x16x32_bf16 v[168:171], a[124:127], v[52:55], v[168:171]
 v_mfma_f32_16x16x32_bf16 v[168:171], a[144:147], v[36:39], v[168:171]
 v_mfma_f32_16x16x32_bf16 v[164:167], a[140:143], v[36:39], v[164:167]
 v_mfma_f32_16x16x32_bf16 v[164:167], a[120:123], v[52:55], v[164:167]
 global_load_dwordx4 a[8:11], v242, s[16:17] offset:0 sc1
 s_waitcnt vmcnt(22)
 v_mfma_f32_16x16x32_bf16 v[184:187], a[120:123], v[56:59], v[184:187]
 v_mfma_f32_16x16x32_bf16 v[184:187], a[140:143], v[40:43], v[184:187]
 global_load_dwordx4 a[12:15], v242, s[16:17] offset:1024 sc1
 v_mfma_f32_16x16x32_bf16 v[188:191], a[144:147], v[40:43], v[188:191]
 v_mfma_f32_16x16x32_bf16 v[188:191], a[124:127], v[56:59], v[188:191]
 v_mfma_f32_16x16x32_bf16 v[192:195], a[128:131], v[56:59], v[192:195]
 v_mfma_f32_16x16x32_bf16 v[192:195], a[148:151], v[40:43], v[192:195]
 global_load_dwordx4 a[16:19], v242, s[16:17] offset:2048 sc1
 v_mfma_f32_16x16x32_bf16 v[196:199], a[152:155], v[40:43], v[196:199]
 v_mfma_f32_16x16x32_bf16 v[196:199], a[132:135], v[56:59], v[196:199]
 v_mfma_f32_16x16x32_bf16 v[200:203], a[136:139], v[56:59], v[200:203]
 v_mfma_f32_16x16x32_bf16 v[200:203], a[156:159], v[40:43], v[200:203]
 s_add_u32 s42, s73, 64512
 s_cmp_lt_u32 s3, 2
 s_cselect_b32 s42, s42, 67108864
 buffer_load_dwordx4 a[20:23], v254, s[16:19], s42 offen offset:0 sc1
 s_waitcnt vmcnt(23)
 v_mfma_f32_16x16x32_bf16 v[220:223], a[156:159], v[44:47], v[220:223]
 v_mfma_f32_16x16x32_bf16 v[220:223], a[136:139], v[60:63], v[220:223]
 v_mfma_f32_16x16x32_bf16 v[216:219], a[132:135], v[60:63], v[216:219]
 v_mfma_f32_16x16x32_bf16 v[216:219], a[152:155], v[44:47], v[216:219]
 buffer_load_dwordx4 a[24:27], v254, s[16:19], s42 offen offset:1024 sc1
 v_mfma_f32_16x16x32_bf16 v[212:215], a[148:151], v[44:47], v[212:215]
 v_mfma_f32_16x16x32_bf16 v[212:215], a[128:131], v[60:63], v[212:215]
 v_mfma_f32_16x16x32_bf16 v[208:211], a[124:127], v[60:63], v[208:211]
 v_mfma_f32_16x16x32_bf16 v[208:211], a[144:147], v[44:47], v[208:211]
 buffer_load_dwordx4 a[28:31], v254, s[16:19], s42 offen offset:2048 sc1
 v_mfma_f32_16x16x32_bf16 v[204:207], a[140:143], v[44:47], v[204:207]
 v_mfma_f32_16x16x32_bf16 v[204:207], a[120:123], v[60:63], v[204:207]
 buffer_load_dwordx4 a[32:35], v254, s[16:19], s42 offen offset:3072 sc1
 s_waitcnt vmcnt(24)
 v_mfma_f32_16x16x32_bf16 v[144:147], a[160:163], v[64:67], v[144:147]
 v_mfma_f32_16x16x32_bf16 v[144:147], a[180:183], v[80:83], v[144:147]
 v_mfma_f32_16x16x32_bf16 v[148:151], a[184:187], v[80:83], v[148:151]
 v_mfma_f32_16x16x32_bf16 v[148:151], a[164:167], v[64:67], v[148:151]
 s_add_u32 s42, s73, 68608
 s_cmp_lt_u32 s3, 2
 s_cselect_b32 s42, s42, 67108864
 buffer_load_dwordx4 a[36:39], v254, s[16:19], s42 offen offset:0 sc1
 v_mfma_f32_16x16x32_bf16 v[152:155], a[168:171], v[64:67], v[152:155]
 v_mfma_f32_16x16x32_bf16 v[152:155], a[188:191], v[80:83], v[152:155]
 v_mfma_f32_16x16x32_bf16 v[156:159], a[192:195], v[80:83], v[156:159]
 v_mfma_f32_16x16x32_bf16 v[156:159], a[172:175], v[64:67], v[156:159]
 s_movk_i32 s1, 24576
 buffer_load_dwordx4 v[128:131], v232, s[16:19], s1 offen offset:0 sc1
 v_mfma_f32_16x16x32_bf16 v[160:163], a[176:179], v[64:67], v[160:163]
 v_mfma_f32_16x16x32_bf16 v[160:163], a[196:199], v[80:83], v[160:163]
 s_waitcnt vmcnt(23)
 v_mfma_f32_16x16x32_bf16 v[180:183], a[196:199], v[84:87], v[180:183]
 v_mfma_f32_16x16x32_bf16 v[180:183], a[176:179], v[68:71], v[180:183]
 s_cmp_lt_u32 s3, 2
 s_cselect_b32 s45, s1, 67108864
 buffer_load_dwordx4 v[16:19], v232, s[16:19], s45 offen offset:2048 sc1
 v_mfma_f32_16x16x32_bf16 v[176:179], a[172:175], v[68:71], v[176:179]
 v_mfma_f32_16x16x32_bf16 v[176:179], a[192:195], v[84:87], v[176:179]
 v_mfma_f32_16x16x32_bf16 v[172:175], a[188:191], v[84:87], v[172:175]
 v_mfma_f32_16x16x32_bf16 v[172:175], a[168:171], v[68:71], v[172:175]
 buffer_load_dwordx4 v[132:135], v233, s[16:19], s1 offen offset:0 sc1
 v_mfma_f32_16x16x32_bf16 v[168:171], a[164:167], v[68:71], v[168:171]
 v_mfma_f32_16x16x32_bf16 v[168:171], a[184:187], v[84:87], v[168:171]
 v_mfma_f32_16x16x32_bf16 v[164:167], a[180:183], v[84:87], v[164:167]
 v_mfma_f32_16x16x32_bf16 v[164:167], a[160:163], v[68:71], v[164:167]
 buffer_load_dwordx4 v[20:23], v233, s[16:19], s45 offen offset:2048 sc1
 s_waitcnt vmcnt(24)
 v_mfma_f32_16x16x32_bf16 v[184:187], a[160:163], v[72:75], v[184:187]
 v_mfma_f32_16x16x32_bf16 v[184:187], a[180:183], v[88:91], v[184:187]
 buffer_load_dwordx4 v[136:139], v234, s[16:19], s1 offen offset:0 sc1
 v_mfma_f32_16x16x32_bf16 v[188:191], a[184:187], v[88:91], v[188:191]
 v_mfma_f32_16x16x32_bf16 v[188:191], a[164:167], v[72:75], v[188:191]
 v_mfma_f32_16x16x32_bf16 v[192:195], a[168:171], v[72:75], v[192:195]
 v_mfma_f32_16x16x32_bf16 v[192:195], a[188:191], v[88:91], v[192:195]
 buffer_load_dwordx4 v[24:27], v234, s[16:19], s45 offen offset:2048 sc1
 v_mfma_f32_16x16x32_bf16 v[196:199], a[192:195], v[88:91], v[196:199]
 v_mfma_f32_16x16x32_bf16 v[196:199], a[172:175], v[72:75], v[196:199]
 v_mfma_f32_16x16x32_bf16 v[200:203], a[176:179], v[72:75], v[200:203]
 v_mfma_f32_16x16x32_bf16 v[200:203], a[196:199], v[88:91], v[200:203]
 buffer_load_dwordx4 v[140:143], v235, s[16:19], s1 offen offset:0 sc1
 s_waitcnt vmcnt(25)
 v_mfma_f32_16x16x32_bf16 v[220:223], a[196:199], v[92:95], v[220:223]
 v_mfma_f32_16x16x32_bf16 v[220:223], a[176:179], v[76:79], v[220:223]
 v_mfma_f32_16x16x32_bf16 v[216:219], a[172:175], v[76:79], v[216:219]
 v_mfma_f32_16x16x32_bf16 v[216:219], a[192:195], v[92:95], v[216:219]
 buffer_load_dwordx4 v[28:31], v235, s[16:19], s45 offen offset:2048 sc1
 v_mfma_f32_16x16x32_bf16 v[212:215], a[188:191], v[92:95], v[212:215]
 v_mfma_f32_16x16x32_bf16 v[212:215], a[168:171], v[76:79], v[212:215]
 v_mfma_f32_16x16x32_bf16 v[208:211], a[164:167], v[76:79], v[208:211]
 v_mfma_f32_16x16x32_bf16 v[208:211], a[184:187], v[92:95], v[208:211]
 v_add_u32 v242, s8, v254
 v_add_u32 v242, 10240, v242
 global_load_dwordx4 a[80:83], v242, s[16:17] offset:-2048 sc1
 v_mfma_f32_16x16x32_bf16 v[204:207], a[180:183], v[92:95], v[204:207]
 v_mfma_f32_16x16x32_bf16 v[204:207], a[160:163], v[76:79], v[204:207]
 global_load_dwordx4 a[84:87], v242, s[16:17] offset:-1024 sc1
 buffer_load_dwordx2 v[246:247], v245, s[16:19], 0 offen sc1
 s_waitcnt vmcnt(27)
 v_mfma_f32_16x16x32_bf16 v[144:147], a[200:203], v[96:99], v[144:147]
 v_mfma_f32_16x16x32_bf16 v[144:147], a[220:223], v[112:115], v[144:147]
 v_mfma_f32_16x16x32_bf16 v[148:151], a[224:227], v[112:115], v[148:151]
 v_mfma_f32_16x16x32_bf16 v[148:151], a[204:207], v[96:99], v[148:151]
 global_load_dwordx4 a[88:91], v242, s[16:17] offset:0 sc1
 v_mfma_f32_16x16x32_bf16 v[152:155], a[208:211], v[96:99], v[152:155]
 v_mfma_f32_16x16x32_bf16 v[152:155], a[228:231], v[112:115], v[152:155]
 v_mfma_f32_16x16x32_bf16 v[156:159], a[232:235], v[112:115], v[156:159]
 v_mfma_f32_16x16x32_bf16 v[156:159], a[212:215], v[96:99], v[156:159]
 global_load_dwordx4 a[92:95], v242, s[16:17] offset:1024 sc1
 v_mfma_f32_16x16x32_bf16 v[160:163], a[216:219], v[96:99], v[160:163]
 v_mfma_f32_16x16x32_bf16 v[160:163], a[236:239], v[112:115], v[160:163]
 s_waitcnt vmcnt(27)
 v_mfma_f32_16x16x32_bf16 v[180:183], a[236:239], v[116:119], v[180:183]
 v_mfma_f32_16x16x32_bf16 v[180:183], a[216:219], v[100:103], v[180:183]
 global_load_dwordx4 a[96:99], v242, s[16:17] offset:2048 sc1
 v_mfma_f32_16x16x32_bf16 v[176:179], a[212:215], v[100:103], v[176:179]
 v_mfma_f32_16x16x32_bf16 v[176:179], a[232:235], v[116:119], v[176:179]
 v_mfma_f32_16x16x32_bf16 v[172:175], a[228:231], v[116:119], v[172:175]
 v_mfma_f32_16x16x32_bf16 v[172:175], a[208:211], v[100:103], v[172:175]
 v_add_u32 v242, 5120, v242
 global_load_dwordx4 a[100:103], v242, s[16:17] offset:-2048 sc1
 v_mfma_f32_16x16x32_bf16 v[168:171], a[204:207], v[100:103], v[168:171]
 v_mfma_f32_16x16x32_bf16 v[168:171], a[224:227], v[116:119], v[168:171]
 v_mfma_f32_16x16x32_bf16 v[164:167], a[220:223], v[116:119], v[164:167]
 v_mfma_f32_16x16x32_bf16 v[164:167], a[200:203], v[100:103], v[164:167]
 global_load_dwordx4 a[104:107], v242, s[16:17] offset:-1024 sc1
 s_waitcnt vmcnt(28)
 v_mfma_f32_16x16x32_bf16 v[184:187], a[200:203], v[104:107], v[184:187]
 v_mfma_f32_16x16x32_bf16 v[184:187], a[220:223], v[120:123], v[184:187]
 global_load_dwordx4 a[108:111], v242, s[16:17] offset:0 sc1
 v_mfma_f32_16x16x32_bf16 v[188:191], a[224:227], v[120:123], v[188:191]
 v_mfma_f32_16x16x32_bf16 v[188:191], a[204:207], v[104:107], v[188:191]
 v_mfma_f32_16x16x32_bf16 v[192:195], a[208:211], v[104:107], v[192:195]
 v_mfma_f32_16x16x32_bf16 v[192:195], a[228:231], v[120:123], v[192:195]
 global_load_dwordx4 a[112:115], v242, s[16:17] offset:1024 sc1
 v_mfma_f32_16x16x32_bf16 v[196:199], a[232:235], v[120:123], v[196:199]
 v_mfma_f32_16x16x32_bf16 v[196:199], a[212:215], v[104:107], v[196:199]
 v_mfma_f32_16x16x32_bf16 v[200:203], a[216:219], v[104:107], v[200:203]
 v_mfma_f32_16x16x32_bf16 v[200:203], a[236:239], v[120:123], v[200:203]
 global_load_dwordx4 a[116:119], v242, s[16:17] offset:2048 sc1
 s_waitcnt vmcnt(29)
 v_mfma_f32_16x16x32_bf16 v[220:223], a[236:239], v[124:127], v[220:223]
 v_mfma_f32_16x16x32_bf16 v[220:223], a[216:219], v[108:111], v[220:223]
 v_mfma_f32_16x16x32_bf16 v[216:219], a[212:215], v[108:111], v[216:219]
 v_mfma_f32_16x16x32_bf16 v[216:219], a[232:235], v[124:127], v[216:219]
 v_add_u32 v242, 5120, v242
 global_load_dwordx4 a[120:123], v242, s[16:17] offset:-2048 sc1
 v_mfma_f32_16x16x32_bf16 v[212:215], a[228:231], v[124:127], v[212:215]
 v_mfma_f32_16x16x32_bf16 v[212:215], a[208:211], v[108:111], v[212:215]
 v_mfma_f32_16x16x32_bf16 v[208:211], a[204:207], v[108:111], v[208:211]
 v_mfma_f32_16x16x32_bf16 v[208:211], a[224:227], v[124:127], v[208:211]
 global_load_dwordx4 a[124:127], v242, s[16:17] offset:-1024 sc1
 v_mfma_f32_16x16x32_bf16 v[204:207], a[220:223], v[124:127], v[204:207]
 v_mfma_f32_16x16x32_bf16 v[204:207], a[200:203], v[108:111], v[204:207]
 global_load_dwordx4 a[128:131], v242, s[16:17] offset:0 sc1
 s_waitcnt lgkmcnt(0)
 s_waitcnt vmcnt(11)
 v_cmp_ne_u64 vcc, s[90:91], v[246:247]
 s_nop 0
 s_cbranch_vccnz L_poll_17
L_poll_ok_18:
 v_mfma_f32_16x16x32_bf16 v[144:147], a[0:3], v[128:131], v[144:147]
 v_mfma_f32_16x16x32_bf16 v[144:147], a[20:23], v[16:19], v[144:147]
 v_mfma_f32_16x16x32_bf16 v[148:151], a[24:27], v[16:19], v[148:151]
 v_mfma_f32_16x16x32_bf16 v[148:151], a[4:7], v[128:131], v[148:151]
 global_load_dwordx4 a[132:135], v242, s[16:17] offset:1024 sc1
 v_mfma_f32_16x16x32_bf16 v[152:155], a[8:11], v[128:131], v[152:155]
 v_mfma_f32_16x16x32_bf16 v[152:155], a[28:31], v[16:19], v[152:155]
 v_mfma_f32_16x16x32_bf16 v[156:159], a[32:35], v[16:19], v[156:159]
 v_mfma_f32_16x16x32_bf16 v[156:159], a[12:15], v[128:131], v[156:159]
 global_load_dwordx4 a[136:139], v242, s[16:17] offset:2048 sc1
 v_mfma_f32_16x16x32_bf16 v[160:163], a[16:19], v[128:131], v[160:163]
 v_mfma_f32_16x16x32_bf16 v[160:163], a[36:39], v[16:19], v[160:163]
 v_mfma_f32_16x16x32_bf16 v[180:183], a[36:39], v[20:23], v[180:183]
 v_mfma_f32_16x16x32_bf16 v[180:183], a[16:19], v[132:135], v[180:183]
 buffer_load_dwordx4 v[48:51], v228, s[16:19], 0 offen offset:0 sc1
 v_mfma_f32_16x16x32_bf16 v[176:179], a[12:15], v[132:135], v[176:179]
 v_mfma_f32_16x16x32_bf16 v[176:179], a[32:35], v[20:23], v[176:179]
 v_mfma_f32_16x16x32_bf16 v[172:175], a[28:31], v[20:23], v[172:175]
 v_mfma_f32_16x16x32_bf16 v[172:175], a[8:11], v[132:135], v[172:175]
 buffer_load_dwordx4 v[52:55], v228, s[16:19], 0 offen offset:2048 sc1
 v_mfma_f32_16x16x32_bf16 v[168:171], a[4:7], v[132:135], v[168:171]
 v_mfma_f32_16x16x32_bf16 v[168:171], a[24:27], v[20:23], v[168:171]
 v_mfma_f32_16x16x32_bf16 v[164:167], a[20:23], v[20:23], v[164:167]
 v_mfma_f32_16x16x32_bf16 v[164:167], a[0:3], v[132:135], v[164:167]
 buffer_load_dwordx4 v[56:59], v228, s[16:19], s96 offen offset:0 sc1
 v_mfma_f32_16x16x32_bf16 v[184:187], a[0:3], v[136:139], v[184:187]
 v_mfma_f32_16x16x32_bf16 v[184:187], a[20:23], v[24:27], v[184:187]
 buffer_load_dwordx4 v[60:63], v228, s[16:19], s96 offen offset:2048 sc1
 v_mfma_f32_16x16x32_bf16 v[188:191], a[24:27], v[24:27], v[188:191]
 v_mfma_f32_16x16x32_bf16 v[188:191], a[4:7], v[136:139], v[188:191]
 v_mfma_f32_16x16x32_bf16 v[192:195], a[8:11], v[136:139], v[192:195]
 v_mfma_f32_16x16x32_bf16 v[192:195], a[28:31], v[24:27], v[192:195]
 buffer_load_dwordx4 v[32:35], v228, s[16:19], s97 offen offset:0 sc1
 v_mfma_f32_16x16x32_bf16 v[196:199], a[32:35], v[24:27], v[196:199]
 v_mfma_f32_16x16x32_bf16 v[196:199], a[12:15], v[136:139], v[196:199]
 v_mfma_f32_16x16x32_bf16 v[200:203], a[16:19], v[136:139], v[200:203]
 v_mfma_f32_16x16x32_bf16 v[200:203], a[36:39], v[24:27], v[200:203]
 buffer_load_dwordx4 v[36:39], v229, s[16:19], 0 offen offset:0 sc1
 v_mfma_f32_16x16x32_bf16 v[220:223], a[36:39], v[28:31], v[220:223]
 v_mfma_f32_16x16x32_bf16 v[220:223], a[16:19], v[140:143], v[220:223]
 v_mfma_f32_16x16x32_bf16 v[216:219], a[12:15], v[140:143], v[216:219]
 v_mfma_f32_16x16x32_bf16 v[216:219], a[32:35], v[28:31], v[216:219]
 buffer_load_dwordx4 v[40:43], v229, s[16:19], 0 offen offset:2048 sc1
 v_mfma_f32_16x16x32_bf16 v[212:215], a[28:31], v[28:31], v[212:215]
 v_mfma_f32_16x16x32_bf16 v[212:215], a[8:11], v[140:143], v[212:215]
 v_mfma_f32_16x16x32_bf16 v[208:211], a[4:7], v[140:143], v[208:211]
 v_mfma_f32_16x16x32_bf16 v[208:211], a[24:27], v[28:31], v[208:211]
 buffer_load_dwordx4 v[44:47], v229, s[16:19], s96 offen offset:0 sc1
 v_mfma_f32_16x16x32_bf16 v[204:207], a[20:23], v[28:31], v[204:207]
 v_mfma_f32_16x16x32_bf16 v[204:207], a[0:3], v[140:143], v[204:207]
 buffer_load_dwordx4 v[64:67], v229, s[16:19], s96 offen offset:2048 sc1
 s_waitcnt vmcnt(8)
 v_mfma_f32_16x16x32_bf16 v[144:147], a[40:43], v[48:51], v[144:147]
 buffer_load_dwordx4 v[68:71], v229, s[16:19], s97 offen offset:0 sc1
 s_waitcnt vmcnt(8)
 v_mfma_f32_16x16x32_bf16 v[144:147], a[60:63], v[52:55], v[144:147]
 s_waitcnt vmcnt(7)
 v_mfma_f32_16x16x32_bf16 v[144:147], a[80:83], v[56:59], v[144:147]
 s_waitcnt vmcnt(6)
 v_mfma_f32_16x16x32_bf16 v[144:147], a[100:103], v[60:63], v[144:147]
 s_waitcnt vmcnt(5)
 v_mfma_f32_16x16x32_bf16 v[144:147], a[120:123], v[32:35], v[144:147]
 buffer_load_dwordx4 v[72:75], v230, s[16:19], 0 offen offset:0 sc1
 v_mfma_f32_16x16x32_bf16 v[148:151], a[124:127], v[32:35], v[148:151]
 v_mfma_f32_16x16x32_bf16 v[148:151], a[104:107], v[60:63], v[148:151]
 v_mfma_f32_16x16x32_bf16 v[148:151], a[84:87], v[56:59], v[148:151]
 v_mfma_f32_16x16x32_bf16 v[148:151], a[64:67], v[52:55], v[148:151]
 buffer_load_dwordx4 v[76:79], v230, s[16:19], 0 offen offset:2048 sc1
 v_mfma_f32_16x16x32_bf16 v[148:151], a[44:47], v[48:51], v[148:151]
 v_mfma_f32_16x16x32_bf16 v[152:155], a[48:51], v[48:51], v[152:155]
 v_mfma_f32_16x16x32_bf16 v[152:155], a[68:71], v[52:55], v[152:155]
 v_mfma_f32_16x16x32_bf16 v[152:155], a[88:91], v[56:59], v[152:155]
 buffer_load_dwordx4 v[80:83], v230, s[16:19], s96 offen offset:0 sc1
 v_mfma_f32_16x16x32_bf16 v[152:155], a[108:111], v[60:63], v[152:155]
 v_mfma_f32_16x16x32_bf16 v[152:155], a[128:131], v[32:35], v[152:155]
 v_mfma_f32_16x16x32_bf16 v[156:159], a[132:135], v[32:35], v[156:159]
 v_mfma_f32_16x16x32_bf16 v[156:159], a[112:115], v[60:63], v[156:159]
 buffer_load_dwordx4 v[84:87], v230, s[16:19], s96 offen offset:2048 sc1
 v_mfma_f32_16x16x32_bf16 v[156:159], a[92:95], v[56:59], v[156:159]
 v_mfma_f32_16x16x32_bf16 v[156:159], a[72:75], v[52:55], v[156:159]
 v_mfma_f32_16x16x32_bf16 v[156:159], a[52:55], v[48:51], v[156:159]
 v_mfma_f32_16x16x32_bf16 v[160:163], a[56:59], v[48:51], v[160:163]
 buffer_load_dwordx4 v[88:91], v230, s[16:19], s97 offen offset:0 sc1
 v_mfma_f32_16x16x32_bf16 v[160:163], a[76:79], v[52:55], v[160:163]
 v_mfma_f32_16x16x32_bf16 v[160:163], a[96:99], v[56:59], v[160:163]
 v_mfma_f32_16x16x32_bf16 v[160:163], a[116:119], v[60:63], v[160:163]
 v_mfma_f32_16x16x32_bf16 v[160:163], a[136:139], v[32:35], v[160:163]
 buffer_load_dwordx4 v[92:95], v231, s[16:19], 0 offen offset:0 sc1
 s_waitcnt vmcnt(10)
 v_mfma_f32_16x16x32_bf16 v[164:167], a[40:43], v[36:39], v[164:167]
 buffer_load_dwordx4 v[96:99], v231, s[16:19], 0 offen offset:2048 sc1
 s_waitcnt vmcnt(10)
 v_mfma_f32_16x16x32_bf16 v[164:167], a[60:63], v[40:43], v[164:167]
 s_waitcnt vmcnt(9)
 v_mfma_f32_16x16x32_bf16 v[164:167], a[80:83], v[44:47], v[164:167]
 s_waitcnt vmcnt(8)
 v_mfma_f32_16x16x32_bf16 v[164:167], a[100:103], v[64:67], v[164:167]
 s_waitcnt vmcnt(7)
 v_mfma_f32_16x16x32_bf16 v[164:167], a[120:123], v[68:71], v[164:167]
 buffer_load_dwordx4 v[100:103], v231, s[16:19], s96 offen offset:0 sc1
 v_mfma_f32_16x16x32_bf16 v[168:171], a[124:127], v[68:71], v[168:171]
 ds_write_b128 v243, v[144:147] offset:0
 v_mfma_f32_16x16x32_bf16 v[168:171], a[104:107], v[64:67], v[168:171]
 ds_write_b128 v243, v[148:151] offset:1024
 v_mfma_f32_16x16x32_bf16 v[168:171], a[84:87], v[44:47], v[168:171]
 ds_write_b128 v243, v[152:155] offset:2048
 v_mfma_f32_16x16x32_bf16 v[168:171], a[64:67], v[40:43], v[168:171]
 buffer_load_dwordx4 v[104:107], v231, s[16:19], s96 offen offset:2048 sc1
 v_mfma_f32_16x16x32_bf16 v[168:171], a[44:47], v[36:39], v[168:171]
 ds_write_b128 v243, v[156:159] offset:3072
 v_mfma_f32_16x16x32_bf16 v[172:175], a[48:51], v[36:39], v[172:175]
 ds_write_b128 v243, v[160:163] offset:4096
 v_mfma_f32_16x16x32_bf16 v[172:175], a[68:71], v[40:43], v[172:175]
 v_mfma_f32_16x16x32_bf16 v[172:175], a[88:91], v[44:47], v[172:175]
 buffer_load_dwordx4 v[108:111], v231, s[16:19], s97 offen offset:0 sc1
 v_mfma_f32_16x16x32_bf16 v[172:175], a[108:111], v[64:67], v[172:175]
 v_mfma_f32_16x16x32_bf16 v[172:175], a[128:131], v[68:71], v[172:175]
 v_mfma_f32_16x16x32_bf16 v[176:179], a[132:135], v[68:71], v[176:179]
 v_mfma_f32_16x16x32_bf16 v[176:179], a[112:115], v[64:67], v[176:179]
 v_mfma_f32_16x16x32_bf16 v[176:179], a[92:95], v[44:47], v[176:179]
 v_mfma_f32_16x16x32_bf16 v[176:179], a[72:75], v[40:43], v[176:179]
 v_mfma_f32_16x16x32_bf16 v[176:179], a[52:55], v[36:39], v[176:179]
 v_mfma_f32_16x16x32_bf16 v[180:183], a[56:59], v[36:39], v[180:183]
 v_mfma_f32_16x16x32_bf16 v[180:183], a[76:79], v[40:43], v[180:183]
 v_mfma_f32_16x16x32_bf16 v[180:183], a[96:99], v[44:47], v[180:183]
 v_mfma_f32_16x16x32_bf16 v[180:183], a[116:119], v[64:67], v[180:183]
 v_mfma_f32_16x16x32_bf16 v[180:183], a[136:139], v[68:71], v[180:183]
 s_waitcnt vmcnt(9)
 v_mfma_f32_16x16x32_bf16 v[184:187], a[40:43], v[72:75], v[184:187]
 s_waitcnt vmcnt(8)
 v_mfma_f32_16x16x32_bf16 v[184:187], a[60:63], v[76:79], v[184:187]
 s_waitcnt vmcnt(7)
 v_mfma_f32_16x16x32_bf16 v[184:187], a[80:83], v[80:83], v[184:187]
 s_waitcnt vmcnt(6)
 v_mfma_f32_16x16x32_bf16 v[184:187], a[100:103], v[84:87], v[184:187]
 ds_write_b128 v243, v[164:167] offset:5120
 s_waitcnt vmcnt(5)
 v_mfma_f32_16x16x32_bf16 v[184:187], a[120:123], v[88:91], v[184:187]
 ds_write_b128 v243, v[168:171] offset:6144
 v_mfma_f32_16x16x32_bf16 v[188:191], a[124:127], v[88:91], v[188:191]
 ds_write_b128 v243, v[172:175] offset:7168
 v_mfma_f32_16x16x32_bf16 v[188:191], a[104:107], v[84:87], v[188:191]
 ds_write_b128 v243, v[176:179] offset:8192
 v_mfma_f32_16x16x32_bf16 v[188:191], a[84:87], v[80:83], v[188:191]
 ds_write_b128 v243, v[180:183] offset:9216
 v_mfma_f32_16x16x32_bf16 v[188:191], a[64:67], v[76:79], v[188:191]
 v_mfma_f32_16x16x32_bf16 v[188:191], a[44:47], v[72:75], v[188:191]
 v_mfma_f32_16x16x32_bf16 v[192:195], a[48:51], v[72:75], v[192:195]
 v_mfma_f32_16x16x32_bf16 v[192:195], a[68:71], v[76:79], v[192:195]
 v_mfma_f32_16x16x32_bf16 v[192:195], a[88:91], v[80:83], v[192:195]
 v_mfma_f32_16x16x32_bf16 v[192:195], a[108:111], v[84:87], v[192:195]
 v_mfma_f32_16x16x32_bf16 v[192:195], a[128:131], v[88:91], v[192:195]
 v_mfma_f32_16x16x32_bf16 v[196:199], a[132:135], v[88:91], v[196:199]
 v_mfma_f32_16x16x32_bf16 v[196:199], a[112:115], v[84:87], v[196:199]
 v_mfma_f32_16x16x32_bf16 v[196:199], a[92:95], v[80:83], v[196:199]
 v_mfma_f32_16x16x32_bf16 v[196:199], a[72:75], v[76:79], v[196:199]
 v_mfma_f32_16x16x32_bf16 v[196:199], a[52:55], v[72:75], v[196:199]
 v_mfma_f32_16x16x32_bf16 v[200:203], a[56:59], v[72:75], v[200:203]
 v_mfma_f32_16x16x32_bf16 v[200:203], a[76:79], v[76:79], v[200:203]
 v_mfma_f32_16x16x32_bf16 v[200:203], a[96:99], v[80:83], v[200:203]
 v_mfma_f32_16x16x32_bf16 v[200:203], a[116:119], v[84:87], v[200:203]
 v_mfma_f32_16x16x32_bf16 v[200:203], a[136:139], v[88:91], v[200:203]
 s_waitcnt vmcnt(4)
 v_mfma_f32_16x16x32_bf16 v[204:207], a[40:43], v[92:95], v[204:207]
 s_waitcnt lgkmcnt(0)
 s_barrier
 s_waitcnt vmcnt(3)
 v_mfma_f32_16x16x32_bf16 v[204:207], a[60:63], v[96:99], v[204:207]
 ds_read_b128 v[0:3], v224 offset:0
 s_waitcnt vmcnt(2)
 v_mfma_f32_16x16x32_bf16 v[204:207], a[80:83], v[100:103], v[204:207]
 ds_read_b128 v[20:23], v225 offset:0
 s_waitcnt vmcnt(1)
 v_mfma_f32_16x16x32_bf16 v[204:207], a[100:103], v[104:107], v[204:207]
 ds_read_b128 v[4:7], v224 offset:1024
 s_waitcnt vmcnt(0)
 v_mfma_f32_16x16x32_bf16 v[204:207], a[120:123], v[108:111], v[204:207]
 ds_read_b128 v[24:27], v225 offset:1024
 v_mfma_f32_16x16x32_bf16 v[208:211], a[124:127], v[108:111], v[208:211]
 ds_write_b128 v243, v[184:187] offset:10240
 v_mfma_f32_16x16x32_bf16 v[208:211], a[104:107], v[104:107], v[208:211]
 ds_write_b128 v243, v[188:191] offset:11264
 v_mfma_f32_16x16x32_bf16 v[208:211], a[84:87], v[100:103], v[208:211]
 ds_write_b128 v243, v[192:195] offset:12288
 v_mfma_f32_16x16x32_bf16 v[208:211], a[64:67], v[96:99], v[208:211]
 ds_write_b128 v243, v[196:199] offset:13312
 v_mfma_f32_16x16x32_bf16 v[208:211], a[44:47], v[92:95], v[208:211]
 ds_write_b128 v243, v[200:203] offset:14336
 v_mfma_f32_16x16x32_bf16 v[212:215], a[48:51], v[92:95], v[212:215]
 ds_read_b128 v[8:11], v224 offset:2048
 v_mfma_f32_16x16x32_bf16 v[212:215], a[68:71], v[96:99], v[212:215]
 ds_read_b128 v[28:31], v225 offset:2048
 v_mfma_f32_16x16x32_bf16 v[212:215], a[88:91], v[100:103], v[212:215]
 ds_read_b128 v[12:15], v224 offset:3072
 v_mfma_f32_16x16x32_bf16 v[212:215], a[108:111], v[104:107], v[212:215]
 ds_read_b128 v[32:35], v225 offset:3072
 v_mfma_f32_16x16x32_bf16 v[212:215], a[128:131], v[108:111], v[212:215]
 ds_read_b128 v[16:19], v224 offset:4096
 v_mfma_f32_16x16x32_bf16 v[216:219], a[132:135], v[108:111], v[216:219]
 ds_read_b128 v[36:39], v225 offset:4096
 v_mfma_f32_16x16x32_bf16 v[216:219], a[112:115], v[104:107], v[216:219]
 s_waitcnt lgkmcnt(13)
 v_add_f32 v0, v0, v20
 v_add_f32 v1, v1, v21
 v_mfma_f32_16x16x32_bf16 v[216:219], a[92:95], v[100:103], v[216:219]
 v_add_f32 v2, v2, v22
 v_add_f32 v3, v3, v23
 v_mfma_f32_16x16x32_bf16 v[216:219], a[72:75], v[96:99], v[216:219]
 s_waitcnt lgkmcnt(11)
 v_add_f32 v4, v4, v24
 v_add_f32 v5, v5, v25
 v_mfma_f32_16x16x32_bf16 v[216:219], a[52:55], v[92:95], v[216:219]
 v_add_f32 v6, v6, v26
 v_add_f32 v7, v7, v27
 v_mfma_f32_16x16x32_bf16 v[220:223], a[56:59], v[92:95], v[220:223]
 s_waitcnt lgkmcnt(4)
 v_add_f32 v8, v8, v28
 v_add_f32 v9, v9, v29
 v_mfma_f32_16x16x32_bf16 v[220:223], a[76:79], v[96:99], v[220:223]
 v_add_f32 v10, v10, v30
 v_add_f32 v11, v11, v31
 v_mfma_f32_16x16x32_bf16 v[220:223], a[96:99], v[100:103], v[220:223]
 s_waitcnt lgkmcnt(2)
 v_add_f32 v12, v12, v32
 v_add_f32 v13, v13, v33
 v_mfma_f32_16x16x32_bf16 v[220:223], a[116:119], v[104:107], v[220:223]
 v_add_f32 v14, v14, v34
 v_add_f32 v15, v15, v35
 v_mfma_f32_16x16x32_bf16 v[220:223], a[136:139], v[108:111], v[220:223]
 s_waitcnt lgkmcnt(0)
 v_add_f32 v16, v16, v36
 v_add_f32 v17, v17, v37
 s_barrier
 ds_read_b128 v[144:147], v226 offset:0
 ds_read_b128 v[148:151], v226 offset:1024
 ds_read_b128 v[152:155], v226 offset:2048
 ds_read_b128 v[156:159], v226 offset:3072
 ds_read_b128 v[160:163], v226 offset:4096
 v_add_f32 v18, v18, v38
 v_add_f32 v19, v19, v39
 v_pk_add_f32 v[204:205], v[204:205], v[0:1]
 v_pk_add_f32 v[206:207], v[206:207], v[2:3]
 v_pk_add_f32 v[208:209], v[208:209], v[4:5]
 v_pk_add_f32 v[210:211], v[210:211], v[6:7]
 v_pk_add_f32 v[212:213], v[212:213], v[8:9]
 v_pk_add_f32 v[214:215], v[214:215], v[10:11]
 v_pk_add_f32 v[216:217], v[216:217], v[12:13]
 v_pk_add_f32 v[218:219], v[218:219], v[14:15]
 v_pk_add_f32 v[220:221], v[220:221], v[16:17]
 v_pk_add_f32 v[222:223], v[222:223], v[18:19]
 v_pk_mul_f32 v[204:205], v[204:205], v[244:245] op_sel_hi:[1,0]
 v_pk_mul_f32 v[206:207], v[206:207], v[244:245] op_sel_hi:[1,0]
 v_pk_mul_f32 v[208:209], v[208:209], v[244:245] op_sel_hi:[1,0]
 v_pk_mul_f32 v[210:211], v[210:211], v[244:245] op_sel_hi:[1,0]
 v_pk_mul_f32 v[212:213], v[212:213], v[244:245] op_sel_hi:[1,0]
 v_pk_mul_f32 v[214:215], v[214:215], v[244:245] op_sel_hi:[1,0]
 v_pk_mul_f32 v[216:217], v[216:217], v[244:245] op_sel_hi:[1,0]
 v_pk_mul_f32 v[218:219], v[218:219], v[244:245] op_sel_hi:[1,0]
 v_pk_mul_f32 v[220:221], v[220:221], v[244:245] op_sel_hi:[1,0]
 v_pk_mul_f32 v[222:223], v[222:223], v[244:245] op_sel_hi:[1,0]
 s_waitcnt lgkmcnt(3)
 v_pk_fma_f32 v[204:205], v[144:145], v[244:245], v[204:205] op_sel_hi:[1,0,1]
 v_pk_fma_f32 v[206:207], v[146:147], v[244:245], v[206:207] op_sel_hi:[1,0,1]
 v_pk_fma_f32 v[208:209], v[148:149], v[244:245], v[208:209] op_sel_hi:[1,0,1]
 v_pk_fma_f32 v[210:211], v[150:151], v[244:245], v[210:211] op_sel_hi:[1,0,1]
 v_cvt_pk_bf16_f32 v0, v204, v205
 v_cvt_pk_bf16_f32 v1, v206, v207
 v_cvt_pk_bf16_f32 v2, v208, v209
 v_cvt_pk_bf16_f32 v3, v210, v211
 buffer_store_dwordx4 v[0:3], v240, s[20:23], 0 offen offset:0 sc1
 s_waitcnt lgkmcnt(1)
 v_pk_fma_f32 v[212:213], v[152:153], v[244:245], v[212:213] op_sel_hi:[1,0,1]
 v_pk_fma_f32 v[214:215], v[154:155], v[244:245], v[214:215] op_sel_hi:[1,0,1]
 v_pk_fma_f32 v[216:217], v[156:157], v[244:245], v[216:217] op_sel_hi:[1,0,1]
 v_pk_fma_f32 v[218:219], v[158:159], v[244:245], v[218:219] op_sel_hi:[1,0,1]
 v_cvt_pk_bf16_f32 v4, v212, v213
 v_cvt_pk_bf16_f32 v5, v214, v215
 v_cvt_pk_bf16_f32 v6, v216, v217
 v_cvt_pk_bf16_f32 v7, v218, v219
 buffer_store_dwordx4 v[4:7], v240, s[20:23], 0 offen offset:64 sc1
 s_waitcnt lgkmcnt(0)
 v_pk_fma_f32 v[220:221], v[160:161], v[244:245], v[220:221] op_sel_hi:[1,0,1]
 v_pk_fma_f32 v[222:223], v[162:163], v[244:245], v[222:223] op_sel_hi:[1,0,1]
 v_cvt_pk_bf16_f32 v8, v220, v221
 v_cvt_pk_bf16_f32 v9, v222, v223
 buffer_store_dwordx2 v[8:9], v241, s[20:23], s35 offen
 s_endpgm
L_att_lo:
 v_mov_b32 v208, 0xff800000
 v_mov_b32 v209, 0xff800000
 v_mov_b32 v210, 0xff800000
 v_mov_b32 v211, 0xff800000
 v_mov_b32 v212, 0xff800000
 v_mov_b32 v213, 0xff800000
 v_mov_b32 v214, 0xff800000
 v_mov_b32 v215, 0xff800000
 v_mov_b32 v216, 0xff800000
 v_mov_b32 v217, 0xff800000
 v_mov_b32 v218, 0xff800000
 v_mov_b32 v219, 0xff800000
 v_mov_b32 v220, 0xff800000
 v_mov_b32 v221, 0xff800000
 v_mov_b32 v222, 0xff800000
 v_mov_b32 v223, 0xff800000
 s_waitcnt lgkmcnt(0)
 ds_read_b128 v[168:171], v241 offset:1024
 ds_read_b128 v[172:175], v241 offset:13312
 s_cmp_eq_u32 s59, 7
 s_cbranch_scc1 L_open_19
L_open_ok_20:
 s_waitcnt lgkmcnt(0)
 v_mfma_f32_32x32x16_bf16 v[16:31], v[168:171], v[144:147], v[208:223]
 buffer_store_dwordx4 v[72:75], v226, s[16:19], s51 offen offset:0 sc1
 v_mfma_f32_32x32x16_bf16 v[16:31], v[172:175], v[148:151], v[16:31]
 ds_read_b128 v[168:171], v241 offset:2048
 ds_read_b128 v[172:175], v241 offset:14336
 buffer_store_dwordx4 v[80:83], v226, s[16:19], s50 offen offset:128 sc1
 s_cmp_eq_u32 s59, 6
 s_cbranch_scc1 L_open_21
L_open_ok_22:
 buffer_store_dwordx4 v[88:91], v226, s[16:19], s51 offen offset:128 sc1
 buffer_store_dwordx4 v[96:99], v226, s[16:19], s50 offen offset:2048 sc1
 s_waitcnt vmcnt(5)
 s_barrier
 s_waitcnt lgkmcnt(0)
 v_mfma_f32_32x32x16_bf16 v[176:191], v[168:171], v[144:147], v[208:223]
 buffer_store_dwordx4 v[104:107], v226, s[16:19], s51 offen offset:2048 sc1
 v_exp_f32 v16, v16
 v_exp_f32 v17, v17
 v_exp_f32 v18, v18
 v_exp_f32 v19, v19
 v_mfma_f32_32x32x16_bf16 v[176:191], v[172:175], v[148:151], v[176:191]
 ds_read_b128 v[168:171], v241 offset:3072
 ds_read_b128 v[172:175], v241 offset:15360
 buffer_store_dwordx4 v[112:115], v226, s[16:19], s50 offen offset:2176 sc1
 v_exp_f32 v20, v20
 v_exp_f32 v21, v21
 v_exp_f32 v22, v22
 v_exp_f32 v23, v23
 v_cvt_pk_bf16_f32 v16, v16, v17
 v_cvt_pk_bf16_f32 v17, v18, v19
 s_cmp_eq_u32 s59, 5
 s_cbranch_scc1 L_open_23
L_open_ok_24:
 buffer_store_dwordx4 v[120:123], v226, s[16:19], s51 offen offset:2176 sc1
 v_exp_f32 v24, v24
 v_exp_f32 v25, v25
 v_exp_f32 v26, v26
 v_exp_f32 v27, v27
 v_cvt_pk_bf16_f32 v18, v20, v21
 v_cvt_pk_bf16_f32 v19, v22, v23
 s_mov_b64 exec, s[94:95]
 ds_read_b128 v[160:163], v240 offset:3072
 ds_read_b128 v[164:167], v240 offset:4352
 s_mov_b64 exec, -1
 v_add_u32 v242, 5120, v242
 global_load_dwordx4 a[80:83], v242, s[16:17] offset:-2048 sc1
 v_exp_f32 v28, v28
 v_exp_f32 v29, v29
 v_exp_f32 v30, v30
 v_exp_f32 v31, v31
 v_cvt_pk_bf16_f32 v20, v24, v25
 v_cvt_pk_bf16_f32 v21, v26, v27
 v_cvt_pk_bf16_f32 v22, v28, v29
 v_cvt_pk_bf16_f32 v23, v30, v31
 s_waitcnt lgkmcnt(2)
 v_mfma_f32_32x32x16_bf16 v[0:15], v[168:171], v[144:147], v[208:223]
 global_load_dwordx4 a[84:87], v242, s[16:17] offset:-1024 sc1
 v_exp_f32 v176, v176
 v_exp_f32 v177, v177
 v_exp_f32 v178, v178
 v_exp_f32 v179, v179
 v_mfma_f32_32x32x16_bf16 v[0:15], v[172:175], v[148:151], v[0:15]
 s_waitcnt lgkmcnt(0)
 ds_read_b128 v[168:171], v241 offset:4096
 ds_read_b128 v[172:175], v241 offset:16384
 global_load_dwordx4 a[88:91], v242, s[16:17] offset:0 sc1
 v_exp_f32 v180, v180
 v_exp_f32 v181, v181
 v_exp_f32 v182, v182
 v_exp_f32 v183, v183
 v_cvt_pk_bf16_f32 v176, v176, v177
 v_cvt_pk_bf16_f32 v177, v178, v179
 v_mfma_f32_32x32x16_bf16 v[32:47], v[160:163], v[16:19], 0
 s_cmp_eq_u32 s59, 4
 s_cbranch_scc1 L_open_25
L_open_ok_26:
 global_load_dwordx4 a[92:95], v242, s[16:17] offset:1024 sc1
 v_exp_f32 v184, v184
 v_exp_f32 v185, v185
 v_exp_f32 v186, v186
 v_exp_f32 v187, v187
 v_cvt_pk_bf16_f32 v178, v180, v181
 v_cvt_pk_bf16_f32 v179, v182, v183
 v_mfma_f32_32x32x16_bf16 v[32:47], v[164:167], v[20:23], v[32:47]
 s_mov_b64 exec, s[94:95]
 ds_read_b128 v[160:163], v240 offset:6144
 ds_read_b128 v[164:167], v240 offset:7424
 s_mov_b64 exec, -1
 global_load_dwordx4 a[96:99], v242, s[16:17] offset:2048 sc1
 v_exp_f32 v188, v188
 v_exp_f32 v189, v189
 v_exp_f32 v190, v190
 v_exp_f32 v191, v191
 v_cvt_pk_bf16_f32 v180, v184, v185
 v_cvt_pk_bf16_f32 v181, v186, v187
 v_cvt_pk_bf16_f32 v182, v188, v189
 v_cvt_pk_bf16_f32 v183, v190, v191
 s_waitcnt lgkmcnt(2)
 v_mfma_f32_32x32x16_bf16 v[16:31], v[168:171], v[144:147], v[208:223]
 v_add_u32 v242, 5120, v242
 global_load_dwordx4 a[100:103], v242, s[16:17] offset:-2048 sc1
 v_exp_f32 v0, v0
 v_exp_f32 v1, v1
 v_exp_f32 v2, v2
 v_exp_f32 v3, v3
 v_mfma_f32_32x32x16_bf16 v[16:31], v[172:175], v[148:151], v[16:31]
 s_waitcnt lgkmcnt(0)
 ds_read_b128 v[168:171], v241 offset:5120
 ds_read_b128 v[172:175], v241 offset:17408
 global_load_dwordx4 a[104:107], v242, s[16:17] offset:-1024 sc1
 v_exp_f32 v4, v4
 v_exp_f32 v5, v5
 v_exp_f32 v6, v6
 v_exp_f32 v7, v7
 v_cvt_pk_bf16_f32 v0, v0, v1
 v_cvt_pk_bf16_f32 v1, v2, v3
 v_mfma_f32_32x32x16_bf16 v[32:47], v[160:163], v[176:179], v[32:47]
 s_cmp_eq_u32 s59, 3
 s_cbranch_scc1 L_open_27
L_open_ok_28:
 global_load_dwordx4 a[108:111], v242, s[16:17] offset:0 sc1
 v_exp_f32 v8, v8
 v_exp_f32 v9, v9
 v_exp_f32 v10, v10
 v_exp_f32 v11, v11
 v_cvt_pk_bf16_f32 v2, v4, v5
 v_cvt_pk_bf16_f32 v3, v6, v7
 v_mfma_f32_32x32x16_bf16 v[32:47], v[164:167], v[180:183], v[32:47]
 s_mov_b64 exec, s[94:95]
 ds_read_b128 v[160:163], v240 offset:9216
 ds_read_b128 v[164:167], v240 offset:10496
 s_mov_b64 exec, -1
 global_load_dwordx4 a[112:115], v242, s[16:17] offset:1024 sc1
 v_exp_f32 v12, v12
 v_exp_f32 v13, v13
 v_exp_f32 v14, v14
 v_exp_f32 v15, v15
 v_cvt_pk_bf16_f32 v4, v8, v9
 v_cvt_pk_bf16_f32 v5, v10, v11
 v_cvt_pk_bf16_f32 v6, v12, v13
 v_cvt_pk_bf16_f32 v7, v14, v15
 s_waitcnt lgkmcnt(2)
 v_mfma_f32_32x32x16_bf16 v[176:191], v[168:171], v[144:147], v[208:223]
 global_load_dwordx4 a[116:119], v242, s[16:17] offset:2048 sc1
 v_exp_f32 v16, v16
 v_exp_f32 v17, v17
 v_exp_f32 v18, v18
 v_exp_f32 v19, v19
 v_mfma_f32_32x32x16_bf16 v[176:191], v[172:175], v[148:151], v[176:191]
 s_waitcnt lgkmcnt(0)
 ds_read_b128 v[168:171], v241 offset:6144
 ds_read_b128 v[172:175], v241 offset:18432
 v_add_u32 v242, 5120, v242
 global_load_dwordx4 a[120:123], v242, s[16:17] offset:-2048 sc1
 v_exp_f32 v20, v20
 v_exp_f32 v21, v21
 v_exp_f32 v22, v22
 v_exp_f32 v23, v23
 v_cvt_pk_bf16_f32 v16, v16, v17
 v_cvt_pk_bf16_f32 v17, v18, v19
 v_mfma_f32_32x32x16_bf16 v[32:47], v[160:163], v[0:3], v[32:47]
 s_cmp_eq_u32 s59, 2
 s_cbranch_scc1 L_open_29
L_open_ok_30:
 global_load_dwordx4 a[124:127], v242, s[16:17] offset:-1024 sc1
 v_exp_f32 v24, v24
 v_exp_f32 v25, v25
 v_exp_f32 v26, v26
 v_exp_f32 v27, v27
 v_cvt_pk_bf16_f32 v18, v20, v21
 v_cvt_pk_bf16_f32 v19, v22, v23
 v_mfma_f32_32x32x16_bf16 v[32:47], v[164:167], v[4:7], v[32:47]
 s_mov_b64 exec, s[94:95]
 ds_read_b128 v[160:163], v240 offset:12288
 ds_read_b128 v[164:167], v240 offset:13568
 s_mov_b64 exec, -1
 global_load_dwordx4 a[128:131], v242, s[16:17] offset:0 sc1
 v_exp_f32 v28, v28
 v_exp_f32 v29, v29
 v_exp_f32 v30, v30
 v_exp_f32 v31, v31
 v_cvt_pk_bf16_f32 v20, v24, v25
 v_cvt_pk_bf16_f32 v21, v26, v27
 v_cvt_pk_bf16_f32 v22, v28, v29
 v_cvt_pk_bf16_f32 v23, v30, v31
 s_waitcnt lgkmcnt(2)
 v_mfma_f32_32x32x16_bf16 v[0:15], v[168:171], v[144:147], v[208:223]
 global_load_dwordx4 a[132:135], v242, s[16:17] offset:1024 sc1
 v_exp_f32 v176, v176
 v_exp_f32 v177, v177
 v_exp_f32 v178, v178
 v_exp_f32 v179, v179
 v_mfma_f32_32x32x16_bf16 v[0:15], v[172:175], v[148:151], v[0:15]
 s_waitcnt lgkmcnt(0)
 ds_read_b128 v[168:171], v241 offset:7168
 ds_read_b128 v[172:175], v241 offset:19456
 global_load_dwordx4 a[136:139], v242, s[16:17] offset:2048 sc1
 v_exp_f32 v180, v180
 v_exp_f32 v181, v181
 v_exp_f32 v182, v182
 v_exp_f32 v183, v183
 v_cvt_pk_bf16_f32 v176, v176, v177
 v_cvt_pk_bf16_f32 v177, v178, v179
 v_mfma_f32_32x32x16_bf16 v[32:47], v[160:163], v[16:19], v[32:47]
 s_cmp_eq_u32 s59, 1
 s_cbranch_scc1 L_open_31
L_open_ok_32:
 v_add_u32 v242, 5120, v242
 global_load_dwordx4 a[140:143], v242, s[16:17] offset:-2048 sc1
 v_exp_f32 v184, v184
 v_exp_f32 v185, v185
 v_exp_f32 v186, v186
 v_exp_f32 v187, v187
 v_cvt_pk_bf16_f32 v178, v180, v181
 v_cvt_pk_bf16_f32 v179, v182, v183
 v_mfma_f32_32x32x16_bf16 v[32:47], v[164:167], v[20:23], v[32:47]
 s_mov_b64 exec, s[94:95]
 ds_read_b128 v[160:163], v240 offset:15360
 ds_read_b128 v[164:167], v240 offset:16640
 s_mov_b64 exec, -1
 global_load_dwordx4 a[144:147], v242, s[16:17] offset:-1024 sc1
 v_exp_f32 v188, v188
 v_exp_f32 v189, v189
 v_exp_f32 v190, v190
 v_exp_f32 v191, v191
 v_cvt_pk_bf16_f32 v180, v184, v185
 v_cvt_pk_bf16_f32 v181, v186, v187
 v_cvt_pk_bf16_f32 v182, v188, v189
 v_cvt_pk_bf16_f32 v183, v190, v191
 s_waitcnt lgkmcnt(2)
 v_mfma_f32_32x32x16_bf16 v[16:31], v[168:171], v[144:147], v[208:223]
 s_waitcnt vmcnt(17)
 s_mov_b64 exec, 1
 buffer_store_dwordx2 v[252:253], v237, s[16:19], s53 offen offset:32 sc1
 s_mov_b64 exec, -1
 v_exp_f32 v0, v0
 v_exp_f32 v1, v1
 v_exp_f32 v2, v2
 v_exp_f32 v3, v3
 v_mfma_f32_32x32x16_bf16 v[16:31], v[172:175], v[148:151], v[16:31]
 s_waitcnt lgkmcnt(0)
 ds_read_b128 v[168:171], v241 offset:8192
 ds_read_b128 v[172:175], v241 offset:20480
 global_load_dwordx4 a[148:151], v242, s[16:17] offset:0 sc1
 v_exp_f32 v4, v4
 v_exp_f32 v5, v5
 v_exp_f32 v6, v6
 v_exp_f32 v7, v7
 v_cvt_pk_bf16_f32 v0, v0, v1
 v_cvt_pk_bf16_f32 v1, v2, v3
 v_mfma_f32_32x32x16_bf16 v[32:47], v[160:163], v[176:179], v[32:47]
 global_load_dwordx4 a[152:155], v242, s[16:17] offset:1024 sc1
 v_exp_f32 v8, v8
 v_exp_f32 v9, v9
 v_exp_f32 v10, v10
 v_exp_f32 v11, v11
 v_cvt_pk_bf16_f32 v2, v4, v5
 v_cvt_pk_bf16_f32 v3, v6, v7
 v_mfma_f32_32x32x16_bf16 v[32:47], v[164:167], v[180:183], v[32:47]
 s_mov_b64 exec, s[94:95]
 ds_read_b128 v[160:163], v240 offset:18432
 ds_read_b128 v[164:167], v240 offset:19712
 s_mov_b64 exec, -1
 global_load_dwordx4 a[156:159], v242, s[16:17] offset:2048 sc1
 v_exp_f32 v12, v12
 v_exp_f32 v13, v13
 v_exp_f32 v14, v14
 v_exp_f32 v15, v15
 v_cvt_pk_bf16_f32 v4, v8, v9
 v_cvt_pk_bf16_f32 v5, v10, v11
 v_cvt_pk_bf16_f32 v6, v12, v13
 v_cvt_pk_bf16_f32 v7, v14, v15
 s_waitcnt lgkmcnt(2)
 v_mfma_f32_32x32x16_bf16 v[176:191], v[168:171], v[144:147], v[192:207]
 v_add_u32 v242, 5120, v242
 global_load_dwordx4 a[160:163], v242, s[16:17] offset:-2048 sc1
 v_exp_f32 v16, v16
 v_exp_f32 v17, v17
 v_exp_f32 v18, v18
 v_exp_f32 v19, v19
 v_mfma_f32_32x32x16_bf16 v[176:191], v[172:175], v[148:151], v[176:191]
 s_waitcnt lgkmcnt(0)
 global_load_dwordx4 a[164:167], v242, s[16:17] offset:-1024 sc1
 v_exp_f32 v20, v20
 v_exp_f32 v21, v21
 v_exp_f32 v22, v22
 v_exp_f32 v23, v23
 v_cvt_pk_bf16_f32 v16, v16, v17
 v_cvt_pk_bf16_f32 v17, v18, v19
 v_mfma_f32_32x32x16_bf16 v[32:47], v[160:163], v[0:3], v[32:47]
 v_mov_b32 v208, 0xff800000
 v_mov_b32 v209, 0xff800000
 v_mov_b32 v210, 0xff800000
 v_mov_b32 v211, 0xff800000
 v_mov_b32 v212, 0xff800000
 v_mov_b32 v213, 0xff800000
 v_mov_b32 v214, 0xff800000
 v_mov_b32 v215, 0xff800000
 v_mov_b32 v216, 0xff800000
 v_mov_b32 v217, 0xff800000
 v_mov_b32 v218, 0xff800000
 v_mov_b32 v219, 0xff800000
 v_mov_b32 v220, 0xff800000
 v_mov_b32 v221, 0xff800000
 v_mov_b32 v222, 0xff800000
 v_mov_b32 v223, 0xff800000
 global_load_dwordx4 a[168:171], v242, s[16:17] offset:0 sc1
 v_exp_f32 v24, v24
 v_exp_f32 v25, v25
 v_exp_f32 v26, v26
 v_exp_f32 v27, v27
 v_cvt_pk_bf16_f32 v18, v20, v21
 v_cvt_pk_bf16_f32 v19, v22, v23
 v_mfma_f32_32x32x16_bf16 v[32:47], v[164:167], v[4:7], v[32:47]
 s_mov_b64 exec, s[94:95]
 ds_read_b128 v[160:163], v240 offset:21504
 ds_read_b128 v[164:167], v240 offset:22784
 s_mov_b64 exec, -1
 global_load_dwordx4 a[172:175], v242, s[16:17] offset:1024 sc1
 v_exp_f32 v28, v28
 v_exp_f32 v29, v29
 v_exp_f32 v30, v30
 v_exp_f32 v31, v31
 v_cvt_pk_bf16_f32 v20, v24, v25
 v_cvt_pk_bf16_f32 v21, v26, v27
 v_cvt_pk_bf16_f32 v22, v28, v29
 v_cvt_pk_bf16_f32 v23, v30, v31
 global_load_dwordx4 a[176:179], v242, s[16:17] offset:2048 sc1
 v_exp_f32 v176, v176
 v_exp_f32 v177, v177
 v_exp_f32 v178, v178
 v_exp_f32 v179, v179
 s_waitcnt lgkmcnt(0)
 ds_read_b128 v[168:171], v241 offset:13312
 ds_read_b128 v[172:175], v241 offset:25600
 v_add_u32 v242, 5120, v242
 global_load_dwordx4 a[180:183], v242, s[16:17] offset:-2048 sc1
 v_exp_f32 v180, v180
 v_exp_f32 v181, v181
 v_exp_f32 v182, v182
 v_exp_f32 v183, v183
 v_cvt_pk_bf16_f32 v176, v176, v177
 v_cvt_pk_bf16_f32 v177, v178, v179
 v_mfma_f32_32x32x16_bf16 v[32:47], v[160:163], v[16:19], v[32:47]
 s_cmp_eq_u32 s59, 7
 s_cbranch_scc1 L_open_33
L_open_ok_34:
 global_load_dwordx4 a[184:187], v242, s[16:17] offset:-1024 sc1
 v_exp_f32 v184, v184
 v_exp_f32 v185, v185
 v_exp_f32 v186, v186
 v_exp_f32 v187, v187
 v_cvt_pk_bf16_f32 v178, v180, v181
 v_cvt_pk_bf16_f32 v179, v182, v183
 v_mfma_f32_32x32x16_bf16 v[32:47], v[164:167], v[20:23], v[32:47]
 s_mov_b64 exec, s[94:95]
 ds_read_b128 v[160:163], v240 offset:24576
 ds_read_b128 v[164:167], v240 offset:25856
 s_mov_b64 exec, -1
 global_load_dwordx4 a[188:191], v242, s[16:17] offset:0 sc1
 v_exp_f32 v188, v188
 v_exp_f32 v189, v189
 v_exp_f32 v190, v190
 v_exp_f32 v191, v191
 v_cvt_pk_bf16_f32 v180, v184, v185
 v_cvt_pk_bf16_f32 v181, v186, v187
 v_cvt_pk_bf16_f32 v182, v188, v189
 v_cvt_pk_bf16_f32 v183, v190, v191
 s_waitcnt lgkmcnt(2)
 v_mfma_f32_32x32x16_bf16 v[16:31], v[168:171], v[152:155], v[208:223]
 global_load_dwordx4 a[192:195], v242, s[16:17] offset:1024 sc1
 v_mfma_f32_32x32x16_bf16 v[16:31], v[172:175], v[156:159], v[16:31]
 s_waitcnt lgkmcnt(0)
 ds_read_b128 v[168:171], v241 offset:14336
 ds_read_b128 v[172:175], v241 offset:26624
 global_load_dwordx4 a[196:199], v242, s[16:17] offset:2048 sc1
 v_mfma_f32_32x32x16_bf16 v[32:47], v[160:163], v[176:179], v[32:47]
 s_cmp_eq_u32 s59, 6
 s_cbranch_scc1 L_open_35
L_open_ok_36:
 v_add_u32 v242, 5120, v242
 global_load_dwordx4 a[200:203], v242, s[16:17] offset:-2048 sc1
 v_mfma_f32_32x32x16_bf16 v[32:47], v[164:167], v[180:183], v[32:47]
 global_load_dwordx4 a[204:207], v242, s[16:17] offset:-1024 sc1
 s_waitcnt lgkmcnt(0)
 v_mfma_f32_32x32x16_bf16 v[176:191], v[168:171], v[152:155], v[208:223]
 global_load_dwordx4 a[208:211], v242, s[16:17] offset:0 sc1
 v_exp_f32 v16, v16
 v_exp_f32 v17, v17
 v_exp_f32 v18, v18
 v_exp_f32 v19, v19
 v_mfma_f32_32x32x16_bf16 v[176:191], v[172:175], v[156:159], v[176:191]
 ds_read_b128 v[168:171], v241 offset:15360
 ds_read_b128 v[172:175], v241 offset:27648
 global_load_dwordx4 a[212:215], v242, s[16:17] offset:1024 sc1
 v_exp_f32 v20, v20
 v_exp_f32 v21, v21
 v_exp_f32 v22, v22
 v_exp_f32 v23, v23
 v_cvt_pk_bf16_f32 v16, v16, v17
 v_cvt_pk_bf16_f32 v17, v18, v19
 s_cmp_eq_u32 s59, 5
 s_cbranch_scc1 L_open_37
L_open_ok_38:
 global_load_dwordx4 a[216:219], v242, s[16:17] offset:2048 sc1
 v_exp_f32 v24, v24
 v_exp_f32 v25, v25
 v_exp_f32 v26, v26
 v_exp_f32 v27, v27
 v_cvt_pk_bf16_f32 v18, v20, v21
 v_cvt_pk_bf16_f32 v19, v22, v23
 s_mov_b64 exec, s[94:95]
 ds_read_b128 v[160:163], v240 offset:3392
 ds_read_b128 v[164:167], v240 offset:4672
 s_mov_b64 exec, -1
 v_add_u32 v242, 5120, v242
 global_load_dwordx4 a[220:223], v242, s[16:17] offset:-2048 sc1
 v_exp_f32 v28, v28
 v_exp_f32 v29, v29
 v_exp_f32 v30, v30
 v_exp_f32 v31, v31
 v_cvt_pk_bf16_f32 v20, v24, v25
 v_cvt_pk_bf16_f32 v21, v26, v27
 v_cvt_pk_bf16_f32 v22, v28, v29
 v_cvt_pk_bf16_f32 v23, v30, v31
 s_waitcnt lgkmcnt(2)
 v_mfma_f32_32x32x16_bf16 v[0:15], v[168:171], v[152:155], v[208:223]
 global_load_dwordx4 a[224:227], v242, s[16:17] offset:-1024 sc1
 v_exp_f32 v176, v176
 v_exp_f32 v177, v177
 v_exp_f32 v178, v178
 v_exp_f32 v179, v179
 v_mfma_f32_32x32x16_bf16 v[0:15], v[172:175], v[156:159], v[0:15]
 s_waitcnt lgkmcnt(0)
 ds_read_b128 v[168:171], v241 offset:16384
 ds_read_b128 v[172:175], v241 offset:28672
 global_load_dwordx4 a[228:231], v242, s[16:17] offset:0 sc1
 v_exp_f32 v180, v180
 v_exp_f32 v181, v181
 v_exp_f32 v182, v182
 v_exp_f32 v183, v183
 v_cvt_pk_bf16_f32 v176, v176, v177
 v_cvt_pk_bf16_f32 v177, v178, v179
 v_mfma_f32_32x32x16_bf16 v[48:63], v[160:163], v[16:19], 0
 s_cmp_eq_u32 s59, 4
 s_cbranch_scc1 L_open_39
L_open_ok_40:
 global_load_dwordx4 a[232:235], v242, s[16:17] offset:1024 sc1
 v_exp_f32 v184, v184
 v_exp_f32 v185, v185
 v_exp_f32 v186, v186
 v_exp_f32 v187, v187
 v_cvt_pk_bf16_f32 v178, v180, v181
 v_cvt_pk_bf16_f32 v179, v182, v183
 v_mfma_f32_32x32x16_bf16 v[48:63], v[164:167], v[20:23], v[48:63]
 s_mov_b64 exec, s[94:95]
 ds_read_b128 v[160:163], v240 offset:6464
 ds_read_b128 v[164:167], v240 offset:7744
 s_mov_b64 exec, -1
 global_load_dwordx4 a[236:239], v242, s[16:17] offset:2048 sc1
 v_exp_f32 v188, v188
 v_exp_f32 v189, v189
 v_exp_f32 v190, v190
 v_exp_f32 v191, v191
 v_cvt_pk_bf16_f32 v180, v184, v185
 v_cvt_pk_bf16_f32 v181, v186, v187
 v_cvt_pk_bf16_f32 v182, v188, v189
 v_cvt_pk_bf16_f32 v183, v190, v191
 s_waitcnt lgkmcnt(2)
 v_mfma_f32_32x32x16_bf16 v[16:31], v[168:171], v[152:155], v[208:223]
 s_mul_i32 s44, s3, 20480
 s_lshl_b32 s42, s3, 3
 s_lshr_b32 s42, 0x1c242d36, s42
 s_and_b32 s42, s42, 0xff
 s_mul_i32 s42, s42, 5120
 s_add_u32 s0, s42, s73
 s_add_u32 m0, s44, 0
 s_add_u32 s0, s0, -2048
 buffer_load_dwordx4 v254, s[16:19], s0 offen offset:0 sc1 lds
 v_exp_f32 v0, v0
 v_exp_f32 v1, v1
 v_exp_f32 v2, v2
 v_exp_f32 v3, v3
 v_mfma_f32_32x32x16_bf16 v[16:31], v[172:175], v[156:159], v[16:31]
 s_waitcnt lgkmcnt(0)
 ds_read_b128 v[168:171], v241 offset:17408
 ds_read_b128 v[172:175], v241 offset:29696
 buffer_load_dwordx4 v254, s[16:19], s0 offen offset:1024 sc1 lds
 v_exp_f32 v4, v4
 v_exp_f32 v5, v5
 v_exp_f32 v6, v6
 v_exp_f32 v7, v7
 v_cvt_pk_bf16_f32 v0, v0, v1
 v_cvt_pk_bf16_f32 v1, v2, v3
 v_mfma_f32_32x32x16_bf16 v[48:63], v[160:163], v[176:179], v[48:63]
 s_cmp_eq_u32 s59, 3
 s_cbranch_scc1 L_open_41
L_open_ok_42:
 buffer_load_dwordx2 v[246:247], v243, s[16:19], 0 offen sc1
 v_exp_f32 v8, v8
 v_exp_f32 v9, v9
 v_exp_f32 v10, v10
 v_exp_f32 v11, v11
 v_cvt_pk_bf16_f32 v2, v4, v5
 v_cvt_pk_bf16_f32 v3, v6, v7
 v_mfma_f32_32x32x16_bf16 v[48:63], v[164:167], v[180:183], v[48:63]
 s_mov_b64 exec, s[94:95]
 ds_read_b128 v[160:163], v240 offset:9536
 ds_read_b128 v[164:167], v240 offset:10816
 s_mov_b64 exec, -1
 buffer_load_dwordx4 v254, s[16:19], s0 offen offset:2048 sc1 lds
 v_exp_f32 v12, v12
 v_exp_f32 v13, v13
 v_exp_f32 v14, v14
 v_exp_f32 v15, v15
 v_cvt_pk_bf16_f32 v4, v8, v9
 v_cvt_pk_bf16_f32 v5, v10, v11
 v_cvt_pk_bf16_f32 v6, v12, v13
 v_cvt_pk_bf16_f32 v7, v14, v15
 s_waitcnt lgkmcnt(2)
 v_mfma_f32_32x32x16_bf16 v[176:191], v[168:171], v[152:155], v[208:223]
 buffer_load_dwordx4 v254, s[16:19], s0 offen offset:3072 sc1 lds
 v_exp_f32 v16, v16
 v_exp_f32 v17, v17
 v_exp_f32 v18, v18
 v_exp_f32 v19, v19
 v_mfma_f32_32x32x16_bf16 v[176:191], v[172:175], v[156:159], v[176:191]
 s_waitcnt lgkmcnt(0)
 ds_read_b128 v[168:171], v241 offset:18432
 ds_read_b128 v[172:175], v241 offset:30720
 s_add_u32 m0, s44, 4096
 s_add_u32 s0, s0, 4096
 buffer_load_dwordx4 v254, s[16:19], s0 offen offset:0 sc1 lds
 v_exp_f32 v20, v20
 v_exp_f32 v21, v21
 v_exp_f32 v22, v22
 v_exp_f32 v23, v23
 v_cvt_pk_bf16_f32 v16, v16, v17
 v_cvt_pk_bf16_f32 v17, v18, v19
 v_mfma_f32_32x32x16_bf16 v[48:63], v[160:163], v[0:3], v[48:63]
 s_cmp_eq_u32 s59, 2
 s_cbranch_scc1 L_open_43
L_open_ok_44:
 buffer_load_dwordx4 v254, s[16:19], s0 offen offset:1024 sc1 lds
 v_exp_f32 v24, v24
 v_exp_f32 v25, v25
 v_exp_f32 v26, v26
 v_exp_f32 v27, v27
 v_cvt_pk_bf16_f32 v18, v20, v21
 v_cvt_pk_bf16_f32 v19, v22, v23
 v_mfma_f32_32x32x16_bf16 v[48:63], v[164:167], v[4:7], v[48:63]
 s_mov_b64 exec, s[94:95]
 ds_read_b128 v[160:163], v240 offset:12608
 ds_read_b128 v[164:167], v240 offset:13888
 s_mov_b64 exec, -1
 buffer_load_dwordx4 v254, s[16:19], s0 offen offset:2048 sc1 lds
 v_exp_f32 v28, v28
 v_exp_f32 v29, v29
 v_exp_f32 v30, v30
 v_exp_f32 v31, v31
 v_cvt_pk_bf16_f32 v20, v24, v25
 v_cvt_pk_bf16_f32 v21, v26, v27
 v_cvt_pk_bf16_f32 v22, v28, v29
 v_cvt_pk_bf16_f32 v23, v30, v31
 s_waitcnt lgkmcnt(2)
 v_mfma_f32_32x32x16_bf16 v[0:15], v[168:171], v[152:155], v[208:223]
 buffer_load_dwordx4 v254, s[16:19], s0 offen offset:3072 sc1 lds
 v_exp_f32 v176, v176
 v_exp_f32 v177, v177
 v_exp_f32 v178, v178
 v_exp_f32 v179, v179
 v_mfma_f32_32x32x16_bf16 v[0:15], v[172:175], v[156:159], v[0:15]
 s_waitcnt lgkmcnt(0)
 ds_read_b128 v[168:171], v241 offset:19456
 ds_read_b128 v[172:175], v241 offset:31744
 s_add_u32 m0, s44, 8192
 s_add_u32 s0, s0, 4096
 buffer_load_dwordx4 v254, s[16:19], s0 offen offset:0 sc1 lds
 v_exp_f32 v180, v180
 v_exp_f32 v181, v181
 v_exp_f32 v182, v182
 v_exp_f32 v183, v183
 v_cvt_pk_bf16_f32 v176, v176, v177
 v_cvt_pk_bf16_f32 v177, v178, v179
 v_mfma_f32_32x32x16_bf16 v[48:63], v[160:163], v[16:19], v[48:63]
 s_cmp_eq_u32 s59, 1
 s_cbranch_scc1 L_open_45
L_open_ok_46:
 buffer_load_dwordx4 v254, s[16:19], s0 offen offset:1024 sc1 lds
 v_exp_f32 v184, v184
 v_exp_f32 v185, v185
 v_exp_f32 v186, v186
 v_exp_f32 v187, v187
 v_cvt_pk_bf16_f32 v178, v180, v181
 v_cvt_pk_bf16_f32 v179, v182, v183
 v_mfma_f32_32x32x16_bf16 v[48:63], v[164:167], v[20:23], v[48:63]
 s_mov_b64 exec, s[94:95]
 ds_read_b128 v[160:163], v240 offset:15680
 ds_read_b128 v[164:167], v240 offset:16960
 s_mov_b64 exec, -1
 v_exp_f32 v188, v188
 v_exp_f32 v189, v189
 v_exp_f32 v190, v190
 v_exp_f32 v191, v191
 v_cvt_pk_bf16_f32 v180, v184, v185
 v_cvt_pk_bf16_f32 v181, v186, v187
 v_cvt_pk_bf16_f32 v182, v188, v189
 v_cvt_pk_bf16_f32 v183, v190, v191
 s_waitcnt lgkmcnt(2)
 v_mfma_f32_32x32x16_bf16 v[16:31], v[168:171], v[152:155], v[208:223]
 v_exp_f32 v0, v0
 v_exp_f32 v1, v1
 v_exp_f32 v2, v2
 v_exp_f32 v3, v3
 v_mfma_f32_32x32x16_bf16 v[16:31], v[172:175], v[156:159], v[16:31]
 s_waitcnt lgkmcnt(0)
 ds_read_b128 v[168:171], v241 offset:20480
 ds_read_b128 v[172:175], v241 offset:32768
 s_waitcnt vmcnt(8)
 v_cmp_ne_u64 vcc, s[90:91], v[246:247]
 s_nop 0
 s_cbranch_vccnz L_poll_47
L_poll_ok_48:
 buffer_load_dword v227, v227, s[16:19], 0 offen sc1
 v_exp_f32 v4, v4
 v_exp_f32 v5, v5
 v_exp_f32 v6, v6
 v_exp_f32 v7, v7
 v_cvt_pk_bf16_f32 v0, v0, v1
 v_cvt_pk_bf16_f32 v1, v2, v3
 v_mfma_f32_32x32x16_bf16 v[48:63], v[160:163], v[176:179], v[48:63]
 buffer_load_dwordx4 v[64:67], v232, s[16:19], 0 offen offset:0 sc1
 v_exp_f32 v8, v8
 v_exp_f32 v9, v9
 v_exp_f32 v10, v10
 v_exp_f32 v11, v11
 v_cvt_pk_bf16_f32 v2, v4, v5
 v_cvt_pk_bf16_f32 v3, v6, v7
 v_mfma_f32_32x32x16_bf16 v[48:63], v[164:167], v[180:183], v[48:63]
 s_mov_b64 exec, s[94:95]
 ds_read_b128 v[160:163], v240 offset:18752
 ds_read_b128 v[164:167], v240 offset:20032
 s_mov_b64 exec, -1
 buffer_load_dwordx4 v[80:83], v232, s[16:19], 0 offen offset:2048 sc1
 v_exp_f32 v12, v12
 v_exp_f32 v13, v13
 v_exp_f32 v14, v14
 v_exp_f32 v15, v15
 v_cvt_pk_bf16_f32 v4, v8, v9
 v_cvt_pk_bf16_f32 v5, v10, v11
 v_cvt_pk_bf16_f32 v6, v12, v13
 v_cvt_pk_bf16_f32 v7, v14, v15
 s_waitcnt lgkmcnt(2)
 v_mfma_f32_32x32x16_bf16 v[176:191], v[168:171], v[152:155], v[192:207]
 buffer_load_dwordx4 v[68:71], v233, s[16:19], 0 offen offset:0 sc1
 v_exp_f32 v16, v16
 v_exp_f32 v17, v17
 v_exp_f32 v18, v18
 v_exp_f32 v19, v19
 v_mfma_f32_32x32x16_bf16 v[176:191], v[172:175], v[156:159], v[176:191]
 s_waitcnt lgkmcnt(0)
 buffer_load_dwordx4 v[84:87], v233, s[16:19], 0 offen offset:2048 sc1
 v_exp_f32 v20, v20
 v_exp_f32 v21, v21
 v_exp_f32 v22, v22
 v_exp_f32 v23, v23
 v_cvt_pk_bf16_f32 v16, v16, v17
 v_cvt_pk_bf16_f32 v17, v18, v19
 v_mfma_f32_32x32x16_bf16 v[48:63], v[160:163], v[0:3], v[48:63]
 buffer_load_dwordx4 v[72:75], v234, s[16:19], 0 offen offset:0 sc1
 v_exp_f32 v24, v24
 v_exp_f32 v25, v25
 v_exp_f32 v26, v26
 v_exp_f32 v27, v27
 v_cvt_pk_bf16_f32 v18, v20, v21
 v_cvt_pk_bf16_f32 v19, v22, v23
 v_mfma_f32_32x32x16_bf16 v[48:63], v[164:167], v[4:7], v[48:63]
 s_mov_b64 exec, s[94:95]
 ds_read_b128 v[160:163], v240 offset:21824
 ds_read_b128 v[164:167], v240 offset:23104
 s_mov_b64 exec, -1
 buffer_load_dwordx4 v[88:91], v234, s[16:19], 0 offen offset:2048 sc1
 v_exp_f32 v28, v28
 v_exp_f32 v29, v29
 v_exp_f32 v30, v30
 v_exp_f32 v31, v31
 v_cvt_pk_bf16_f32 v20, v24, v25
 v_cvt_pk_bf16_f32 v21, v26, v27
 v_cvt_pk_bf16_f32 v22, v28, v29
 v_cvt_pk_bf16_f32 v23, v30, v31
 buffer_load_dwordx4 v[76:79], v235, s[16:19], 0 offen offset:0 sc1
 v_exp_f32 v176, v176
 v_exp_f32 v177, v177
 v_exp_f32 v178, v178
 v_exp_f32 v179, v179
 s_waitcnt lgkmcnt(0)
 buffer_load_dwordx4 v[92:95], v235, s[16:19], 0 offen offset:2048 sc1
 v_exp_f32 v180, v180
 v_exp_f32 v181, v181
 v_exp_f32 v182, v182
 v_exp_f32 v183, v183
 v_cvt_pk_bf16_f32 v176, v176, v177
 v_cvt_pk_bf16_f32 v177, v178, v179
 v_mfma_f32_32x32x16_bf16 v[48:63], v[160:163], v[16:19], v[48:63]
 s_movk_i32 s1, 4096
 buffer_load_dwordx4 v[96:99], v232, s[16:19], s1 offen offset:0 sc1
 v_exp_f32 v184, v184
 v_exp_f32 v185, v185
 v_exp_f32 v186, v186
 v_exp_f32 v187, v187
 v_cvt_pk_bf16_f32 v178, v180, v181
 v_cvt_pk_bf16_f32 v179, v182, v183
 v_mfma_f32_32x32x16_bf16 v[48:63], v[164:167], v[20:23], v[48:63]
 s_mov_b64 exec, s[94:95]
 ds_read_b128 v[160:163], v240 offset:24896
 ds_read_b128 v[164:167], v240 offset:26176
 s_mov_b64 exec, -1
 buffer_load_dwordx4 v[112:115], v232, s[16:19], s1 offen offset:2048 sc1
 v_exp_f32 v188, v188
 v_exp_f32 v189, v189
 v_exp_f32 v190, v190
 v_exp_f32 v191, v191
 v_cvt_pk_bf16_f32 v180, v184, v185
 v_cvt_pk_bf16_f32 v181, v186, v187
 v_cvt_pk_bf16_f32 v182, v188, v189
 v_cvt_pk_bf16_f32 v183, v190, v191
 s_waitcnt lgkmcnt(0)
 v_mfma_f32_32x32x16_bf16 v[48:63], v[160:163], v[176:179], v[48:63]
 v_mfma_f32_32x32x16_bf16 v[48:63], v[164:167], v[180:183], v[48:63]
 s_branch L_att_join
L_gate:
 buffer_load_dwordx2 v[246:247], v244, s[16:19], 0 offen sc1
 s_lshr_b32 s43, s86, 1
 s_add_u32 s43, s43, 155648
 v_lshrrev_b32 v249, 4, v255
 v_lshl_add_u32 v249, v249, 4, s43
 s_waitcnt lgkmcnt(0)
 s_bfe_u32 s44, s81, 0x40004
 s_mul_i32 s44, s44, 128
 v_add_u32 v250, s44, v249
 ds_read_b128 v[32:35], v250 offset:0
 ds_read_b128 v[36:39], v250 offset:64
 s_bfe_u32 s44, s80, 0x40000
 s_mul_i32 s44, s44, 128
 v_add_u32 v250, s44, v249
 ds_read_b128 v[40:43], v250 offset:0
 ds_read_b128 v[44:47], v250 offset:64
 v_mul_f32 v128, s52, v128
 v_mul_f32 v129, s52, v129
 v_mul_f32 v130, s52, v130
 v_mul_f32 v131, s52, v131
 v_mul_f32 v132, s52, v132
 v_mul_f32 v133, s52, v133
 v_mul_f32 v134, s52, v134
 v_mul_f32 v135, s52, v135
 v_cvt_pk_bf16_f32 v128, v128, v129
 v_cvt_pk_bf16_f32 v129, v130, v131
 v_cvt_pk_bf16_f32 v130, v132, v133
 v_cvt_pk_bf16_f32 v131, v134, v135
 buffer_store_dwordx4 v[128:131], v24, s[16:19], s48 offen sc1
 v_mul_f32 v136, s52, v136
 v_mul_f32 v137, s52, v137
 v_mul_f32 v138, s52, v138
 v_mul_f32 v139, s52, v139
 v_mul_f32 v140, s52, v140
 v_mul_f32 v141, s52, v141
 v_mul_f32 v142, s52, v142
 v_mul_f32 v143, s52, v143
 v_cvt_pk_bf16_f32 v136, v136, v137
 v_cvt_pk_bf16_f32 v137, v138, v139
 v_cvt_pk_bf16_f32 v138, v140, v141
 v_cvt_pk_bf16_f32 v139, v142, v143
 buffer_store_dwordx4 v[136:139], v24, s[16:19], s49 offen sc1
 v_mul_f32 v144, s52, v144
 v_mul_f32 v145, s52, v145
 v_mul_f32 v146, s52, v146
 v_mul_f32 v147, s52, v147
 v_mul_f32 v148, s52, v148
 v_mul_f32 v149, s52, v149
 v_mul_f32 v150, s52, v150
 v_mul_f32 v151, s52, v151
 v_cvt_pk_bf16_f32 v144, v144, v145
 v_cvt_pk_bf16_f32 v145, v146, v147
 v_cvt_pk_bf16_f32 v146, v148, v149
 v_cvt_pk_bf16_f32 v147, v150, v151
 buffer_store_dwordx4 v[144:147], v25, s[16:19], s48 offen sc1
 v_mul_f32 v152, s52, v152
 v_mul_f32 v153, s52, v153
 v_mul_f32 v154, s52, v154
 v_mul_f32 v155, s52, v155
 v_mul_f32 v156, s52, v156
 v_mul_f32 v157, s52, v157
 v_mul_f32 v158, s52, v158
 v_mul_f32 v159, s52, v159
 v_cvt_pk_bf16_f32 v152, v152, v153
 v_cvt_pk_bf16_f32 v153, v154, v155
 v_cvt_pk_bf16_f32 v154, v156, v157
 v_cvt_pk_bf16_f32 v155, v158, v159
 buffer_store_dwordx4 v[152:155], v25, s[16:19], s49 offen sc1
 s_waitcnt lgkmcnt(3)
 v_mfma_f32_16x16x32_bf16 v[48:51], v[32:35], a[224:227], 0
 v_mul_f32 v160, s52, v160
 v_mul_f32 v161, s52, v161
 v_mfma_f32_16x16x32_bf16 v[52:55], v[32:35], a[228:231], 0
 v_mul_f32 v162, s52, v162
 v_mul_f32 v163, s52, v163
 v_mfma_f32_16x16x32_bf16 v[56:59], v[32:35], a[232:235], 0
 v_mul_f32 v164, s52, v164
 v_mul_f32 v165, s52, v165
 v_mfma_f32_16x16x32_bf16 v[60:63], v[32:35], a[236:239], 0
 s_bfe_u32 s44, s80, 0x40004
 s_mul_i32 s44, s44, 128
 v_add_u32 v250, s44, v249
 ds_read_b128 v[32:35], v250 offset:0
 s_waitcnt lgkmcnt(3)
 v_mfma_f32_16x16x32_bf16 v[48:51], v[36:39], a[240:243], v[48:51]
 v_mul_f32 v166, s52, v166
 v_mul_f32 v167, s52, v167
 v_mfma_f32_16x16x32_bf16 v[52:55], v[36:39], a[244:247], v[52:55]
 v_cvt_pk_bf16_f32 v160, v160, v161
 v_cvt_pk_bf16_f32 v161, v162, v163
 v_mfma_f32_16x16x32_bf16 v[56:59], v[36:39], a[248:251], v[56:59]
 v_cvt_pk_bf16_f32 v162, v164, v165
 v_cvt_pk_bf16_f32 v163, v166, v167
 v_mfma_f32_16x16x32_bf16 v[60:63], v[36:39], a[252:255], v[60:63]
 ds_read_b128 v[36:39], v250 offset:64
 s_lshr_b32 s41, s79, 2
 s_lshl4_add_u32 s41, s41, s3
 s_lshl3_add_u32 s41, s41, 20684800
 s_mov_b64 exec, 1
 buffer_store_dwordx2 v[252:253], v237, s[16:19], s41 offen offset:0 sc1
 s_mov_b64 exec, -1
 s_waitcnt lgkmcnt(3)
 v_mfma_f32_16x16x32_bf16 v[48:51], v[40:43], a[0:3], v[48:51]
 ds_read_b128 a[224:227], v12 offset:12288
 buffer_store_dwordx4 v[160:163], v26, s[16:19], s48 offen sc1
 v_mul_f32 v168, s52, v168
 v_mfma_f32_16x16x32_bf16 v[52:55], v[40:43], a[4:7], v[52:55]
 ds_read_b128 a[228:231], v12 offset:13312
 v_mul_f32 v169, s52, v169
 v_mul_f32 v170, s52, v170
 v_mfma_f32_16x16x32_bf16 v[56:59], v[40:43], a[8:11], v[56:59]
 ds_read_b128 a[232:235], v12 offset:28672
 v_mul_f32 v171, s52, v171
 v_mul_f32 v172, s52, v172
 v_mfma_f32_16x16x32_bf16 v[60:63], v[40:43], a[12:15], v[60:63]
 ds_read_b128 a[236:239], v12 offset:29696
 s_bfe_u32 s44, s80, 0x40008
 s_mul_i32 s44, s44, 128
 v_add_u32 v250, s44, v249
 ds_read_b128 v[40:43], v250 offset:0
 s_waitcnt lgkmcnt(7)
 v_mfma_f32_16x16x32_bf16 v[48:51], v[44:47], a[16:19], v[48:51]
 ds_read_b128 a[240:243], v13 offset:12288
 v_mul_f32 v173, s52, v173
 v_mul_f32 v174, s52, v174
 v_mfma_f32_16x16x32_bf16 v[52:55], v[44:47], a[20:23], v[52:55]
 ds_read_b128 a[244:247], v13 offset:13312
 v_mul_f32 v175, s52, v175
 v_cvt_pk_bf16_f32 v168, v168, v169
 v_mfma_f32_16x16x32_bf16 v[56:59], v[44:47], a[24:27], v[56:59]
 ds_read_b128 a[248:251], v13 offset:28672
 v_cvt_pk_bf16_f32 v169, v170, v171
 v_cvt_pk_bf16_f32 v170, v172, v173
 v_mfma_f32_16x16x32_bf16 v[60:63], v[44:47], a[28:31], v[60:63]
 ds_read_b128 a[252:255], v13 offset:29696
 ds_read_b128 v[44:47], v250 offset:64
 s_waitcnt lgkmcnt(11)
 v_mfma_f32_16x16x32_bf16 v[48:51], v[32:35], a[32:35], v[48:51]
 v_cvt_pk_bf16_f32 v171, v174, v175
 buffer_store_dwordx4 v[168:171], v26, s[16:19], s49 offen sc1
 v_mfma_f32_16x16x32_bf16 v[52:55], v[32:35], a[36:39], v[52:55]
 v_mul_f32 v176, s52, v176
 v_mul_f32 v177, s52, v177
 v_mfma_f32_16x16x32_bf16 v[56:59], v[32:35], a[40:43], v[56:59]
 v_mul_f32 v178, s52, v178
 v_mul_f32 v179, s52, v179
 v_mfma_f32_16x16x32_bf16 v[60:63], v[32:35], a[44:47], v[60:63]
 s_bfe_u32 s44, s80, 0x4001c
 s_mul_i32 s44, s44, 128
 v_add_u32 v250, s44, v249
 ds_read_b128 v[32:35], v250 offset:0
 s_waitcnt lgkmcnt(11)
 v_mfma_f32_16x16x32_bf16 v[48:51], v[36:39], a[48:51], v[48:51]
 v_mul_f32 v180, s52, v180
 v_mul_f32 v181, s52, v181
 v_mfma_f32_16x16x32_bf16 v[52:55], v[36:39], a[52:55], v[52:55]
 v_mul_f32 v182, s52, v182
 v_mul_f32 v183, s52, v183
 v_mfma_f32_16x16x32_bf16 v[56:59], v[36:39], a[56:59], v[56:59]
 v_cvt_pk_bf16_f32 v176, v176, v177
 v_cvt_pk_bf16_f32 v177, v178, v179
 v_mfma_f32_16x16x32_bf16 v[60:63], v[36:39], a[60:63], v[60:63]
 ds_read_b128 v[36:39], v250 offset:64
 s_waitcnt lgkmcnt(7)
 v_mfma_f32_16x16x32_bf16 v[48:51], v[40:43], a[64:67], v[48:51]
 v_cvt_pk_bf16_f32 v178, v180, v181
 v_cvt_pk_bf16_f32 v179, v182, v183
 v_mfma_f32_16x16x32_bf16 v[52:55], v[40:43], a[68:71], v[52:55]
 buffer_store_dwordx4 v[176:179], v27, s[16:19], s48 offen sc1
 v_mul_f32 v184, s52, v184
 v_mfma_f32_16x16x32_bf16 v[56:59], v[40:43], a[72:75], v[56:59]
 v_mul_f32 v185, s52, v185
 v_mul_f32 v186, s52, v186
 v_mfma_f32_16x16x32_bf16 v[60:63], v[40:43], a[76:79], v[60:63]
 s_bfe_u32 s44, s80, 0x4000c
 s_mul_i32 s44, s44, 128
 v_add_u32 v250, s44, v249
 ds_read_b128 v[40:43], v250 offset:0
 s_waitcnt lgkmcnt(3)
 v_mfma_f32_16x16x32_bf16 v[48:51], v[44:47], a[80:83], v[48:51]
 v_mul_f32 v187, s52, v187
 v_mul_f32 v188, s52, v188
 v_mfma_f32_16x16x32_bf16 v[52:55], v[44:47], a[84:87], v[52:55]
 v_mul_f32 v189, s52, v189
 v_mul_f32 v190, s52, v190
 v_mfma_f32_16x16x32_bf16 v[56:59], v[44:47], a[88:91], v[56:59]
 v_mul_f32 v191, s52, v191
 v_cvt_pk_bf16_f32 v184, v184, v185
 v_mfma_f32_16x16x32_bf16 v[60:63], v[44:47], a[92:95], v[60:63]
 ds_read_b128 v[44:47], v250 offset:64
 s_waitcnt lgkmcnt(3)
 v_mfma_f32_16x16x32_bf16 v[48:51], v[32:35], a[224:227], v[48:51]
 v_cvt_pk_bf16_f32 v185, v186, v187
 v_cvt_pk_bf16_f32 v186, v188, v189
 v_mfma_f32_16x16x32_bf16 v[52:55], v[32:35], a[228:231], v[52:55]
 v_cvt_pk_bf16_f32 v187, v190, v191
 buffer_store_dwordx4 v[184:187], v27, s[16:19], s49 offen sc1
 v_mfma_f32_16x16x32_bf16 v[56:59], v[32:35], a[232:235], v[56:59]
 v_mfma_f32_16x16x32_bf16 v[60:63], v[32:35], a[236:239], v[60:63]
 s_bfe_u32 s44, s80, 0x40010
 s_mul_i32 s44, s44, 128
 v_add_u32 v250, s44, v249
 ds_read_b128 v[32:35], v250 offset:0
 s_waitcnt lgkmcnt(3)
 v_mfma_f32_16x16x32_bf16 v[48:51], v[36:39], a[240:243], v[48:51]
 v_mfma_f32_16x16x32_bf16 v[52:55], v[36:39], a[244:247], v[52:55]
 v_mfma_f32_16x16x32_bf16 v[56:59], v[36:39], a[248:251], v[56:59]
 v_mfma_f32_16x16x32_bf16 v[60:63], v[36:39], a[252:255], v[60:63]
 ds_read_b128 v[36:39], v250 offset:64
 s_waitcnt lgkmcnt(3)
 v_mfma_f32_16x16x32_bf16 v[48:51], v[40:43], a[96:99], v[48:51]
 ds_read_b128 a[224:227], v12 offset:4096
 v_mfma_f32_16x16x32_bf16 v[52:55], v[40:43], a[100:103], v[52:55]
 ds_read_b128 a[228:231], v12 offset:5120
 v_mfma_f32_16x16x32_bf16 v[56:59], v[40:43], a[104:107], v[56:59]
 ds_read_b128 a[232:235], v12 offset:20480
 v_mfma_f32_16x16x32_bf16 v[60:63], v[40:43], a[108:111], v[60:63]
 ds_read_b128 a[236:239], v12 offset:21504
 s_bfe_u32 s44, s80, 0x40014
 s_mul_i32 s44, s44, 128
 v_add_u32 v250, s44, v249
 ds_read_b128 v[40:43], v250 offset:0
 s_waitcnt lgkmcnt(7)
 v_mfma_f32_16x16x32_bf16 v[48:51], v[44:47], a[112:115], v[48:51]
 ds_read_b128 a[240:243], v13 offset:4096
 v_mfma_f32_16x16x32_bf16 v[52:55], v[44:47], a[116:119], v[52:55]
 ds_read_b128 a[244:247], v13 offset:5120
 v_mfma_f32_16x16x32_bf16 v[56:59], v[44:47], a[120:123], v[56:59]
 ds_read_b128 a[248:251], v13 offset:20480
 v_mfma_f32_16x16x32_bf16 v[60:63], v[44:47], a[124:127], v[60:63]
 ds_read_b128 a[252:255], v13 offset:21504
 ds_read_b128 v[44:47], v250 offset:64
 s_waitcnt lgkmcnt(11)
 v_mfma_f32_16x16x32_bf16 v[48:51], v[32:35], a[128:131], v[48:51]
 v_mfma_f32_16x16x32_bf16 v[52:55], v[32:35], a[132:135], v[52:55]
 v_mfma_f32_16x16x32_bf16 v[56:59], v[32:35], a[136:139], v[56:59]
 v_mfma_f32_16x16x32_bf16 v[60:63], v[32:35], a[140:143], v[60:63]
 s_bfe_u32 s44, s80, 0x40018
 s_mul_i32 s44, s44, 128
 v_add_u32 v250, s44, v249
 ds_read_b128 v[32:35], v250 offset:0
 s_waitcnt lgkmcnt(11)
 v_mfma_f32_16x16x32_bf16 v[48:51], v[36:39], a[144:147], v[48:51]
 v_mfma_f32_16x16x32_bf16 v[52:55], v[36:39], a[148:151], v[52:55]
 v_mfma_f32_16x16x32_bf16 v[56:59], v[36:39], a[152:155], v[56:59]
 v_mfma_f32_16x16x32_bf16 v[60:63], v[36:39], a[156:159], v[60:63]
 ds_read_b128 v[36:39], v250 offset:64
 s_waitcnt vmcnt(0)
 s_mov_b64 exec, 1
 buffer_store_dwordx2 v[252:253], v237, s[16:19], s53 offen offset:0 sc1
 s_mov_b64 exec, -1
 v_cmp_ne_u64 vcc, s[90:91], v[246:247]
 s_nop 0
 s_cbranch_vccnz L_poll_49
L_poll_ok_50:
 s_waitcnt lgkmcnt(7)
 v_mfma_f32_16x16x32_bf16 v[48:51], v[40:43], a[224:227], v[48:51]
 v_mfma_f32_16x16x32_bf16 v[52:55], v[40:43], a[228:231], v[52:55]
 v_mfma_f32_16x16x32_bf16 v[56:59], v[40:43], a[232:235], v[56:59]
 v_mfma_f32_16x16x32_bf16 v[60:63], v[40:43], a[236:239], v[60:63]
 s_bfe_u32 s44, s81, 0x40000
 s_mul_i32 s44, s44, 128
 v_add_u32 v250, s44, v249
 ds_read_b128 v[40:43], v250 offset:0
 v_add_u32 v242, s73, v254
 global_load_dwordx4 a[0:3], v242, s[16:17] offset:-2048 sc1
 s_waitcnt lgkmcnt(3)
 v_mfma_f32_16x16x32_bf16 v[48:51], v[44:47], a[240:243], v[48:51]
 v_mfma_f32_16x16x32_bf16 v[52:55], v[44:47], a[244:247], v[52:55]
 v_mfma_f32_16x16x32_bf16 v[56:59], v[44:47], a[248:251], v[56:59]
 v_mfma_f32_16x16x32_bf16 v[60:63], v[44:47], a[252:255], v[60:63]
 ds_read_b128 v[44:47], v250 offset:64
 global_load_dwordx4 a[4:7], v242, s[16:17] offset:-1024 sc1
 s_waitcnt lgkmcnt(3)
 v_mfma_f32_16x16x32_bf16 v[48:51], v[32:35], a[160:163], v[48:51]
 v_mfma_f32_16x16x32_bf16 v[52:55], v[32:35], a[164:167], v[52:55]
 v_mfma_f32_16x16x32_bf16 v[56:59], v[32:35], a[168:171], v[56:59]
 v_mfma_f32_16x16x32_bf16 v[60:63], v[32:35], a[172:175], v[60:63]
 global_load_dwordx4 a[8:11], v242, s[16:17] offset:0 sc1
 s_waitcnt lgkmcnt(2)
 v_mfma_f32_16x16x32_bf16 v[48:51], v[36:39], a[176:179], v[48:51]
 v_mfma_f32_16x16x32_bf16 v[52:55], v[36:39], a[180:183], v[52:55]
 v_mfma_f32_16x16x32_bf16 v[56:59], v[36:39], a[184:187], v[56:59]
 v_mfma_f32_16x16x32_bf16 v[60:63], v[36:39], a[188:191], v[60:63]
 global_load_dwordx4 a[12:15], v242, s[16:17] offset:1024 sc1
 s_waitcnt lgkmcnt(1)
 v_mfma_f32_16x16x32_bf16 v[48:51], v[40:43], a[192:195], v[48:51]
 v_mfma_f32_16x16x32_bf16 v[52:55], v[40:43], a[196:199], v[52:55]
 v_mfma_f32_16x16x32_bf16 v[56:59], v[40:43], a[200:203], v[56:59]
 v_mfma_f32_16x16x32_bf16 v[60:63], v[40:43], a[204:207], v[60:63]
 global_load_dwordx4 a[16:19], v242, s[16:17] offset:2048 sc1
 s_waitcnt lgkmcnt(0)
 v_mfma_f32_16x16x32_bf16 v[48:51], v[44:47], a[208:211], v[48:51]
 v_mfma_f32_16x16x32_bf16 v[52:55], v[44:47], a[212:215], v[52:55]
 v_mfma_f32_16x16x32_bf16 v[56:59], v[44:47], a[216:219], v[56:59]
 v_mfma_f32_16x16x32_bf16 v[60:63], v[44:47], a[220:223], v[60:63]
 s_barrier
 s_mov_b32 s92, 0x11000000
 s_mov_b32 s93, 0x11000000
 v_mov_b32 v160, 0x3f803f80
 v_cndmask_b32 v160, 0, v160, s[92:93]
 v_mov_b32 v161, v160
 v_mov_b32 v162, v160
 v_mov_b32 v163, v160
 v_mov_b32 v164, v160
 v_mov_b32 v165, v160
 v_mov_b32 v166, v160
 v_mov_b32 v167, v160
 s_bitcmp1_b32 s3, 0
 s_cselect_b64 s[92:93], -1, 0
 s_mov_b32 vcc_lo, 0xffff0000
 s_mov_b32 vcc_hi, 0xffff0000
 v_cndmask_b32 v0, v48, v56, s[92:93]
 v_cndmask_b32 v4, v52, v60, s[92:93]
 v_cndmask_b32 v0, v0, v4, vcc
 v_min_f32 v249, 0x41f00000, v0
 v_mul_f32 v249, 0x3fb8aa3b, v249
 v_exp_f32 v249, v249
 s_nop 0
 v_add_f32 v250, 1.0, v249
 v_rcp_f32 v250, v250
 v_cmp_gt_u32 vcc, 32, v255
 v_and_b32 v251, 39, v255
 v_bfe_u32 v1, v255, 3, 1
 v_lshl_add_u32 v251, v1, 4, v251
 v_bfe_u32 v1, v255, 4, 1
 v_lshl_add_u32 v251, v1, 3, v251
 v_lshlrev_b32 v251, 2, v251
 s_lshl_b32 s41, s79, 8
 s_add_u32 s41, s41, 20594688
 v_cndmask_b32 v249, v250, v249, vcc
 buffer_store_dword v249, v251, s[16:19], s41 offen sc1
 v_bfe_u32 v250, v255, 2, 2
 v_and_b32 v251, 3, v255
 v_lshlrev_b32 v251, 3, v251
 v_lshl_add_u32 v250, v250, 7, v251
 v_add_u32 v225, 20684288, v250
 buffer_load_dwordx2 v[246:247], v225, s[16:19], 0 offen sc1
 v_add_u32 v242, 5120, v242
 global_load_dwordx4 a[20:23], v242, s[16:17] offset:-2048 sc1
 global_load_dwordx4 a[24:27], v242, s[16:17] offset:-1024 sc1
 global_load_dwordx4 a[28:31], v242, s[16:17] offset:0 sc1
 global_load_dwordx4 a[32:35], v242, s[16:17] offset:1024 sc1
 global_load_dwordx4 a[36:39], v242, s[16:17] offset:2048 sc1
 v_add_u32 v242, 5120, v242
 global_load_dwordx4 a[40:43], v242, s[16:17] offset:-2048 sc1
 global_load_dwordx4 a[44:47], v242, s[16:17] offset:-1024 sc1
 global_load_dwordx4 a[48:51], v242, s[16:17] offset:0 sc1
 global_load_dwordx4 a[52:55], v242, s[16:17] offset:1024 sc1
 global_load_dwordx4 a[56:59], v242, s[16:17] offset:2048 sc1
 v_add_u32 v242, 5120, v242
 global_load_dwordx4 a[60:63], v242, s[16:17] offset:-2048 sc1
 global_load_dwordx4 a[64:67], v242, s[16:17] offset:-1024 sc1
 global_load_dwordx4 a[68:71], v242, s[16:17] offset:0 sc1
 global_load_dwordx4 a[72:75], v242, s[16:17] offset:1024 sc1
 global_load_dwordx4 a[76:79], v242, s[16:17] offset:2048 sc1
 s_waitcnt vmcnt(15)
 v_cmp_ne_u64 vcc, s[90:91], v[246:247]
 s_nop 0
 s_cbranch_vccnz L_poll_51
L_poll_ok_52:
 buffer_load_dwordx2 v[246:247], v245, s[16:19], 0 offen sc1
 s_or_b32 s41, s53, 1920
 s_mov_b64 exec, 1
 buffer_store_dwordx2 v[252:253], v237, s[16:19], s41 offen offset:0 sc1
 s_mov_b64 exec, -1
 s_waitcnt vmcnt(1)
 v_cmp_ne_u64 vcc, s[90:91], v[246:247]
 s_nop 0
 s_cbranch_vccnz L_poll_53
L_poll_ok_54:
 buffer_load_dwordx4 v[128:131], v231, s[16:19], 0 offen sc1
 buffer_load_dwordx4 v[132:135], v231, s[16:19], s96 offen sc1
 buffer_load_dwordx4 v[136:139], v231, s[16:19], s97 offen sc1
 s_mul_i32 s45, s3, 3072
 s_add_u32 m0, s45, 81920
 s_nop 0
 buffer_load_dwordx4 v228, s[16:19], 0 offen offset:0 sc1 lds
 buffer_load_dwordx4 v229, s[16:19], 0 offen offset:1024 sc1 lds
 buffer_load_dwordx4 v230, s[16:19], 0 offen offset:2048 sc1 lds
 s_add_u32 m0, s45, 94208
 s_nop 0
 buffer_load_dwordx4 v228, s[16:19], s96 offen offset:0 sc1 lds
 buffer_load_dwordx4 v229, s[16:19], s96 offen offset:1024 sc1 lds
 buffer_load_dwordx4 v230, s[16:19], s96 offen offset:2048 sc1 lds
 s_add_u32 m0, s45, 106496
 s_nop 0
 buffer_load_dwordx4 v228, s[16:19], s97 offen offset:0 sc1 lds
 buffer_load_dwordx4 v229, s[16:19], s97 offen offset:1024 sc1 lds
 buffer_load_dwordx4 v230, s[16:19], s97 offen offset:2048 sc1 lds
 s_mul_i32 s45, s3, 9216
 s_add_u32 m0, s45, 118784
 s_nop 0
 buffer_load_dwordx4 v254, s[16:19], s64 offen offset:0 sc1 lds
 buffer_load_dwordx4 v254, s[16:19], s64 offen offset:1024 sc1 lds
 buffer_load_dwordx4 v236, s[16:19], s64 offen offset:2048 sc1 lds
 s_add_u32 m0, s45, 121856
 s_nop 0
 buffer_load_dwordx4 v254, s[16:19], s65 offen offset:0 sc1 lds
 buffer_load_dwordx4 v254, s[16:19], s65 offen offset:1024 sc1 lds
 buffer_load_dwordx4 v236, s[16:19], s65 offen offset:2048 sc1 lds
 s_add_u32 m0, s45, 124928
 s_nop 0
 buffer_load_dwordx4 v254, s[16:19], s66 offen offset:0 sc1 lds
 buffer_load_dwordx4 v254, s[16:19], s66 offen offset:1024 sc1 lds
 buffer_load_dwordx4 v236, s[16:19], s66 offen offset:2048 sc1 lds
 s_bitcmp1_b32 s58, 0
 s_cselect_b64 s[92:93], 0, -1
 s_cselect_b32 s83, -1, 0
 s_cselect_b32 s84, -1, 0
 s_mov_b32 s82, -1
 s_mov_b32 s85, 0
 s_waitcnt vmcnt(18)
 v_cndmask_b32 v144, 0, v128, s[92:93]
 v_cndmask_b32 v145, 0, v129, s[92:93]
 v_mov_b32 v146, v130
 v_mov_b32 v147, v131
 v_cndmask_b32 v148, 0, v132, s[82:83]
 v_cndmask_b32 v149, 0, v133, s[82:83]
 v_cndmask_b32 v150, 0, v134, s[84:85]
 v_cndmask_b32 v151, 0, v135, s[84:85]
 v_cndmask_b32 v152, v132, 0, s[82:83]
 v_cndmask_b32 v153, v133, 0, s[82:83]
 v_cndmask_b32 v154, v134, 0, s[84:85]
 v_cndmask_b32 v155, v135, 0, s[84:85]
 v_mov_b32 v156, v136
 v_mov_b32 v157, v137
 v_cndmask_b32 v158, v138, 0, s[92:93]
 v_cndmask_b32 v159, v139, 0, s[92:93]
 s_waitcnt lgkmcnt(0)
 s_branch L_att
L_spare:
 s_memrealtime s[90:91]
 s_lshl_b32 s40, s3, 3
 s_lshr_b32 s40, 0x30102820, s40
 s_and_b32 s40, s40, 0xff
 s_load_dwordx2 s[28:29], s[0:1], s40
 s_mov_b32 s14, 2211840
 s_mov_b32 s15, 0x20000
 s_mov_b32 s18, 26060800
 s_mov_b32 s19, 0x20000
 s_mov_b32 s22, 2621440
 s_mov_b32 s23, 0x20000
 s_mov_b32 s26, 256
 s_mov_b32 s27, 0x20000
 s_mov_b32 s31, 0x20000
 v_lshlrev_b32 v254, 4, v255
 v_mov_b32 v237, 0
 v_lshrrev_b32 v236, 5, v255
 v_lshl_add_u32 v236, v236, 26, v254
 s_mov_b32 s94, 0xfffff
 s_mov_b32 s95, 0xfffff
 s_mov_b32 s96, 0x10000
 s_mov_b32 s97, 0x20000
 s_mov_b32 s30, 2211840
 s_cmp_eq_u32 s3, 2
 s_cselect_b32 s30, 819200, s30
 s_cmp_eq_u32 s3, 3
 s_cselect_b32 s30, 1280, s30
 s_cselect_b32 s42, 7, 16
 v_lshlrev_b32 v248, s42, v255
 s_sub_u32 s41, s2, 240
 s_lshl2_add_u32 s41, s41, s3
 s_lshl_b32 s42, s41, 13
 v_lshl_add_u32 v225, v255, 7, s42
 s_waitcnt lgkmcnt(0)
 s_load_dwordx2 s[32:33], s[0:1], 16
 s_load_dwordx4 s[36:39], s[0:1], 40
 s_load_dwordx16 s[48:63], s[46:47], 0
 s_load_dwordx16 s[64:79], s[46:47], 64
 s_load_dword s87, s[46:47], 128
 s_or_b32 s42, s90, 1
 v_mov_b32 v252, s42
 v_mov_b32 v253, s91
 s_cmp_lg_u32 s41, 0
 s_cbranch_scc1 L_nononce
 s_mov_b64 exec, 1
 buffer_store_dwordx2 v[252:253], v237, s[24:27], 0 offen sc1
 s_mov_b64 exec, -1
L_nononce:
 buffer_load_dword v224, v248, s[28:31], 0 offen
 s_mov_b32 s42, 0
 buffer_load_dword v224, v225, s[12:15], s42 offen
 s_mov_b32 s42, 524288
 buffer_load_dword v224, v225, s[12:15], s42 offen
 s_mov_b32 s42, 1048576
 buffer_load_dword v224, v225, s[12:15], s42 offen
 v_mov_b32 v226, 0
 s_and_b32 s40, s3, 1
 s_mul_i32 s40, s40, 160
 v_add_u32 v248, s40, v255
 v_mul_u32_u24 v249, 820, v248
 v_lshrrev_b32 v249, 16, v249
 v_lshlrev_b32 v249, 2, v249
 v_xor_b32 v249, v248, v249
 v_lshlrev_b32 v76, 4, v249
 v_add_u32 v248, 64, v248
 v_mul_u32_u24 v249, 820, v248
 v_lshrrev_b32 v249, 16, v249
 v_lshlrev_b32 v249, 2, v249
 v_xor_b32 v249, v248, v249
 v_lshlrev_b32 v77, 4, v249
 v_add_u32 v248, 64, v248
 v_mul_u32_u24 v249, 820, v248
 v_lshrrev_b32 v249, 16, v249
 v_lshlrev_b32 v249, 2, v249
 v_xor_b32 v249, v248, v249
 v_lshlrev_b32 v78, 4, v249
 v_lshrrev_b32 v248, 4, v255
 v_and_b32 v249, 3, v255
 v_bfe_u32 v247, v255, 2, 2
 v_lshlrev_b32 v251, 3, v247
 v_mul_u32_u24 v247, 1280, v247
 v_add_u32 v247, 0, v247
 s_lshl_b32 s40, s3, 5
 v_and_b32 v246, 1, v248
 v_lshl_add_u32 v250, v249, 1, v246
 v_lshrrev_b32 v64, 5, v255
 v_lshl_add_u32 v250, v64, 3, v250
 v_add_u32 v250, s40, v250
 v_xor_b32 v64, v250, v251
 v_lshl_add_u32 v79, v64, 3, v247
 v_add_u32 v250, 16, v250
 v_xor_b32 v64, v250, v251
 v_lshl_add_u32 v80, v64, 3, v247
 v_lshl_add_u32 v250, v246, 2, v249
 s_lshl3_add_u32 s40, s3, 0x80
 v_add_u32 v250, s40, v250
 v_xor_b32 v250, v250, v251
 v_lshl_add_u32 v81, v250, 3, v247
 v_mul_u32_u24 v248, 768, v248
 v_add_u32 v82, v248, v254
 v_add_u32 v83, 378880, v82
 s_mov_b32 s40, 378624
 v_mad_u32_u24 v248, v246, s40, v236
 v_add_u32 v84, 4096, v248
 s_waitcnt lgkmcnt(0)
 s_mul_i32 s40, s3, 2560
 s_bitcmp1_b32 s79, 0
 s_cselect_b64 s[28:29], s[32:33], s[36:37]
 s_mov_b32 s30, 819200
 s_cselect_b32 s30, s30, 2211840
 s_add_u32 m0, s40, 0
 s_nop 0
 buffer_load_dwordx4 v76, s[28:31], s57 offen nt lds
 s_add_u32 m0, s40, 1024
 s_nop 0
 buffer_load_dwordx4 v77, s[28:31], s57 offen nt lds
 s_add_u32 m0, s40, 2048
 s_mov_b32 exec_hi, 0
 buffer_load_dwordx4 v78, s[28:31], s57 offen nt lds
 s_mov_b32 exec_hi, -1
 s_bitcmp1_b32 s79, 1
 s_cselect_b64 s[28:29], s[32:33], s[36:37]
 s_mov_b32 s30, 819200
 s_cselect_b32 s30, s30, 2211840
 s_add_u32 m0, s40, 10240
 s_nop 0
 buffer_load_dwordx4 v76, s[28:31], s48 offen nt lds
 s_add_u32 m0, s40, 11264
 s_nop 0
 buffer_load_dwordx4 v77, s[28:31], s48 offen nt lds
 s_add_u32 m0, s40, 12288
 s_mov_b32 exec_hi, 0
 buffer_load_dwordx4 v78, s[28:31], s48 offen nt lds
 s_mov_b32 exec_hi, -1
 s_bitcmp1_b32 s79, 2
 s_cselect_b64 s[28:29], s[32:33], s[36:37]
 s_mov_b32 s30, 819200
 s_cselect_b32 s30, s30, 2211840
 s_add_u32 m0, s40, 20480
 s_nop 0
 buffer_load_dwordx4 v76, s[28:31], s49 offen nt lds
 s_add_u32 m0, s40, 21504
 s_nop 0
 buffer_load_dwordx4 v77, s[28:31], s49 offen nt lds
 s_add_u32 m0, s40, 22528
 s_mov_b32 exec_hi, 0
 buffer_load_dwordx4 v78, s[28:31], s49 offen nt lds
 s_mov_b32 exec_hi, -1
 s_bitcmp1_b32 s79, 3
 s_cselect_b64 s[28:29], s[32:33], s[36:37]
 s_mov_b32 s30, 819200
 s_cselect_b32 s30, s30, 2211840
 s_add_u32 m0, s40, 30720
 s_nop 0
 buffer_load_dwordx4 v76, s[28:31], s52 offen nt lds
 s_add_u32 m0, s40, 31744
 s_nop 0
 buffer_load_dwordx4 v77, s[28:31], s52 offen nt lds
 s_add_u32 m0, s40, 32768
 s_mov_b32 exec_hi, 0
 buffer_load_dwordx4 v78, s[28:31], s52 offen nt lds
 s_mov_b32 exec_hi, -1
 s_cmp_eq_u32 s3, 1
 s_cselect_b32 s41, s54, 67108864
 s_andn2_b32 s41, s41, 127
 v_lshl_add_u32 v248, v255, 2, 0
 s_mov_b32 exec_hi, 0
 buffer_store_dword v237, v248, s[16:19], s41 offen sc1
 s_mov_b32 exec_hi, -1
 s_mov_b32 s42, 1572864
 buffer_load_dword v224, v225, s[12:15], s42 offen
 v_and_b32 v248, 31, v255
 v_lshrrev_b32 v249, 5, v255
 v_lshlrev_b32 v227, 2, v248
 s_lshl_b32 s41, s3, 10
 s_add_u32 s42, s41, 81920
 v_add_u32 v241, s42, v254
 s_mul_i32 s41, s41, 3
 s_add_u32 s41, s41, 118784
 v_lshl_add_u32 v250, v249, 7, v254
 v_add_u32 v240, s41, v250
 v_lshlrev_b32 v250, 2, v249
 v_sub_u32 v250, v248, v250
 v_cvt_f32_i32 v250, v250
 v_mov_b32 v251, 0x71800000
 v_fmaak_f32 v208, v250, v251, 0x71000000
 v_min_f32 v192, 0, v208
 v_min_f32 v208, -v208, 0
 v_fmaak_f32 v209, v250, v251, 0xf1000000
 v_min_f32 v193, 0, v209
 v_min_f32 v209, -v209, 0
 v_fmaak_f32 v210, v250, v251, 0xf1c00000
 v_min_f32 v194, 0, v210
 v_min_f32 v210, -v210, 0
 v_fmaak_f32 v211, v250, v251, 0xf2200000
 v_min_f32 v195, 0, v211
 v_min_f32 v211, -v211, 0
 v_fmaak_f32 v212, v250, v251, 0xf2f00000
 v_min_f32 v196, 0, v212
 v_min_f32 v212, -v212, 0
 v_fmaak_f32 v213, v250, v251, 0xf3080000
 v_min_f32 v197, 0, v213
 v_min_f32 v213, -v213, 0
 v_fmaak_f32 v214, v250, v251, 0xf3180000
 v_min_f32 v198, 0, v214
 v_min_f32 v214, -v214, 0
 v_fmaak_f32 v215, v250, v251, 0xf3280000
 v_min_f32 v199, 0, v215
 v_min_f32 v215, -v215, 0
 v_fmaak_f32 v216, v250, v251, 0xf3780000
 v_min_f32 v200, 0, v216
 v_min_f32 v216, -v216, 0
 v_fmaak_f32 v217, v250, v251, 0xf3840000
 v_min_f32 v201, 0, v217
 v_min_f32 v217, -v217, 0
 v_fmaak_f32 v218, v250, v251, 0xf38c0000
 v_min_f32 v202, 0, v218
 v_min_f32 v218, -v218, 0
 v_fmaak_f32 v219, v250, v251, 0xf3940000
 v_min_f32 v203, 0, v219
 v_min_f32 v219, -v219, 0
 v_fmaak_f32 v220, v250, v251, 0xf3bc0000
 v_min_f32 v204, 0, v220
 v_min_f32 v220, -v220, 0
 v_fmaak_f32 v221, v250, v251, 0xf3c40000
 v_min_f32 v205, 0, v221
 v_min_f32 v221, -v221, 0
 v_fmaak_f32 v222, v250, v251, 0xf3cc0000
 v_min_f32 v206, 0, v222
 v_min_f32 v222, -v222, 0
 v_fmaak_f32 v223, v250, v251, 0xf3d40000
 v_min_f32 v207, 0, v223
 v_min_f32 v223, -v223, 0
 v_lshrrev_b32 v249, 4, v255
 v_lshl_add_u32 v239, v249, 8, v254
 v_add_u32 v232, s69, v239
 v_add_u32 v233, s70, v239
 v_add_u32 v234, s71, v239
 v_add_u32 v235, s72, v239
 v_add_u32 v228, s61, v254
 v_add_u32 v229, s62, v254
 v_add_u32 v230, s63, v254
 v_add_u32 v231, s60, v254
 v_lshl_add_u32 v227, s59, 8, v227
 v_add_u32 v227, 20594688, v227
 v_min_u32 v248, 59, v255
 v_and_b32 v249, 3, v248
 v_lshl_add_u32 v249, v249, 3, s76
 v_lshrrev_b32 v248, 2, v248
 v_lshl_add_u32 v249, v248, 7, v249
 s_mul_i32 s40, s3, -1152
 s_add_u32 s40, s40, 4608
 v_cmp_lt_u32 vcc, 47, v255
 v_add_u32 v248, s40, v249
 s_nop 0
 v_cndmask_b32 v244, v249, v248, vcc
 v_lshrrev_b32 v248, 1, v255
 v_min_u32 v248, 4, v248
 v_and_b32 v249, 1, v255
 v_lshl_add_u32 v249, v249, 3, s74
 v_lshl_add_u32 v243, v248, 7, v249
 v_writelane_b32 v243, s75, 63
 s_bfe_u32 s40, s58, 0x1a0002
 v_writelane_b32 v243, s40, 62
 s_lshr_b32 s40, s59, 2
 s_sub_u32 s40, s40, 2
 v_lshrrev_b32 v248, 4, v255
 v_min_u32 v248, 2, v248
 v_add_u32 v248, s40, v248
 v_max_i32 v248, 0, v248
 v_and_b32 v249, 3, v255
 v_lshl_add_u32 v249, v249, 3, s77
 v_lshl_add_u32 v248, v248, 11, v249
 v_bfe_u32 v249, v255, 2, 1
 v_mad_u32_u24 v248, v249, s78, v248
 v_cmp_gt_u32 vcc, 48, v255
 v_bfe_u32 v249, v255, 3, 1
 v_add_u32 v249, 1, v249
 v_mul_u32_u24 v249, 640, v249
 v_cndmask_b32 v249, 0, v249, vcc
 v_add_u32 v245, v248, v249
 s_waitcnt vmcnt(2)
 s_barrier
 s_mov_b32 s42, 2097152
 buffer_load_dword v224, v225, s[12:15], s42 offen
 ds_read_b64_tr_b16 v[96:97], v79 offset:0
 ds_read_b64_tr_b16 v[98:99], v79 offset:5120
 ds_read_b64_tr_b16 v[100:101], v80 offset:0
 ds_read_b64_tr_b16 v[102:103], v80 offset:5120
 ds_read_b64_tr_b16 v[104:105], v81 offset:0
 ds_read_b64_tr_b16 v[106:107], v81 offset:5120
 s_waitcnt lgkmcnt(4)
 buffer_store_dwordx4 v[96:99], v82, s[16:19], s55 offen sc1
 s_waitcnt lgkmcnt(2)
 buffer_store_dwordx4 v[100:103], v83, s[16:19], s55 offen sc1
 s_waitcnt lgkmcnt(0)
 buffer_store_dwordx4 v[104:107], v84, s[16:19], s55 offen sc1
 ds_read_b64_tr_b16 v[108:109], v79 offset:10240
 ds_read_b64_tr_b16 v[110:111], v79 offset:15360
 ds_read_b64_tr_b16 v[112:113], v80 offset:10240
 ds_read_b64_tr_b16 v[114:115], v80 offset:15360
 ds_read_b64_tr_b16 v[116:117], v81 offset:10240
 ds_read_b64_tr_b16 v[118:119], v81 offset:15360
 s_waitcnt lgkmcnt(4)
 buffer_store_dwordx4 v[108:111], v82, s[16:19], s50 offen sc1
 s_waitcnt lgkmcnt(2)
 buffer_store_dwordx4 v[112:115], v83, s[16:19], s50 offen sc1
 s_waitcnt lgkmcnt(0)
 buffer_store_dwordx4 v[116:119], v84, s[16:19], s50 offen sc1
 ds_read_b64_tr_b16 v[120:121], v79 offset:20480
 ds_read_b64_tr_b16 v[122:123], v79 offset:25600
 ds_read_b64_tr_b16 v[124:125], v80 offset:20480
 ds_read_b64_tr_b16 v[126:127], v80 offset:25600
 ds_read_b64_tr_b16 v[128:129], v81 offset:20480
 ds_read_b64_tr_b16 v[130:131], v81 offset:25600
 s_waitcnt lgkmcnt(4)
 buffer_store_dwordx4 v[120:123], v82, s[16:19], s51 offen sc1
 s_waitcnt lgkmcnt(2)
 buffer_store_dwordx4 v[124:127], v83, s[16:19], s51 offen sc1
 s_waitcnt lgkmcnt(0)
 buffer_store_dwordx4 v[128:131], v84, s[16:19], s51 offen sc1
 ds_read_b64_tr_b16 v[132:133], v79 offset:30720
 ds_read_b64_tr_b16 v[134:135], v79 offset:35840
 ds_read_b64_tr_b16 v[136:137], v80 offset:30720
 ds_read_b64_tr_b16 v[138:139], v80 offset:35840
 ds_read_b64_tr_b16 v[140:141], v81 offset:30720
 ds_read_b64_tr_b16 v[142:143], v81 offset:35840
 s_waitcnt lgkmcnt(4)
 buffer_store_dwordx4 v[132:135], v82, s[16:19], s53 offen sc1
 s_waitcnt lgkmcnt(2)
 buffer_store_dwordx4 v[136:139], v83, s[16:19], s53 offen sc1
 s_waitcnt lgkmcnt(0)
 buffer_store_dwordx4 v[140:143], v84, s[16:19], s53 offen sc1
 s_mov_b32 s50, 67108864
 s_mov_b32 s51, 67108864
 s_mov_b32 s53, 67108864
 buffer_load_dwordx2 v[252:253], v237, s[24:27], 0 offen sc1
 s_waitcnt vmcnt(0)
 v_readfirstlane_b32 s90, v252
 v_readfirstlane_b32 s91, v253
 s_cmp_eq_u32 s90, 0
 s_cbranch_scc1 L_nonce_55
L_nonce_ok_56:
 s_barrier
 s_mov_b64 exec, 1
 buffer_store_dwordx2 v[252:253], v237, s[16:19], s56 offen offset:0 sc1
 s_mov_b64 exec, -1
 s_sub_u32 s41, s2, 240
 s_lshl4_add_u32 s41, s41, s3
 s_lshl3_add_u32 s41, s41, 20684800
 v_mov_b32 v28, s41
 buffer_load_dwordx2 v[246:247], v28, s[16:19], 0 offen sc1
 s_waitcnt vmcnt(0)
 v_cmp_ne_u64 vcc, s[90:91], v[246:247]
 s_nop 0
 s_cbranch_vccnz L_poll_57
L_poll_ok_58:
 buffer_load_dwordx2 v[246:247], v244, s[16:19], 0 offen sc1
 s_mov_b32 s92, 0x11000000
 s_mov_b32 s93, 0x11000000
 v_mov_b32 v160, 0x3f803f80
 v_cndmask_b32 v160, 0, v160, s[92:93]
 v_mov_b32 v161, v160
 v_mov_b32 v162, v160
 v_mov_b32 v163, v160
 v_mov_b32 v164, v160
 v_mov_b32 v165, v160
 v_mov_b32 v166, v160
 v_mov_b32 v167, v160
 s_waitcnt vmcnt(0)
 v_cmp_ne_u64 vcc, s[90:91], v[246:247]
 s_nop 0
 s_cbranch_vccnz L_poll_59
L_poll_ok_60:
 v_add_u32 v242, s73, v254
 global_load_dwordx4 a[0:3], v242, s[16:17] offset:-2048 sc1
 global_load_dwordx4 a[4:7], v242, s[16:17] offset:-1024 sc1
 global_load_dwordx4 a[8:11], v242, s[16:17] offset:0 sc1
 global_load_dwordx4 a[12:15], v242, s[16:17] offset:1024 sc1
 global_load_dwordx4 a[16:19], v242, s[16:17] offset:2048 sc1
 v_add_u32 v242, 5120, v242
 global_load_dwordx4 a[20:23], v242, s[16:17] offset:-2048 sc1
 global_load_dwordx4 a[24:27], v242, s[16:17] offset:-1024 sc1
 global_load_dwordx4 a[28:31], v242, s[16:17] offset:0 sc1
 global_load_dwordx4 a[32:35], v242, s[16:17] offset:1024 sc1
 global_load_dwordx4 a[36:39], v242, s[16:17] offset:2048 sc1
 v_add_u32 v242, 5120, v242
 global_load_dwordx4 a[40:43], v242, s[16:17] offset:-2048 sc1
 global_load_dwordx4 a[44:47], v242, s[16:17] offset:-1024 sc1
 global_load_dwordx4 a[48:51], v242, s[16:17] offset:0 sc1
 global_load_dwordx4 a[52:55], v242, s[16:17] offset:1024 sc1
 global_load_dwordx4 a[56:59], v242, s[16:17] offset:2048 sc1
 v_add_u32 v242, 5120, v242
 global_load_dwordx4 a[60:63], v242, s[16:17] offset:-2048 sc1
 global_load_dwordx4 a[64:67], v242, s[16:17] offset:-1024 sc1
 global_load_dwordx4 a[68:71], v242, s[16:17] offset:0 sc1
 global_load_dwordx4 a[72:75], v242, s[16:17] offset:1024 sc1
 global_load_dwordx4 a[76:79], v242, s[16:17] offset:2048 sc1
 buffer_load_dwordx2 v[246:247], v245, s[16:19], 0 offen sc1
 s_waitcnt vmcnt(0)
 v_cmp_ne_u64 vcc, s[90:91], v[246:247]
 s_nop 0
 s_cbranch_vccnz L_poll_61
L_poll_ok_62:
 buffer_load_dwordx4 v[128:131], v231, s[16:19], 0 offen sc1
 buffer_load_dwordx4 v[132:135], v231, s[16:19], s96 offen sc1
 buffer_load_dwordx4 v[136:139], v231, s[16:19], s97 offen sc1
 s_mul_i32 s45, s3, 3072
 s_add_u32 m0, s45, 81920
 s_nop 0
 buffer_load_dwordx4 v228, s[16:19], 0 offen offset:0 sc1 lds
 buffer_load_dwordx4 v229, s[16:19], 0 offen offset:1024 sc1 lds
 buffer_load_dwordx4 v230, s[16:19], 0 offen offset:2048 sc1 lds
 s_add_u32 m0, s45, 94208
 s_nop 0
 buffer_load_dwordx4 v228, s[16:19], s96 offen offset:0 sc1 lds
 buffer_load_dwordx4 v229, s[16:19], s96 offen offset:1024 sc1 lds
 buffer_load_dwordx4 v230, s[16:19], s96 offen offset:2048 sc1 lds
 s_add_u32 m0, s45, 106496
 s_nop 0
 buffer_load_dwordx4 v228, s[16:19], s97 offen offset:0 sc1 lds
 buffer_load_dwordx4 v229, s[16:19], s97 offen offset:1024 sc1 lds
 buffer_load_dwordx4 v230, s[16:19], s97 offen offset:2048 sc1 lds
 s_mul_i32 s45, s3, 9216
 s_add_u32 m0, s45, 118784
 s_nop 0
 buffer_load_dwordx4 v254, s[16:19], s64 offen offset:0 sc1 lds
 buffer_load_dwordx4 v254, s[16:19], s64 offen offset:1024 sc1 lds
 buffer_load_dwordx4 v236, s[16:19], s64 offen offset:2048 sc1 lds
 s_add_u32 m0, s45, 121856
 s_nop 0
 buffer_load_dwordx4 v254, s[16:19], s65 offen offset:0 sc1 lds
 buffer_load_dwordx4 v254, s[16:19], s65 offen offset:1024 sc1 lds
 buffer_load_dwordx4 v236, s[16:19], s65 offen offset:2048 sc1 lds
 s_add_u32 m0, s45, 124928
 s_nop 0
 buffer_load_dwordx4 v254, s[16:19], s66 offen offset:0 sc1 lds
 buffer_load_dwordx4 v254, s[16:19], s66 offen offset:1024 sc1 lds
 buffer_load_dwordx4 v236, s[16:19], s66 offen offset:2048 sc1 lds
 s_bitcmp1_b32 s58, 0
 s_cselect_b64 s[92:93], 0, -1
 s_cselect_b32 s83, -1, 0
 s_cselect_b32 s84, -1, 0
 s_mov_b32 s82, -1
 s_mov_b32 s85, 0
 s_waitcnt vmcnt(18)
 v_cndmask_b32 v144, 0, v128, s[92:93]
 v_cndmask_b32 v145, 0, v129, s[92:93]
 v_mov_b32 v146, v130
 v_mov_b32 v147, v131
 v_cndmask_b32 v148, 0, v132, s[82:83]
 v_cndmask_b32 v149, 0, v133, s[82:83]
 v_cndmask_b32 v150, 0, v134, s[84:85]
 v_cndmask_b32 v151, 0, v135, s[84:85]
 v_cndmask_b32 v152, v132, 0, s[82:83]
 v_cndmask_b32 v153, v133, 0, s[82:83]
 v_cndmask_b32 v154, v134, 0, s[84:85]
 v_cndmask_b32 v155, v135, 0, s[84:85]
 v_mov_b32 v156, v136
 v_mov_b32 v157, v137
 v_cndmask_b32 v158, v138, 0, s[92:93]
 v_cndmask_b32 v159, v139, 0, s[92:93]
 s_waitcnt lgkmcnt(0)
 s_branch L_att
L_nonce_3:
 s_mov_b32 s87, 0
L_nonce_3_l:
 s_sleep 4
 buffer_load_dwordx2 v[252:253], v237, s[24:27], 0 offen sc1
 s_add_u32 s87, s87, 1
 s_waitcnt vmcnt(0)
 v_readfirstlane_b32 s90, v252
 v_readfirstlane_b32 s91, v253
 s_cmp_gt_u32 s87, 262144
 s_cbranch_scc1 L_nonce_ok_4
 s_cmp_eq_u32 s90, 0
 s_cbranch_scc1 L_nonce_3_l
 s_branch L_nonce_ok_4
L_nonce_5:
 s_mov_b32 s87, 0
L_nonce_5_l:
 s_sleep 4
 buffer_load_dwordx2 v[252:253], v237, s[24:27], 0 offen sc1
 s_add_u32 s87, s87, 1
 s_waitcnt vmcnt(0)
 v_readfirstlane_b32 s90, v252
 v_readfirstlane_b32 s91, v253
 s_cmp_gt_u32 s87, 262144
 s_cbranch_scc1 L_nonce_ok_6
 s_cmp_eq_u32 s90, 0
 s_cbranch_scc1 L_nonce_5_l
 s_branch L_nonce_ok_6
L_poll_7:
 s_mov_b32 s87, 0
 s_branch L_poll_7_f
L_poll_7_l:
 s_sleep 4
L_poll_7_f:
 buffer_load_dwordx2 v[246:247], v244, s[16:19], 0 offen sc1
 s_add_u32 s87, s87, 1
 s_waitcnt vmcnt(0)
 v_cmp_ne_u64 vcc, s[90:91], v[246:247]
 s_cmp_gt_u32 s87, 262144
 s_cbranch_scc1 L_poll_ok_8
 s_cbranch_vccnz L_poll_7_l
 s_branch L_poll_ok_8
L_poll_9:
 s_mov_b32 s87, 0
 s_branch L_poll_9_f
L_poll_9_l:
 s_sleep 4
L_poll_9_f:
 buffer_load_dwordx2 v[246:247], v245, s[16:19], 0 offen sc1
 s_add_u32 s87, s87, 1
 s_waitcnt vmcnt(0)
 v_cmp_ne_u64 vcc, s[90:91], v[246:247]
 s_cmp_gt_u32 s87, 262144
 s_cbranch_scc1 L_poll_ok_10
 s_cbranch_vccnz L_poll_9_l
 s_branch L_poll_ok_10
L_poll_11:
 s_mov_b32 s87, 0
 s_branch L_poll_11_f
L_poll_11_l:
 s_sleep 4
L_poll_11_f:
 buffer_load_dwordx2 v[246:247], v243, s[16:19], 0 offen sc1
 s_add_u32 s87, s87, 1
 s_waitcnt vmcnt(0)
 v_cmp_ne_u64 vcc, s[90:91], v[246:247]
 s_cmp_gt_u32 s87, 262144
 s_cbranch_scc1 L_poll_ok_12
 s_cbranch_vccnz L_poll_11_l
 s_branch L_poll_ok_12
L_poll_17:
 s_mov_b32 s87, 0
 s_branch L_poll_17_f
L_poll_17_l:
 s_sleep 4
L_poll_17_f:
 buffer_load_dwordx2 v[246:247], v245, s[16:19], 0 offen sc1
 s_add_u32 s87, s87, 1
 s_waitcnt vmcnt(0)
 v_cmp_ne_u64 vcc, s[90:91], v[246:247]
 s_cmp_gt_u32 s87, 262144
 s_cbranch_scc1 L_poll_ok_18
 s_cbranch_vccnz L_poll_17_l
 s_branch L_poll_ok_18
L_open_19:
 s_nop 7
 v_mov_b32 v208, 0
 v_mov_b32 v209, 0
 v_mov_b32 v210, 0
 v_mov_b32 v211, 0
 v_mov_b32 v212, 0
 v_mov_b32 v213, 0
 v_mov_b32 v214, 0
 v_mov_b32 v215, 0
 v_mov_b32 v216, 0
 v_mov_b32 v217, 0
 v_mov_b32 v218, 0
 v_mov_b32 v219, 0
 v_mov_b32 v220, 0
 v_mov_b32 v221, 0
 v_mov_b32 v222, 0
 v_mov_b32 v223, 0
 s_nop 0
 s_branch L_open_ok_20
L_open_21:
 s_nop 7
 v_mov_b32 v208, 0
 v_mov_b32 v209, 0
 v_mov_b32 v210, 0
 v_mov_b32 v211, 0
 v_mov_b32 v212, 0
 v_mov_b32 v213, 0
 v_mov_b32 v214, 0
 v_mov_b32 v215, 0
 v_mov_b32 v216, 0
 v_mov_b32 v217, 0
 v_mov_b32 v218, 0
 v_mov_b32 v219, 0
 v_mov_b32 v220, 0
 v_mov_b32 v221, 0
 v_mov_b32 v222, 0
 v_mov_b32 v223, 0
 s_nop 0
 s_branch L_open_ok_22
L_open_23:
 s_nop 7
 v_mov_b32 v208, 0
 v_mov_b32 v209, 0
 v_mov_b32 v210, 0
 v_mov_b32 v211, 0
 v_mov_b32 v212, 0
 v_mov_b32 v213, 0
 v_mov_b32 v214, 0
 v_mov_b32 v215, 0
 v_mov_b32 v216, 0
 v_mov_b32 v217, 0
 v_mov_b32 v218, 0
 v_mov_b32 v219, 0
 v_mov_b32 v220, 0
 v_mov_b32 v221, 0
 v_mov_b32 v222, 0
 v_mov_b32 v223, 0
 s_nop 0
 s_branch L_open_ok_24
L_open_25:
 s_nop 7
 v_mov_b32 v208, 0
 v_mov_b32 v209, 0
 v_mov_b32 v210, 0
 v_mov_b32 v211, 0
 v_mov_b32 v212, 0
 v_mov_b32 v213, 0
 v_mov_b32 v214, 0
 v_mov_b32 v215, 0
 v_mov_b32 v216, 0
 v_mov_b32 v217, 0
 v_mov_b32 v218, 0
 v_mov_b32 v219, 0
 v_mov_b32 v220, 0
 v_mov_b32 v221, 0
 v_mov_b32 v222, 0
 v_mov_b32 v223, 0
 s_nop 0
 s_branch L_open_ok_26
L_open_27:
 s_nop 7
 v_mov_b32 v208, 0
 v_mov_b32 v209, 0
 v_mov_b32 v210, 0
 v_mov_b32 v211, 0
 v_mov_b32 v212, 0
 v_mov_b32 v213, 0
 v_mov_b32 v214, 0
 v_mov_b32 v215, 0
 v_mov_b32 v216, 0
 v_mov_b32 v217, 0
 v_mov_b32 v218, 0
 v_mov_b32 v219, 0
 v_mov_b32 v220, 0
 v_mov_b32 v221, 0
 v_mov_b32 v222, 0
 v_mov_b32 v223, 0
 s_nop 0
 s_branch L_open_ok_28
L_open_29:
 s_nop 7
 v_mov_b32 v208, 0
 v_mov_b32 v209, 0
 v_mov_b32 v210, 0
 v_mov_b32 v211, 0
 v_mov_b32 v212, 0
 v_mov_b32 v213, 0
 v_mov_b32 v214, 0
 v_mov_b32 v215, 0
 v_mov_b32 v216, 0
 v_mov_b32 v217, 0
 v_mov_b32 v218, 0
 v_mov_b32 v219, 0
 v_mov_b32 v220, 0
 v_mov_b32 v221, 0
 v_mov_b32 v222, 0
 v_mov_b32 v223, 0
 s_nop 0
 s_branch L_open_ok_30
L_open_31:
 s_nop 7
 v_mov_b32 v208, 0
 v_mov_b32 v209, 0
 v_mov_b32 v210, 0
 v_mov_b32 v211, 0
 v_mov_b32 v212, 0
 v_mov_b32 v213, 0
 v_mov_b32 v214, 0
 v_mov_b32 v215, 0
 v_mov_b32 v216, 0
 v_mov_b32 v217, 0
 v_mov_b32 v218, 0
 v_mov_b32 v219, 0
 v_mov_b32 v220, 0
 v_mov_b32 v221, 0
 v_mov_b32 v222, 0
 v_mov_b32 v223, 0
 s_nop 0
 s_branch L_open_ok_32
L_open_33:
 s_nop 7
 v_mov_b32 v208, 0
 v_mov_b32 v209, 0
 v_mov_b32 v210, 0
 v_mov_b32 v211, 0
 v_mov_b32 v212, 0
 v_mov_b32 v213, 0
 v_mov_b32 v214, 0
 v_mov_b32 v215, 0
 v_mov_b32 v216, 0
 v_mov_b32 v217, 0
 v_mov_b32 v218, 0
 v_mov_b32 v219, 0
 v_mov_b32 v220, 0
 v_mov_b32 v221, 0
 v_mov_b32 v222, 0
 v_mov_b32 v223, 0
 s_nop 0
 s_branch L_open_ok_34
L_open_35:
 s_nop 7
 v_mov_b32 v208, 0
 v_mov_b32 v209, 0
 v_mov_b32 v210, 0
 v_mov_b32 v211, 0
 v_mov_b32 v212, 0
 v_mov_b32 v213, 0
 v_mov_b32 v214, 0
 v_mov_b32 v215, 0
 v_mov_b32 v216, 0
 v_mov_b32 v217, 0
 v_mov_b32 v218, 0
 v_mov_b32 v219, 0
 v_mov_b32 v220, 0
 v_mov_b32 v221, 0
 v_mov_b32 v222, 0
 v_mov_b32 v223, 0
 s_nop 0
 s_branch L_open_ok_36
L_open_37:
 s_nop 7
 v_mov_b32 v208, 0
 v_mov_b32 v209, 0
 v_mov_b32 v210, 0
 v_mov_b32 v211, 0
 v_mov_b32 v212, 0
 v_mov_b32 v213, 0
 v_mov_b32 v214, 0
 v_mov_b32 v215, 0
 v_mov_b32 v216, 0
 v_mov_b32 v217, 0
 v_mov_b32 v218, 0
 v_mov_b32 v219, 0
 v_mov_b32 v220, 0
 v_mov_b32 v221, 0
 v_mov_b32 v222, 0
 v_mov_b32 v223, 0
 s_nop 0
 s_branch L_open_ok_38
L_open_39:
 s_nop 7
 v_mov_b32 v208, 0
 v_mov_b32 v209, 0
 v_mov_b32 v210, 0
 v_mov_b32 v211, 0
 v_mov_b32 v212, 0
 v_mov_b32 v213, 0
 v_mov_b32 v214, 0
 v_mov_b32 v215, 0
 v_mov_b32 v216, 0
 v_mov_b32 v217, 0
 v_mov_b32 v218, 0
 v_mov_b32 v219, 0
 v_mov_b32 v220, 0
 v_mov_b32 v221, 0
 v_mov_b32 v222, 0
 v_mov_b32 v223, 0
 s_nop 0
 s_branch L_open_ok_40
L_open_41:
 s_nop 7
 v_mov_b32 v208, 0
 v_mov_b32 v209, 0
 v_mov_b32 v210, 0
 v_mov_b32 v211, 0
 v_mov_b32 v212, 0
 v_mov_b32 v213, 0
 v_mov_b32 v214, 0
 v_mov_b32 v215, 0
 v_mov_b32 v216, 0
 v_mov_b32 v217, 0
 v_mov_b32 v218, 0
 v_mov_b32 v219, 0
 v_mov_b32 v220, 0
 v_mov_b32 v221, 0
 v_mov_b32 v222, 0
 v_mov_b32 v223, 0
 s_nop 0
 s_branch L_open_ok_42
L_open_43:
 s_nop 7
 v_mov_b32 v208, 0
 v_mov_b32 v209, 0
 v_mov_b32 v210, 0
 v_mov_b32 v211, 0
 v_mov_b32 v212, 0
 v_mov_b32 v213, 0
 v_mov_b32 v214, 0
 v_mov_b32 v215, 0
 v_mov_b32 v216, 0
 v_mov_b32 v217, 0
 v_mov_b32 v218, 0
 v_mov_b32 v219, 0
 v_mov_b32 v220, 0
 v_mov_b32 v221, 0
 v_mov_b32 v222, 0
 v_mov_b32 v223, 0
 s_nop 0
 s_branch L_open_ok_44
L_open_45:
 s_nop 7
 v_mov_b32 v208, 0
 v_mov_b32 v209, 0
 v_mov_b32 v210, 0
 v_mov_b32 v211, 0
 v_mov_b32 v212, 0
 v_mov_b32 v213, 0
 v_mov_b32 v214, 0
 v_mov_b32 v215, 0
 v_mov_b32 v216, 0
 v_mov_b32 v217, 0
 v_mov_b32 v218, 0
 v_mov_b32 v219, 0
 v_mov_b32 v220, 0
 v_mov_b32 v221, 0
 v_mov_b32 v222, 0
 v_mov_b32 v223, 0
 s_nop 0
 s_branch L_open_ok_46
L_poll_47:
 s_mov_b32 s87, 0
 s_branch L_poll_47_f
L_poll_47_l:
 s_sleep 4
L_poll_47_f:
 buffer_load_dwordx2 v[246:247], v243, s[16:19], 0 offen sc1
 s_add_u32 s87, s87, 1
 s_waitcnt vmcnt(0)
 v_cmp_ne_u64 vcc, s[90:91], v[246:247]
 s_cmp_gt_u32 s87, 262144
 s_cbranch_scc1 L_poll_ok_48
 s_cbranch_vccnz L_poll_47_l
 s_branch L_poll_ok_48
L_poll_49:
 s_mov_b32 s87, 0
 s_branch L_poll_49_f
L_poll_49_l:
 s_sleep 4
L_poll_49_f:
 buffer_load_dwordx2 v[246:247], v244, s[16:19], 0 offen sc1
 s_add_u32 s87, s87, 1
 s_waitcnt vmcnt(0)
 v_cmp_ne_u64 vcc, s[90:91], v[246:247]
 s_cmp_gt_u32 s87, 262144
 s_cbranch_scc1 L_poll_ok_50
 s_cbranch_vccnz L_poll_49_l
 s_branch L_poll_ok_50
L_poll_51:
 s_mov_b32 s87, 0
 s_branch L_poll_51_f
L_poll_51_l:
 s_sleep 4
L_poll_51_f:
 buffer_load_dwordx2 v[246:247], v225, s[16:19], 0 offen sc1
 s_add_u32 s87, s87, 1
 s_waitcnt vmcnt(0)
 v_cmp_ne_u64 vcc, s[90:91], v[246:247]
 s_cmp_gt_u32 s87, 262144
 s_cbranch_scc1 L_poll_ok_52
 s_cbranch_vccnz L_poll_51_l
 s_branch L_poll_ok_52
L_poll_53:
 s_mov_b32 s87, 0
 s_branch L_poll_53_f
L_poll_53_l:
 s_sleep 4
L_poll_53_f:
 buffer_load_dwordx2 v[246:247], v245, s[16:19], 0 offen sc1
 s_add_u32 s87, s87, 1
 s_waitcnt vmcnt(0)
 v_cmp_ne_u64 vcc, s[90:91], v[246:247]
 s_cmp_gt_u32 s87, 262144
 s_cbranch_scc1 L_poll_ok_54
 s_cbranch_vccnz L_poll_53_l
 s_branch L_poll_ok_54
L_nonce_55:
 s_mov_b32 s87, 0
L_nonce_55_l:
 s_sleep 4
 buffer_load_dwordx2 v[252:253], v237, s[24:27], 0 offen sc1
 s_add_u32 s87, s87, 1
 s_waitcnt vmcnt(0)
 v_readfirstlane_b32 s90, v252
 v_readfirstlane_b32 s91, v253
 s_cmp_gt_u32 s87, 262144
 s_cbranch_scc1 L_nonce_ok_56
 s_cmp_eq_u32 s90, 0
 s_cbranch_scc1 L_nonce_55_l
 s_branch L_nonce_ok_56
L_poll_57:
 s_mov_b32 s87, 0
 s_branch L_poll_57_f
L_poll_57_l:
 s_sleep 4
L_poll_57_f:
 buffer_load_dwordx2 v[246:247], v28, s[16:19], 0 offen sc1
 s_add_u32 s87, s87, 1
 s_waitcnt vmcnt(0)
 v_cmp_ne_u64 vcc, s[90:91], v[246:247]
 s_cmp_gt_u32 s87, 262144
 s_cbranch_scc1 L_poll_ok_58
 s_cbranch_vccnz L_poll_57_l
 s_branch L_poll_ok_58
L_poll_59:
 s_mov_b32 s87, 0
 s_branch L_poll_59_f
L_poll_59_l:
 s_sleep 4
L_poll_59_f:
 buffer_load_dwordx2 v[246:247], v244, s[16:19], 0 offen sc1
 s_add_u32 s87, s87, 1
 s_waitcnt vmcnt(0)
 v_cmp_ne_u64 vcc, s[90:91], v[246:247]
 s_cmp_gt_u32 s87, 262144
 s_cbranch_scc1 L_poll_ok_60
 s_cbranch_vccnz L_poll_59_l
 s_branch L_poll_ok_60
L_poll_61:
 s_mov_b32 s87, 0
 s_branch L_poll_61_f
L_poll_61_l:
 s_sleep 4
L_poll_61_f:
 buffer_load_dwordx2 v[246:247], v245, s[16:19], 0 offen sc1
 s_add_u32 s87, s87, 1
 s_waitcnt vmcnt(0)
 v_cmp_ne_u64 vcc, s[90:91], v[246:247]
 s_cmp_gt_u32 s87, 262144
 s_cbranch_scc1 L_poll_ok_62
 s_cbranch_vccnz L_poll_61_l
 s_branch L_poll_ok_62
L_cold:
L_slow_13:
 s_nop 15
 v_mov_b32 v249, 0xff800000
 v_mov_b32 v32, 0
 v_mov_b32 v33, 0
 v_mov_b32 v34, 0
 v_mov_b32 v35, 0
 v_mov_b32 v36, 0
 v_mov_b32 v37, 0
 v_mov_b32 v38, 0
 v_mov_b32 v39, 0
 v_mov_b32 v40, 0
 v_mov_b32 v41, 0
 v_mov_b32 v42, 0
 v_mov_b32 v43, 0
 v_mov_b32 v44, 0
 v_mov_b32 v45, 0
 v_mov_b32 v46, 0
 v_mov_b32 v47, 0
 s_cmp_lt_u32 s59, 8
 s_cbranch_scc1 L_sk_63
 ds_read_b128 v[168:171], v241 offset:0
 ds_read_b128 v[172:175], v241 offset:12288
 s_waitcnt lgkmcnt(0)
 v_mfma_f32_32x32x16_bf16 v[0:15], v[168:171], v[144:147], v[208:223]
 v_mfma_f32_32x32x16_bf16 v[0:15], v[172:175], v[148:151], v[0:15]
 s_nop 11
 v_max3_f32 v249, v249, v0, v1
 v_max3_f32 v249, v249, v2, v3
 v_max3_f32 v249, v249, v4, v5
 v_max3_f32 v249, v249, v6, v7
 v_max3_f32 v249, v249, v8, v9
 v_max3_f32 v249, v249, v10, v11
 v_max3_f32 v249, v249, v12, v13
 v_max3_f32 v249, v249, v14, v15
L_sk_63:
 s_cmp_lt_u32 s59, 7
 s_cbranch_scc1 L_sk_64
 ds_read_b128 v[168:171], v241 offset:1024
 ds_read_b128 v[172:175], v241 offset:13312
 s_waitcnt lgkmcnt(0)
 v_mfma_f32_32x32x16_bf16 v[0:15], v[168:171], v[144:147], 0
 v_mfma_f32_32x32x16_bf16 v[0:15], v[172:175], v[148:151], v[0:15]
 s_nop 11
 v_max3_f32 v249, v249, v0, v1
 v_max3_f32 v249, v249, v2, v3
 v_max3_f32 v249, v249, v4, v5
 v_max3_f32 v249, v249, v6, v7
 v_max3_f32 v249, v249, v8, v9
 v_max3_f32 v249, v249, v10, v11
 v_max3_f32 v249, v249, v12, v13
 v_max3_f32 v249, v249, v14, v15
L_sk_64:
 s_cmp_lt_u32 s59, 6
 s_cbranch_scc1 L_sk_65
 ds_read_b128 v[168:171], v241 offset:2048
 ds_read_b128 v[172:175], v241 offset:14336
 s_waitcnt lgkmcnt(0)
 v_mfma_f32_32x32x16_bf16 v[0:15], v[168:171], v[144:147], 0
 v_mfma_f32_32x32x16_bf16 v[0:15], v[172:175], v[148:151], v[0:15]
 s_nop 11
 v_max3_f32 v249, v249, v0, v1
 v_max3_f32 v249, v249, v2, v3
 v_max3_f32 v249, v249, v4, v5
 v_max3_f32 v249, v249, v6, v7
 v_max3_f32 v249, v249, v8, v9
 v_max3_f32 v249, v249, v10, v11
 v_max3_f32 v249, v249, v12, v13
 v_max3_f32 v249, v249, v14, v15
L_sk_65:
 s_cmp_lt_u32 s59, 5
 s_cbranch_scc1 L_sk_66
 ds_read_b128 v[168:171], v241 offset:3072
 ds_read_b128 v[172:175], v241 offset:15360
 s_waitcnt lgkmcnt(0)
 v_mfma_f32_32x32x16_bf16 v[0:15], v[168:171], v[144:147], 0
 v_mfma_f32_32x32x16_bf16 v[0:15], v[172:175], v[148:151], v[0:15]
 s_nop 11
 v_max3_f32 v249, v249, v0, v1
 v_max3_f32 v249, v249, v2, v3
 v_max3_f32 v249, v249, v4, v5
 v_max3_f32 v249, v249, v6, v7
 v_max3_f32 v249, v249, v8, v9
 v_max3_f32 v249, v249, v10, v11
 v_max3_f32 v249, v249, v12, v13
 v_max3_f32 v249, v249, v14, v15
L_sk_66:
 s_cmp_lt_u32 s59, 4
 s_cbranch_scc1 L_sk_67
 ds_read_b128 v[168:171], v241 offset:4096
 ds_read_b128 v[172:175], v241 offset:16384
 s_waitcnt lgkmcnt(0)
 v_mfma_f32_32x32x16_bf16 v[0:15], v[168:171], v[144:147], 0
 v_mfma_f32_32x32x16_bf16 v[0:15], v[172:175], v[148:151], v[0:15]
 s_nop 11
 v_max3_f32 v249, v249, v0, v1
 v_max3_f32 v249, v249, v2, v3
 v_max3_f32 v249, v249, v4, v5
 v_max3_f32 v249, v249, v6, v7
 v_max3_f32 v249, v249, v8, v9
 v_max3_f32 v249, v249, v10, v11
 v_max3_f32 v249, v249, v12, v13
 v_max3_f32 v249, v249, v14, v15
L_sk_67:
 s_cmp_lt_u32 s59, 3
 s_cbranch_scc1 L_sk_68
 ds_read_b128 v[168:171], v241 offset:5120
 ds_read_b128 v[172:175], v241 offset:17408
 s_waitcnt lgkmcnt(0)
 v_mfma_f32_32x32x16_bf16 v[0:15], v[168:171], v[144:147], 0
 v_mfma_f32_32x32x16_bf16 v[0:15], v[172:175], v[148:151], v[0:15]
 s_nop 11
 v_max3_f32 v249, v249, v0, v1
 v_max3_f32 v249, v249, v2, v3
 v_max3_f32 v249, v249, v4, v5
 v_max3_f32 v249, v249, v6, v7
 v_max3_f32 v249, v249, v8, v9
 v_max3_f32 v249, v249, v10, v11
 v_max3_f32 v249, v249, v12, v13
 v_max3_f32 v249, v249, v14, v15
L_sk_68:
 s_cmp_lt_u32 s59, 2
 s_cbranch_scc1 L_sk_69
 ds_read_b128 v[168:171], v241 offset:6144
 ds_read_b128 v[172:175], v241 offset:18432
 s_waitcnt lgkmcnt(0)
 v_mfma_f32_32x32x16_bf16 v[0:15], v[168:171], v[144:147], 0
 v_mfma_f32_32x32x16_bf16 v[0:15], v[172:175], v[148:151], v[0:15]
 s_nop 11
 v_max3_f32 v249, v249, v0, v1
 v_max3_f32 v249, v249, v2, v3
 v_max3_f32 v249, v249, v4, v5
 v_max3_f32 v249, v249, v6, v7
 v_max3_f32 v249, v249, v8, v9
 v_max3_f32 v249, v249, v10, v11
 v_max3_f32 v249, v249, v12, v13
 v_max3_f32 v249, v249, v14, v15
L_sk_69:
 s_cmp_lt_u32 s59, 1
 s_cbranch_scc1 L_sk_70
 ds_read_b128 v[168:171], v241 offset:7168
 ds_read_b128 v[172:175], v241 offset:19456
 s_waitcnt lgkmcnt(0)
 v_mfma_f32_32x32x16_bf16 v[0:15], v[168:171], v[144:147], 0
 v_mfma_f32_32x32x16_bf16 v[0:15], v[172:175], v[148:151], v[0:15]
 s_nop 11
 v_max3_f32 v249, v249, v0, v1
 v_max3_f32 v249, v249, v2, v3
 v_max3_f32 v249, v249, v4, v5
 v_max3_f32 v249, v249, v6, v7
 v_max3_f32 v249, v249, v8, v9
 v_max3_f32 v249, v249, v10, v11
 v_max3_f32 v249, v249, v12, v13
 v_max3_f32 v249, v249, v14, v15
L_sk_70:
 ds_read_b128 v[168:171], v241 offset:8192
 ds_read_b128 v[172:175], v241 offset:20480
 s_waitcnt lgkmcnt(0)
 v_mfma_f32_32x32x16_bf16 v[0:15], v[168:171], v[144:147], v[192:207]
 v_mfma_f32_32x32x16_bf16 v[0:15], v[172:175], v[148:151], v[0:15]
 s_nop 11
 v_max3_f32 v249, v249, v0, v1
 v_max3_f32 v249, v249, v2, v3
 v_max3_f32 v249, v249, v4, v5
 v_max3_f32 v249, v249, v6, v7
 v_max3_f32 v249, v249, v8, v9
 v_max3_f32 v249, v249, v10, v11
 v_max3_f32 v249, v249, v12, v13
 v_max3_f32 v249, v249, v14, v15
L_sk_71:
 v_mov_b32 v248, v249
 s_nop 1
 v_permlane32_swap_b32 v248, v249
 s_nop 1
 v_max_f32 v249, v248, v249
 s_cmp_lt_u32 s59, 8
 s_cbranch_scc1 L_sk_72
 s_mov_b64 exec, s[94:95]
 ds_read_b128 v[160:163], v240 offset:0
 ds_read_b128 v[164:167], v240 offset:1280
 s_mov_b64 exec, -1
 ds_read_b128 v[168:171], v241 offset:0
 ds_read_b128 v[172:175], v241 offset:12288
 s_waitcnt lgkmcnt(0)
 v_mfma_f32_32x32x16_bf16 v[0:15], v[168:171], v[144:147], v[208:223]
 v_mfma_f32_32x32x16_bf16 v[0:15], v[172:175], v[148:151], v[0:15]
 s_nop 11
 v_sub_f32 v0, v0, v249
 v_sub_f32 v1, v1, v249
 v_sub_f32 v2, v2, v249
 v_sub_f32 v3, v3, v249
 v_sub_f32 v4, v4, v249
 v_sub_f32 v5, v5, v249
 v_sub_f32 v6, v6, v249
 v_sub_f32 v7, v7, v249
 v_sub_f32 v8, v8, v249
 v_sub_f32 v9, v9, v249
 v_sub_f32 v10, v10, v249
 v_sub_f32 v11, v11, v249
 v_sub_f32 v12, v12, v249
 v_sub_f32 v13, v13, v249
 v_sub_f32 v14, v14, v249
 v_sub_f32 v15, v15, v249
 v_exp_f32 v0, v0
 v_exp_f32 v1, v1
 v_exp_f32 v2, v2
 v_exp_f32 v3, v3
 v_exp_f32 v4, v4
 v_exp_f32 v5, v5
 v_exp_f32 v6, v6
 v_exp_f32 v7, v7
 v_exp_f32 v8, v8
 v_exp_f32 v9, v9
 v_exp_f32 v10, v10
 v_exp_f32 v11, v11
 v_exp_f32 v12, v12
 v_exp_f32 v13, v13
 v_exp_f32 v14, v14
 v_exp_f32 v15, v15
 v_cvt_pk_bf16_f32 v0, v0, v1
 v_cvt_pk_bf16_f32 v1, v2, v3
 v_cvt_pk_bf16_f32 v2, v4, v5
 v_cvt_pk_bf16_f32 v3, v6, v7
 v_cvt_pk_bf16_f32 v4, v8, v9
 v_cvt_pk_bf16_f32 v5, v10, v11
 v_cvt_pk_bf16_f32 v6, v12, v13
 v_cvt_pk_bf16_f32 v7, v14, v15
 v_mfma_f32_32x32x16_bf16 v[32:47], v[160:163], v[0:3], v[32:47]
 s_nop 0
 v_mfma_f32_32x32x16_bf16 v[32:47], v[164:167], v[4:7], v[32:47]
 s_nop 7
L_sk_72:
 s_cmp_lt_u32 s59, 7
 s_cbranch_scc1 L_sk_73
 s_mov_b64 exec, s[94:95]
 ds_read_b128 v[160:163], v240 offset:3072
 ds_read_b128 v[164:167], v240 offset:4352
 s_mov_b64 exec, -1
 ds_read_b128 v[168:171], v241 offset:1024
 ds_read_b128 v[172:175], v241 offset:13312
 s_waitcnt lgkmcnt(0)
 v_mfma_f32_32x32x16_bf16 v[0:15], v[168:171], v[144:147], 0
 v_mfma_f32_32x32x16_bf16 v[0:15], v[172:175], v[148:151], v[0:15]
 s_nop 11
 v_sub_f32 v0, v0, v249
 v_sub_f32 v1, v1, v249
 v_sub_f32 v2, v2, v249
 v_sub_f32 v3, v3, v249
 v_sub_f32 v4, v4, v249
 v_sub_f32 v5, v5, v249
 v_sub_f32 v6, v6, v249
 v_sub_f32 v7, v7, v249
 v_sub_f32 v8, v8, v249
 v_sub_f32 v9, v9, v249
 v_sub_f32 v10, v10, v249
 v_sub_f32 v11, v11, v249
 v_sub_f32 v12, v12, v249
 v_sub_f32 v13, v13, v249
 v_sub_f32 v14, v14, v249
 v_sub_f32 v15, v15, v249
 v_exp_f32 v0, v0
 v_exp_f32 v1, v1
 v_exp_f32 v2, v2
 v_exp_f32 v3, v3
 v_exp_f32 v4, v4
 v_exp_f32 v5, v5
 v_exp_f32 v6, v6
 v_exp_f32 v7, v7
 v_exp_f32 v8, v8
 v_exp_f32 v9, v9
 v_exp_f32 v10, v10
 v_exp_f32 v11, v11
 v_exp_f32 v12, v12
 v_exp_f32 v13, v13
 v_exp_f32 v14, v14
 v_exp_f32 v15, v15
 v_cvt_pk_bf16_f32 v0, v0, v1
 v_cvt_pk_bf16_f32 v1, v2, v3
 v_cvt_pk_bf16_f32 v2, v4, v5
 v_cvt_pk_bf16_f32 v3, v6, v7
 v_cvt_pk_bf16_f32 v4, v8, v9
 v_cvt_pk_bf16_f32 v5, v10, v11
 v_cvt_pk_bf16_f32 v6, v12, v13
 v_cvt_pk_bf16_f32 v7, v14, v15
 v_mfma_f32_32x32x16_bf16 v[32:47], v[160:163], v[0:3], v[32:47]
 s_nop 0
 v_mfma_f32_32x32x16_bf16 v[32:47], v[164:167], v[4:7], v[32:47]
 s_nop 7
L_sk_73:
 s_cmp_lt_u32 s59, 6
 s_cbranch_scc1 L_sk_74
 s_mov_b64 exec, s[94:95]
 ds_read_b128 v[160:163], v240 offset:6144
 ds_read_b128 v[164:167], v240 offset:7424
 s_mov_b64 exec, -1
 ds_read_b128 v[168:171], v241 offset:2048
 ds_read_b128 v[172:175], v241 offset:14336
 s_waitcnt lgkmcnt(0)
 v_mfma_f32_32x32x16_bf16 v[0:15], v[168:171], v[144:147], 0
 v_mfma_f32_32x32x16_bf16 v[0:15], v[172:175], v[148:151], v[0:15]
 s_nop 11
 v_sub_f32 v0, v0, v249
 v_sub_f32 v1, v1, v249
 v_sub_f32 v2, v2, v249
 v_sub_f32 v3, v3, v249
 v_sub_f32 v4, v4, v249
 v_sub_f32 v5, v5, v249
 v_sub_f32 v6, v6, v249
 v_sub_f32 v7, v7, v249
 v_sub_f32 v8, v8, v249
 v_sub_f32 v9, v9, v249
 v_sub_f32 v10, v10, v249
 v_sub_f32 v11, v11, v249
 v_sub_f32 v12, v12, v249
 v_sub_f32 v13, v13, v249
 v_sub_f32 v14, v14, v249
 v_sub_f32 v15, v15, v249
 v_exp_f32 v0, v0
 v_exp_f32 v1, v1
 v_exp_f32 v2, v2
 v_exp_f32 v3, v3
 v_exp_f32 v4, v4
 v_exp_f32 v5, v5
 v_exp_f32 v6, v6
 v_exp_f32 v7, v7
 v_exp_f32 v8, v8
 v_exp_f32 v9, v9
 v_exp_f32 v10, v10
 v_exp_f32 v11, v11
 v_exp_f32 v12, v12
 v_exp_f32 v13, v13
 v_exp_f32 v14, v14
 v_exp_f32 v15, v15
 v_cvt_pk_bf16_f32 v0, v0, v1
 v_cvt_pk_bf16_f32 v1, v2, v3
 v_cvt_pk_bf16_f32 v2, v4, v5
 v_cvt_pk_bf16_f32 v3, v6, v7
 v_cvt_pk_bf16_f32 v4, v8, v9
 v_cvt_pk_bf16_f32 v5, v10, v11
 v_cvt_pk_bf16_f32 v6, v12, v13
 v_cvt_pk_bf16_f32 v7, v14, v15
 v_mfma_f32_32x32x16_bf16 v[32:47], v[160:163], v[0:3], v[32:47]
 s_nop 0
 v_mfma_f32_32x32x16_bf16 v[32:47], v[164:167], v[4:7], v[32:47]
 s_nop 7
L_sk_74:
 s_cmp_lt_u32 s59, 5
 s_cbranch_scc1 L_sk_75
 s_mov_b64 exec, s[94:95]
 ds_read_b128 v[160:163], v240 offset:9216
 ds_read_b128 v[164:167], v240 offset:10496
 s_mov_b64 exec, -1
 ds_read_b128 v[168:171], v241 offset:3072
 ds_read_b128 v[172:175], v241 offset:15360
 s_waitcnt lgkmcnt(0)
 v_mfma_f32_32x32x16_bf16 v[0:15], v[168:171], v[144:147], 0
 v_mfma_f32_32x32x16_bf16 v[0:15], v[172:175], v[148:151], v[0:15]
 s_nop 11
 v_sub_f32 v0, v0, v249
 v_sub_f32 v1, v1, v249
 v_sub_f32 v2, v2, v249
 v_sub_f32 v3, v3, v249
 v_sub_f32 v4, v4, v249
 v_sub_f32 v5, v5, v249
 v_sub_f32 v6, v6, v249
 v_sub_f32 v7, v7, v249
 v_sub_f32 v8, v8, v249
 v_sub_f32 v9, v9, v249
 v_sub_f32 v10, v10, v249
 v_sub_f32 v11, v11, v249
 v_sub_f32 v12, v12, v249
 v_sub_f32 v13, v13, v249
 v_sub_f32 v14, v14, v249
 v_sub_f32 v15, v15, v249
 v_exp_f32 v0, v0
 v_exp_f32 v1, v1
 v_exp_f32 v2, v2
 v_exp_f32 v3, v3
 v_exp_f32 v4, v4
 v_exp_f32 v5, v5
 v_exp_f32 v6, v6
 v_exp_f32 v7, v7
 v_exp_f32 v8, v8
 v_exp_f32 v9, v9
 v_exp_f32 v10, v10
 v_exp_f32 v11, v11
 v_exp_f32 v12, v12
 v_exp_f32 v13, v13
 v_exp_f32 v14, v14
 v_exp_f32 v15, v15
 v_cvt_pk_bf16_f32 v0, v0, v1
 v_cvt_pk_bf16_f32 v1, v2, v3
 v_cvt_pk_bf16_f32 v2, v4, v5
 v_cvt_pk_bf16_f32 v3, v6, v7
 v_cvt_pk_bf16_f32 v4, v8, v9
 v_cvt_pk_bf16_f32 v5, v10, v11
 v_cvt_pk_bf16_f32 v6, v12, v13
 v_cvt_pk_bf16_f32 v7, v14, v15
 v_mfma_f32_32x32x16_bf16 v[32:47], v[160:163], v[0:3], v[32:47]
 s_nop 0
 v_mfma_f32_32x32x16_bf16 v[32:47], v[164:167], v[4:7], v[32:47]
 s_nop 7
L_sk_75:
 s_cmp_lt_u32 s59, 4
 s_cbranch_scc1 L_sk_76
 s_mov_b64 exec, s[94:95]
 ds_read_b128 v[160:163], v240 offset:12288
 ds_read_b128 v[164:167], v240 offset:13568
 s_mov_b64 exec, -1
 ds_read_b128 v[168:171], v241 offset:4096
 ds_read_b128 v[172:175], v241 offset:16384
 s_waitcnt lgkmcnt(0)
 v_mfma_f32_32x32x16_bf16 v[0:15], v[168:171], v[144:147], 0
 v_mfma_f32_32x32x16_bf16 v[0:15], v[172:175], v[148:151], v[0:15]
 s_nop 11
 v_sub_f32 v0, v0, v249
 v_sub_f32 v1, v1, v249
 v_sub_f32 v2, v2, v249
 v_sub_f32 v3, v3, v249
 v_sub_f32 v4, v4, v249
 v_sub_f32 v5, v5, v249
 v_sub_f32 v6, v6, v249
 v_sub_f32 v7, v7, v249
 v_sub_f32 v8, v8, v249
 v_sub_f32 v9, v9, v249
 v_sub_f32 v10, v10, v249
 v_sub_f32 v11, v11, v249
 v_sub_f32 v12, v12, v249
 v_sub_f32 v13, v13, v249
 v_sub_f32 v14, v14, v249
 v_sub_f32 v15, v15, v249
 v_exp_f32 v0, v0
 v_exp_f32 v1, v1
 v_exp_f32 v2, v2
 v_exp_f32 v3, v3
 v_exp_f32 v4, v4
 v_exp_f32 v5, v5
 v_exp_f32 v6, v6
 v_exp_f32 v7, v7
 v_exp_f32 v8, v8
 v_exp_f32 v9, v9
 v_exp_f32 v10, v10
 v_exp_f32 v11, v11
 v_exp_f32 v12, v12
 v_exp_f32 v13, v13
 v_exp_f32 v14, v14
 v_exp_f32 v15, v15
 v_cvt_pk_bf16_f32 v0, v0, v1
 v_cvt_pk_bf16_f32 v1, v2, v3
 v_cvt_pk_bf16_f32 v2, v4, v5
 v_cvt_pk_bf16_f32 v3, v6, v7
 v_cvt_pk_bf16_f32 v4, v8, v9
 v_cvt_pk_bf16_f32 v5, v10, v11
 v_cvt_pk_bf16_f32 v6, v12, v13
 v_cvt_pk_bf16_f32 v7, v14, v15
 v_mfma_f32_32x32x16_bf16 v[32:47], v[160:163], v[0:3], v[32:47]
 s_nop 0
 v_mfma_f32_32x32x16_bf16 v[32:47], v[164:167], v[4:7], v[32:47]
 s_nop 7
L_sk_76:
 s_cmp_lt_u32 s59, 3
 s_cbranch_scc1 L_sk_77
 s_mov_b64 exec, s[94:95]
 ds_read_b128 v[160:163], v240 offset:15360
 ds_read_b128 v[164:167], v240 offset:16640
 s_mov_b64 exec, -1
 ds_read_b128 v[168:171], v241 offset:5120
 ds_read_b128 v[172:175], v241 offset:17408
 s_waitcnt lgkmcnt(0)
 v_mfma_f32_32x32x16_bf16 v[0:15], v[168:171], v[144:147], 0
 v_mfma_f32_32x32x16_bf16 v[0:15], v[172:175], v[148:151], v[0:15]
 s_nop 11
 v_sub_f32 v0, v0, v249
 v_sub_f32 v1, v1, v249
 v_sub_f32 v2, v2, v249
 v_sub_f32 v3, v3, v249
 v_sub_f32 v4, v4, v249
 v_sub_f32 v5, v5, v249
 v_sub_f32 v6, v6, v249
 v_sub_f32 v7, v7, v249
 v_sub_f32 v8, v8, v249
 v_sub_f32 v9, v9, v249
 v_sub_f32 v10, v10, v249
 v_sub_f32 v11, v11, v249
 v_sub_f32 v12, v12, v249
 v_sub_f32 v13, v13, v249
 v_sub_f32 v14, v14, v249
 v_sub_f32 v15, v15, v249
 v_exp_f32 v0, v0
 v_exp_f32 v1, v1
 v_exp_f32 v2, v2
 v_exp_f32 v3, v3
 v_exp_f32 v4, v4
 v_exp_f32 v5, v5
 v_exp_f32 v6, v6
 v_exp_f32 v7, v7
 v_exp_f32 v8, v8
 v_exp_f32 v9, v9
 v_exp_f32 v10, v10
 v_exp_f32 v11, v11
 v_exp_f32 v12, v12
 v_exp_f32 v13, v13
 v_exp_f32 v14, v14
 v_exp_f32 v15, v15
 v_cvt_pk_bf16_f32 v0, v0, v1
 v_cvt_pk_bf16_f32 v1, v2, v3
 v_cvt_pk_bf16_f32 v2, v4, v5
 v_cvt_pk_bf16_f32 v3, v6, v7
 v_cvt_pk_bf16_f32 v4, v8, v9
 v_cvt_pk_bf16_f32 v5, v10, v11
 v_cvt_pk_bf16_f32 v6, v12, v13
 v_cvt_pk_bf16_f32 v7, v14, v15
 v_mfma_f32_32x32x16_bf16 v[32:47], v[160:163], v[0:3], v[32:47]
 s_nop 0
 v_mfma_f32_32x32x16_bf16 v[32:47], v[164:167], v[4:7], v[32:47]
 s_nop 7
L_sk_77:
 s_cmp_lt_u32 s59, 2
 s_cbranch_scc1 L_sk_78
 s_mov_b64 exec, s[94:95]
 ds_read_b128 v[160:163], v240 offset:18432
 ds_read_b128 v[164:167], v240 offset:19712
 s_mov_b64 exec, -1
 ds_read_b128 v[168:171], v241 offset:6144
 ds_read_b128 v[172:175], v241 offset:18432
 s_waitcnt lgkmcnt(0)
 v_mfma_f32_32x32x16_bf16 v[0:15], v[168:171], v[144:147], 0
 v_mfma_f32_32x32x16_bf16 v[0:15], v[172:175], v[148:151], v[0:15]
 s_nop 11
 v_sub_f32 v0, v0, v249
 v_sub_f32 v1, v1, v249
 v_sub_f32 v2, v2, v249
 v_sub_f32 v3, v3, v249
 v_sub_f32 v4, v4, v249
 v_sub_f32 v5, v5, v249
 v_sub_f32 v6, v6, v249
 v_sub_f32 v7, v7, v249
 v_sub_f32 v8, v8, v249
 v_sub_f32 v9, v9, v249
 v_sub_f32 v10, v10, v249
 v_sub_f32 v11, v11, v249
 v_sub_f32 v12, v12, v249
 v_sub_f32 v13, v13, v249
 v_sub_f32 v14, v14, v249
 v_sub_f32 v15, v15, v249
 v_exp_f32 v0, v0
 v_exp_f32 v1, v1
 v_exp_f32 v2, v2
 v_exp_f32 v3, v3
 v_exp_f32 v4, v4
 v_exp_f32 v5, v5
 v_exp_f32 v6, v6
 v_exp_f32 v7, v7
 v_exp_f32 v8, v8
 v_exp_f32 v9, v9
 v_exp_f32 v10, v10
 v_exp_f32 v11, v11
 v_exp_f32 v12, v12
 v_exp_f32 v13, v13
 v_exp_f32 v14, v14
 v_exp_f32 v15, v15
 v_cvt_pk_bf16_f32 v0, v0, v1
 v_cvt_pk_bf16_f32 v1, v2, v3
 v_cvt_pk_bf16_f32 v2, v4, v5
 v_cvt_pk_bf16_f32 v3, v6, v7
 v_cvt_pk_bf16_f32 v4, v8, v9
 v_cvt_pk_bf16_f32 v5, v10, v11
 v_cvt_pk_bf16_f32 v6, v12, v13
 v_cvt_pk_bf16_f32 v7, v14, v15
 v_mfma_f32_32x32x16_bf16 v[32:47], v[160:163], v[0:3], v[32:47]
 s_nop 0
 v_mfma_f32_32x32x16_bf16 v[32:47], v[164:167], v[4:7], v[32:47]
 s_nop 7
L_sk_78:
 s_cmp_lt_u32 s59, 1
 s_cbranch_scc1 L_sk_79
 s_mov_b64 exec, s[94:95]
 ds_read_b128 v[160:163], v240 offset:21504
 ds_read_b128 v[164:167], v240 offset:22784
 s_mov_b64 exec, -1
 ds_read_b128 v[168:171], v241 offset:7168
 ds_read_b128 v[172:175], v241 offset:19456
 s_waitcnt lgkmcnt(0)
 v_mfma_f32_32x32x16_bf16 v[0:15], v[168:171], v[144:147], 0
 v_mfma_f32_32x32x16_bf16 v[0:15], v[172:175], v[148:151], v[0:15]
 s_nop 11
 v_sub_f32 v0, v0, v249
 v_sub_f32 v1, v1, v249
 v_sub_f32 v2, v2, v249
 v_sub_f32 v3, v3, v249
 v_sub_f32 v4, v4, v249
 v_sub_f32 v5, v5, v249
 v_sub_f32 v6, v6, v249
 v_sub_f32 v7, v7, v249
 v_sub_f32 v8, v8, v249
 v_sub_f32 v9, v9, v249
 v_sub_f32 v10, v10, v249
 v_sub_f32 v11, v11, v249
 v_sub_f32 v12, v12, v249
 v_sub_f32 v13, v13, v249
 v_sub_f32 v14, v14, v249
 v_sub_f32 v15, v15, v249
 v_exp_f32 v0, v0
 v_exp_f32 v1, v1
 v_exp_f32 v2, v2
 v_exp_f32 v3, v3
 v_exp_f32 v4, v4
 v_exp_f32 v5, v5
 v_exp_f32 v6, v6
 v_exp_f32 v7, v7
 v_exp_f32 v8, v8
 v_exp_f32 v9, v9
 v_exp_f32 v10, v10
 v_exp_f32 v11, v11
 v_exp_f32 v12, v12
 v_exp_f32 v13, v13
 v_exp_f32 v14, v14
 v_exp_f32 v15, v15
 v_cvt_pk_bf16_f32 v0, v0, v1
 v_cvt_pk_bf16_f32 v1, v2, v3
 v_cvt_pk_bf16_f32 v2, v4, v5
 v_cvt_pk_bf16_f32 v3, v6, v7
 v_cvt_pk_bf16_f32 v4, v8, v9
 v_cvt_pk_bf16_f32 v5, v10, v11
 v_cvt_pk_bf16_f32 v6, v12, v13
 v_cvt_pk_bf16_f32 v7, v14, v15
 v_mfma_f32_32x32x16_bf16 v[32:47], v[160:163], v[0:3], v[32:47]
 s_nop 0
 v_mfma_f32_32x32x16_bf16 v[32:47], v[164:167], v[4:7], v[32:47]
 s_nop 7
L_sk_79:
 s_mov_b64 exec, s[94:95]
 ds_read_b128 v[160:163], v240 offset:24576
 ds_read_b128 v[164:167], v240 offset:25856
 s_mov_b64 exec, -1
 ds_read_b128 v[168:171], v241 offset:8192
 ds_read_b128 v[172:175], v241 offset:20480
 s_waitcnt lgkmcnt(0)
 v_mfma_f32_32x32x16_bf16 v[0:15], v[168:171], v[144:147], v[192:207]
 v_mfma_f32_32x32x16_bf16 v[0:15], v[172:175], v[148:151], v[0:15]
 s_nop 11
 v_sub_f32 v0, v0, v249
 v_sub_f32 v1, v1, v249
 v_sub_f32 v2, v2, v249
 v_sub_f32 v3, v3, v249
 v_sub_f32 v4, v4, v249
 v_sub_f32 v5, v5, v249
 v_sub_f32 v6, v6, v249
 v_sub_f32 v7, v7, v249
 v_sub_f32 v8, v8, v249
 v_sub_f32 v9, v9, v249
 v_sub_f32 v10, v10, v249
 v_sub_f32 v11, v11, v249
 v_sub_f32 v12, v12, v249
 v_sub_f32 v13, v13, v249
 v_sub_f32 v14, v14, v249
 v_sub_f32 v15, v15, v249
 v_exp_f32 v0, v0
 v_exp_f32 v1, v1
 v_exp_f32 v2, v2
 v_exp_f32 v3, v3
 v_exp_f32 v4, v4
 v_exp_f32 v5, v5
 v_exp_f32 v6, v6
 v_exp_f32 v7, v7
 v_exp_f32 v8, v8
 v_exp_f32 v9, v9
 v_exp_f32 v10, v10
 v_exp_f32 v11, v11
 v_exp_f32 v12, v12
 v_exp_f32 v13, v13
 v_exp_f32 v14, v14
 v_exp_f32 v15, v15
 v_cvt_pk_bf16_f32 v0, v0, v1
 v_cvt_pk_bf16_f32 v1, v2, v3
 v_cvt_pk_bf16_f32 v2, v4, v5
 v_cvt_pk_bf16_f32 v3, v6, v7
 v_cvt_pk_bf16_f32 v4, v8, v9
 v_cvt_pk_bf16_f32 v5, v10, v11
 v_cvt_pk_bf16_f32 v6, v12, v13
 v_cvt_pk_bf16_f32 v7, v14, v15
 v_mfma_f32_32x32x16_bf16 v[32:47], v[160:163], v[0:3], v[32:47]
 s_nop 0
 v_mfma_f32_32x32x16_bf16 v[32:47], v[164:167], v[4:7], v[32:47]
 s_nop 7
L_sk_80:
 s_nop 15
 s_branch L_slow_ok_14
L_slow_15:
 s_nop 15
 v_mov_b32 v249, 0xff800000
 v_mov_b32 v48, 0
 v_mov_b32 v49, 0
 v_mov_b32 v50, 0
 v_mov_b32 v51, 0
 v_mov_b32 v52, 0
 v_mov_b32 v53, 0
 v_mov_b32 v54, 0
 v_mov_b32 v55, 0
 v_mov_b32 v56, 0
 v_mov_b32 v57, 0
 v_mov_b32 v58, 0
 v_mov_b32 v59, 0
 v_mov_b32 v60, 0
 v_mov_b32 v61, 0
 v_mov_b32 v62, 0
 v_mov_b32 v63, 0
 s_cmp_lt_u32 s59, 8
 s_cbranch_scc1 L_sk_81
 ds_read_b128 v[168:171], v241 offset:12288
 ds_read_b128 v[172:175], v241 offset:24576
 s_waitcnt lgkmcnt(0)
 v_mfma_f32_32x32x16_bf16 v[0:15], v[168:171], v[152:155], v[208:223]
 v_mfma_f32_32x32x16_bf16 v[0:15], v[172:175], v[156:159], v[0:15]
 s_nop 11
 v_max3_f32 v249, v249, v0, v1
 v_max3_f32 v249, v249, v2, v3
 v_max3_f32 v249, v249, v4, v5
 v_max3_f32 v249, v249, v6, v7
 v_max3_f32 v249, v249, v8, v9
 v_max3_f32 v249, v249, v10, v11
 v_max3_f32 v249, v249, v12, v13
 v_max3_f32 v249, v249, v14, v15
L_sk_81:
 s_cmp_lt_u32 s59, 7
 s_cbranch_scc1 L_sk_82
 ds_read_b128 v[168:171], v241 offset:13312
 ds_read_b128 v[172:175], v241 offset:25600
 s_waitcnt lgkmcnt(0)
 v_mfma_f32_32x32x16_bf16 v[0:15], v[168:171], v[152:155], 0
 v_mfma_f32_32x32x16_bf16 v[0:15], v[172:175], v[156:159], v[0:15]
 s_nop 11
 v_max3_f32 v249, v249, v0, v1
 v_max3_f32 v249, v249, v2, v3
 v_max3_f32 v249, v249, v4, v5
 v_max3_f32 v249, v249, v6, v7
 v_max3_f32 v249, v249, v8, v9
 v_max3_f32 v249, v249, v10, v11
 v_max3_f32 v249, v249, v12, v13
 v_max3_f32 v249, v249, v14, v15
L_sk_82:
 s_cmp_lt_u32 s59, 6
 s_cbranch_scc1 L_sk_83
 ds_read_b128 v[168:171], v241 offset:14336
 ds_read_b128 v[172:175], v241 offset:26624
 s_waitcnt lgkmcnt(0)
 v_mfma_f32_32x32x16_bf16 v[0:15], v[168:171], v[152:155], 0
 v_mfma_f32_32x32x16_bf16 v[0:15], v[172:175], v[156:159], v[0:15]
 s_nop 11
 v_max3_f32 v249, v249, v0, v1
 v_max3_f32 v249, v249, v2, v3
 v_max3_f32 v249, v249, v4, v5
 v_max3_f32 v249, v249, v6, v7
 v_max3_f32 v249, v249, v8, v9
 v_max3_f32 v249, v249, v10, v11
 v_max3_f32 v249, v249, v12, v13
 v_max3_f32 v249, v249, v14, v15
L_sk_83:
 s_cmp_lt_u32 s59, 5
 s_cbranch_scc1 L_sk_84
 ds_read_b128 v[168:171], v241 offset:15360
 ds_read_b128 v[172:175], v241 offset:27648
 s_waitcnt lgkmcnt(0)
 v_mfma_f32_32x32x16_bf16 v[0:15], v[168:171], v[152:155], 0
 v_mfma_f32_32x32x16_bf16 v[0:15], v[172:175], v[156:159], v[0:15]
 s_nop 11
 v_max3_f32 v249, v249, v0, v1
 v_max3_f32 v249, v249, v2, v3
 v_max3_f32 v249, v249, v4, v5
 v_max3_f32 v249, v249, v6, v7
 v_max3_f32 v249, v249, v8, v9
 v_max3_f32 v249, v249, v10, v11
 v_max3_f32 v249, v249, v12, v13
 v_max3_f32 v249, v249, v14, v15
L_sk_84:
 s_cmp_lt_u32 s59, 4
 s_cbranch_scc1 L_sk_85
 ds_read_b128 v[168:171], v241 offset:16384
 ds_read_b128 v[172:175], v241 offset:28672
 s_waitcnt lgkmcnt(0)
 v_mfma_f32_32x32x16_bf16 v[0:15], v[168:171], v[152:155], 0
 v_mfma_f32_32x32x16_bf16 v[0:15], v[172:175], v[156:159], v[0:15]
 s_nop 11
 v_max3_f32 v249, v249, v0, v1
 v_max3_f32 v249, v249, v2, v3
 v_max3_f32 v249, v249, v4, v5
 v_max3_f32 v249, v249, v6, v7
 v_max3_f32 v249, v249, v8, v9
 v_max3_f32 v249, v249, v10, v11
 v_max3_f32 v249, v249, v12, v13
 v_max3_f32 v249, v249, v14, v15
L_sk_85:
 s_cmp_lt_u32 s59, 3
 s_cbranch_scc1 L_sk_86
 ds_read_b128 v[168:171], v241 offset:17408
 ds_read_b128 v[172:175], v241 offset:29696
 s_waitcnt lgkmcnt(0)
 v_mfma_f32_32x32x16_bf16 v[0:15], v[168:171], v[152:155], 0
 v_mfma_f32_32x32x16_bf16 v[0:15], v[172:175], v[156:159], v[0:15]
 s_nop 11
 v_max3_f32 v249, v249, v0, v1
 v_max3_f32 v249, v249, v2, v3
 v_max3_f32 v249, v249, v4, v5
 v_max3_f32 v249, v249, v6, v7
 v_max3_f32 v249, v249, v8, v9
 v_max3_f32 v249, v249, v10, v11
 v_max3_f32 v249, v249, v12, v13
 v_max3_f32 v249, v249, v14, v15
L_sk_86:
 s_cmp_lt_u32 s59, 2
 s_cbranch_scc1 L_sk_87
 ds_read_b128 v[168:171], v241 offset:18432
 ds_read_b128 v[172:175], v241 offset:30720
 s_waitcnt lgkmcnt(0)
 v_mfma_f32_32x32x16_bf16 v[0:15], v[168:171], v[152:155], 0
 v_mfma_f32_32x32x16_bf16 v[0:15], v[172:175], v[156:159], v[0:15]
 s_nop 11
 v_max3_f32 v249, v249, v0, v1
 v_max3_f32 v249, v249, v2, v3
 v_max3_f32 v249, v249, v4, v5
 v_max3_f32 v249, v249, v6, v7
 v_max3_f32 v249, v249, v8, v9
 v_max3_f32 v249, v249, v10, v11
 v_max3_f32 v249, v249, v12, v13
 v_max3_f32 v249, v249, v14, v15
L_sk_87:
 s_cmp_lt_u32 s59, 1
 s_cbranch_scc1 L_sk_88
 ds_read_b128 v[168:171], v241 offset:19456
 ds_read_b128 v[172:175], v241 offset:31744
 s_waitcnt lgkmcnt(0)
 v_mfma_f32_32x32x16_bf16 v[0:15], v[168:171], v[152:155], 0
 v_mfma_f32_32x32x16_bf16 v[0:15], v[172:175], v[156:159], v[0:15]
 s_nop 11
 v_max3_f32 v249, v249, v0, v1
 v_max3_f32 v249, v249, v2, v3
 v_max3_f32 v249, v249, v4, v5
 v_max3_f32 v249, v249, v6, v7
 v_max3_f32 v249, v249, v8, v9
 v_max3_f32 v249, v249, v10, v11
 v_max3_f32 v249, v249, v12, v13
 v_max3_f32 v249, v249, v14, v15
L_sk_88:
 ds_read_b128 v[168:171], v241 offset:20480
 ds_read_b128 v[172:175], v241 offset:32768
 s_waitcnt lgkmcnt(0)
 v_mfma_f32_32x32x16_bf16 v[0:15], v[168:171], v[152:155], v[192:207]
 v_mfma_f32_32x32x16_bf16 v[0:15], v[172:175], v[156:159], v[0:15]
 s_nop 11
 v_max3_f32 v249, v249, v0, v1
 v_max3_f32 v249, v249, v2, v3
 v_max3_f32 v249, v249, v4, v5
 v_max3_f32 v249, v249, v6, v7
 v_max3_f32 v249, v249, v8, v9
 v_max3_f32 v249, v249, v10, v11
 v_max3_f32 v249, v249, v12, v13
 v_max3_f32 v249, v249, v14, v15
L_sk_89:
 v_mov_b32 v248, v249
 s_nop 1
 v_permlane32_swap_b32 v248, v249
 s_nop 1
 v_max_f32 v249, v248, v249
 s_cmp_lt_u32 s59, 8
 s_cbranch_scc1 L_sk_90
 s_mov_b64 exec, s[94:95]
 ds_read_b128 v[160:163], v240 offset:320
 ds_read_b128 v[164:167], v240 offset:1600
 s_mov_b64 exec, -1
 ds_read_b128 v[168:171], v241 offset:12288
 ds_read_b128 v[172:175], v241 offset:24576
 s_waitcnt lgkmcnt(0)
 v_mfma_f32_32x32x16_bf16 v[0:15], v[168:171], v[152:155], v[208:223]
 v_mfma_f32_32x32x16_bf16 v[0:15], v[172:175], v[156:159], v[0:15]
 s_nop 11
 v_sub_f32 v0, v0, v249
 v_sub_f32 v1, v1, v249
 v_sub_f32 v2, v2, v249
 v_sub_f32 v3, v3, v249
 v_sub_f32 v4, v4, v249
 v_sub_f32 v5, v5, v249
 v_sub_f32 v6, v6, v249
 v_sub_f32 v7, v7, v249
 v_sub_f32 v8, v8, v249
 v_sub_f32 v9, v9, v249
 v_sub_f32 v10, v10, v249
 v_sub_f32 v11, v11, v249
 v_sub_f32 v12, v12, v249
 v_sub_f32 v13, v13, v249
 v_sub_f32 v14, v14, v249
 v_sub_f32 v15, v15, v249
 v_exp_f32 v0, v0
 v_exp_f32 v1, v1
 v_exp_f32 v2, v2
 v_exp_f32 v3, v3
 v_exp_f32 v4, v4
 v_exp_f32 v5, v5
 v_exp_f32 v6, v6
 v_exp_f32 v7, v7
 v_exp_f32 v8, v8
 v_exp_f32 v9, v9
 v_exp_f32 v10, v10
 v_exp_f32 v11, v11
 v_exp_f32 v12, v12
 v_exp_f32 v13, v13
 v_exp_f32 v14, v14
 v_exp_f32 v15, v15
 v_cvt_pk_bf16_f32 v0, v0, v1
 v_cvt_pk_bf16_f32 v1, v2, v3
 v_cvt_pk_bf16_f32 v2, v4, v5
 v_cvt_pk_bf16_f32 v3, v6, v7
 v_cvt_pk_bf16_f32 v4, v8, v9
 v_cvt_pk_bf16_f32 v5, v10, v11
 v_cvt_pk_bf16_f32 v6, v12, v13
 v_cvt_pk_bf16_f32 v7, v14, v15
 v_mfma_f32_32x32x16_bf16 v[48:63], v[160:163], v[0:3], v[48:63]
 s_nop 0
 v_mfma_f32_32x32x16_bf16 v[48:63], v[164:167], v[4:7], v[48:63]
 s_nop 7
L_sk_90:
 s_cmp_lt_u32 s59, 7
 s_cbranch_scc1 L_sk_91
 s_mov_b64 exec, s[94:95]
 ds_read_b128 v[160:163], v240 offset:3392
 ds_read_b128 v[164:167], v240 offset:4672
 s_mov_b64 exec, -1
 ds_read_b128 v[168:171], v241 offset:13312
 ds_read_b128 v[172:175], v241 offset:25600
 s_waitcnt lgkmcnt(0)
 v_mfma_f32_32x32x16_bf16 v[0:15], v[168:171], v[152:155], 0
 v_mfma_f32_32x32x16_bf16 v[0:15], v[172:175], v[156:159], v[0:15]
 s_nop 11
 v_sub_f32 v0, v0, v249
 v_sub_f32 v1, v1, v249
 v_sub_f32 v2, v2, v249
 v_sub_f32 v3, v3, v249
 v_sub_f32 v4, v4, v249
 v_sub_f32 v5, v5, v249
 v_sub_f32 v6, v6, v249
 v_sub_f32 v7, v7, v249
 v_sub_f32 v8, v8, v249
 v_sub_f32 v9, v9, v249
 v_sub_f32 v10, v10, v249
 v_sub_f32 v11, v11, v249
 v_sub_f32 v12, v12, v249
 v_sub_f32 v13, v13, v249
 v_sub_f32 v14, v14, v249
 v_sub_f32 v15, v15, v249
 v_exp_f32 v0, v0
 v_exp_f32 v1, v1
 v_exp_f32 v2, v2
 v_exp_f32 v3, v3
 v_exp_f32 v4, v4
 v_exp_f32 v5, v5
 v_exp_f32 v6, v6
 v_exp_f32 v7, v7
 v_exp_f32 v8, v8
 v_exp_f32 v9, v9
 v_exp_f32 v10, v10
 v_exp_f32 v11, v11
 v_exp_f32 v12, v12
 v_exp_f32 v13, v13
 v_exp_f32 v14, v14
 v_exp_f32 v15, v15
 v_cvt_pk_bf16_f32 v0, v0, v1
 v_cvt_pk_bf16_f32 v1, v2, v3
 v_cvt_pk_bf16_f32 v2, v4, v5
 v_cvt_pk_bf16_f32 v3, v6, v7
 v_cvt_pk_bf16_f32 v4, v8, v9
 v_cvt_pk_bf16_f32 v5, v10, v11
 v_cvt_pk_bf16_f32 v6, v12, v13
 v_cvt_pk_bf16_f32 v7, v14, v15
 v_mfma_f32_32x32x16_bf16 v[48:63], v[160:163], v[0:3], v[48:63]
 s_nop 0
 v_mfma_f32_32x32x16_bf16 v[48:63], v[164:167], v[4:7], v[48:63]
 s_nop 7
L_sk_91:
 s_cmp_lt_u32 s59, 6
 s_cbranch_scc1 L_sk_92
 s_mov_b64 exec, s[94:95]
 ds_read_b128 v[160:163], v240 offset:6464
 ds_read_b128 v[164:167], v240 offset:7744
 s_mov_b64 exec, -1
 ds_read_b128 v[168:171], v241 offset:14336
 ds_read_b128 v[172:175], v241 offset:26624
 s_waitcnt lgkmcnt(0)
 v_mfma_f32_32x32x16_bf16 v[0:15], v[168:171], v[152:155], 0
 v_mfma_f32_32x32x16_bf16 v[0:15], v[172:175], v[156:159], v[0:15]
 s_nop 11
 v_sub_f32 v0, v0, v249
 v_sub_f32 v1, v1, v249
 v_sub_f32 v2, v2, v249
 v_sub_f32 v3, v3, v249
 v_sub_f32 v4, v4, v249
 v_sub_f32 v5, v5, v249
 v_sub_f32 v6, v6, v249
 v_sub_f32 v7, v7, v249
 v_sub_f32 v8, v8, v249
 v_sub_f32 v9, v9, v249
 v_sub_f32 v10, v10, v249
 v_sub_f32 v11, v11, v249
 v_sub_f32 v12, v12, v249
 v_sub_f32 v13, v13, v249
 v_sub_f32 v14, v14, v249
 v_sub_f32 v15, v15, v249
 v_exp_f32 v0, v0
 v_exp_f32 v1, v1
 v_exp_f32 v2, v2
 v_exp_f32 v3, v3
 v_exp_f32 v4, v4
 v_exp_f32 v5, v5
 v_exp_f32 v6, v6
 v_exp_f32 v7, v7
 v_exp_f32 v8, v8
 v_exp_f32 v9, v9
 v_exp_f32 v10, v10
 v_exp_f32 v11, v11
 v_exp_f32 v12, v12
 v_exp_f32 v13, v13
 v_exp_f32 v14, v14
 v_exp_f32 v15, v15
 v_cvt_pk_bf16_f32 v0, v0, v1
 v_cvt_pk_bf16_f32 v1, v2, v3
 v_cvt_pk_bf16_f32 v2, v4, v5
 v_cvt_pk_bf16_f32 v3, v6, v7
 v_cvt_pk_bf16_f32 v4, v8, v9
 v_cvt_pk_bf16_f32 v5, v10, v11
 v_cvt_pk_bf16_f32 v6, v12, v13
 v_cvt_pk_bf16_f32 v7, v14, v15
 v_mfma_f32_32x32x16_bf16 v[48:63], v[160:163], v[0:3], v[48:63]
 s_nop 0
 v_mfma_f32_32x32x16_bf16 v[48:63], v[164:167], v[4:7], v[48:63]
 s_nop 7
L_sk_92:
 s_cmp_lt_u32 s59, 5
 s_cbranch_scc1 L_sk_93
 s_mov_b64 exec, s[94:95]
 ds_read_b128 v[160:163], v240 offset:9536
 ds_read_b128 v[164:167], v240 offset:10816
 s_mov_b64 exec, -1
 ds_read_b128 v[168:171], v241 offset:15360
 ds_read_b128 v[172:175], v241 offset:27648
 s_waitcnt lgkmcnt(0)
 v_mfma_f32_32x32x16_bf16 v[0:15], v[168:171], v[152:155], 0
 v_mfma_f32_32x32x16_bf16 v[0:15], v[172:175], v[156:159], v[0:15]
 s_nop 11
 v_sub_f32 v0, v0, v249
 v_sub_f32 v1, v1, v249
 v_sub_f32 v2, v2, v249
 v_sub_f32 v3, v3, v249
 v_sub_f32 v4, v4, v249
 v_sub_f32 v5, v5, v249
 v_sub_f32 v6, v6, v249
 v_sub_f32 v7, v7, v249
 v_sub_f32 v8, v8, v249
 v_sub_f32 v9, v9, v249
 v_sub_f32 v10, v10, v249
 v_sub_f32 v11, v11, v249
 v_sub_f32 v12, v12, v249
 v_sub_f32 v13, v13, v249
 v_sub_f32 v14, v14, v249
 v_sub_f32 v15, v15, v249
 v_exp_f32 v0, v0
 v_exp_f32 v1, v1
 v_exp_f32 v2, v2
 v_exp_f32 v3, v3
 v_exp_f32 v4, v4
 v_exp_f32 v5, v5
 v_exp_f32 v6, v6
 v_exp_f32 v7, v7
 v_exp_f32 v8, v8
 v_exp_f32 v9, v9
 v_exp_f32 v10, v10
 v_exp_f32 v11, v11
 v_exp_f32 v12, v12
 v_exp_f32 v13, v13
 v_exp_f32 v14, v14
 v_exp_f32 v15, v15
 v_cvt_pk_bf16_f32 v0, v0, v1
 v_cvt_pk_bf16_f32 v1, v2, v3
 v_cvt_pk_bf16_f32 v2, v4, v5
 v_cvt_pk_bf16_f32 v3, v6, v7
 v_cvt_pk_bf16_f32 v4, v8, v9
 v_cvt_pk_bf16_f32 v5, v10, v11
 v_cvt_pk_bf16_f32 v6, v12, v13
 v_cvt_pk_bf16_f32 v7, v14, v15
 v_mfma_f32_32x32x16_bf16 v[48:63], v[160:163], v[0:3], v[48:63]
 s_nop 0
 v_mfma_f32_32x32x16_bf16 v[48:63], v[164:167], v[4:7], v[48:63]
 s_nop 7
L_sk_93:
 s_cmp_lt_u32 s59, 4
 s_cbranch_scc1 L_sk_94
 s_mov_b64 exec, s[94:95]
 ds_read_b128 v[160:163], v240 offset:12608
 ds_read_b128 v[164:167], v240 offset:13888
 s_mov_b64 exec, -1
 ds_read_b128 v[168:171], v241 offset:16384
 ds_read_b128 v[172:175], v241 offset:28672
 s_waitcnt lgkmcnt(0)
 v_mfma_f32_32x32x16_bf16 v[0:15], v[168:171], v[152:155], 0
 v_mfma_f32_32x32x16_bf16 v[0:15], v[172:175], v[156:159], v[0:15]
 s_nop 11
 v_sub_f32 v0, v0, v249
 v_sub_f32 v1, v1, v249
 v_sub_f32 v2, v2, v249
 v_sub_f32 v3, v3, v249
 v_sub_f32 v4, v4, v249
 v_sub_f32 v5, v5, v249
 v_sub_f32 v6, v6, v249
 v_sub_f32 v7, v7, v249
 v_sub_f32 v8, v8, v249
 v_sub_f32 v9, v9, v249
 v_sub_f32 v10, v10, v249
 v_sub_f32 v11, v11, v249
 v_sub_f32 v12, v12, v249
 v_sub_f32 v13, v13, v249
 v_sub_f32 v14, v14, v249
 v_sub_f32 v15, v15, v249
 v_exp_f32 v0, v0
 v_exp_f32 v1, v1
 v_exp_f32 v2, v2
 v_exp_f32 v3, v3
 v_exp_f32 v4, v4
 v_exp_f32 v5, v5
 v_exp_f32 v6, v6
 v_exp_f32 v7, v7
 v_exp_f32 v8, v8
 v_exp_f32 v9, v9
 v_exp_f32 v10, v10
 v_exp_f32 v11, v11
 v_exp_f32 v12, v12
 v_exp_f32 v13, v13
 v_exp_f32 v14, v14
 v_exp_f32 v15, v15
 v_cvt_pk_bf16_f32 v0, v0, v1
 v_cvt_pk_bf16_f32 v1, v2, v3
 v_cvt_pk_bf16_f32 v2, v4, v5
 v_cvt_pk_bf16_f32 v3, v6, v7
 v_cvt_pk_bf16_f32 v4, v8, v9
 v_cvt_pk_bf16_f32 v5, v10, v11
 v_cvt_pk_bf16_f32 v6, v12, v13
 v_cvt_pk_bf16_f32 v7, v14, v15
 v_mfma_f32_32x32x16_bf16 v[48:63], v[160:163], v[0:3], v[48:63]
 s_nop 0
 v_mfma_f32_32x32x16_bf16 v[48:63], v[164:167], v[4:7], v[48:63]
 s_nop 7
L_sk_94:
 s_cmp_lt_u32 s59, 3
 s_cbranch_scc1 L_sk_95
 s_mov_b64 exec, s[94:95]
 ds_read_b128 v[160:163], v240 offset:15680
 ds_read_b128 v[164:167], v240 offset:16960
 s_mov_b64 exec, -1
 ds_read_b128 v[168:171], v241 offset:17408
 ds_read_b128 v[172:175], v241 offset:29696
 s_waitcnt lgkmcnt(0)
 v_mfma_f32_32x32x16_bf16 v[0:15], v[168:171], v[152:155], 0
 v_mfma_f32_32x32x16_bf16 v[0:15], v[172:175], v[156:159], v[0:15]
 s_nop 11
 v_sub_f32 v0, v0, v249
 v_sub_f32 v1, v1, v249
 v_sub_f32 v2, v2, v249
 v_sub_f32 v3, v3, v249
 v_sub_f32 v4, v4, v249
 v_sub_f32 v5, v5, v249
 v_sub_f32 v6, v6, v249
 v_sub_f32 v7, v7, v249
 v_sub_f32 v8, v8, v249
 v_sub_f32 v9, v9, v249
 v_sub_f32 v10, v10, v249
 v_sub_f32 v11, v11, v249
 v_sub_f32 v12, v12, v249
 v_sub_f32 v13, v13, v249
 v_sub_f32 v14, v14, v249
 v_sub_f32 v15, v15, v249
 v_exp_f32 v0, v0
 v_exp_f32 v1, v1
 v_exp_f32 v2, v2
 v_exp_f32 v3, v3
 v_exp_f32 v4, v4
 v_exp_f32 v5, v5
 v_exp_f32 v6, v6
 v_exp_f32 v7, v7
 v_exp_f32 v8, v8
 v_exp_f32 v9, v9
 v_exp_f32 v10, v10
 v_exp_f32 v11, v11
 v_exp_f32 v12, v12
 v_exp_f32 v13, v13
 v_exp_f32 v14, v14
 v_exp_f32 v15, v15
 v_cvt_pk_bf16_f32 v0, v0, v1
 v_cvt_pk_bf16_f32 v1, v2, v3
 v_cvt_pk_bf16_f32 v2, v4, v5
 v_cvt_pk_bf16_f32 v3, v6, v7
 v_cvt_pk_bf16_f32 v4, v8, v9
 v_cvt_pk_bf16_f32 v5, v10, v11
 v_cvt_pk_bf16_f32 v6, v12, v13
 v_cvt_pk_bf16_f32 v7, v14, v15
 v_mfma_f32_32x32x16_bf16 v[48:63], v[160:163], v[0:3], v[48:63]
 s_nop 0
 v_mfma_f32_32x32x16_bf16 v[48:63], v[164:167], v[4:7], v[48:63]
 s_nop 7
L_sk_95:
 s_cmp_lt_u32 s59, 2
 s_cbranch_scc1 L_sk_96
 s_mov_b64 exec, s[94:95]
 ds_read_b128 v[160:163], v240 offset:18752
 ds_read_b128 v[164:167], v240 offset:20032
 s_mov_b64 exec, -1
 ds_read_b128 v[168:171], v241 offset:18432
 ds_read_b128 v[172:175], v241 offset:30720
 s_waitcnt lgkmcnt(0)
 v_mfma_f32_32x32x16_bf16 v[0:15], v[168:171], v[152:155], 0
 v_mfma_f32_32x32x16_bf16 v[0:15], v[172:175], v[156:159], v[0:15]
 s_nop 11
 v_sub_f32 v0, v0, v249
 v_sub_f32 v1, v1, v249
 v_sub_f32 v2, v2, v249
 v_sub_f32 v3, v3, v249
 v_sub_f32 v4, v4, v249
 v_sub_f32 v5, v5, v249
 v_sub_f32 v6, v6, v249
 v_sub_f32 v7, v7, v249
 v_sub_f32 v8, v8, v249
 v_sub_f32 v9, v9, v249
 v_sub_f32 v10, v10, v249
 v_sub_f32 v11, v11, v249
 v_sub_f32 v12, v12, v249
 v_sub_f32 v13, v13, v249
 v_sub_f32 v14, v14, v249
 v_sub_f32 v15, v15, v249
 v_exp_f32 v0, v0
 v_exp_f32 v1, v1
 v_exp_f32 v2, v2
 v_exp_f32 v3, v3
 v_exp_f32 v4, v4
 v_exp_f32 v5, v5
 v_exp_f32 v6, v6
 v_exp_f32 v7, v7
 v_exp_f32 v8, v8
 v_exp_f32 v9, v9
 v_exp_f32 v10, v10
 v_exp_f32 v11, v11
 v_exp_f32 v12, v12
 v_exp_f32 v13, v13
 v_exp_f32 v14, v14
 v_exp_f32 v15, v15
 v_cvt_pk_bf16_f32 v0, v0, v1
 v_cvt_pk_bf16_f32 v1, v2, v3
 v_cvt_pk_bf16_f32 v2, v4, v5
 v_cvt_pk_bf16_f32 v3, v6, v7
 v_cvt_pk_bf16_f32 v4, v8, v9
 v_cvt_pk_bf16_f32 v5, v10, v11
 v_cvt_pk_bf16_f32 v6, v12, v13
 v_cvt_pk_bf16_f32 v7, v14, v15
 v_mfma_f32_32x32x16_bf16 v[48:63], v[160:163], v[0:3], v[48:63]
 s_nop 0
 v_mfma_f32_32x32x16_bf16 v[48:63], v[164:167], v[4:7], v[48:63]
 s_nop 7
L_sk_96:
 s_cmp_lt_u32 s59, 1
 s_cbranch_scc1 L_sk_97
 s_mov_b64 exec, s[94:95]
 ds_read_b128 v[160:163], v240 offset:21824
 ds_read_b128 v[164:167], v240 offset:23104
 s_mov_b64 exec, -1
 ds_read_b128 v[168:171], v241 offset:19456
 ds_read_b128 v[172:175], v241 offset:31744
 s_waitcnt lgkmcnt(0)
 v_mfma_f32_32x32x16_bf16 v[0:15], v[168:171], v[152:155], 0
 v_mfma_f32_32x32x16_bf16 v[0:15], v[172:175], v[156:159], v[0:15]
 s_nop 11
 v_sub_f32 v0, v0, v249
 v_sub_f32 v1, v1, v249
 v_sub_f32 v2, v2, v249
 v_sub_f32 v3, v3, v249
 v_sub_f32 v4, v4, v249
 v_sub_f32 v5, v5, v249
 v_sub_f32 v6, v6, v249
 v_sub_f32 v7, v7, v249
 v_sub_f32 v8, v8, v249
 v_sub_f32 v9, v9, v249
 v_sub_f32 v10, v10, v249
 v_sub_f32 v11, v11, v249
 v_sub_f32 v12, v12, v249
 v_sub_f32 v13, v13, v249
 v_sub_f32 v14, v14, v249
 v_sub_f32 v15, v15, v249
 v_exp_f32 v0, v0
 v_exp_f32 v1, v1
 v_exp_f32 v2, v2
 v_exp_f32 v3, v3
 v_exp_f32 v4, v4
 v_exp_f32 v5, v5
 v_exp_f32 v6, v6
 v_exp_f32 v7, v7
 v_exp_f32 v8, v8
 v_exp_f32 v9, v9
 v_exp_f32 v10, v10
 v_exp_f32 v11, v11
 v_exp_f32 v12, v12
 v_exp_f32 v13, v13
 v_exp_f32 v14, v14
 v_exp_f32 v15, v15
 v_cvt_pk_bf16_f32 v0, v0, v1
 v_cvt_pk_bf16_f32 v1, v2, v3
 v_cvt_pk_bf16_f32 v2, v4, v5
 v_cvt_pk_bf16_f32 v3, v6, v7
 v_cvt_pk_bf16_f32 v4, v8, v9
 v_cvt_pk_bf16_f32 v5, v10, v11
 v_cvt_pk_bf16_f32 v6, v12, v13
 v_cvt_pk_bf16_f32 v7, v14, v15
 v_mfma_f32_32x32x16_bf16 v[48:63], v[160:163], v[0:3], v[48:63]
 s_nop 0
 v_mfma_f32_32x32x16_bf16 v[48:63], v[164:167], v[4:7], v[48:63]
 s_nop 7
L_sk_97:
 s_mov_b64 exec, s[94:95]
 ds_read_b128 v[160:163], v240 offset:24896
 ds_read_b128 v[164:167], v240 offset:26176
 s_mov_b64 exec, -1
 ds_read_b128 v[168:171], v241 offset:20480
 ds_read_b128 v[172:175], v241 offset:32768
 s_waitcnt lgkmcnt(0)
 v_mfma_f32_32x32x16_bf16 v[0:15], v[168:171], v[152:155], v[192:207]
 v_mfma_f32_32x32x16_bf16 v[0:15], v[172:175], v[156:159], v[0:15]
 s_nop 11
 v_sub_f32 v0, v0, v249
 v_sub_f32 v1, v1, v249
 v_sub_f32 v2, v2, v249
 v_sub_f32 v3, v3, v249
 v_sub_f32 v4, v4, v249
 v_sub_f32 v5, v5, v249
 v_sub_f32 v6, v6, v249
 v_sub_f32 v7, v7, v249
 v_sub_f32 v8, v8, v249
 v_sub_f32 v9, v9, v249
 v_sub_f32 v10, v10, v249
 v_sub_f32 v11, v11, v249
 v_sub_f32 v12, v12, v249
 v_sub_f32 v13, v13, v249
 v_sub_f32 v14, v14, v249
 v_sub_f32 v15, v15, v249
 v_exp_f32 v0, v0
 v_exp_f32 v1, v1
 v_exp_f32 v2, v2
 v_exp_f32 v3, v3
 v_exp_f32 v4, v4
 v_exp_f32 v5, v5
 v_exp_f32 v6, v6
 v_exp_f32 v7, v7
 v_exp_f32 v8, v8
 v_exp_f32 v9, v9
 v_exp_f32 v10, v10
 v_exp_f32 v11, v11
 v_exp_f32 v12, v12
 v_exp_f32 v13, v13
 v_exp_f32 v14, v14
 v_exp_f32 v15, v15
 v_cvt_pk_bf16_f32 v0, v0, v1
 v_cvt_pk_bf16_f32 v1, v2, v3
 v_cvt_pk_bf16_f32 v2, v4, v5
 v_cvt_pk_bf16_f32 v3, v6, v7
 v_cvt_pk_bf16_f32 v4, v8, v9
 v_cvt_pk_bf16_f32 v5, v10, v11
 v_cvt_pk_bf16_f32 v6, v12, v13
 v_cvt_pk_bf16_f32 v7, v14, v15
 v_mfma_f32_32x32x16_bf16 v[48:63], v[160:163], v[0:3], v[48:63]
 s_nop 0
 v_mfma_f32_32x32x16_bf16 v[48:63], v[164:167], v[4:7], v[48:63]
 s_nop 7
L_sk_98:
 s_nop 15
 s_branch L_slow_ok_16
L_end:
 s_endpgm
.section .rodata,"a"
.p2align 6
.amdhsa_kernel gated_mix__sliding_block__dense_activation_relu__prompt_kernel
  .amdhsa_next_free_vgpr 512
  .amdhsa_next_free_sgpr 102
  .amdhsa_accum_offset 256
  .amdhsa_group_segment_fixed_size 0
  .amdhsa_kernarg_size 80
  .amdhsa_user_sgpr_count 2
  .amdhsa_user_sgpr_kernarg_segment_ptr 1
  .amdhsa_system_sgpr_workgroup_id_x 1
.end_amdhsa_kernel
.p2align 8
.type wave_table,@object
wave_table:
.long 0,1024,7864320,7974912,1051011932,20611072,20643840,17563648,20676608,0,82451968,0,0,67108864,67108864,67108864,67108864,67108864,67108864,14942208,14950400,7864576,7974912,7975168,7864320,17565696,20611104,20612992,20676608,20611072,0,0,14942464,14983168,14983424,14942208,17842176,20643840,20594816,0,61440,46080,30720,0,1024,0,0,0
.long 262144,263168,7868416,7979008,1051011932,20611080,20643848,18321408,67108864,0,82451968,1,1024,67108864,67108864,67108864,67108864,67108864,67108864,14983168,14991360,8003584,8003840,7892992,7893248,17637376,20611616,20613000,20678144,20611072,0,1,14993408,14993664,14952448,14952704,17867776,20644352,20594880,20480,0,66560,51200,20480,1024,0,0,0
.long 2048,3072,8085504,8196096,1051011932,20611088,20643856,19079168,67108864,10240,82452000,2,2048,67108864,67108864,2619392,67108864,67108864,5242880,15024128,15032320,8032512,7921664,7921920,8032256,17709056,20612128,20613008,20679680,20611072,0,2,15003904,14962688,14962944,15003648,17893376,20644864,20595072,40960,20480,5120,71680,40960,1024,0,0,0
.long 264192,265216,8089600,8200192,1051011932,20611096,20643864,19836928,67108864,10240,82452000,3,3072,2622464,2622464,2622464,5245440,5248000,5250560,15065088,15073280,7948288,7948544,8058880,8059136,17775616,20612384,20613016,20681216,20611072,0,3,14972928,14973184,15013888,15014144,17918976,20645376,20595136,61440,40960,25600,10240,61440,1024,0,0,0
.long 32768,33792,11403264,11513856,1051011932,20627456,20644096,17568768,20676736,40960,82451968,0,327680,67108864,67108864,67108864,67108864,67108864,67108864,14946304,14951424,7864576,7974912,7975168,7864320,19081216,20611104,20612992,20676608,20611072,0,32,14942464,14983168,14983424,14942208,19357696,20643840,20594816,512,61440,46080,30720,0,640,0,0,0
.long 294912,295936,11407360,11517952,1051011932,20627464,20644104,18326528,67108864,40960,82451968,1,328704,67108864,67108864,67108864,67108864,67108864,67108864,14987264,14992384,8003584,8003840,7892992,7893248,19152896,20611616,20613000,20678144,20611072,0,33,14993408,14993664,14952448,14952704,19383296,20644352,20594880,20992,0,66560,51200,20480,640,0,0,0
.long 34816,35840,11624448,11735040,1051011932,20627472,20644112,19084288,67108864,51200,82452000,2,329728,67108864,67108864,2947072,67108864,67108864,5570560,15028224,15033344,8032512,7921664,7921920,8032256,19224576,20612128,20613008,20679680,20611072,0,34,15003904,14962688,14962944,15003648,19408896,20644864,20595072,41472,20480,5120,71680,40960,640,0,0,0
.long 296960,297984,11628544,11739136,1051011932,20627480,20644120,19842048,67108864,51200,82452000,3,330752,2950144,2950144,2950144,5573120,5575680,5578240,15069184,15074304,7948288,7948544,8058880,8059136,19291136,20612384,20613016,20681216,20611072,0,35,14972928,14973184,15013888,15014144,19434496,20645376,20595136,61952,40960,25600,10240,61440,640,0,0,0
.long 1597440,1598464,10543104,10653696,1051011932,20623744,20644352,17573888,20676864,81920,887791104,0,655360,67108864,67108864,67108864,67108864,67108864,67108864,14952448,14960640,9634048,9744384,9744640,9633792,17565696,20619296,20612992,20676608,20611200,0,24,15597824,15638528,15638784,15597568,17842176,20652032,20598912,655360,61440,46080,30720,0,1024,0,0,0
.long 1859584,1860608,10547200,10657792,1051011932,20623752,20644360,18331648,67108864,81920,887791104,1,656384,67108864,67108864,67108864,67108864,67108864,67108864,14993408,15001600,9773056,9773312,9662464,9662720,17637376,20619808,20613000,20678144,20611200,0,25,15648768,15649024,15607808,15608064,17867776,20652544,20598976,675840,0,66560,51200,20480,1024,0,0,0
.long 1599488,1600512,10764288,10874880,1051011932,20623760,20644368,19089408,67108864,92160,887791136,2,657408,67108864,67108864,3274752,67108864,67108864,5898240,15034368,15042560,9801984,9691136,9691392,9801728,17709056,20620320,20613008,20679680,20611200,0,26,15659264,15618048,15618304,15659008,17893376,20653056,20599168,696320,20480,5120,71680,40960,1024,0,0,0
.long 1861632,1862656,10768384,10878976,1051011932,20623768,20644376,19847168,67108864,92160,887791136,3,658432,3277824,3277824,3277824,5900800,5903360,5905920,15075328,15083520,9717760,9718016,9828352,9828608,17775616,20620576,20613016,20681216,20611200,0,27,15628288,15628544,15669248,15669504,17918976,20653568,20599232,716800,40960,25600,10240,61440,1024,0,0,0
.long 1630208,1631232,14082048,14192640,1051011932,20640128,20644608,17579008,20676992,122880,887791104,0,983040,67108864,67108864,67108864,67108864,67108864,67108864,14956544,14961664,9634048,9744384,9744640,9633792,19081216,20619296,20612992,20676608,20611200,128,56,15597824,15638528,15638784,15597568,19357696,20652032,20598912,655872,61440,46080,30720,0,640,0,0,0
.long 1892352,1893376,14086144,14196736,1051011932,20640136,20644616,18336768,67108864,122880,887791104,1,984064,67108864,67108864,67108864,67108864,67108864,67108864,14997504,15002624,9773056,9773312,9662464,9662720,19152896,20619808,20613000,20678144,20611200,128,57,15648768,15649024,15607808,15608064,19383296,20652544,20598976,676352,0,66560,51200,20480,640,0,0,0
.long 1632256,1633280,14303232,14413824,1051011932,20640144,20644624,19094528,67108864,133120,887791136,2,985088,67108864,67108864,3602432,67108864,67108864,6225920,15038464,15043584,9801984,9691136,9691392,9801728,19224576,20620320,20613008,20679680,20611200,128,58,15659264,15618048,15618304,15659008,19408896,20653056,20599168,696832,20480,5120,71680,40960,640,0,0,0
.long 1894400,1895424,14307328,14417920,1051011932,20640152,20644632,19852288,67108864,133120,887791136,3,986112,3605504,3605504,3605504,6228480,6231040,6233600,15079424,15084544,9717760,9718016,9828352,9828608,19291136,20620576,20613016,20681216,20611200,128,59,15628288,15628544,15669248,15669504,19434496,20653568,20599232,717312,40960,25600,10240,61440,640,0,0,0
.long 3686400,3687424,9682944,9793536,1065353216,20620160,20644864,17584128,20677120,163840,1693130240,0,1310720,67108864,67108864,67108864,67108864,67108864,67108864,14962688,14970880,11403520,11513856,11514112,11403264,17565696,20627488,20612992,20676608,20611328,0,16,16253184,16293888,16294144,16252928,17842176,20660224,20603008,1310720,61440,46080,30720,0,1024,0,0,0
.long 3948544,3949568,9687040,9797632,1065353216,20620168,20644872,18341888,67108864,163840,1693130240,1,1311744,67108864,67108864,67108864,67108864,67108864,67108864,15003648,15011840,11542528,11542784,11431936,11432192,17637376,20628000,20613000,20678144,20611328,0,17,16304128,16304384,16263168,16263424,17867776,20660736,20603072,1331200,0,66560,51200,20480,1024,0,0,0
.long 3688448,3689472,9904128,10014720,1065353216,20620176,20644880,19099648,67108864,174080,1693130272,2,1312768,67108864,67108864,3930112,67108864,67108864,6553600,15044608,15052800,11571456,11460608,11460864,11571200,17709056,20628512,20613008,20679680,20611328,0,18,16314624,16273408,16273664,16314368,17893376,20661248,20603264,1351680,20480,5120,71680,40960,1024,0,0,0
.long 3950592,3951616,9908224,10018816,1065353216,20620184,20644888,19857408,67108864,174080,1693130272,3,1313792,3933184,3933184,3933184,6556160,6558720,6561280,15085568,15093760,11487232,11487488,11597824,11598080,17775616,20628768,20613016,20681216,20611328,0,19,16283648,16283904,16324608,16324864,17918976,20661760,20603328,1372160,40960,25600,10240,61440,1024,0,0,0
.long 3719168,3720192,13221888,13332480,1065353216,20636544,20645120,17589248,20677248,204800,1693130240,0,1638400,67108864,67108864,67108864,67108864,67108864,67108864,14966784,14971904,11403520,11513856,11514112,11403264,19081216,20627488,20612992,20676608,20611456,0,48,16253184,16293888,16294144,16252928,19357696,20660224,20603008,1311232,61440,46080,30720,0,640,0,0,0
.long 3981312,3982336,13225984,13336576,1065353216,20636552,20645128,18347008,67108864,204800,1693130240,1,1639424,67108864,67108864,67108864,67108864,67108864,67108864,15007744,15012864,11542528,11542784,11431936,11432192,19152896,20628000,20613000,20678144,20611456,0,49,16304128,16304384,16263168,16263424,19383296,20660736,20603072,1331712,0,66560,51200,20480,640,0,0,0
.long 3721216,3722240,13443072,13553664,1065353216,20636560,20645136,19104768,67108864,215040,1693130272,2,1640448,67108864,67108864,4257792,67108864,67108864,6881280,15048704,15053824,11571456,11460608,11460864,11571200,19224576,20628512,20613008,20679680,20611456,0,50,16314624,16273408,16273664,16314368,19408896,20661248,20603264,1352192,20480,5120,71680,40960,640,0,0,0
.long 3983360,3984384,13447168,13557760,1065353216,20636568,20645144,19862528,67108864,215040,1693130272,3,1641472,4260864,4260864,4260864,6883840,6886400,6888960,15089664,15094784,11487232,11487488,11597824,11598080,19291136,20628768,20613016,20681216,20611456,0,51,16283648,16283904,16324608,16324864,19434496,20661760,20603328,1372672,40960,25600,10240,61440,640,0,0,0
.long 5263360,5265920,8830976,8941568,1065353216,20616576,20645376,17594368,20677376,245760,2766904832,0,1966080,67108864,67108864,67108864,67108864,67108864,67108864,14972928,14981120,13172992,13283328,13283584,13172736,17565696,20635680,20612992,20676608,20611456,128,8,16908544,16949248,16949504,16908288,17842176,20668416,20607104,1966080,61440,46080,30720,0,1024,0,0,0
.long 5263360,5265920,8835072,8945664,1065353216,20616584,20645384,18352128,67108864,245760,2766904832,1,1967104,67108864,67108864,67108864,67108864,67108864,67108864,15013888,15022080,13312000,13312256,13201408,13201664,17637376,20636192,20613000,20678144,20611456,128,9,16959488,16959744,16918528,16918784,17867776,20668928,20607168,1986560,0,66560,51200,20480,1024,0,0,0
.long 5268480,5271040,9052160,9162752,1065353216,20616592,20645392,19109888,67108864,256000,2766904864,2,1968128,67108864,67108864,4585472,67108864,67108864,7208960,15054848,15063040,13340928,13230080,13230336,13340672,17709056,20636704,20613008,20679680,20611456,128,10,16969984,16928768,16929024,16969728,17893376,20669440,20607360,2007040,20480,5120,71680,40960,1024,0,0,0
.long 5268480,5271040,9056256,9166848,1065353216,20616600,20645400,19867648,67108864,256000,2766904864,3,1969152,4588544,4588544,4588544,7211520,7214080,7216640,15095808,15104000,13256704,13256960,13367296,13367552,17775616,20636960,20613016,20681216,20611456,128,11,16939008,16939264,16979968,16980224,17918976,20669952,20607424,2027520,40960,25600,10240,61440,1024,0,0,0
.long 5345280,5347840,12369920,12480512,1065353216,20632960,20645632,17599488,20677504,286720,2766904832,0,2293760,67108864,67108864,67108864,67108864,67108864,67108864,14977024,14982144,13172992,13283328,13283584,13172736,19081216,20635680,20612992,20676608,20611584,0,40,16908544,16949248,16949504,16908288,19357696,20668416,20607104,1966592,61440,46080,30720,0,640,0,0,0
.long 5345280,5347840,12374016,12484608,1065353216,20632968,20645640,18357248,67108864,286720,2766904832,1,2294784,67108864,67108864,67108864,67108864,67108864,67108864,15017984,15023104,13312000,13312256,13201408,13201664,19152896,20636192,20613000,20678144,20611584,0,41,16959488,16959744,16918528,16918784,19383296,20668928,20607168,1987072,0,66560,51200,20480,640,0,0,0
.long 5350400,5352960,12591104,12701696,1065353216,20632976,20645648,19115008,67108864,296960,2766904864,2,2295808,67108864,67108864,4913152,67108864,67108864,7536640,15058944,15064064,13340928,13230080,13230336,13340672,19224576,20636704,20613008,20679680,20611584,0,42,16969984,16928768,16929024,16969728,19408896,20669440,20607360,2007552,20480,5120,71680,40960,640,0,0,0
.long 5350400,5352960,12595200,12705792,1065353216,20632984,20645656,19872768,67108864,296960,2766904864,3,2296832,4916224,4916224,4916224,7539200,7541760,7544320,15099904,15105024,13256704,13256960,13367296,13367552,19291136,20636960,20613016,20681216,20611584,0,43,16939008,16939264,16979968,16980224,19434496,20669952,20607424,2028032,40960,25600,10240,61440,640,0,0,0
.long 4096,5120,8306688,8417280,1051011932,20613120,20645888,17563904,20676616,5120,82452032,4,4096,67108864,67108864,67108864,67108864,67108864,67108864,15106048,15114240,8085760,8196096,8196352,8085504,17565696,20611120,20615040,20676608,20611072,0,4,15024384,15065088,15065344,15024128,17842176,20643856,20595328,81920,61440,46080,30720,0,1024,0,0,0
.long 266240,267264,8310784,8421376,1051011932,20613128,20645896,18321664,67108864,5120,82452032,5,5120,67108864,2620416,2620416,67108864,5242880,5245440,15147008,15155200,8224768,8225024,8114176,8114432,17637376,20611632,20615048,20678144,20611072,0,5,15075328,15075584,15034368,15034624,17867776,20644368,20595392,102400,0,66560,51200,20480,1024,0,0,0
.long 6144,7168,8527872,8638464,1051011932,20613136,20645904,19079424,67108864,15360,82452064,6,6144,2623488,2623488,2623488,5248000,5250560,5253120,15187968,15196160,8253696,8142848,8143104,8253440,17709056,20612144,20615056,20679680,20611072,0,6,15085824,15044608,15044864,15085568,17893376,20644880,20595584,122880,20480,5120,71680,40960,1024,0,0,0
.long 268288,269312,8531968,8642560,1051011932,20613144,20645912,19837184,67108864,15360,82452064,7,7168,2626560,2626560,2626560,5255680,5258240,5260800,15228928,15237120,8169472,8169728,8280064,8280320,17775616,20612400,20615064,20681216,20611072,0,7,15054848,15055104,15095808,15096064,17918976,20645392,20595648,143360,40960,25600,10240,61440,1024,0,0,0
.long 36864,37888,11845632,11956224,1051011932,20629504,20646144,17569024,20676744,46080,82452032,4,331776,67108864,67108864,67108864,67108864,67108864,67108864,15110144,15115264,8085760,8196096,8196352,8085504,19081216,20611120,20615040,20676608,20611072,0,36,15024384,15065088,15065344,15024128,19357696,20643856,20595328,82432,61440,46080,30720,0,640,0,0,0
.long 299008,300032,11849728,11960320,1051011932,20629512,20646152,18326784,67108864,46080,82452032,5,332800,67108864,2948096,2948096,67108864,5570560,5573120,15151104,15156224,8224768,8225024,8114176,8114432,19152896,20611632,20615048,20678144,20611072,0,37,15075328,15075584,15034368,15034624,19383296,20644368,20595392,102912,0,66560,51200,20480,640,0,0,0
.long 38912,39936,12066816,12177408,1051011932,20629520,20646160,19084544,67108864,56320,82452064,6,333824,2951168,2951168,2951168,5575680,5578240,5580800,15192064,15197184,8253696,8142848,8143104,8253440,19224576,20612144,20615056,20679680,20611072,0,38,15085824,15044608,15044864,15085568,19408896,20644880,20595584,123392,20480,5120,71680,40960,640,0,0,0
.long 301056,302080,12070912,12181504,1051011932,20629528,20646168,19842304,67108864,56320,82452064,7,334848,2954240,2954240,2954240,5583360,5585920,5588480,15233024,15238144,8169472,8169728,8280064,8280320,19291136,20612400,20615064,20681216,20611072,0,39,15054848,15055104,15095808,15096064,19434496,20645392,20595648,143872,40960,25600,10240,61440,640,0,0,0
.long 1601536,1602560,10985472,11096064,1051011932,20625792,20646400,17574144,20676872,87040,887791168,4,659456,67108864,67108864,67108864,67108864,67108864,67108864,15116288,15124480,9855232,9965568,9965824,9854976,17565696,20619312,20615040,20676608,20611200,0,28,15679744,15720448,15720704,15679488,17842176,20652048,20599424,737280,61440,46080,30720,0,1024,0,0,0
.long 1863680,1864704,10989568,11100160,1051011932,20625800,20646408,18331904,67108864,87040,887791168,5,660480,67108864,3275776,3275776,67108864,5898240,5900800,15157248,15165440,9994240,9994496,9883648,9883904,17637376,20619824,20615048,20678144,20611200,0,29,15730688,15730944,15689728,15689984,17867776,20652560,20599488,757760,0,66560,51200,20480,1024,0,0,0
.long 1603584,1604608,11206656,11317248,1051011932,20625808,20646416,19089664,67108864,97280,887791200,6,661504,3278848,3278848,3278848,5903360,5905920,5908480,15198208,15206400,10023168,9912320,9912576,10022912,17709056,20620336,20615056,20679680,20611200,0,30,15741184,15699968,15700224,15740928,17893376,20653072,20599680,778240,20480,5120,71680,40960,1024,0,0,0
.long 1865728,1866752,11210752,11321344,1051011932,20625816,20646424,19847424,67108864,97280,887791200,7,662528,3281920,3281920,3281920,5911040,5913600,5916160,15239168,15247360,9938944,9939200,10049536,10049792,17775616,20620592,20615064,20681216,20611200,0,31,15710208,15710464,15751168,15751424,17918976,20653584,20599744,798720,40960,25600,10240,61440,1024,0,0,0
.long 1634304,1635328,14524416,14635008,1051011932,20642176,20646656,17579264,20677000,128000,887791168,4,987136,67108864,67108864,67108864,67108864,67108864,67108864,15120384,15125504,9855232,9965568,9965824,9854976,19081216,20619312,20615040,20676608,20611200,128,60,15679744,15720448,15720704,15679488,19357696,20652048,20599424,737792,61440,46080,30720,0,640,0,0,0
.long 1896448,1897472,14528512,14639104,1051011932,20642184,20646664,18337024,67108864,128000,887791168,5,988160,67108864,3603456,3603456,67108864,6225920,6228480,15161344,15166464,9994240,9994496,9883648,9883904,19152896,20619824,20615048,20678144,20611200,128,61,15730688,15730944,15689728,15689984,19383296,20652560,20599488,758272,0,66560,51200,20480,640,0,0,0
.long 1636352,1637376,14745600,14856192,1051011932,20642192,20646672,19094784,67108864,138240,887791200,6,989184,3606528,3606528,3606528,6231040,6233600,6236160,15202304,15207424,10023168,9912320,9912576,10022912,19224576,20620336,20615056,20679680,20611200,128,62,15741184,15699968,15700224,15740928,19408896,20653072,20599680,778752,20480,5120,71680,40960,640,0,0,0
.long 1898496,1899520,14749696,14860288,1051011932,20642200,20646680,19852544,67108864,138240,887791200,7,990208,3609600,3609600,3609600,6238720,6241280,6243840,15243264,15248384,9938944,9939200,10049536,10049792,19291136,20620592,20615064,20681216,20611200,128,63,15710208,15710464,15751168,15751424,19434496,20653584,20599744,799232,40960,25600,10240,61440,640,0,0,0
.long 3690496,3691520,10125312,10235904,1065353216,20622208,20646912,17584384,20677128,168960,1693130304,4,1314816,67108864,67108864,67108864,67108864,67108864,67108864,15126528,15134720,11624704,11735040,11735296,11624448,17565696,20627504,20615040,20676608,20611328,0,20,16335104,16375808,16376064,16334848,17842176,20660240,20603520,1392640,61440,46080,30720,0,1024,0,0,0
.long 3952640,3953664,10129408,10240000,1065353216,20622216,20646920,18342144,67108864,168960,1693130304,5,1315840,67108864,3931136,3931136,67108864,6553600,6556160,15167488,15175680,11763712,11763968,11653120,11653376,17637376,20628016,20615048,20678144,20611328,0,21,16386048,16386304,16345088,16345344,17867776,20660752,20603584,1413120,0,66560,51200,20480,1024,0,0,0
.long 3692544,3693568,10346496,10457088,1065353216,20622224,20646928,19099904,67108864,179200,1693130336,6,1316864,3934208,3934208,3934208,6558720,6561280,6563840,15208448,15216640,11792640,11681792,11682048,11792384,17709056,20628528,20615056,20679680,20611328,0,22,16396544,16355328,16355584,16396288,17893376,20661264,20603776,1433600,20480,5120,71680,40960,1024,0,0,0
.long 3954688,3955712,10350592,10461184,1065353216,20622232,20646936,19857664,67108864,179200,1693130336,7,1317888,3937280,3937280,3937280,6566400,6568960,6571520,15249408,15257600,11708416,11708672,11819008,11819264,17775616,20628784,20615064,20681216,20611328,0,23,16365568,16365824,16406528,16406784,17918976,20661776,20603840,1454080,40960,25600,10240,61440,1024,0,0,0
.long 3723264,3724288,13664256,13774848,1065353216,20638592,20647168,17589504,20677256,209920,1693130304,4,1642496,67108864,67108864,67108864,67108864,67108864,67108864,15130624,15135744,11624704,11735040,11735296,11624448,19081216,20627504,20615040,20676608,20611456,0,52,16335104,16375808,16376064,16334848,19357696,20660240,20603520,1393152,61440,46080,30720,0,640,0,0,0
.long 3985408,3986432,13668352,13778944,1065353216,20638600,20647176,18347264,67108864,209920,1693130304,5,1643520,67108864,4258816,4258816,67108864,6881280,6883840,15171584,15176704,11763712,11763968,11653120,11653376,19152896,20628016,20615048,20678144,20611456,0,53,16386048,16386304,16345088,16345344,19383296,20660752,20603584,1413632,0,66560,51200,20480,640,0,0,0
.long 3725312,3726336,13885440,13996032,1065353216,20638608,20647184,19105024,67108864,220160,1693130336,6,1644544,4261888,4261888,4261888,6886400,6888960,6891520,15212544,15217664,11792640,11681792,11682048,11792384,19224576,20628528,20615056,20679680,20611456,0,54,16396544,16355328,16355584,16396288,19408896,20661264,20603776,1434112,20480,5120,71680,40960,640,0,0,0
.long 3987456,3988480,13889536,14000128,1065353216,20638616,20647192,19862784,67108864,220160,1693130336,7,1645568,4264960,4264960,4264960,6894080,6896640,6899200,15253504,15258624,11708416,11708672,11819008,11819264,19291136,20628784,20615064,20681216,20611456,0,55,16365568,16365824,16406528,16406784,19434496,20661776,20603840,1454592,40960,25600,10240,61440,640,0,0,0
.long 5273600,5276160,9281536,9392128,1065353216,20618624,20647424,17594624,20677384,250880,3035340352,4,1970176,67108864,67108864,67108864,67108864,67108864,67108864,15136768,15144960,13394176,13504512,13504768,13393920,17565696,20635696,20615040,20676608,20611456,128,12,16990464,17031168,17031424,16990208,17842176,20668432,20607616,2048000,61440,46080,30720,0,1024,0,0,0
.long 5273600,5276160,9285632,9396224,1065353216,20618632,20647432,18352384,67108864,250880,3035340352,5,1971200,67108864,4586496,4586496,67108864,7208960,7211520,15177728,15185920,13533184,13533440,13422592,13422848,17637376,20636208,20615048,20678144,20611456,128,13,17041408,17041664,17000448,17000704,17867776,20668944,20607680,2068480,0,66560,51200,20480,1024,0,0,0
.long 5278720,5281280,9502720,9613312,1065353216,20618640,20647440,19110144,67108864,261120,3035340384,6,1972224,4589568,4589568,4589568,7214080,7216640,7219200,15218688,15226880,13562112,13451264,13451520,13561856,17709056,20636720,20615056,20679680,20611456,128,14,17051904,17010688,17010944,17051648,17893376,20669456,20607872,2088960,20480,5120,71680,40960,1024,0,0,0
.long 5278720,5281280,9506816,9617408,1065353216,20618648,20647448,19867904,67108864,261120,3035340384,7,1973248,4592640,4592640,4592640,7221760,7224320,7226880,15259648,15267840,13477888,13478144,13588480,13588736,17775616,20636976,20615064,20681216,20611456,128,15,17020928,17021184,17061888,17062144,17918976,20669968,20607936,2109440,40960,25600,10240,61440,1024,0,0,0
.long 5355520,5358080,12820480,12931072,1065353216,20635008,20647680,17599744,20677512,291840,3035340352,4,2297856,67108864,67108864,67108864,67108864,67108864,67108864,15140864,15145984,13394176,13504512,13504768,13393920,19081216,20635696,20615040,20676608,20611584,0,44,16990464,17031168,17031424,16990208,19357696,20668432,20607616,2048512,61440,46080,30720,0,640,0,0,0
.long 5355520,5358080,12824576,12935168,1065353216,20635016,20647688,18357504,67108864,291840,3035340352,5,2298880,67108864,4914176,4914176,67108864,7536640,7539200,15181824,15186944,13533184,13533440,13422592,13422848,19152896,20636208,20615048,20678144,20611584,0,45,17041408,17041664,17000448,17000704,19383296,20668944,20607680,2068992,0,66560,51200,20480,640,0,0,0
.long 5360640,5363200,13041664,13152256,1065353216,20635024,20647696,19115264,67108864,302080,3035340384,6,2299904,4917248,4917248,4917248,7541760,7544320,7546880,15222784,15227904,13562112,13451264,13451520,13561856,19224576,20636720,20615056,20679680,20611584,0,46,17051904,17010688,17010944,17051648,19408896,20669456,20607872,2089472,20480,5120,71680,40960,640,0,0,0
.long 5360640,5363200,13045760,13156352,1065353216,20635032,20647704,19873024,67108864,302080,3035340384,7,2300928,4920320,4920320,4920320,7549440,7552000,7554560,15263744,15268864,13477888,13478144,13588480,13588736,19291136,20636976,20615064,20681216,20611584,0,47,17020928,17021184,17061888,17062144,19434496,20669968,20607936,2109952,40960,25600,10240,61440,640,0,0,0
.long 8192,9216,8749056,8859648,1051011932,20615168,20647936,17564160,20676624,20480,82460160,8,8192,2621440,2621440,2621440,5242880,5245440,5248000,15269888,15278080,8306944,8417280,8417536,8306688,17565696,20613152,20617088,20676608,20611072,0,8,15106304,15147008,15147264,15106048,17842176,20645888,20595840,163840,61440,46080,30720,0,1024,0,0,0
.long 270336,271360,8753152,8863744,1051011932,20615176,20647944,18321920,67108864,20480,82460160,9,9216,2624512,2624512,2624512,5250560,5253120,5255680,15310848,15319040,8445952,8446208,8335360,8335616,17637376,20613536,20617096,20678144,20611072,0,9,15157248,15157504,15116288,15116544,17867776,20646400,20595904,184320,0,66560,51200,20480,1024,0,0,0
.long 10240,11264,8970240,9080832,1051011932,20615184,20647952,19079680,67108864,30720,82460192,10,10240,2627584,2627584,2627584,5258240,5260800,5263360,15351808,15360000,8474880,8364032,8364288,8474624,17709056,20614176,20617104,20679680,20611072,0,10,15167744,15126528,15126784,15167488,17893376,20646912,20596096,204800,20480,5120,71680,40960,1024,0,0,0
.long 272384,273408,8974336,9084928,1051011932,20615192,20647960,19837440,67108864,30720,82460192,11,11264,2630656,2630656,2630656,5265920,5268480,5271040,15392768,15400960,8390656,8390912,8501248,8501504,17775616,20614432,20617112,20681216,20611072,0,11,15136768,15137024,15177728,15177984,17918976,20647424,20596160,225280,40960,25600,10240,61440,1024,0,0,0
.long 40960,41984,12288000,12398592,1051011932,20631552,20648192,17569280,20676752,61440,82460160,8,335872,2949120,2949120,2949120,5570560,5573120,5575680,15273984,15279104,8306944,8417280,8417536,8306688,19081216,20613152,20617088,20676608,20611072,0,40,15106304,15147008,15147264,15106048,19357696,20645888,20595840,164352,61440,46080,30720,0,640,0,0,0
.long 303104,304128,12292096,12402688,1051011932,20631560,20648200,18327040,67108864,61440,82460160,9,336896,2952192,2952192,2952192,5578240,5580800,5583360,15314944,15320064,8445952,8446208,8335360,8335616,19152896,20613536,20617096,20678144,20611072,0,41,15157248,15157504,15116288,15116544,19383296,20646400,20595904,184832,0,66560,51200,20480,640,0,0,0
.long 43008,44032,12509184,12619776,1051011932,20631568,20648208,19084800,67108864,71680,82460192,10,337920,2955264,2955264,2955264,5585920,5588480,5591040,15355904,15361024,8474880,8364032,8364288,8474624,19224576,20614176,20617104,20679680,20611072,0,42,15167744,15126528,15126784,15167488,19408896,20646912,20596096,205312,20480,5120,71680,40960,640,0,0,0
.long 305152,306176,12513280,12623872,1051011932,20631576,20648216,19842560,67108864,71680,82460192,11,338944,2958336,2958336,2958336,5593600,5596160,5598720,15396864,15401984,8390656,8390912,8501248,8501504,19291136,20614432,20617112,20681216,20611072,0,43,15136768,15137024,15177728,15177984,19434496,20647424,20596160,225792,40960,25600,10240,61440,640,0,0,0
.long 2097152,2098176,7888896,7999488,1051011932,20611584,20648448,17574400,20676880,102400,887799296,8,663552,3276800,3276800,3276800,5898240,5900800,5903360,15280128,15288320,10076416,10186752,10187008,10076160,17565696,20621344,20617088,20676608,20611200,0,0,15761664,15802368,15802624,15761408,17842176,20654080,20599936,819200,61440,46080,30720,0,1024,0,0,0
.long 2359296,2360320,7892992,8003584,1051011932,20611592,20648456,18332160,67108864,102400,887799296,9,664576,3279872,3279872,3279872,5905920,5908480,5911040,15321088,15329280,10215424,10215680,10104832,10105088,17637376,20621728,20617096,20678144,20611200,0,1,15812608,15812864,15771648,15771904,17867776,20654592,20600000,839680,0,66560,51200,20480,1024,0,0,0
.long 2099200,2100224,8110080,8220672,1051011932,20611600,20648464,19089920,67108864,112640,887799328,10,665600,3282944,3282944,3282944,5913600,5916160,5918720,15362048,15370240,10244352,10133504,10133760,10244096,17709056,20622368,20617104,20679680,20611200,0,2,15823104,15781888,15782144,15822848,17893376,20655104,20600192,860160,20480,5120,71680,40960,1024,0,0,0
.long 2361344,2362368,8114176,8224768,1051011932,20611608,20648472,19847680,67108864,112640,887799328,11,666624,3286016,3286016,3286016,5921280,5923840,5926400,15403008,15411200,10160128,10160384,10270720,10270976,17775616,20622624,20617112,20681216,20611200,0,3,15792128,15792384,15833088,15833344,17918976,20655616,20600256,880640,40960,25600,10240,61440,1024,0,0,0
.long 2129920,2130944,11427840,11538432,1051011932,20627968,20648704,17579520,20677008,143360,887799296,8,991232,3604480,3604480,3604480,6225920,6228480,6231040,15284224,15289344,10076416,10186752,10187008,10076160,19081216,20621344,20617088,20676608,20611200,128,32,15761664,15802368,15802624,15761408,19357696,20654080,20599936,819712,61440,46080,30720,0,640,0,0,0
.long 2392064,2393088,11431936,11542528,1051011932,20627976,20648712,18337280,67108864,143360,887799296,9,992256,3607552,3607552,3607552,6233600,6236160,6238720,15325184,15330304,10215424,10215680,10104832,10105088,19152896,20621728,20617096,20678144,20611200,128,33,15812608,15812864,15771648,15771904,19383296,20654592,20600000,840192,0,66560,51200,20480,640,0,0,0
.long 2131968,2132992,11649024,11759616,1051011932,20627984,20648720,19095040,67108864,153600,887799328,10,993280,3610624,3610624,3610624,6241280,6243840,6246400,15366144,15371264,10244352,10133504,10133760,10244096,19224576,20622368,20617104,20679680,20611200,128,34,15823104,15781888,15782144,15822848,19408896,20655104,20600192,860672,20480,5120,71680,40960,640,0,0,0
.long 2394112,2395136,11653120,11763712,1051011932,20627992,20648728,19852800,67108864,153600,887799328,11,994304,3613696,3613696,3613696,6248960,6251520,6254080,15407104,15412224,10160128,10160384,10270720,10270976,19291136,20622624,20617112,20681216,20611200,128,35,15792128,15792384,15833088,15833344,19434496,20655616,20600256,881152,40960,25600,10240,61440,640,0,0,0
.long 3694592,3695616,10575872,10686464,1065353216,20624256,20648960,17584640,20677136,184320,1961573888,8,1318912,3932160,3932160,3932160,6553600,6556160,6558720,15290368,15298560,11845888,11956224,11956480,11845632,17565696,20629536,20617088,20676608,20611328,0,24,16417024,16457728,16457984,16416768,17842176,20662272,20604032,1474560,61440,46080,30720,0,1024,0,0,0
.long 3956736,3957760,10579968,10690560,1065353216,20624264,20648968,18342400,67108864,184320,1961573888,9,1319936,3935232,3935232,3935232,6561280,6563840,6566400,15331328,15339520,11984896,11985152,11874304,11874560,17637376,20629920,20617096,20678144,20611328,0,25,16467968,16468224,16427008,16427264,17867776,20662784,20604096,1495040,0,66560,51200,20480,1024,0,0,0
.long 3696640,3697664,10797056,10907648,1065353216,20624272,20648976,19100160,67108864,194560,1961573920,10,1320960,3938304,3938304,3938304,6568960,6571520,6574080,15372288,15380480,12013824,11902976,11903232,12013568,17709056,20630560,20617104,20679680,20611328,0,26,16478464,16437248,16437504,16478208,17893376,20663296,20604288,1515520,20480,5120,71680,40960,1024,0,0,0
.long 3958784,3959808,10801152,10911744,1065353216,20624280,20648984,19857920,67108864,194560,1961573920,11,1321984,3941376,3941376,3941376,6576640,6579200,6581760,15413248,15421440,11929600,11929856,12040192,12040448,17775616,20630816,20617112,20681216,20611328,0,27,16447488,16447744,16488448,16488704,17918976,20663808,20604352,1536000,40960,25600,10240,61440,1024,0,0,0
.long 3727360,3728384,14114816,14225408,1065353216,20640640,20649216,17589760,20677264,225280,1961573888,8,1646592,4259840,4259840,4259840,6881280,6883840,6886400,15294464,15299584,11845888,11956224,11956480,11845632,19081216,20629536,20617088,20676608,20611456,0,56,16417024,16457728,16457984,16416768,19357696,20662272,20604032,1475072,61440,46080,30720,0,640,0,0,0
.long 3989504,3990528,14118912,14229504,1065353216,20640648,20649224,18347520,67108864,225280,1961573888,9,1647616,4262912,4262912,4262912,6888960,6891520,6894080,15335424,15340544,11984896,11985152,11874304,11874560,19152896,20629920,20617096,20678144,20611456,0,57,16467968,16468224,16427008,16427264,19383296,20662784,20604096,1495552,0,66560,51200,20480,640,0,0,0
.long 3729408,3730432,14336000,14446592,1065353216,20640656,20649232,19105280,67108864,235520,1961573920,10,1648640,4265984,4265984,4265984,6896640,6899200,6901760,15376384,15381504,12013824,11902976,11903232,12013568,19224576,20630560,20617104,20679680,20611456,0,58,16478464,16437248,16437504,16478208,19408896,20663296,20604288,1516032,20480,5120,71680,40960,640,0,0,0
.long 3991552,3992576,14340096,14450688,1065353216,20640664,20649240,19863040,67108864,235520,1961573920,11,1649664,4269056,4269056,4269056,6904320,6906880,6909440,15417344,15422464,11929600,11929856,12040192,12040448,19291136,20630816,20617112,20681216,20611456,0,59,16447488,16447744,16488448,16488704,19434496,20663808,20604352,1536512,40960,25600,10240,61440,640,0,0,0
.long 5283840,5286400,9715712,9826304,1065353216,20620672,20649472,17594880,20677392,266240,2766913024,8,1974272,4587520,4587520,4587520,7208960,7211520,7214080,15300608,15308800,13615360,13725696,13725952,13615104,17565696,20637728,20617088,20676608,20611456,128,16,17072384,17113088,17113344,17072128,17842176,20670464,20608128,2129920,61440,46080,30720,0,1024,0,0,0
.long 5283840,5286400,9719808,9830400,1065353216,20620680,20649480,18352640,67108864,266240,2766913024,9,1975296,4590592,4590592,4590592,7216640,7219200,7221760,15341568,15349760,13754368,13754624,13643776,13644032,17637376,20638112,20617096,20678144,20611456,128,17,17123328,17123584,17082368,17082624,17867776,20670976,20608192,2150400,0,66560,51200,20480,1024,0,0,0
.long 5288960,5291520,9936896,10047488,1065353216,20620688,20649488,19110400,67108864,276480,2766913056,10,1976320,4593664,4593664,4593664,7224320,7226880,7229440,15382528,15390720,13783296,13672448,13672704,13783040,17709056,20638752,20617104,20679680,20611456,128,18,17133824,17092608,17092864,17133568,17893376,20671488,20608384,2170880,20480,5120,71680,40960,1024,0,0,0
.long 5288960,5291520,9940992,10051584,1065353216,20620696,20649496,19868160,67108864,276480,2766913056,11,1977344,4596736,4596736,4596736,7232000,7234560,7237120,15423488,15431680,13699072,13699328,13809664,13809920,17775616,20639008,20617112,20681216,20611456,128,19,17102848,17103104,17143808,17144064,17918976,20672000,20608448,2191360,40960,25600,10240,61440,1024,0,0,0
.long 5365760,5368320,13254656,13365248,1065353216,20637056,20649728,17600000,20677520,307200,2766913024,8,2301952,4915200,4915200,4915200,7536640,7539200,7541760,15304704,15309824,13615360,13725696,13725952,13615104,19081216,20637728,20617088,20676608,20611584,0,48,17072384,17113088,17113344,17072128,19357696,20670464,20608128,2130432,61440,46080,30720,0,640,0,0,0
.long 5365760,5368320,13258752,13369344,1065353216,20637064,20649736,18357760,67108864,307200,2766913024,9,2302976,4918272,4918272,4918272,7544320,7546880,7549440,15345664,15350784,13754368,13754624,13643776,13644032,19152896,20638112,20617096,20678144,20611584,0,49,17123328,17123584,17082368,17082624,19383296,20670976,20608192,2150912,0,66560,51200,20480,640,0,0,0
.long 5370880,5373440,13475840,13586432,1065353216,20637072,20649744,19115520,67108864,317440,2766913056,10,2304000,4921344,4921344,4921344,7552000,7554560,7557120,15386624,15391744,13783296,13672448,13672704,13783040,19224576,20638752,20617104,20679680,20611584,0,50,17133824,17092608,17092864,17133568,19408896,20671488,20608384,2171392,20480,5120,71680,40960,640,0,0,0
.long 5370880,5373440,13479936,13590528,1065353216,20637080,20649752,19873280,67108864,317440,2766913056,11,2305024,4924416,4924416,4924416,7559680,7562240,7564800,15427584,15432704,13699072,13699328,13809664,13809920,19291136,20639008,20617112,20681216,20611584,0,51,17102848,17103104,17143808,17144064,19434496,20672000,20608448,2191872,40960,25600,10240,61440,640,0,0,0
.long 12288,13312,9191424,9302016,1051011932,20617216,20649984,17564416,20676632,25600,82460224,12,12288,2625536,2625536,2625536,5253120,5255680,5258240,15433728,15441920,8528128,8638464,8638720,8527872,17565696,20613168,20619136,20676608,20611072,0,12,15188224,15228928,15229184,15187968,17842176,20645904,20596352,245760,61440,46080,30720,0,1024,0,0,0
.long 274432,275456,9195520,9306112,1051011932,20617224,20649992,18322176,67108864,25600,82460224,13,13312,2628608,2628608,2628608,5260800,5263360,5265920,15474688,15482880,8667136,8667392,8556544,8556800,17637376,20613552,20619144,20678144,20611072,0,13,15239168,15239424,15198208,15198464,17867776,20646416,20596416,266240,0,66560,51200,20480,1024,0,0,0
.long 14336,15360,9412608,9523200,1051011932,20617232,20650000,19079936,67108864,35840,82460256,14,14336,2631680,2631680,2631680,5268480,5271040,5273600,15515648,15523840,8696064,8585216,8585472,8695808,17709056,20614192,20619152,20679680,20611072,0,14,15249664,15208448,15208704,15249408,17893376,20646928,20596608,286720,20480,5120,71680,40960,1024,0,0,0
.long 276480,277504,9416704,9527296,1051011932,20617240,20650008,19837696,67108864,35840,82460256,15,15360,2634752,2634752,2634752,5276160,5278720,5281280,15556608,15564800,8611840,8612096,8722432,8722688,17775616,20614448,20619160,20681216,20611072,0,15,15218688,15218944,15259648,15259904,17918976,20647440,20596672,307200,40960,25600,10240,61440,1024,0,0,0
.long 45056,46080,12730368,12840960,1051011932,20633600,20650240,17569536,20676760,66560,82460224,12,339968,2953216,2953216,2953216,5580800,5583360,5585920,15437824,15442944,8528128,8638464,8638720,8527872,19081216,20613168,20619136,20676608,20611072,0,44,15188224,15228928,15229184,15187968,19357696,20645904,20596352,246272,61440,46080,30720,0,640,0,0,0
.long 307200,308224,12734464,12845056,1051011932,20633608,20650248,18327296,67108864,66560,82460224,13,340992,2956288,2956288,2956288,5588480,5591040,5593600,15478784,15483904,8667136,8667392,8556544,8556800,19152896,20613552,20619144,20678144,20611072,0,45,15239168,15239424,15198208,15198464,19383296,20646416,20596416,266752,0,66560,51200,20480,640,0,0,0
.long 47104,48128,12951552,13062144,1051011932,20633616,20650256,19085056,67108864,76800,82460256,14,342016,2959360,2959360,2959360,5596160,5598720,5601280,15519744,15524864,8696064,8585216,8585472,8695808,19224576,20614192,20619152,20679680,20611072,0,46,15249664,15208448,15208704,15249408,19408896,20646928,20596608,287232,20480,5120,71680,40960,640,0,0,0
.long 309248,310272,12955648,13066240,1051011932,20633624,20650264,19842816,67108864,76800,82460256,15,343040,2962432,2962432,2962432,5603840,5606400,5608960,15560704,15565824,8611840,8612096,8722432,8722688,19291136,20614448,20619160,20681216,20611072,0,47,15218688,15218944,15259648,15259904,19434496,20647440,20596672,307712,40960,25600,10240,61440,640,0,0,0
.long 2101248,2102272,8339456,8450048,1051011932,20613632,20650496,17574656,20676888,107520,1156234816,12,667648,3280896,3280896,3280896,5908480,5911040,5913600,15443968,15452160,10297600,10407936,10408192,10297344,17565696,20621360,20619136,20676608,20611200,0,4,15843584,15884288,15884544,15843328,17842176,20654096,20600448,901120,61440,46080,30720,0,1024,0,0,0
.long 2363392,2364416,8343552,8454144,1051011932,20613640,20650504,18332416,67108864,107520,1156234816,13,668672,3283968,3283968,3283968,5916160,5918720,5921280,15484928,15493120,10436608,10436864,10326016,10326272,17637376,20621744,20619144,20678144,20611200,0,5,15894528,15894784,15853568,15853824,17867776,20654608,20600512,921600,0,66560,51200,20480,1024,0,0,0
.long 2103296,2104320,8560640,8671232,1051011932,20613648,20650512,19090176,67108864,117760,1156234848,14,669696,3287040,3287040,3287040,5923840,5926400,5928960,15525888,15534080,10465536,10354688,10354944,10465280,17709056,20622384,20619152,20679680,20611200,0,6,15905024,15863808,15864064,15904768,17893376,20655120,20600704,942080,20480,5120,71680,40960,1024,0,0,0
.long 2365440,2366464,8564736,8675328,1051011932,20613656,20650520,19847936,67108864,117760,1156234848,15,670720,3290112,3290112,3290112,5931520,5934080,5936640,15566848,15575040,10381312,10381568,10491904,10492160,17775616,20622640,20619160,20681216,20611200,0,7,15874048,15874304,15915008,15915264,17918976,20655632,20600768,962560,40960,25600,10240,61440,1024,0,0,0
.long 2134016,2135040,11878400,11988992,1051011932,20630016,20650752,17579776,20677016,148480,1156234816,12,995328,3608576,3608576,3608576,6236160,6238720,6241280,15448064,15453184,10297600,10407936,10408192,10297344,19081216,20621360,20619136,20676608,20611200,128,36,15843584,15884288,15884544,15843328,19357696,20654096,20600448,901632,61440,46080,30720,0,640,0,0,0
.long 2396160,2397184,11882496,11993088,1051011932,20630024,20650760,18337536,67108864,148480,1156234816,13,996352,3611648,3611648,3611648,6243840,6246400,6248960,15489024,15494144,10436608,10436864,10326016,10326272,19152896,20621744,20619144,20678144,20611200,128,37,15894528,15894784,15853568,15853824,19383296,20654608,20600512,922112,0,66560,51200,20480,640,0,0,0
.long 2136064,2137088,12099584,12210176,1051011932,20630032,20650768,19095296,67108864,158720,1156234848,14,997376,3614720,3614720,3614720,6251520,6254080,6256640,15529984,15535104,10465536,10354688,10354944,10465280,19224576,20622384,20619152,20679680,20611200,128,38,15905024,15863808,15864064,15904768,19408896,20655120,20600704,942592,20480,5120,71680,40960,640,0,0,0
.long 2398208,2399232,12103680,12214272,1051011932,20630040,20650776,19853056,67108864,158720,1156234848,15,998400,3617792,3617792,3617792,6259200,6261760,6264320,15570944,15576064,10381312,10381568,10491904,10492160,19291136,20622640,20619160,20681216,20611200,128,39,15874048,15874304,15915008,15915264,19434496,20655632,20600768,963072,40960,25600,10240,61440,640,0,0,0
.long 3698688,3699712,11018240,11128832,1065353216,20626304,20651008,17584896,20677144,189440,1961573952,12,1323008,3936256,3936256,3936256,6563840,6566400,6568960,15454208,15462400,12067072,12177408,12177664,12066816,17565696,20629552,20619136,20676608,20611328,0,28,16498944,16539648,16539904,16498688,17842176,20662288,20604544,1556480,61440,46080,30720,0,1024,0,0,0
.long 3960832,3961856,11022336,11132928,1065353216,20626312,20651016,18342656,67108864,189440,1961573952,13,1324032,3939328,3939328,3939328,6571520,6574080,6576640,15495168,15503360,12206080,12206336,12095488,12095744,17637376,20629936,20619144,20678144,20611328,0,29,16549888,16550144,16508928,16509184,17867776,20662800,20604608,1576960,0,66560,51200,20480,1024,0,0,0
.long 3700736,3701760,11239424,11350016,1065353216,20626320,20651024,19100416,67108864,199680,1961573984,14,1325056,3942400,3942400,3942400,6579200,6581760,6584320,15536128,15544320,12235008,12124160,12124416,12234752,17709056,20630576,20619152,20679680,20611328,0,30,16560384,16519168,16519424,16560128,17893376,20663312,20604800,1597440,20480,5120,71680,40960,1024,0,0,0
.long 3962880,3963904,11243520,11354112,1065353216,20626328,20651032,19858176,67108864,199680,1961573984,15,1326080,3945472,3945472,3945472,6586880,6589440,6592000,15577088,15585280,12150784,12151040,12261376,12261632,17775616,20630832,20619160,20681216,20611328,0,31,16529408,16529664,16570368,16570624,17918976,20663824,20604864,1617920,40960,25600,10240,61440,1024,0,0,0
.long 3731456,3732480,14557184,14667776,1065353216,20642688,20651264,17590016,20677272,230400,1961573952,12,1650688,4263936,4263936,4263936,6891520,6894080,6896640,15458304,15463424,12067072,12177408,12177664,12066816,19081216,20629552,20619136,20676608,20611456,0,60,16498944,16539648,16539904,16498688,19357696,20662288,20604544,1556992,61440,46080,30720,0,640,0,0,0
.long 3993600,3994624,14561280,14671872,1065353216,20642696,20651272,18347776,67108864,230400,1961573952,13,1651712,4267008,4267008,4267008,6899200,6901760,6904320,15499264,15504384,12206080,12206336,12095488,12095744,19152896,20629936,20619144,20678144,20611456,0,61,16549888,16550144,16508928,16509184,19383296,20662800,20604608,1577472,0,66560,51200,20480,640,0,0,0
.long 3733504,3734528,14778368,14888960,1065353216,20642704,20651280,19105536,67108864,240640,1961573984,14,1652736,4270080,4270080,4270080,6906880,6909440,6912000,15540224,15545344,12235008,12124160,12124416,12234752,19224576,20630576,20619152,20679680,20611456,0,62,16560384,16519168,16519424,16560128,19408896,20663312,20604800,1597952,20480,5120,71680,40960,640,0,0,0
.long 3995648,3996672,14782464,14893056,1065353216,20642712,20651288,19863296,67108864,240640,1961573984,15,1653760,4273152,4273152,4273152,6914560,6917120,6919680,15581184,15586304,12150784,12151040,12261376,12261632,19291136,20630832,20619160,20681216,20611456,0,63,16529408,16529664,16570368,16570624,19434496,20663824,20604864,1618432,40960,25600,10240,61440,640,0,0,0
.long 5294080,5296640,10158080,10268672,1065353216,20622720,20651520,17595136,20677400,271360,2766913088,12,1978368,4591616,4591616,4591616,7219200,7221760,7224320,15464448,15472640,13836544,13946880,13947136,13836288,17565696,20637744,20619136,20676608,20611456,128,20,17154304,17195008,17195264,17154048,17842176,20670480,20608640,2211840,61440,46080,30720,0,1024,0,0,0
.long 5294080,5296640,10162176,10272768,1065353216,20622728,20651528,18352896,67108864,271360,2766913088,13,1979392,4594688,4594688,4594688,7226880,7229440,7232000,15505408,15513600,13975552,13975808,13864960,13865216,17637376,20638128,20619144,20678144,20611456,128,21,17205248,17205504,17164288,17164544,17867776,20670992,20608704,2232320,0,66560,51200,20480,1024,0,0,0
.long 5299200,5301760,10379264,10489856,1065353216,20622736,20651536,19110656,67108864,281600,2766913120,14,1980416,4597760,4597760,4597760,7234560,7237120,7239680,15546368,15554560,14004480,13893632,13893888,14004224,17709056,20638768,20619152,20679680,20611456,128,22,17215744,17174528,17174784,17215488,17893376,20671504,20608896,2252800,20480,5120,71680,40960,1024,0,0,0
.long 5299200,5301760,10383360,10493952,1065353216,20622744,20651544,19868416,67108864,281600,2766913120,15,1981440,4600832,4600832,4600832,7242240,7244800,7247360,15587328,15595520,13920256,13920512,14030848,14031104,17775616,20639024,20619160,20681216,20611456,128,23,17184768,17185024,17225728,17225984,17918976,20672016,20608960,2273280,40960,25600,10240,61440,1024,0,0,0
.long 5376000,5378560,13697024,13807616,1065353216,20639104,20651776,17600256,20677528,312320,2766913088,12,2306048,4919296,4919296,4919296,7546880,7549440,7552000,15468544,15473664,13836544,13946880,13947136,13836288,19081216,20637744,20619136,20676608,20611584,0,52,17154304,17195008,17195264,17154048,19357696,20670480,20608640,2212352,61440,46080,30720,0,640,0,0,0
.long 5376000,5378560,13701120,13811712,1065353216,20639112,20651784,18358016,67108864,312320,2766913088,13,2307072,4922368,4922368,4922368,7554560,7557120,7559680,15509504,15514624,13975552,13975808,13864960,13865216,19152896,20638128,20619144,20678144,20611584,0,53,17205248,17205504,17164288,17164544,19383296,20670992,20608704,2232832,0,66560,51200,20480,640,0,0,0
.long 5381120,5383680,13918208,14028800,1065353216,20639120,20651792,19115776,67108864,322560,2766913120,14,2308096,4925440,4925440,4925440,7562240,7564800,7567360,15550464,15555584,14004480,13893632,13893888,14004224,19224576,20638768,20619152,20679680,20611584,0,54,17215744,17174528,17174784,17215488,19408896,20671504,20608896,2253312,20480,5120,71680,40960,640,0,0,0
.long 5381120,5383680,13922304,14032896,1065353216,20639128,20651800,19873536,67108864,322560,2766913120,15,2309120,4928512,4928512,4928512,7569920,7572480,7575040,15591424,15596544,13920256,13920512,14030848,14031104,19291136,20639024,20619160,20681216,20611584,0,55,17184768,17185024,17225728,17225984,19434496,20672016,20608960,2273792,40960,25600,10240,61440,640,0,0,0
.long 16384,17408,9633792,9744384,1051011932,20619264,20652032,17604608,20677632,327680,82468352,16,16384,2629632,2629632,2629632,5263360,5265920,5268480,15597568,15605760,8749312,8859648,8859904,8749056,17565696,20615200,20621184,20676608,20611072,0,16,15270144,15310848,15311104,15269888,17842176,20647936,20596864,327680,61440,46080,30720,0,1024,0,0,0
.long 278528,279552,9637888,9748480,1051011932,20619272,20652040,18362368,67108864,327680,82468352,17,17408,2632704,2632704,2632704,5271040,5273600,5276160,15638528,15646720,8888320,8888576,8777728,8777984,17637376,20615584,20621192,20678144,20611072,0,17,15321088,15321344,15280128,15280384,17867776,20648448,20596928,348160,0,66560,51200,20480,1024,0,0,0
.long 18432,19456,9854976,9965568,1051011932,20619280,20652048,19120128,67108864,337920,82468384,18,18432,2635776,2635776,2635776,5278720,5281280,5283840,15679488,15687680,8917248,8806400,8806656,8916992,17709056,20616096,20621200,20679680,20611072,0,18,15331584,15290368,15290624,15331328,17893376,20648960,20597120,368640,20480,5120,71680,40960,1024,0,0,0
.long 280576,281600,9859072,9969664,1051011932,20619288,20652056,19877888,67108864,337920,82468384,19,19456,2638848,2638848,2638848,5286400,5288960,5291520,15720448,15728640,8833024,8833280,8943616,8943872,17775616,20616480,20621208,20681216,20611072,0,19,15300608,15300864,15341568,15341824,17918976,20649472,20597184,389120,40960,25600,10240,61440,1024,0,0,0
.long 49152,50176,13172736,13283328,1051011932,20635648,20652288,17609728,20677760,368640,82468352,16,344064,2957312,2957312,2957312,5591040,5593600,5596160,15601664,15606784,8749312,8859648,8859904,8749056,19081216,20615200,20621184,20676608,20611072,0,48,15270144,15310848,15311104,15269888,19357696,20647936,20596864,328192,61440,46080,30720,0,640,0,0,0
.long 311296,312320,13176832,13287424,1051011932,20635656,20652296,18367488,67108864,368640,82468352,17,345088,2960384,2960384,2960384,5598720,5601280,5603840,15642624,15647744,8888320,8888576,8777728,8777984,19152896,20615584,20621192,20678144,20611072,0,49,15321088,15321344,15280128,15280384,19383296,20648448,20596928,348672,0,66560,51200,20480,640,0,0,0
.long 51200,52224,13393920,13504512,1051011932,20635664,20652304,19125248,67108864,378880,82468384,18,346112,2963456,2963456,2963456,5606400,5608960,5611520,15683584,15688704,8917248,8806400,8806656,8916992,19224576,20616096,20621200,20679680,20611072,0,50,15331584,15290368,15290624,15331328,19408896,20648960,20597120,369152,20480,5120,71680,40960,640,0,0,0
.long 313344,314368,13398016,13508608,1051011932,20635672,20652312,19883008,67108864,378880,82468384,19,347136,2966528,2966528,2966528,5614080,5616640,5619200,15724544,15729664,8833024,8833280,8943616,8943872,19291136,20616480,20621208,20681216,20611072,0,51,15300608,15300864,15341568,15341824,19434496,20649472,20597184,389632,40960,25600,10240,61440,640,0,0,0
.long 2105344,2106368,8781824,8892416,1051011932,20615680,20652544,17614848,20677888,409600,1156242944,16,671744,3284992,3284992,3284992,5918720,5921280,5923840,15607808,15616000,10518784,10629120,10629376,10518528,17565696,20623392,20621184,20676608,20611200,0,8,15925504,15966208,15966464,15925248,17842176,20656128,20600960,983040,61440,46080,30720,0,1024,0,0,0
.long 2367488,2368512,8785920,8896512,1051011932,20615688,20652552,18372608,67108864,409600,1156242944,17,672768,3288064,3288064,3288064,5926400,5928960,5931520,15648768,15656960,10657792,10658048,10547200,10547456,17637376,20623776,20621192,20678144,20611200,0,9,15976448,15976704,15935488,15935744,17867776,20656640,20601024,1003520,0,66560,51200,20480,1024,0,0,0
.long 2107392,2108416,9003008,9113600,1051011932,20615696,20652560,19130368,67108864,419840,1156242976,18,673792,3291136,3291136,3291136,5934080,5936640,5939200,15689728,15697920,10686720,10575872,10576128,10686464,17709056,20624288,20621200,20679680,20611200,0,10,15986944,15945728,15945984,15986688,17893376,20657152,20601216,1024000,20480,5120,71680,40960,1024,0,0,0
.long 2369536,2370560,9007104,9117696,1051011932,20615704,20652568,19888128,67108864,419840,1156242976,19,674816,3294208,3294208,3294208,5941760,5944320,5946880,15730688,15738880,10602496,10602752,10713088,10713344,17775616,20624672,20621208,20681216,20611200,0,11,15955968,15956224,15996928,15997184,17918976,20657664,20601280,1044480,40960,25600,10240,61440,1024,0,0,0
.long 2138112,2139136,12320768,12431360,1051011932,20632064,20652800,17619968,20678016,450560,1156242944,16,999424,3612672,3612672,3612672,6246400,6248960,6251520,15611904,15617024,10518784,10629120,10629376,10518528,19081216,20623392,20621184,20676608,20611200,128,40,15925504,15966208,15966464,15925248,19357696,20656128,20600960,983552,61440,46080,30720,0,640,0,0,0
.long 2400256,2401280,12324864,12435456,1051011932,20632072,20652808,18377728,67108864,450560,1156242944,17,1000448,3615744,3615744,3615744,6254080,6256640,6259200,15652864,15657984,10657792,10658048,10547200,10547456,19152896,20623776,20621192,20678144,20611200,128,41,15976448,15976704,15935488,15935744,19383296,20656640,20601024,1004032,0,66560,51200,20480,640,0,0,0
.long 2140160,2141184,12541952,12652544,1051011932,20632080,20652816,19135488,67108864,460800,1156242976,18,1001472,3618816,3618816,3618816,6261760,6264320,6266880,15693824,15698944,10686720,10575872,10576128,10686464,19224576,20624288,20621200,20679680,20611200,128,42,15986944,15945728,15945984,15986688,19408896,20657152,20601216,1024512,20480,5120,71680,40960,640,0,0,0
.long 2402304,2403328,12546048,12656640,1051011932,20632088,20652824,19893248,67108864,460800,1156242976,19,1002496,3621888,3621888,3621888,6269440,6272000,6274560,15734784,15739904,10602496,10602752,10713088,10713344,19291136,20624672,20621208,20681216,20611200,128,43,15955968,15956224,15996928,15997184,19434496,20657664,20601280,1044992,40960,25600,10240,61440,640,0,0,0
.long 4194304,4195328,7921664,8032256,1065353216,20612096,20653056,17635328,20678144,573440,1961582080,16,1327104,3940352,3940352,3940352,6574080,6576640,6579200,15618048,15626240,12288256,12398592,12398848,12288000,17565696,20631584,20621184,20676608,20611328,0,0,16580864,16621568,16621824,16580608,17842176,20664320,20605056,1638400,61440,46080,30720,0,1024,0,0,0
.long 4456448,4457472,7925760,8036352,1065353216,20612104,20653064,18393088,67108864,573440,1961582080,17,1328128,3943424,3943424,3943424,6581760,6584320,6586880,15659008,15667200,12427264,12427520,12316672,12316928,17637376,20631968,20621192,20678144,20611328,0,1,16631808,16632064,16590848,16591104,17867776,20664832,20605120,1658880,0,66560,51200,20480,1024,0,0,0
.long 4196352,4197376,8142848,8253440,1065353216,20612112,20653072,19150848,67108864,583680,1961582112,18,1329152,3946496,3946496,3946496,6589440,6592000,6594560,15699968,15708160,12456192,12345344,12345600,12455936,17709056,20632480,20621200,20679680,20611328,0,2,16642304,16601088,16601344,16642048,17893376,20665344,20605312,1679360,20480,5120,71680,40960,1024,0,0,0
.long 4458496,4459520,8146944,8257536,1065353216,20612120,20653080,19908608,67108864,583680,1961582112,19,1330176,3949568,3949568,3949568,6597120,6599680,6602240,15740928,15749120,12371968,12372224,12482560,12482816,17775616,20632864,20621208,20681216,20611328,0,3,16611328,16611584,16652288,16652544,17918976,20665856,20605376,1699840,40960,25600,10240,61440,1024,0,0,0
.long 4227072,4228096,11460608,11571200,1065353216,20628480,20653312,17640448,20678272,614400,1961582080,16,1654784,4268032,4268032,4268032,6901760,6904320,6906880,15622144,15627264,12288256,12398592,12398848,12288000,19081216,20631584,20621184,20676608,20611456,0,32,16580864,16621568,16621824,16580608,19357696,20664320,20605056,1638912,61440,46080,30720,0,640,0,0,0
.long 4489216,4490240,11464704,11575296,1065353216,20628488,20653320,18398208,67108864,614400,1961582080,17,1655808,4271104,4271104,4271104,6909440,6912000,6914560,15663104,15668224,12427264,12427520,12316672,12316928,19152896,20631968,20621192,20678144,20611456,0,33,16631808,16632064,16590848,16591104,19383296,20664832,20605120,1659392,0,66560,51200,20480,640,0,0,0
.long 4229120,4230144,11681792,11792384,1065353216,20628496,20653328,19155968,67108864,624640,1961582112,18,1656832,4274176,4274176,4274176,6917120,6919680,6922240,15704064,15709184,12456192,12345344,12345600,12455936,19224576,20632480,20621200,20679680,20611456,0,34,16642304,16601088,16601344,16642048,19408896,20665344,20605312,1679872,20480,5120,71680,40960,640,0,0,0
.long 4491264,4492288,11685888,11796480,1065353216,20628504,20653336,19913728,67108864,624640,1961582112,19,1657856,4277248,4277248,4277248,6924800,6927360,6929920,15745024,15750144,12371968,12372224,12482560,12482816,19291136,20632864,20621208,20681216,20611456,0,35,16611328,16611584,16652288,16652544,19434496,20665856,20605376,1700352,40960,25600,10240,61440,640,0,0,0
.long 5304320,5306880,10600448,10711040,1065353216,20624768,20653568,17645568,20678400,655360,2766921216,16,1982464,4595712,4595712,4595712,7229440,7232000,7234560,15628288,15636480,14057728,14168064,14168320,14057472,17565696,20639776,20621184,20676608,20611456,128,24,17236224,17276928,17277184,17235968,17842176,20672512,20609152,2293760,61440,46080,30720,0,1024,0,0,0
.long 5304320,5306880,10604544,10715136,1065353216,20624776,20653576,18403328,67108864,655360,2766921216,17,1983488,4598784,4598784,4598784,7237120,7239680,7242240,15669248,15677440,14196736,14196992,14086144,14086400,17637376,20640160,20621192,20678144,20611456,128,25,17287168,17287424,17246208,17246464,17867776,20673024,20609216,2314240,0,66560,51200,20480,1024,0,0,0
.long 5309440,5312000,10821632,10932224,1065353216,20624784,20653584,19161088,67108864,665600,2766921248,18,1984512,4601856,4601856,4601856,7244800,7247360,7249920,15710208,15718400,14225664,14114816,14115072,14225408,17709056,20640672,20621200,20679680,20611456,128,26,17297664,17256448,17256704,17297408,17893376,20673536,20609408,2334720,20480,5120,71680,40960,1024,0,0,0
.long 5309440,5312000,10825728,10936320,1065353216,20624792,20653592,19918848,67108864,665600,2766921248,19,1985536,4604928,4604928,4604928,7252480,7255040,7257600,15751168,15759360,14141440,14141696,14252032,14252288,17775616,20641056,20621208,20681216,20611456,128,27,17266688,17266944,17307648,17307904,17918976,20674048,20609472,2355200,40960,25600,10240,61440,1024,0,0,0
.long 5386240,5388800,14139392,14249984,1065353216,20641152,20653824,17650688,20678528,696320,2766921216,16,2310144,4923392,4923392,4923392,7557120,7559680,7562240,15632384,15637504,14057728,14168064,14168320,14057472,19081216,20639776,20621184,20676608,20611584,0,56,17236224,17276928,17277184,17235968,19357696,20672512,20609152,2294272,61440,46080,30720,0,640,0,0,0
.long 5386240,5388800,14143488,14254080,1065353216,20641160,20653832,18408448,67108864,696320,2766921216,17,2311168,4926464,4926464,4926464,7564800,7567360,7569920,15673344,15678464,14196736,14196992,14086144,14086400,19152896,20640160,20621192,20678144,20611584,0,57,17287168,17287424,17246208,17246464,19383296,20673024,20609216,2314752,0,66560,51200,20480,640,0,0,0
.long 5391360,5393920,14360576,14471168,1065353216,20641168,20653840,19166208,67108864,706560,2766921248,18,2312192,4929536,4929536,4929536,7572480,7575040,7577600,15714304,15719424,14225664,14114816,14115072,14225408,19224576,20640672,20621200,20679680,20611584,0,58,17297664,17256448,17256704,17297408,19408896,20673536,20609408,2335232,20480,5120,71680,40960,640,0,0,0
.long 5391360,5393920,14364672,14475264,1065353216,20641176,20653848,19923968,67108864,706560,2766921248,19,2313216,4932608,4932608,4932608,7580160,7582720,7585280,15755264,15760384,14141440,14141696,14252032,14252288,19291136,20641056,20621208,20681216,20611584,0,59,17266688,17266944,17307648,17307904,19434496,20674048,20609472,2355712,40960,25600,10240,61440,640,0,0,0
.long 20480,21504,10076160,10186752,1051011932,20621312,20654080,17604864,20677640,332800,82468416,20,20480,2633728,2633728,2633728,5273600,5276160,5278720,15761408,15769600,8970496,9080832,9081088,8970240,17565696,20615216,20623232,20676608,20611072,0,20,15352064,15392768,15393024,15351808,17842176,20647952,20597376,409600,61440,46080,30720,0,1024,0,0,0
.long 282624,283648,10080256,10190848,1051011932,20621320,20654088,18362624,67108864,332800,82468416,21,21504,2636800,2636800,2636800,5281280,5283840,5286400,15802368,15810560,9109504,9109760,8998912,8999168,17637376,20615600,20623240,20678144,20611072,0,21,15403008,15403264,15362048,15362304,17867776,20648464,20597440,430080,0,66560,51200,20480,1024,0,0,0
.long 22528,23552,10297344,10407936,1051011932,20621328,20654096,19120384,67108864,343040,82468448,22,22528,2639872,2639872,2639872,5288960,5291520,5294080,15843328,15851520,9138432,9027584,9027840,9138176,17709056,20616112,20623248,20679680,20611072,0,22,15413504,15372288,15372544,15413248,17893376,20648976,20597632,450560,20480,5120,71680,40960,1024,0,0,0
.long 284672,285696,10301440,10412032,1051011932,20621336,20654104,19878144,67108864,343040,82468448,23,23552,2642944,2642944,2642944,5296640,5299200,5301760,15884288,15892480,9054208,9054464,9164800,9165056,17775616,20616496,20623256,20681216,20611072,0,23,15382528,15382784,15423488,15423744,17918976,20649488,20597696,471040,40960,25600,10240,61440,1024,0,0,0
.long 53248,54272,13615104,13725696,1051011932,20637696,20654336,17609984,20677768,373760,82468416,20,348160,2961408,2961408,2961408,5601280,5603840,5606400,15765504,15770624,8970496,9080832,9081088,8970240,19081216,20615216,20623232,20676608,20611072,0,52,15352064,15392768,15393024,15351808,19357696,20647952,20597376,410112,61440,46080,30720,0,640,0,0,0
.long 315392,316416,13619200,13729792,1051011932,20637704,20654344,18367744,67108864,373760,82468416,21,349184,2964480,2964480,2964480,5608960,5611520,5614080,15806464,15811584,9109504,9109760,8998912,8999168,19152896,20615600,20623240,20678144,20611072,0,53,15403008,15403264,15362048,15362304,19383296,20648464,20597440,430592,0,66560,51200,20480,640,0,0,0
.long 55296,56320,13836288,13946880,1051011932,20637712,20654352,19125504,67108864,384000,82468448,22,350208,2967552,2967552,2967552,5616640,5619200,5621760,15847424,15852544,9138432,9027584,9027840,9138176,19224576,20616112,20623248,20679680,20611072,0,54,15413504,15372288,15372544,15413248,19408896,20648976,20597632,451072,20480,5120,71680,40960,640,0,0,0
.long 317440,318464,13840384,13950976,1051011932,20637720,20654360,19883264,67108864,384000,82468448,23,351232,2970624,2970624,2970624,5624320,5626880,5629440,15888384,15893504,9054208,9054464,9164800,9165056,19291136,20616496,20623256,20681216,20611072,0,55,15382528,15382784,15423488,15423744,19434496,20649488,20597696,471552,40960,25600,10240,61440,640,0,0,0
.long 2109440,2110464,9224192,9334784,1051011932,20617728,20654592,17615104,20677896,414720,1156243008,20,675840,3289088,3289088,3289088,5928960,5931520,5934080,15771648,15779840,10739968,10850304,10850560,10739712,17565696,20623408,20623232,20676608,20611200,0,12,16007424,16048128,16048384,16007168,17842176,20656144,20601472,1064960,61440,46080,30720,0,1024,0,0,0
.long 2371584,2372608,9228288,9338880,1051011932,20617736,20654600,18372864,67108864,414720,1156243008,21,676864,3292160,3292160,3292160,5936640,5939200,5941760,15812608,15820800,10878976,10879232,10768384,10768640,17637376,20623792,20623240,20678144,20611200,0,13,16058368,16058624,16017408,16017664,17867776,20656656,20601536,1085440,0,66560,51200,20480,1024,0,0,0
.long 2111488,2112512,9445376,9555968,1051011932,20617744,20654608,19130624,67108864,424960,1156243040,22,677888,3295232,3295232,3295232,5944320,5946880,5949440,15853568,15861760,10907904,10797056,10797312,10907648,17709056,20624304,20623248,20679680,20611200,0,14,16068864,16027648,16027904,16068608,17893376,20657168,20601728,1105920,20480,5120,71680,40960,1024,0,0,0
.long 2373632,2374656,9449472,9560064,1051011932,20617752,20654616,19888384,67108864,424960,1156243040,23,678912,3298304,3298304,3298304,5952000,5954560,5957120,15894528,15902720,10823680,10823936,10934272,10934528,17775616,20624688,20623256,20681216,20611200,0,15,16037888,16038144,16078848,16079104,17918976,20657680,20601792,1126400,40960,25600,10240,61440,1024,0,0,0
.long 2142208,2143232,12763136,12873728,1051011932,20634112,20654848,17620224,20678024,455680,1156243008,20,1003520,3616768,3616768,3616768,6256640,6259200,6261760,15775744,15780864,10739968,10850304,10850560,10739712,19081216,20623408,20623232,20676608,20611200,128,44,16007424,16048128,16048384,16007168,19357696,20656144,20601472,1065472,61440,46080,30720,0,640,0,0,0
.long 2404352,2405376,12767232,12877824,1051011932,20634120,20654856,18377984,67108864,455680,1156243008,21,1004544,3619840,3619840,3619840,6264320,6266880,6269440,15816704,15821824,10878976,10879232,10768384,10768640,19152896,20623792,20623240,20678144,20611200,128,45,16058368,16058624,16017408,16017664,19383296,20656656,20601536,1085952,0,66560,51200,20480,640,0,0,0
.long 2144256,2145280,12984320,13094912,1051011932,20634128,20654864,19135744,67108864,465920,1156243040,22,1005568,3622912,3622912,3622912,6272000,6274560,6277120,15857664,15862784,10907904,10797056,10797312,10907648,19224576,20624304,20623248,20679680,20611200,128,46,16068864,16027648,16027904,16068608,19408896,20657168,20601728,1106432,20480,5120,71680,40960,640,0,0,0
.long 2406400,2407424,12988416,13099008,1051011932,20634136,20654872,19893504,67108864,465920,1156243040,23,1006592,3625984,3625984,3625984,6279680,6282240,6284800,15898624,15903744,10823680,10823936,10934272,10934528,19291136,20624688,20623256,20681216,20611200,128,47,16037888,16038144,16078848,16079104,19434496,20657680,20601792,1126912,40960,25600,10240,61440,640,0,0,0
.long 4198400,4199424,8364032,8474624,1065353216,20614144,20655104,17635584,20678152,578560,1961582144,20,1331200,3944448,3944448,3944448,6584320,6586880,6589440,15781888,15790080,12509440,12619776,12620032,12509184,17565696,20631600,20623232,20676608,20611328,0,4,16662784,16703488,16703744,16662528,17842176,20664336,20605568,1720320,61440,46080,30720,0,1024,0,0,0
.long 4460544,4461568,8368128,8478720,1065353216,20614152,20655112,18393344,67108864,578560,1961582144,21,1332224,3947520,3947520,3947520,6592000,6594560,6597120,15822848,15831040,12648448,12648704,12537856,12538112,17637376,20631984,20623240,20678144,20611328,0,5,16713728,16713984,16672768,16673024,17867776,20664848,20605632,1740800,0,66560,51200,20480,1024,0,0,0
.long 4200448,4201472,8585216,8695808,1065353216,20614160,20655120,19151104,67108864,588800,1961582176,22,1333248,3950592,3950592,3950592,6599680,6602240,6604800,15863808,15872000,12677376,12566528,12566784,12677120,17709056,20632496,20623248,20679680,20611328,0,6,16724224,16683008,16683264,16723968,17893376,20665360,20605824,1761280,20480,5120,71680,40960,1024,0,0,0
.long 4462592,4463616,8589312,8699904,1065353216,20614168,20655128,19908864,67108864,588800,1961582176,23,1334272,3953664,3953664,3953664,6607360,6609920,6612480,15904768,15912960,12593152,12593408,12703744,12704000,17775616,20632880,20623256,20681216,20611328,0,7,16693248,16693504,16734208,16734464,17918976,20665872,20605888,1781760,40960,25600,10240,61440,1024,0,0,0
.long 4231168,4232192,11902976,12013568,1065353216,20630528,20655360,17640704,20678280,619520,1961582144,20,1658880,4272128,4272128,4272128,6912000,6914560,6917120,15785984,15791104,12509440,12619776,12620032,12509184,19081216,20631600,20623232,20676608,20611456,0,36,16662784,16703488,16703744,16662528,19357696,20664336,20605568,1720832,61440,46080,30720,0,640,0,0,0
.long 4493312,4494336,11907072,12017664,1065353216,20630536,20655368,18398464,67108864,619520,1961582144,21,1659904,4275200,4275200,4275200,6919680,6922240,6924800,15826944,15832064,12648448,12648704,12537856,12538112,19152896,20631984,20623240,20678144,20611456,0,37,16713728,16713984,16672768,16673024,19383296,20664848,20605632,1741312,0,66560,51200,20480,640,0,0,0
.long 4233216,4234240,12124160,12234752,1065353216,20630544,20655376,19156224,67108864,629760,1961582176,22,1660928,4278272,4278272,4278272,6927360,6929920,6932480,15867904,15873024,12677376,12566528,12566784,12677120,19224576,20632496,20623248,20679680,20611456,0,38,16724224,16683008,16683264,16723968,19408896,20665360,20605824,1761792,20480,5120,71680,40960,640,0,0,0
.long 4495360,4496384,12128256,12238848,1065353216,20630552,20655384,19913984,67108864,629760,1961582176,23,1661952,4281344,4281344,4281344,6935040,6937600,6940160,15908864,15913984,12593152,12593408,12703744,12704000,19291136,20632880,20623256,20681216,20611456,0,39,16693248,16693504,16734208,16734464,19434496,20665872,20605888,1782272,40960,25600,10240,61440,640,0,0,0
.long 5314560,5317120,11051008,11161600,1065353216,20626816,20655616,17645824,20678408,660480,3035356736,20,1986560,4599808,4599808,4599808,7239680,7242240,7244800,15792128,15800320,14278912,14389248,14389504,14278656,17565696,20639792,20623232,20676608,20611456,128,28,17318144,17358848,17359104,17317888,17842176,20672528,20609664,2375680,61440,46080,30720,0,1024,0,0,0
.long 5314560,5317120,11055104,11165696,1065353216,20626824,20655624,18403584,67108864,660480,3035356736,21,1987584,4602880,4602880,4602880,7247360,7249920,7252480,15833088,15841280,14417920,14418176,14307328,14307584,17637376,20640176,20623240,20678144,20611456,128,29,17369088,17369344,17328128,17328384,17867776,20673040,20609728,2396160,0,66560,51200,20480,1024,0,0,0
.long 5319680,5322240,11272192,11382784,1065353216,20626832,20655632,19161344,67108864,670720,3035356768,22,1988608,4605952,4605952,4605952,7255040,7257600,7260160,15874048,15882240,14446848,14336000,14336256,14446592,17709056,20640688,20623248,20679680,20611456,128,30,17379584,17338368,17338624,17379328,17893376,20673552,20609920,2416640,20480,5120,71680,40960,1024,0,0,0
.long 5319680,5322240,11276288,11386880,1065353216,20626840,20655640,19919104,67108864,670720,3035356768,23,1989632,4609024,4609024,4609024,7262720,7265280,7267840,15915008,15923200,14362624,14362880,14473216,14473472,17775616,20641072,20623256,20681216,20611456,128,31,17348608,17348864,17389568,17389824,17918976,20674064,20609984,2437120,40960,25600,10240,61440,1024,0,0,0
.long 5396480,5399040,14589952,14700544,1065353216,20643200,20655872,17650944,20678536,701440,3035356736,20,2314240,4927488,4927488,4927488,7567360,7569920,7572480,15796224,15801344,14278912,14389248,14389504,14278656,19081216,20639792,20623232,20676608,20611584,0,60,17318144,17358848,17359104,17317888,19357696,20672528,20609664,2376192,61440,46080,30720,0,640,0,0,0
.long 5396480,5399040,14594048,14704640,1065353216,20643208,20655880,18408704,67108864,701440,3035356736,21,2315264,4930560,4930560,4930560,7575040,7577600,7580160,15837184,15842304,14417920,14418176,14307328,14307584,19152896,20640176,20623240,20678144,20611584,0,61,17369088,17369344,17328128,17328384,19383296,20673040,20609728,2396672,0,66560,51200,20480,640,0,0,0
.long 5401600,5404160,14811136,14921728,1065353216,20643216,20655888,19166464,67108864,711680,3035356768,22,2316288,4933632,4933632,4933632,7582720,7585280,7587840,15878144,15883264,14446848,14336000,14336256,14446592,19224576,20640688,20623248,20679680,20611584,0,62,17379584,17338368,17338624,17379328,19408896,20673552,20609920,2417152,20480,5120,71680,40960,640,0,0,0
.long 5401600,5404160,14815232,14925824,1065353216,20643224,20655896,19924224,67108864,711680,3035356768,23,2317312,4936704,4936704,4936704,7590400,7592960,7595520,15919104,15924224,14362624,14362880,14473216,14473472,19291136,20641072,20623256,20681216,20611584,0,63,17348608,17348864,17389568,17389824,19434496,20674064,20609984,2437632,40960,25600,10240,61440,640,0,0,0
.long 24576,25600,10518528,10629120,1051011932,20623360,20656128,17605120,20677648,348160,82476544,24,24576,2637824,2637824,2637824,5283840,5286400,5288960,15925248,15933440,9191680,9302016,9302272,9191424,17565696,20617248,20625280,20676608,20611072,0,24,15433984,15474688,15474944,15433728,17842176,20649984,20597888,491520,61440,46080,30720,0,1024,0,0,0
.long 286720,287744,10522624,10633216,1051011932,20623368,20656136,18362880,67108864,348160,82476544,25,25600,2640896,2640896,2640896,5291520,5294080,5296640,15966208,15974400,9330688,9330944,9220096,9220352,17637376,20617632,20625288,20678144,20611072,0,25,15484928,15485184,15443968,15444224,17867776,20650496,20597952,512000,0,66560,51200,20480,1024,0,0,0
.long 26624,27648,10739712,10850304,1051011932,20623376,20656144,19120640,67108864,358400,82476576,26,26624,2643968,2643968,2643968,5299200,5301760,5304320,16007168,16015360,9359616,9248768,9249024,9359360,17709056,20618144,20625296,20679680,20611072,0,26,15495424,15454208,15454464,15495168,17893376,20651008,20598144,532480,20480,5120,71680,40960,1024,0,0,0
.long 288768,289792,10743808,10854400,1051011932,20623384,20656152,19878400,67108864,358400,82476576,27,27648,2647040,2647040,2647040,5306880,5309440,5312000,16048128,16056320,9275392,9275648,9385984,9386240,17775616,20618528,20625304,20681216,20611072,0,27,15464448,15464704,15505408,15505664,17918976,20651520,20598208,552960,40960,25600,10240,61440,1024,0,0,0
.long 57344,58368,14057472,14168064,1051011932,20639744,20656384,17610240,20677776,389120,82476544,24,352256,2965504,2965504,2965504,5611520,5614080,5616640,15929344,15934464,9191680,9302016,9302272,9191424,19081216,20617248,20625280,20676608,20611072,0,56,15433984,15474688,15474944,15433728,19357696,20649984,20597888,492032,61440,46080,30720,0,640,0,0,0
.long 319488,320512,14061568,14172160,1051011932,20639752,20656392,18368000,67108864,389120,82476544,25,353280,2968576,2968576,2968576,5619200,5621760,5624320,15970304,15975424,9330688,9330944,9220096,9220352,19152896,20617632,20625288,20678144,20611072,0,57,15484928,15485184,15443968,15444224,19383296,20650496,20597952,512512,0,66560,51200,20480,640,0,0,0
.long 59392,60416,14278656,14389248,1051011932,20639760,20656400,19125760,67108864,399360,82476576,26,354304,2971648,2971648,2971648,5626880,5629440,5632000,16011264,16016384,9359616,9248768,9249024,9359360,19224576,20618144,20625296,20679680,20611072,0,58,15495424,15454208,15454464,15495168,19408896,20651008,20598144,532992,20480,5120,71680,40960,640,0,0,0
.long 321536,322560,14282752,14393344,1051011932,20639768,20656408,19883520,67108864,399360,82476576,27,355328,2974720,2974720,2974720,5634560,5637120,5639680,16052224,16057344,9275392,9275648,9385984,9386240,19291136,20618528,20625304,20681216,20611072,0,59,15464448,15464704,15505408,15505664,19434496,20651520,20598208,553472,40960,25600,10240,61440,640,0,0,0
.long 2113536,2114560,9658368,9768960,1051011932,20619776,20656640,17615360,20677904,430080,887815680,24,679936,3293184,3293184,3293184,5939200,5941760,5944320,15935488,15943680,10961152,11071488,11071744,10960896,17565696,20625440,20625280,20676608,20611200,0,16,16089344,16130048,16130304,16089088,17842176,20658176,20601984,1146880,61440,46080,30720,0,1024,0,0,0
.long 2375680,2376704,9662464,9773056,1051011932,20619784,20656648,18373120,67108864,430080,887815680,25,680960,3296256,3296256,3296256,5946880,5949440,5952000,15976448,15984640,11100160,11100416,10989568,10989824,17637376,20625824,20625288,20678144,20611200,0,17,16140288,16140544,16099328,16099584,17867776,20658688,20602048,1167360,0,66560,51200,20480,1024,0,0,0
.long 2115584,2116608,9879552,9990144,1051011932,20619792,20656656,19130880,67108864,440320,887815712,26,681984,3299328,3299328,3299328,5954560,5957120,5959680,16017408,16025600,11129088,11018240,11018496,11128832,17709056,20626336,20625296,20679680,20611200,0,18,16150784,16109568,16109824,16150528,17893376,20659200,20602240,1187840,20480,5120,71680,40960,1024,0,0,0
.long 2377728,2378752,9883648,9994240,1051011932,20619800,20656664,19888640,67108864,440320,887815712,27,683008,3302400,3302400,3302400,5962240,5964800,5967360,16058368,16066560,11044864,11045120,11155456,11155712,17775616,20626720,20625304,20681216,20611200,0,19,16119808,16120064,16160768,16161024,17918976,20659712,20602304,1208320,40960,25600,10240,61440,1024,0,0,0
.long 2146304,2147328,13197312,13307904,1051011932,20636160,20656896,17620480,20678032,471040,887815680,24,1007616,3620864,3620864,3620864,6266880,6269440,6272000,15939584,15944704,10961152,11071488,11071744,10960896,19081216,20625440,20625280,20676608,20611200,128,48,16089344,16130048,16130304,16089088,19357696,20658176,20601984,1147392,61440,46080,30720,0,640,0,0,0
.long 2408448,2409472,13201408,13312000,1051011932,20636168,20656904,18378240,67108864,471040,887815680,25,1008640,3623936,3623936,3623936,6274560,6277120,6279680,15980544,15985664,11100160,11100416,10989568,10989824,19152896,20625824,20625288,20678144,20611200,128,49,16140288,16140544,16099328,16099584,19383296,20658688,20602048,1167872,0,66560,51200,20480,640,0,0,0
.long 2148352,2149376,13418496,13529088,1051011932,20636176,20656912,19136000,67108864,481280,887815712,26,1009664,3627008,3627008,3627008,6282240,6284800,6287360,16021504,16026624,11129088,11018240,11018496,11128832,19224576,20626336,20625296,20679680,20611200,128,50,16150784,16109568,16109824,16150528,19408896,20659200,20602240,1188352,20480,5120,71680,40960,640,0,0,0
.long 2410496,2411520,13422592,13533184,1051011932,20636184,20656920,19893760,67108864,481280,887815712,27,1010688,3630080,3630080,3630080,6289920,6292480,6295040,16062464,16067584,11044864,11045120,11155456,11155712,19291136,20626720,20625304,20681216,20611200,128,51,16119808,16120064,16160768,16161024,19434496,20659712,20602304,1208832,40960,25600,10240,61440,640,0,0,0
.long 4202496,4203520,8814592,8925184,1065353216,20616192,20657152,17635840,20678160,593920,2230025728,24,1335296,3948544,3948544,3948544,6594560,6597120,6599680,15945728,15953920,12730624,12840960,12841216,12730368,17565696,20633632,20625280,20676608,20611328,0,8,16744704,16785408,16785664,16744448,17842176,20666368,20606080,1802240,61440,46080,30720,0,1024,0,0,0
.long 4464640,4465664,8818688,8929280,1065353216,20616200,20657160,18393600,67108864,593920,2230025728,25,1336320,3951616,3951616,3951616,6602240,6604800,6607360,15986688,15994880,12869632,12869888,12759040,12759296,17637376,20634016,20625288,20678144,20611328,0,9,16795648,16795904,16754688,16754944,17867776,20666880,20606144,1822720,0,66560,51200,20480,1024,0,0,0
.long 4204544,4205568,9035776,9146368,1065353216,20616208,20657168,19151360,67108864,604160,2230025760,26,1337344,3954688,3954688,3954688,6609920,6612480,6615040,16027648,16035840,12898560,12787712,12787968,12898304,17709056,20634528,20625296,20679680,20611328,0,10,16806144,16764928,16765184,16805888,17893376,20667392,20606336,1843200,20480,5120,71680,40960,1024,0,0,0
.long 4466688,4467712,9039872,9150464,1065353216,20616216,20657176,19909120,67108864,604160,2230025760,27,1338368,3957760,3957760,3957760,6617600,6620160,6622720,16068608,16076800,12814336,12814592,12924928,12925184,17775616,20634912,20625304,20681216,20611328,0,11,16775168,16775424,16816128,16816384,17918976,20667904,20606400,1863680,40960,25600,10240,61440,1024,0,0,0
.long 4235264,4236288,12353536,12464128,1065353216,20632576,20657408,17640960,20678288,634880,2230025728,24,1662976,4276224,4276224,4276224,6922240,6924800,6927360,15949824,15954944,12730624,12840960,12841216,12730368,19081216,20633632,20625280,20676608,20611456,0,40,16744704,16785408,16785664,16744448,19357696,20666368,20606080,1802752,61440,46080,30720,0,640,0,0,0
.long 4497408,4498432,12357632,12468224,1065353216,20632584,20657416,18398720,67108864,634880,2230025728,25,1664000,4279296,4279296,4279296,6929920,6932480,6935040,15990784,15995904,12869632,12869888,12759040,12759296,19152896,20634016,20625288,20678144,20611456,0,41,16795648,16795904,16754688,16754944,19383296,20666880,20606144,1823232,0,66560,51200,20480,640,0,0,0
.long 4237312,4238336,12574720,12685312,1065353216,20632592,20657424,19156480,67108864,645120,2230025760,26,1665024,4282368,4282368,4282368,6937600,6940160,6942720,16031744,16036864,12898560,12787712,12787968,12898304,19224576,20634528,20625296,20679680,20611456,0,42,16806144,16764928,16765184,16805888,19408896,20667392,20606336,1843712,20480,5120,71680,40960,640,0,0,0
.long 4499456,4500480,12578816,12689408,1065353216,20632600,20657432,19914240,67108864,645120,2230025760,27,1666048,4285440,4285440,4285440,6945280,6947840,6950400,16072704,16077824,12814336,12814592,12924928,12925184,19291136,20634912,20625304,20681216,20611456,0,43,16775168,16775424,16816128,16816384,19434496,20667904,20606400,1864192,40960,25600,10240,61440,640,0,0,0
.long 5242880,5245440,7954432,8065024,1065353216,20612608,20657664,17646080,20678416,675840,3035364864,24,1990656,4603904,4603904,4603904,7249920,7252480,7255040,15955968,15964160,14500096,14610432,14610688,14499840,17565696,20641824,20625280,20676608,20611456,128,0,17400064,17440768,17441024,17399808,17842176,20674560,20610176,2457600,61440,46080,30720,0,1024,0,0,0
.long 5242880,5245440,7958528,8069120,1065353216,20612616,20657672,18403840,67108864,675840,3035364864,25,1991680,4606976,4606976,4606976,7257600,7260160,7262720,15996928,16005120,14639104,14639360,14528512,14528768,17637376,20642208,20625288,20678144,20611456,128,1,17451008,17451264,17410048,17410304,17867776,20675072,20610240,2478080,0,66560,51200,20480,1024,0,0,0
.long 5248000,5250560,8175616,8286208,1065353216,20612624,20657680,19161600,67108864,686080,3035364896,26,1992704,4610048,4610048,4610048,7265280,7267840,7270400,16037888,16046080,14668032,14557184,14557440,14667776,17709056,20642720,20625296,20679680,20611456,128,2,17461504,17420288,17420544,17461248,17893376,20675584,20610432,2498560,20480,5120,71680,40960,1024,0,0,0
.long 5248000,5250560,8179712,8290304,1065353216,20612632,20657688,19919360,67108864,686080,3035364896,27,1993728,4613120,4613120,4613120,7272960,7275520,7278080,16078848,16087040,14583808,14584064,14694400,14694656,17775616,20643104,20625304,20681216,20611456,128,3,17430528,17430784,17471488,17471744,17918976,20676096,20610496,2519040,40960,25600,10240,61440,1024,0,0,0
.long 5324800,5327360,11493376,11603968,1065353216,20628992,20657920,17651200,20678544,716800,3035364864,24,2318336,4931584,4931584,4931584,7577600,7580160,7582720,15960064,15965184,14500096,14610432,14610688,14499840,19081216,20641824,20625280,20676608,20611584,0,32,17400064,17440768,17441024,17399808,19357696,20674560,20610176,2458112,61440,46080,30720,0,640,0,0,0
.long 5324800,5327360,11497472,11608064,1065353216,20629000,20657928,18408960,67108864,716800,3035364864,25,2319360,4934656,4934656,4934656,7585280,7587840,7590400,16001024,16006144,14639104,14639360,14528512,14528768,19152896,20642208,20625288,20678144,20611584,0,33,17451008,17451264,17410048,17410304,19383296,20675072,20610240,2478592,0,66560,51200,20480,640,0,0,0
.long 5329920,5332480,11714560,11825152,1065353216,20629008,20657936,19166720,67108864,727040,3035364896,26,2320384,4937728,4937728,4937728,7592960,7595520,7598080,16041984,16047104,14668032,14557184,14557440,14667776,19224576,20642720,20625296,20679680,20611584,0,34,17461504,17420288,17420544,17461248,19408896,20675584,20610432,2499072,20480,5120,71680,40960,640,0,0,0
.long 5329920,5332480,11718656,11829248,1065353216,20629016,20657944,19924480,67108864,727040,3035364896,27,2321408,4940800,4940800,4940800,7600640,7603200,7605760,16082944,16088064,14583808,14584064,14694400,14694656,19291136,20643104,20625304,20681216,20611584,0,35,17430528,17430784,17471488,17471744,19434496,20676096,20610496,2519552,40960,25600,10240,61440,640,0,0,0
.long 28672,29696,10960896,11071488,1051011932,20625408,20658176,17605376,20677656,353280,82476608,28,28672,2641920,2641920,2641920,5294080,5296640,5299200,16089088,16097280,9412864,9523200,9523456,9412608,17565696,20617264,20627328,20676608,20611072,0,28,15515904,15556608,15556864,15515648,17842176,20650000,20598400,573440,61440,46080,30720,0,1024,0,0,0
.long 290816,291840,10964992,11075584,1051011932,20625416,20658184,18363136,67108864,353280,82476608,29,29696,2644992,2644992,2644992,5301760,5304320,5306880,16130048,16138240,9551872,9552128,9441280,9441536,17637376,20617648,20627336,20678144,20611072,0,29,15566848,15567104,15525888,15526144,17867776,20650512,20598464,593920,0,66560,51200,20480,1024,0,0,0
.long 30720,31744,11182080,11292672,1051011932,20625424,20658192,19120896,67108864,363520,82476640,30,30720,2648064,2648064,2648064,5309440,5312000,5314560,16171008,16179200,9580800,9469952,9470208,9580544,17709056,20618160,20627344,20679680,20611072,0,30,15577344,15536128,15536384,15577088,17893376,20651024,20598656,614400,20480,5120,71680,40960,1024,0,0,0
.long 292864,293888,11186176,11296768,1051011932,20625432,20658200,19878656,67108864,363520,82476640,31,31744,2651136,2651136,2651136,5317120,5319680,5322240,16211968,16220160,9496576,9496832,9607168,9607424,17775616,20618544,20627352,20681216,20611072,0,31,15546368,15546624,15587328,15587584,17918976,20651536,20598720,634880,40960,25600,10240,61440,1024,0,0,0
.long 61440,62464,14499840,14610432,1051011932,20641792,20658432,17610496,20677784,394240,82476608,28,356352,2969600,2969600,2969600,5621760,5624320,5626880,16093184,16098304,9412864,9523200,9523456,9412608,19081216,20617264,20627328,20676608,20611072,0,60,15515904,15556608,15556864,15515648,19357696,20650000,20598400,573952,61440,46080,30720,0,640,0,0,0
.long 323584,324608,14503936,14614528,1051011932,20641800,20658440,18368256,67108864,394240,82476608,29,357376,2972672,2972672,2972672,5629440,5632000,5634560,16134144,16139264,9551872,9552128,9441280,9441536,19152896,20617648,20627336,20678144,20611072,0,61,15566848,15567104,15525888,15526144,19383296,20650512,20598464,594432,0,66560,51200,20480,640,0,0,0
.long 63488,64512,14721024,14831616,1051011932,20641808,20658448,19126016,67108864,404480,82476640,30,358400,2975744,2975744,2975744,5637120,5639680,5642240,16175104,16180224,9580800,9469952,9470208,9580544,19224576,20618160,20627344,20679680,20611072,0,62,15577344,15536128,15536384,15577088,19408896,20651024,20598656,614912,20480,5120,71680,40960,640,0,0,0
.long 325632,326656,14725120,14835712,1051011932,20641816,20658456,19883776,67108864,404480,82476640,31,359424,2978816,2978816,2978816,5644800,5647360,5649920,16216064,16221184,9496576,9496832,9607168,9607424,19291136,20618544,20627352,20681216,20611072,0,63,15546368,15546624,15587328,15587584,19434496,20651536,20598720,635392,40960,25600,10240,61440,640,0,0,0
.long 2117632,2118656,10108928,10219520,1051011932,20621824,20658688,17615616,20677912,435200,1156251200,28,684032,3297280,3297280,3297280,5949440,5952000,5954560,16099328,16107520,11182336,11292672,11292928,11182080,17565696,20625456,20627328,20676608,20611200,0,20,16171264,16211968,16212224,16171008,17842176,20658192,20602496,1228800,61440,46080,30720,0,1024,0,0,0
.long 2379776,2380800,10113024,10223616,1051011932,20621832,20658696,18373376,67108864,435200,1156251200,29,685056,3300352,3300352,3300352,5957120,5959680,5962240,16140288,16148480,11321344,11321600,11210752,11211008,17637376,20625840,20627336,20678144,20611200,0,21,16222208,16222464,16181248,16181504,17867776,20658704,20602560,1249280,0,66560,51200,20480,1024,0,0,0
.long 2119680,2120704,10330112,10440704,1051011932,20621840,20658704,19131136,67108864,445440,1156251232,30,686080,3303424,3303424,3303424,5964800,5967360,5969920,16181248,16189440,11350272,11239424,11239680,11350016,17709056,20626352,20627344,20679680,20611200,0,22,16232704,16191488,16191744,16232448,17893376,20659216,20602752,1269760,20480,5120,71680,40960,1024,0,0,0
.long 2381824,2382848,10334208,10444800,1051011932,20621848,20658712,19888896,67108864,445440,1156251232,31,687104,3306496,3306496,3306496,5972480,5975040,5977600,16222208,16230400,11266048,11266304,11376640,11376896,17775616,20626736,20627352,20681216,20611200,0,23,16201728,16201984,16242688,16242944,17918976,20659728,20602816,1290240,40960,25600,10240,61440,1024,0,0,0
.long 2150400,2151424,13647872,13758464,1051011932,20638208,20658944,17620736,20678040,476160,1156251200,28,1011712,3624960,3624960,3624960,6277120,6279680,6282240,16103424,16108544,11182336,11292672,11292928,11182080,19081216,20625456,20627328,20676608,20611200,128,52,16171264,16211968,16212224,16171008,19357696,20658192,20602496,1229312,61440,46080,30720,0,640,0,0,0
.long 2412544,2413568,13651968,13762560,1051011932,20638216,20658952,18378496,67108864,476160,1156251200,29,1012736,3628032,3628032,3628032,6284800,6287360,6289920,16144384,16149504,11321344,11321600,11210752,11211008,19152896,20625840,20627336,20678144,20611200,128,53,16222208,16222464,16181248,16181504,19383296,20658704,20602560,1249792,0,66560,51200,20480,640,0,0,0
.long 2152448,2153472,13869056,13979648,1051011932,20638224,20658960,19136256,67108864,486400,1156251232,30,1013760,3631104,3631104,3631104,6292480,6295040,6297600,16185344,16190464,11350272,11239424,11239680,11350016,19224576,20626352,20627344,20679680,20611200,128,54,16232704,16191488,16191744,16232448,19408896,20659216,20602752,1270272,20480,5120,71680,40960,640,0,0,0
.long 2414592,2415616,13873152,13983744,1051011932,20638232,20658968,19894016,67108864,486400,1156251232,31,1014784,3634176,3634176,3634176,6300160,6302720,6305280,16226304,16231424,11266048,11266304,11376640,11376896,19291136,20626736,20627352,20681216,20611200,128,55,16201728,16201984,16242688,16242944,19434496,20659728,20602816,1290752,40960,25600,10240,61440,640,0,0,0
.long 4206592,4207616,9256960,9367552,1065353216,20618240,20659200,17636096,20678168,599040,2230025792,28,1339392,3952640,3952640,3952640,6604800,6607360,6609920,16109568,16117760,12951808,13062144,13062400,12951552,17565696,20633648,20627328,20676608,20611328,0,12,16826624,16867328,16867584,16826368,17842176,20666384,20606592,1884160,61440,46080,30720,0,1024,0,0,0
.long 4468736,4469760,9261056,9371648,1065353216,20618248,20659208,18393856,67108864,599040,2230025792,29,1340416,3955712,3955712,3955712,6612480,6615040,6617600,16150528,16158720,13090816,13091072,12980224,12980480,17637376,20634032,20627336,20678144,20611328,0,13,16877568,16877824,16836608,16836864,17867776,20666896,20606656,1904640,0,66560,51200,20480,1024,0,0,0
.long 4208640,4209664,9478144,9588736,1065353216,20618256,20659216,19151616,67108864,609280,2230025824,30,1341440,3958784,3958784,3958784,6620160,6622720,6625280,16191488,16199680,13119744,13008896,13009152,13119488,17709056,20634544,20627344,20679680,20611328,0,14,16888064,16846848,16847104,16887808,17893376,20667408,20606848,1925120,20480,5120,71680,40960,1024,0,0,0
.long 4470784,4471808,9482240,9592832,1065353216,20618264,20659224,19909376,67108864,609280,2230025824,31,1342464,3961856,3961856,3961856,6627840,6630400,6632960,16232448,16240640,13035520,13035776,13146112,13146368,17775616,20634928,20627352,20681216,20611328,0,15,16857088,16857344,16898048,16898304,17918976,20667920,20606912,1945600,40960,25600,10240,61440,1024,0,0,0
.long 4239360,4240384,12795904,12906496,1065353216,20634624,20659456,17641216,20678296,640000,2230025792,28,1667072,4280320,4280320,4280320,6932480,6935040,6937600,16113664,16118784,12951808,13062144,13062400,12951552,19081216,20633648,20627328,20676608,20611456,0,44,16826624,16867328,16867584,16826368,19357696,20666384,20606592,1884672,61440,46080,30720,0,640,0,0,0
.long 4501504,4502528,12800000,12910592,1065353216,20634632,20659464,18398976,67108864,640000,2230025792,29,1668096,4283392,4283392,4283392,6940160,6942720,6945280,16154624,16159744,13090816,13091072,12980224,12980480,19152896,20634032,20627336,20678144,20611456,0,45,16877568,16877824,16836608,16836864,19383296,20666896,20606656,1905152,0,66560,51200,20480,640,0,0,0
.long 4241408,4242432,13017088,13127680,1065353216,20634640,20659472,19156736,67108864,650240,2230025824,30,1669120,4286464,4286464,4286464,6947840,6950400,6952960,16195584,16200704,13119744,13008896,13009152,13119488,19224576,20634544,20627344,20679680,20611456,0,46,16888064,16846848,16847104,16887808,19408896,20667408,20606848,1925632,20480,5120,71680,40960,640,0,0,0
.long 4503552,4504576,13021184,13131776,1065353216,20634648,20659480,19914496,67108864,650240,2230025824,31,1670144,4289536,4289536,4289536,6955520,6958080,6960640,16236544,16241664,13035520,13035776,13146112,13146368,19291136,20634928,20627352,20681216,20611456,0,47,16857088,16857344,16898048,16898304,19434496,20667920,20606912,1946112,40960,25600,10240,61440,640,0,0,0
.long 5253120,5255680,8396800,8507392,1065353216,20614656,20659712,17646336,20678424,680960,3035364928,28,1994752,4608000,4608000,4608000,7260160,7262720,7265280,16119808,16128000,14721280,14831616,14831872,14721024,17565696,20641840,20627328,20676608,20611456,128,4,17481984,17522688,17522944,17481728,17842176,20674576,20610688,2539520,61440,46080,30720,0,1024,0,0,0
.long 5253120,5255680,8400896,8511488,1065353216,20614664,20659720,18404096,67108864,680960,3035364928,29,1995776,4611072,4611072,4611072,7267840,7270400,7272960,16160768,16168960,14860288,14860544,14749696,14749952,17637376,20642224,20627336,20678144,20611456,128,5,17532928,17533184,17491968,17492224,17867776,20675088,20610752,2560000,0,66560,51200,20480,1024,0,0,0
.long 5258240,5260800,8617984,8728576,1065353216,20614672,20659728,19161856,67108864,691200,3035364960,30,1996800,4614144,4614144,4614144,7275520,7278080,7280640,16201728,16209920,14889216,14778368,14778624,14888960,17709056,20642736,20627344,20679680,20611456,128,6,17543424,17502208,17502464,17543168,17893376,20675600,20610944,2580480,20480,5120,71680,40960,1024,0,0,0
.long 5258240,5260800,8622080,8732672,1065353216,20614680,20659736,19919616,67108864,691200,3035364960,31,1997824,4617216,4617216,4617216,7283200,7285760,7288320,16242688,16250880,14804992,14805248,14915584,14915840,17775616,20643120,20627352,20681216,20611456,128,7,17512448,17512704,17553408,17553664,17918976,20676112,20611008,2600960,40960,25600,10240,61440,1024,0,0,0
.long 5335040,5337600,11935744,12046336,1065353216,20631040,20659968,17651456,20678552,721920,3035364928,28,2322432,4935680,4935680,4935680,7587840,7590400,7592960,16123904,16129024,14721280,14831616,14831872,14721024,19081216,20641840,20627328,20676608,20611584,0,36,17481984,17522688,17522944,17481728,19357696,20674576,20610688,2540032,61440,46080,30720,0,640,0,0,0
.long 5335040,5337600,11939840,12050432,1065353216,20631048,20659976,18409216,67108864,721920,3035364928,29,2323456,4938752,4938752,4938752,7595520,7598080,7600640,16164864,16169984,14860288,14860544,14749696,14749952,19152896,20642224,20627336,20678144,20611584,0,37,17532928,17533184,17491968,17492224,19383296,20675088,20610752,2560512,0,66560,51200,20480,640,0,0,0
.long 5340160,5342720,12156928,12267520,1065353216,20631056,20659984,19166976,67108864,732160,3035364960,30,2324480,4941824,4941824,4941824,7603200,7605760,7608320,16205824,16210944,14889216,14778368,14778624,14888960,19224576,20642736,20627344,20679680,20611584,0,38,17543424,17502208,17502464,17543168,19408896,20675600,20610944,2580992,20480,5120,71680,40960,640,0,0,0
.long 5340160,5342720,12161024,12271616,1065353216,20631064,20659992,19924736,67108864,732160,3035364960,31,2325504,4944896,4944896,4944896,7610880,7613440,7616000,16246784,16251904,14804992,14805248,14915584,14915840,19291136,20643120,20627352,20681216,20611584,0,39,17512448,17512704,17553408,17553664,19434496,20676112,20611008,2601472,40960,25600,10240,61440,640,0,0,0
.long 524288,525312,67108864,67108864,1051011932,20611200,20660224,17655808,20678656,737280,3840548352,32,32768,2646016,2646016,2646016,5304320,5306880,5309440,16252928,16261120,7864576,7974912,7975168,7864320,17944576,20611104,20629376,20676608,20611072,0,0,14942464,14983168,14983424,14942208,18221056,20643840,20594816,128,61440,46080,30720,0,928,0,0,0
.long 786432,787456,67108864,67108864,1051011932,20611208,20660232,18413568,67108864,737280,3840548352,33,33792,2649088,2649088,2649088,5312000,5314560,5317120,16293888,16302080,8003584,8003840,7892992,7893248,18016256,20611616,20629384,20678144,20611072,0,1,14993408,14993664,14952448,14952704,18246656,20644352,20594880,20608,0,66560,51200,20480,928,0,0,0
.long 526336,527360,67108864,67108864,1051011932,20611216,20660240,19171328,67108864,747520,3840548384,34,34816,2652160,2652160,2652160,5319680,5322240,5324800,16334848,16343040,8032512,7921664,7921920,8032256,18087936,20612128,20629392,20679680,20611072,0,2,15003904,14962688,14962944,15003648,18272256,20644864,20595072,41088,20480,5120,71680,40960,928,0,0,0
.long 788480,789504,67108864,67108864,1051011932,20611224,20660248,19929088,67108864,747520,3840548384,35,35840,2655232,2655232,2655232,5327360,5329920,5332480,16375808,16384000,7948288,7948544,8058880,8059136,18154496,20612384,20629400,20681216,20611072,0,3,14972928,14973184,15013888,15014144,18297856,20645376,20595136,61568,40960,25600,10240,61440,928,0,0,0
.long 557056,558080,67108864,67108864,1051011932,20627584,20660480,17660928,20678784,778240,3840548352,32,360448,2973696,2973696,2973696,5632000,5634560,5637120,16257024,16262144,7864576,7974912,7975168,7864320,19460096,20611104,20629376,20676608,20611072,0,32,14942464,14983168,14983424,14942208,19736576,20643840,20594816,640,61440,46080,30720,0,544,0,0,0
.long 819200,820224,67108864,67108864,1051011932,20627592,20660488,18418688,67108864,778240,3840548352,33,361472,2976768,2976768,2976768,5639680,5642240,5644800,16297984,16303104,8003584,8003840,7892992,7893248,19531776,20611616,20629384,20678144,20611072,0,33,14993408,14993664,14952448,14952704,19762176,20644352,20594880,21120,0,66560,51200,20480,544,0,0,0
.long 559104,560128,67108864,67108864,1051011932,20627600,20660496,19176448,67108864,788480,3840548384,34,362496,2979840,2979840,2979840,5647360,5649920,5652480,16338944,16344064,8032512,7921664,7921920,8032256,19603456,20612128,20629392,20679680,20611072,0,34,15003904,14962688,14962944,15003648,19787776,20644864,20595072,41600,20480,5120,71680,40960,544,0,0,0
.long 821248,822272,67108864,67108864,1051011932,20627608,20660504,19934208,67108864,788480,3840548384,35,363520,2982912,2982912,2982912,5655040,5657600,5660160,16379904,16385024,7948288,7948544,8058880,8059136,19670016,20612384,20629400,20681216,20611072,0,35,14972928,14973184,15013888,15014144,19813376,20645376,20595136,62080,40960,25600,10240,61440,544,0,0,0
.long 2121728,2122752,10551296,10661888,1051011932,20623872,20660736,17666048,20678912,819200,1156226560,32,688128,3301376,3301376,3301376,5959680,5962240,5964800,16263168,16271360,9634048,9744384,9744640,9633792,17944576,20619296,20629376,20676608,20611200,0,24,15597824,15638528,15638784,15597568,18221056,20652032,20598912,655488,61440,46080,30720,0,928,0,0,0
.long 2383872,2384896,10555392,10665984,1051011932,20623880,20660744,18423808,67108864,819200,1156226560,33,689152,3304448,3304448,3304448,5967360,5969920,5972480,16304128,16312320,9773056,9773312,9662464,9662720,18016256,20619808,20629384,20678144,20611200,0,25,15648768,15649024,15607808,15608064,18246656,20652544,20598976,675968,0,66560,51200,20480,928,0,0,0
.long 2123776,2124800,10772480,10883072,1051011932,20623888,20660752,19181568,67108864,829440,1156226592,34,690176,3307520,3307520,3307520,5975040,5977600,5980160,16345088,16353280,9801984,9691136,9691392,9801728,18087936,20620320,20629392,20679680,20611200,0,26,15659264,15618048,15618304,15659008,18272256,20653056,20599168,696448,20480,5120,71680,40960,928,0,0,0
.long 2385920,2386944,10776576,10887168,1051011932,20623896,20660760,19939328,67108864,829440,1156226592,35,691200,3310592,3310592,3310592,5982720,5985280,5987840,16386048,16394240,9717760,9718016,9828352,9828608,18154496,20620576,20629400,20681216,20611200,0,27,15628288,15628544,15669248,15669504,18297856,20653568,20599232,716928,40960,25600,10240,61440,928,0,0,0
.long 2154496,2155520,14090240,14200832,1051011932,20640256,20660992,17671168,20679040,860160,1156226560,32,1015808,3629056,3629056,3629056,6287360,6289920,6292480,16267264,16272384,9634048,9744384,9744640,9633792,19460096,20619296,20629376,20676608,20611200,128,56,15597824,15638528,15638784,15597568,19736576,20652032,20598912,656000,61440,46080,30720,0,544,0,0,0
.long 2416640,2417664,14094336,14204928,1051011932,20640264,20661000,18428928,67108864,860160,1156226560,33,1016832,3632128,3632128,3632128,6295040,6297600,6300160,16308224,16313344,9773056,9773312,9662464,9662720,19531776,20619808,20629384,20678144,20611200,128,57,15648768,15649024,15607808,15608064,19762176,20652544,20598976,676480,0,66560,51200,20480,544,0,0,0
.long 2156544,2157568,14311424,14422016,1051011932,20640272,20661008,19186688,67108864,870400,1156226592,34,1017856,3635200,3635200,3635200,6302720,6305280,6307840,16349184,16354304,9801984,9691136,9691392,9801728,19603456,20620320,20629392,20679680,20611200,128,58,15659264,15618048,15618304,15659008,19787776,20653056,20599168,696960,20480,5120,71680,40960,544,0,0,0
.long 2418688,2419712,14315520,14426112,1051011932,20640280,20661016,19944448,67108864,870400,1156226592,35,1018880,3638272,3638272,3638272,6310400,6312960,6315520,16390144,16395264,9717760,9718016,9828352,9828608,19670016,20620576,20629400,20681216,20611200,128,59,15628288,15628544,15669248,15669504,19813376,20653568,20599232,717440,40960,25600,10240,61440,544,0,0,0
.long 4210688,4211712,9691136,9801728,1065353216,20620288,20661248,17676288,20679168,901120,1961565696,32,1343488,3956736,3956736,3956736,6615040,6617600,6620160,16273408,16281600,11403520,11513856,11514112,11403264,17944576,20627488,20629376,20676608,20611328,0,16,16253184,16293888,16294144,16252928,18221056,20660224,20603008,1310848,61440,46080,30720,0,928,0,0,0
.long 4472832,4473856,9695232,9805824,1065353216,20620296,20661256,18434048,67108864,901120,1961565696,33,1344512,3959808,3959808,3959808,6622720,6625280,6627840,16314368,16322560,11542528,11542784,11431936,11432192,18016256,20628000,20629384,20678144,20611328,0,17,16304128,16304384,16263168,16263424,18246656,20660736,20603072,1331328,0,66560,51200,20480,928,0,0,0
.long 4212736,4213760,9912320,10022912,1065353216,20620304,20661264,19191808,67108864,911360,1961565728,34,1345536,3962880,3962880,3962880,6630400,6632960,6635520,16355328,16363520,11571456,11460608,11460864,11571200,18087936,20628512,20629392,20679680,20611328,0,18,16314624,16273408,16273664,16314368,18272256,20661248,20603264,1351808,20480,5120,71680,40960,928,0,0,0
.long 4474880,4475904,9916416,10027008,1065353216,20620312,20661272,19949568,67108864,911360,1961565728,35,1346560,3965952,3965952,3965952,6638080,6640640,6643200,16396288,16404480,11487232,11487488,11597824,11598080,18154496,20628768,20629400,20681216,20611328,0,19,16283648,16283904,16324608,16324864,18297856,20661760,20603328,1372288,40960,25600,10240,61440,928,0,0,0
.long 4243456,4244480,13230080,13340672,1065353216,20636672,20661504,17681408,20679296,942080,1961565696,32,1671168,4284416,4284416,4284416,6942720,6945280,6947840,16277504,16282624,11403520,11513856,11514112,11403264,19460096,20627488,20629376,20676608,20611456,0,48,16253184,16293888,16294144,16252928,19736576,20660224,20603008,1311360,61440,46080,30720,0,544,0,0,0
.long 4505600,4506624,13234176,13344768,1065353216,20636680,20661512,18439168,67108864,942080,1961565696,33,1672192,4287488,4287488,4287488,6950400,6952960,6955520,16318464,16323584,11542528,11542784,11431936,11432192,19531776,20628000,20629384,20678144,20611456,0,49,16304128,16304384,16263168,16263424,19762176,20660736,20603072,1331840,0,66560,51200,20480,544,0,0,0
.long 4245504,4246528,13451264,13561856,1065353216,20636688,20661520,19196928,67108864,952320,1961565728,34,1673216,4290560,4290560,4290560,6958080,6960640,6963200,16359424,16364544,11571456,11460608,11460864,11571200,19603456,20628512,20629392,20679680,20611456,0,50,16314624,16273408,16273664,16314368,19787776,20661248,20603264,1352320,20480,5120,71680,40960,544,0,0,0
.long 4507648,4508672,13455360,13565952,1065353216,20636696,20661528,19954688,67108864,952320,1961565728,35,1674240,4293632,4293632,4293632,6965760,6968320,6970880,16400384,16405504,11487232,11487488,11597824,11598080,19670016,20628768,20629400,20681216,20611456,0,51,16283648,16283904,16324608,16324864,19813376,20661760,20603328,1372800,40960,25600,10240,61440,544,0,0,0
.long 5263360,5265920,8839168,8949760,1065353216,20616704,20661760,17686528,20679424,983040,3035340288,32,1998848,4612096,4612096,4612096,7270400,7272960,7275520,16283648,16291840,13172992,13283328,13283584,13172736,17944576,20635680,20629376,20676608,20611456,128,8,16908544,16949248,16949504,16908288,18221056,20668416,20607104,1966208,61440,46080,30720,0,928,0,0,0
.long 5263360,5265920,8843264,8953856,1065353216,20616712,20661768,18444288,67108864,983040,3035340288,33,1999872,4615168,4615168,4615168,7278080,7280640,7283200,16324608,16332800,13312000,13312256,13201408,13201664,18016256,20636192,20629384,20678144,20611456,128,9,16959488,16959744,16918528,16918784,18246656,20668928,20607168,1986688,0,66560,51200,20480,928,0,0,0
.long 5268480,5271040,9060352,9170944,1065353216,20616720,20661776,19202048,67108864,993280,3035340320,34,2000896,4618240,4618240,4618240,7285760,7288320,7290880,16365568,16373760,13340928,13230080,13230336,13340672,18087936,20636704,20629392,20679680,20611456,128,10,16969984,16928768,16929024,16969728,18272256,20669440,20607360,2007168,20480,5120,71680,40960,928,0,0,0
.long 5268480,5271040,9064448,9175040,1065353216,20616728,20661784,19959808,67108864,993280,3035340320,35,2001920,4621312,4621312,4621312,7293440,7296000,7298560,16406528,16414720,13256704,13256960,13367296,13367552,18154496,20636960,20629400,20681216,20611456,128,11,16939008,16939264,16979968,16980224,18297856,20669952,20607424,2027648,40960,25600,10240,61440,928,0,0,0
.long 5345280,5347840,12378112,12488704,1065353216,20633088,20662016,17691648,20679552,1024000,3035340288,32,2326528,4939776,4939776,4939776,7598080,7600640,7603200,16287744,16292864,13172992,13283328,13283584,13172736,19460096,20635680,20629376,20676608,20611584,0,40,16908544,16949248,16949504,16908288,19736576,20668416,20607104,1966720,61440,46080,30720,0,544,0,0,0
.long 5345280,5347840,12382208,12492800,1065353216,20633096,20662024,18449408,67108864,1024000,3035340288,33,2327552,4942848,4942848,4942848,7605760,7608320,7610880,16328704,16333824,13312000,13312256,13201408,13201664,19531776,20636192,20629384,20678144,20611584,0,41,16959488,16959744,16918528,16918784,19762176,20668928,20607168,1987200,0,66560,51200,20480,544,0,0,0
.long 5350400,5352960,12599296,12709888,1065353216,20633104,20662032,19207168,67108864,1034240,3035340320,34,2328576,4945920,4945920,4945920,7613440,7616000,7618560,16369664,16374784,13340928,13230080,13230336,13340672,19603456,20636704,20629392,20679680,20611584,0,42,16969984,16928768,16929024,16969728,19787776,20669440,20607360,2007680,20480,5120,71680,40960,544,0,0,0
.long 5350400,5352960,12603392,12713984,1065353216,20633112,20662040,19964928,67108864,1034240,3035340320,35,2329600,4948992,4948992,4948992,7621120,7623680,7626240,16410624,16415744,13256704,13256960,13367296,13367552,19670016,20636960,20629400,20681216,20611584,0,43,16939008,16939264,16979968,16980224,19813376,20669952,20607424,2028160,40960,25600,10240,61440,544,0,0,0
.long 528384,529408,8314880,8425472,1051011932,20613248,20662272,17656064,20678664,742400,350887488,36,36864,2650112,2650112,2650112,5314560,5317120,5319680,16416768,16424960,8085760,8196096,8196352,8085504,17944576,20611120,20631424,20676608,20611072,0,4,15024384,15065088,15065344,15024128,18221056,20643856,20595328,82048,61440,46080,30720,0,928,0,0,0
.long 790528,791552,8318976,8429568,1051011932,20613256,20662280,18413824,67108864,742400,350887488,37,37888,2653184,2653184,2653184,5322240,5324800,5327360,16457728,16465920,8224768,8225024,8114176,8114432,18016256,20611632,20631432,20678144,20611072,0,5,15075328,15075584,15034368,15034624,18246656,20644368,20595392,102528,0,66560,51200,20480,928,0,0,0
.long 530432,531456,8536064,8646656,1051011932,20613264,20662288,19171584,67108864,752640,350887520,38,38912,2656256,2656256,2656256,5329920,5332480,5335040,16498688,16506880,8253696,8142848,8143104,8253440,18087936,20612144,20631440,20679680,20611072,0,6,15085824,15044608,15044864,15085568,18272256,20644880,20595584,123008,20480,5120,71680,40960,928,0,0,0
.long 792576,793600,8540160,8650752,1051011932,20613272,20662296,19929344,67108864,752640,350887520,39,39936,2659328,2659328,2659328,5337600,5340160,5342720,16539648,16547840,8169472,8169728,8280064,8280320,18154496,20612400,20631448,20681216,20611072,0,7,15054848,15055104,15095808,15096064,18297856,20645392,20595648,143488,40960,25600,10240,61440,928,0,0,0
.long 561152,562176,11853824,11964416,1051011932,20629632,20662528,17661184,20678792,783360,350887488,36,364544,2977792,2977792,2977792,5642240,5644800,5647360,16420864,16425984,8085760,8196096,8196352,8085504,19460096,20611120,20631424,20676608,20611072,0,36,15024384,15065088,15065344,15024128,19736576,20643856,20595328,82560,61440,46080,30720,0,544,0,0,0
.long 823296,824320,11857920,11968512,1051011932,20629640,20662536,18418944,67108864,783360,350887488,37,365568,2980864,2980864,2980864,5649920,5652480,5655040,16461824,16466944,8224768,8225024,8114176,8114432,19531776,20611632,20631432,20678144,20611072,0,37,15075328,15075584,15034368,15034624,19762176,20644368,20595392,103040,0,66560,51200,20480,544,0,0,0
.long 563200,564224,12075008,12185600,1051011932,20629648,20662544,19176704,67108864,793600,350887520,38,366592,2983936,2983936,2983936,5657600,5660160,5662720,16502784,16507904,8253696,8142848,8143104,8253440,19603456,20612144,20631440,20679680,20611072,0,38,15085824,15044608,15044864,15085568,19787776,20644880,20595584,123520,20480,5120,71680,40960,544,0,0,0
.long 825344,826368,12079104,12189696,1051011932,20629656,20662552,19934464,67108864,793600,350887520,39,367616,2987008,2987008,2987008,5665280,5667840,5670400,16543744,16548864,8169472,8169728,8280064,8280320,19670016,20612400,20631448,20681216,20611072,0,39,15054848,15055104,15095808,15096064,19813376,20645392,20595648,144000,40960,25600,10240,61440,544,0,0,0
.long 2125824,2126848,10993664,11104256,1051011932,20625920,20662784,17666304,20678920,824320,1156226624,36,692224,3305472,3305472,3305472,5969920,5972480,5975040,16427008,16435200,9855232,9965568,9965824,9854976,17944576,20619312,20631424,20676608,20611200,0,28,15679744,15720448,15720704,15679488,18221056,20652048,20599424,737408,61440,46080,30720,0,928,0,0,0
.long 2387968,2388992,10997760,11108352,1051011932,20625928,20662792,18424064,67108864,824320,1156226624,37,693248,3308544,3308544,3308544,5977600,5980160,5982720,16467968,16476160,9994240,9994496,9883648,9883904,18016256,20619824,20631432,20678144,20611200,0,29,15730688,15730944,15689728,15689984,18246656,20652560,20599488,757888,0,66560,51200,20480,928,0,0,0
.long 2127872,2128896,11214848,11325440,1051011932,20625936,20662800,19181824,67108864,834560,1156226656,38,694272,3311616,3311616,3311616,5985280,5987840,5990400,16508928,16517120,10023168,9912320,9912576,10022912,18087936,20620336,20631440,20679680,20611200,0,30,15741184,15699968,15700224,15740928,18272256,20653072,20599680,778368,20480,5120,71680,40960,928,0,0,0
.long 2390016,2391040,11218944,11329536,1051011932,20625944,20662808,19939584,67108864,834560,1156226656,39,695296,3314688,3314688,3314688,5992960,5995520,5998080,16549888,16558080,9938944,9939200,10049536,10049792,18154496,20620592,20631448,20681216,20611200,0,31,15710208,15710464,15751168,15751424,18297856,20653584,20599744,798848,40960,25600,10240,61440,928,0,0,0
.long 2158592,2159616,14532608,14643200,1051011932,20642304,20663040,17671424,20679048,865280,1156226624,36,1019904,3633152,3633152,3633152,6297600,6300160,6302720,16431104,16436224,9855232,9965568,9965824,9854976,19460096,20619312,20631424,20676608,20611200,128,60,15679744,15720448,15720704,15679488,19736576,20652048,20599424,737920,61440,46080,30720,0,544,0,0,0
.long 2420736,2421760,14536704,14647296,1051011932,20642312,20663048,18429184,67108864,865280,1156226624,37,1020928,3636224,3636224,3636224,6305280,6307840,6310400,16472064,16477184,9994240,9994496,9883648,9883904,19531776,20619824,20631432,20678144,20611200,128,61,15730688,15730944,15689728,15689984,19762176,20652560,20599488,758400,0,66560,51200,20480,544,0,0,0
.long 2160640,2161664,14753792,14864384,1051011932,20642320,20663056,19186944,67108864,875520,1156226656,38,1021952,3639296,3639296,3639296,6312960,6315520,6318080,16513024,16518144,10023168,9912320,9912576,10022912,19603456,20620336,20631440,20679680,20611200,128,62,15741184,15699968,15700224,15740928,19787776,20653072,20599680,778880,20480,5120,71680,40960,544,0,0,0
.long 2422784,2423808,14757888,14868480,1051011932,20642328,20663064,19944704,67108864,875520,1156226656,39,1022976,3642368,3642368,3642368,6320640,6323200,6325760,16553984,16559104,9938944,9939200,10049536,10049792,19670016,20620592,20631448,20681216,20611200,128,63,15710208,15710464,15751168,15751424,19813376,20653584,20599744,799360,40960,25600,10240,61440,544,0,0,0
.long 4214784,4215808,10133504,10244096,1065353216,20622336,20663296,17676544,20679176,906240,1961565760,36,1347584,3960832,3960832,3960832,6625280,6627840,6630400,16437248,16445440,11624704,11735040,11735296,11624448,17944576,20627504,20631424,20676608,20611328,0,20,16335104,16375808,16376064,16334848,18221056,20660240,20603520,1392768,61440,46080,30720,0,928,0,0,0
.long 4476928,4477952,10137600,10248192,1065353216,20622344,20663304,18434304,67108864,906240,1961565760,37,1348608,3963904,3963904,3963904,6632960,6635520,6638080,16478208,16486400,11763712,11763968,11653120,11653376,18016256,20628016,20631432,20678144,20611328,0,21,16386048,16386304,16345088,16345344,18246656,20660752,20603584,1413248,0,66560,51200,20480,928,0,0,0
.long 4216832,4217856,10354688,10465280,1065353216,20622352,20663312,19192064,67108864,916480,1961565792,38,1349632,3966976,3966976,3966976,6640640,6643200,6645760,16519168,16527360,11792640,11681792,11682048,11792384,18087936,20628528,20631440,20679680,20611328,0,22,16396544,16355328,16355584,16396288,18272256,20661264,20603776,1433728,20480,5120,71680,40960,928,0,0,0
.long 4478976,4480000,10358784,10469376,1065353216,20622360,20663320,19949824,67108864,916480,1961565792,39,1350656,3970048,3970048,3970048,6648320,6650880,6653440,16560128,16568320,11708416,11708672,11819008,11819264,18154496,20628784,20631448,20681216,20611328,0,23,16365568,16365824,16406528,16406784,18297856,20661776,20603840,1454208,40960,25600,10240,61440,928,0,0,0
.long 4247552,4248576,13672448,13783040,1065353216,20638720,20663552,17681664,20679304,947200,1961565760,36,1675264,4288512,4288512,4288512,6952960,6955520,6958080,16441344,16446464,11624704,11735040,11735296,11624448,19460096,20627504,20631424,20676608,20611456,0,52,16335104,16375808,16376064,16334848,19736576,20660240,20603520,1393280,61440,46080,30720,0,544,0,0,0
.long 4509696,4510720,13676544,13787136,1065353216,20638728,20663560,18439424,67108864,947200,1961565760,37,1676288,4291584,4291584,4291584,6960640,6963200,6965760,16482304,16487424,11763712,11763968,11653120,11653376,19531776,20628016,20631432,20678144,20611456,0,53,16386048,16386304,16345088,16345344,19762176,20660752,20603584,1413760,0,66560,51200,20480,544,0,0,0
.long 4249600,4250624,13893632,14004224,1065353216,20638736,20663568,19197184,67108864,957440,1961565792,38,1677312,4294656,4294656,4294656,6968320,6970880,6973440,16523264,16528384,11792640,11681792,11682048,11792384,19603456,20628528,20631440,20679680,20611456,0,54,16396544,16355328,16355584,16396288,19787776,20661264,20603776,1434240,20480,5120,71680,40960,544,0,0,0
.long 4511744,4512768,13897728,14008320,1065353216,20638744,20663576,19954944,67108864,957440,1961565792,39,1678336,4297728,4297728,4297728,6976000,6978560,6981120,16564224,16569344,11708416,11708672,11819008,11819264,19670016,20628784,20631448,20681216,20611456,0,55,16365568,16365824,16406528,16406784,19813376,20661776,20603840,1454720,40960,25600,10240,61440,544,0,0,0
.long 5273600,5276160,9289728,9400320,1065353216,20618752,20663808,17686784,20679432,988160,3303775808,36,2002944,4616192,4616192,4616192,7280640,7283200,7285760,16447488,16455680,13394176,13504512,13504768,13393920,17944576,20635696,20631424,20676608,20611456,128,12,16990464,17031168,17031424,16990208,18221056,20668432,20607616,2048128,61440,46080,30720,0,928,0,0,0
.long 5273600,5276160,9293824,9404416,1065353216,20618760,20663816,18444544,67108864,988160,3303775808,37,2003968,4619264,4619264,4619264,7288320,7290880,7293440,16488448,16496640,13533184,13533440,13422592,13422848,18016256,20636208,20631432,20678144,20611456,128,13,17041408,17041664,17000448,17000704,18246656,20668944,20607680,2068608,0,66560,51200,20480,928,0,0,0
.long 5278720,5281280,9510912,9621504,1065353216,20618768,20663824,19202304,67108864,998400,3303775840,38,2004992,4622336,4622336,4622336,7296000,7298560,7301120,16529408,16537600,13562112,13451264,13451520,13561856,18087936,20636720,20631440,20679680,20611456,128,14,17051904,17010688,17010944,17051648,18272256,20669456,20607872,2089088,20480,5120,71680,40960,928,0,0,0
.long 5278720,5281280,9515008,9625600,1065353216,20618776,20663832,19960064,67108864,998400,3303775840,39,2006016,4625408,4625408,4625408,7303680,7306240,7308800,16570368,16578560,13477888,13478144,13588480,13588736,18154496,20636976,20631448,20681216,20611456,128,15,17020928,17021184,17061888,17062144,18297856,20669968,20607936,2109568,40960,25600,10240,61440,928,0,0,0
.long 5355520,5358080,12828672,12939264,1065353216,20635136,20664064,17691904,20679560,1029120,3303775808,36,2330624,4943872,4943872,4943872,7608320,7610880,7613440,16451584,16456704,13394176,13504512,13504768,13393920,19460096,20635696,20631424,20676608,20611584,0,44,16990464,17031168,17031424,16990208,19736576,20668432,20607616,2048640,61440,46080,30720,0,544,0,0,0
.long 5355520,5358080,12832768,12943360,1065353216,20635144,20664072,18449664,67108864,1029120,3303775808,37,2331648,4946944,4946944,4946944,7616000,7618560,7621120,16492544,16497664,13533184,13533440,13422592,13422848,19531776,20636208,20631432,20678144,20611584,0,45,17041408,17041664,17000448,17000704,19762176,20668944,20607680,2069120,0,66560,51200,20480,544,0,0,0
.long 5360640,5363200,13049856,13160448,1065353216,20635152,20664080,19207424,67108864,1039360,3303775840,38,2332672,4950016,4950016,4950016,7623680,7626240,7628800,16533504,16538624,13562112,13451264,13451520,13561856,19603456,20636720,20631440,20679680,20611584,0,46,17051904,17010688,17010944,17051648,19787776,20669456,20607872,2089600,20480,5120,71680,40960,544,0,0,0
.long 5360640,5363200,13053952,13164544,1065353216,20635160,20664088,19965184,67108864,1039360,3303775840,39,2333696,4953088,4953088,4953088,7631360,7633920,7636480,16574464,16579584,13477888,13478144,13588480,13588736,19670016,20636976,20631448,20681216,20611584,0,47,17020928,17021184,17061888,17062144,19813376,20669968,20607936,2110080,40960,25600,10240,61440,544,0,0,0
.long 532480,533504,8757248,8867840,1051011932,20615296,20664320,17656320,20678672,757760,350895616,40,40960,2654208,2654208,2654208,5324800,5327360,5329920,16580608,16588800,8306944,8417280,8417536,8306688,17944576,20613152,20633472,20676608,20611072,0,8,15106304,15147008,15147264,15106048,18221056,20645888,20595840,163968,61440,46080,30720,0,928,0,0,0
.long 794624,795648,8761344,8871936,1051011932,20615304,20664328,18414080,67108864,757760,350895616,41,41984,2657280,2657280,2657280,5332480,5335040,5337600,16621568,16629760,8445952,8446208,8335360,8335616,18016256,20613536,20633480,20678144,20611072,0,9,15157248,15157504,15116288,15116544,18246656,20646400,20595904,184448,0,66560,51200,20480,928,0,0,0
.long 534528,535552,8978432,9089024,1051011932,20615312,20664336,19171840,67108864,768000,350895648,42,43008,2660352,2660352,2660352,5340160,5342720,5345280,16662528,16670720,8474880,8364032,8364288,8474624,18087936,20614176,20633488,20679680,20611072,0,10,15167744,15126528,15126784,15167488,18272256,20646912,20596096,204928,20480,5120,71680,40960,928,0,0,0
.long 796672,797696,8982528,9093120,1051011932,20615320,20664344,19929600,67108864,768000,350895648,43,44032,2663424,2663424,2663424,5347840,5350400,5352960,16703488,16711680,8390656,8390912,8501248,8501504,18154496,20614432,20633496,20681216,20611072,0,11,15136768,15137024,15177728,15177984,18297856,20647424,20596160,225408,40960,25600,10240,61440,928,0,0,0
.long 565248,566272,12296192,12406784,1051011932,20631680,20664576,17661440,20678800,798720,350895616,40,368640,2981888,2981888,2981888,5652480,5655040,5657600,16584704,16589824,8306944,8417280,8417536,8306688,19460096,20613152,20633472,20676608,20611072,0,40,15106304,15147008,15147264,15106048,19736576,20645888,20595840,164480,61440,46080,30720,0,544,0,0,0
.long 827392,828416,12300288,12410880,1051011932,20631688,20664584,18419200,67108864,798720,350895616,41,369664,2984960,2984960,2984960,5660160,5662720,5665280,16625664,16630784,8445952,8446208,8335360,8335616,19531776,20613536,20633480,20678144,20611072,0,41,15157248,15157504,15116288,15116544,19762176,20646400,20595904,184960,0,66560,51200,20480,544,0,0,0
.long 567296,568320,12517376,12627968,1051011932,20631696,20664592,19176960,67108864,808960,350895648,42,370688,2988032,2988032,2988032,5667840,5670400,5672960,16666624,16671744,8474880,8364032,8364288,8474624,19603456,20614176,20633488,20679680,20611072,0,42,15167744,15126528,15126784,15167488,19787776,20646912,20596096,205440,20480,5120,71680,40960,544,0,0,0
.long 829440,830464,12521472,12632064,1051011932,20631704,20664600,19934720,67108864,808960,350895648,43,371712,2991104,2991104,2991104,5675520,5678080,5680640,16707584,16712704,8390656,8390912,8501248,8501504,19670016,20614432,20633496,20681216,20611072,0,43,15136768,15137024,15177728,15177984,19813376,20647424,20596160,225920,40960,25600,10240,61440,544,0,0,0
.long 2621440,2622464,7897088,8007680,1065353216,20611712,20664832,17666560,20678928,839680,1156234752,40,696320,3309568,3309568,3309568,5980160,5982720,5985280,16590848,16599040,10076416,10186752,10187008,10076160,17944576,20621344,20633472,20676608,20611200,0,0,15761664,15802368,15802624,15761408,18221056,20654080,20599936,819328,61440,46080,30720,0,928,0,0,0
.long 2883584,2884608,7901184,8011776,1065353216,20611720,20664840,18424320,67108864,839680,1156234752,41,697344,3312640,3312640,3312640,5987840,5990400,5992960,16631808,16640000,10215424,10215680,10104832,10105088,18016256,20621728,20633480,20678144,20611200,0,1,15812608,15812864,15771648,15771904,18246656,20654592,20600000,839808,0,66560,51200,20480,928,0,0,0
.long 2623488,2624512,8118272,8228864,1065353216,20611728,20664848,19182080,67108864,849920,1156234784,42,698368,3315712,3315712,3315712,5995520,5998080,6000640,16672768,16680960,10244352,10133504,10133760,10244096,18087936,20622368,20633488,20679680,20611200,0,2,15823104,15781888,15782144,15822848,18272256,20655104,20600192,860288,20480,5120,71680,40960,928,0,0,0
.long 2885632,2886656,8122368,8232960,1065353216,20611736,20664856,19939840,67108864,849920,1156234784,43,699392,3318784,3318784,3318784,6003200,6005760,6008320,16713728,16721920,10160128,10160384,10270720,10270976,18154496,20622624,20633496,20681216,20611200,0,3,15792128,15792384,15833088,15833344,18297856,20655616,20600256,880768,40960,25600,10240,61440,928,0,0,0
.long 2654208,2655232,11436032,11546624,1065353216,20628096,20665088,17671680,20679056,880640,1156234752,40,1024000,3637248,3637248,3637248,6307840,6310400,6312960,16594944,16600064,10076416,10186752,10187008,10076160,19460096,20621344,20633472,20676608,20611200,128,32,15761664,15802368,15802624,15761408,19736576,20654080,20599936,819840,61440,46080,30720,0,544,0,0,0
.long 2916352,2917376,11440128,11550720,1065353216,20628104,20665096,18429440,67108864,880640,1156234752,41,1025024,3640320,3640320,3640320,6315520,6318080,6320640,16635904,16641024,10215424,10215680,10104832,10105088,19531776,20621728,20633480,20678144,20611200,128,33,15812608,15812864,15771648,15771904,19762176,20654592,20600000,840320,0,66560,51200,20480,544,0,0,0
.long 2656256,2657280,11657216,11767808,1065353216,20628112,20665104,19187200,67108864,890880,1156234784,42,1026048,3643392,3643392,3643392,6323200,6325760,6328320,16676864,16681984,10244352,10133504,10133760,10244096,19603456,20622368,20633488,20679680,20611200,128,34,15823104,15781888,15782144,15822848,19787776,20655104,20600192,860800,20480,5120,71680,40960,544,0,0,0
.long 2918400,2919424,11661312,11771904,1065353216,20628120,20665112,19944960,67108864,890880,1156234784,43,1027072,3646464,3646464,3646464,6330880,6333440,6336000,16717824,16722944,10160128,10160384,10270720,10270976,19670016,20622624,20633496,20681216,20611200,128,35,15792128,15792384,15833088,15833344,19813376,20655616,20600256,881280,40960,25600,10240,61440,544,0,0,0
.long 4218880,4219904,10584064,10694656,1065353216,20624384,20665344,17676800,20679184,921600,2230009344,40,1351680,3964928,3964928,3964928,6635520,6638080,6640640,16601088,16609280,11845888,11956224,11956480,11845632,17944576,20629536,20633472,20676608,20611328,0,24,16417024,16457728,16457984,16416768,18221056,20662272,20604032,1474688,61440,46080,30720,0,928,0,0,0
.long 4481024,4482048,10588160,10698752,1065353216,20624392,20665352,18434560,67108864,921600,2230009344,41,1352704,3968000,3968000,3968000,6643200,6645760,6648320,16642048,16650240,11984896,11985152,11874304,11874560,18016256,20629920,20633480,20678144,20611328,0,25,16467968,16468224,16427008,16427264,18246656,20662784,20604096,1495168,0,66560,51200,20480,928,0,0,0
.long 4220928,4221952,10805248,10915840,1065353216,20624400,20665360,19192320,67108864,931840,2230009376,42,1353728,3971072,3971072,3971072,6650880,6653440,6656000,16683008,16691200,12013824,11902976,11903232,12013568,18087936,20630560,20633488,20679680,20611328,0,26,16478464,16437248,16437504,16478208,18272256,20663296,20604288,1515648,20480,5120,71680,40960,928,0,0,0
.long 4483072,4484096,10809344,10919936,1065353216,20624408,20665368,19950080,67108864,931840,2230009376,43,1354752,3974144,3974144,3974144,6658560,6661120,6663680,16723968,16732160,11929600,11929856,12040192,12040448,18154496,20630816,20633496,20681216,20611328,0,27,16447488,16447744,16488448,16488704,18297856,20663808,20604352,1536128,40960,25600,10240,61440,928,0,0,0
.long 4251648,4252672,14123008,14233600,1065353216,20640768,20665600,17681920,20679312,962560,2230009344,40,1679360,4292608,4292608,4292608,6963200,6965760,6968320,16605184,16610304,11845888,11956224,11956480,11845632,19460096,20629536,20633472,20676608,20611456,0,56,16417024,16457728,16457984,16416768,19736576,20662272,20604032,1475200,61440,46080,30720,0,544,0,0,0
.long 4513792,4514816,14127104,14237696,1065353216,20640776,20665608,18439680,67108864,962560,2230009344,41,1680384,4295680,4295680,4295680,6970880,6973440,6976000,16646144,16651264,11984896,11985152,11874304,11874560,19531776,20629920,20633480,20678144,20611456,0,57,16467968,16468224,16427008,16427264,19762176,20662784,20604096,1495680,0,66560,51200,20480,544,0,0,0
.long 4253696,4254720,14344192,14454784,1065353216,20640784,20665616,19197440,67108864,972800,2230009376,42,1681408,4298752,4298752,4298752,6978560,6981120,6983680,16687104,16692224,12013824,11902976,11903232,12013568,19603456,20630560,20633488,20679680,20611456,0,58,16478464,16437248,16437504,16478208,19787776,20663296,20604288,1516160,20480,5120,71680,40960,544,0,0,0
.long 4515840,4516864,14348288,14458880,1065353216,20640792,20665624,19955200,67108864,972800,2230009376,43,1682432,4301824,4301824,4301824,6986240,6988800,6991360,16728064,16733184,11929600,11929856,12040192,12040448,19670016,20630816,20633496,20681216,20611456,0,59,16447488,16447744,16488448,16488704,19813376,20663808,20604352,1536640,40960,25600,10240,61440,544,0,0,0
.long 5283840,5286400,9723904,9834496,1065353216,20620800,20665856,17687040,20679440,1003520,3035348480,40,2007040,4620288,4620288,4620288,7290880,7293440,7296000,16611328,16619520,13615360,13725696,13725952,13615104,17944576,20637728,20633472,20676608,20611456,128,16,17072384,17113088,17113344,17072128,18221056,20670464,20608128,2130048,61440,46080,30720,0,928,0,0,0
.long 5283840,5286400,9728000,9838592,1065353216,20620808,20665864,18444800,67108864,1003520,3035348480,41,2008064,4623360,4623360,4623360,7298560,7301120,7303680,16652288,16660480,13754368,13754624,13643776,13644032,18016256,20638112,20633480,20678144,20611456,128,17,17123328,17123584,17082368,17082624,18246656,20670976,20608192,2150528,0,66560,51200,20480,928,0,0,0
.long 5288960,5291520,9945088,10055680,1065353216,20620816,20665872,19202560,67108864,1013760,3035348512,42,2009088,4626432,4626432,4626432,7306240,7308800,7311360,16693248,16701440,13783296,13672448,13672704,13783040,18087936,20638752,20633488,20679680,20611456,128,18,17133824,17092608,17092864,17133568,18272256,20671488,20608384,2171008,20480,5120,71680,40960,928,0,0,0
.long 5288960,5291520,9949184,10059776,1065353216,20620824,20665880,19960320,67108864,1013760,3035348512,43,2010112,4629504,4629504,4629504,7313920,7316480,7319040,16734208,16742400,13699072,13699328,13809664,13809920,18154496,20639008,20633496,20681216,20611456,128,19,17102848,17103104,17143808,17144064,18297856,20672000,20608448,2191488,40960,25600,10240,61440,928,0,0,0
.long 5365760,5368320,13262848,13373440,1065353216,20637184,20666112,17692160,20679568,1044480,3035348480,40,2334720,4947968,4947968,4947968,7618560,7621120,7623680,16615424,16620544,13615360,13725696,13725952,13615104,19460096,20637728,20633472,20676608,20611584,0,48,17072384,17113088,17113344,17072128,19736576,20670464,20608128,2130560,61440,46080,30720,0,544,0,0,0
.long 5365760,5368320,13266944,13377536,1065353216,20637192,20666120,18449920,67108864,1044480,3035348480,41,2335744,4951040,4951040,4951040,7626240,7628800,7631360,16656384,16661504,13754368,13754624,13643776,13644032,19531776,20638112,20633480,20678144,20611584,0,49,17123328,17123584,17082368,17082624,19762176,20670976,20608192,2151040,0,66560,51200,20480,544,0,0,0
.long 5370880,5373440,13484032,13594624,1065353216,20637200,20666128,19207680,67108864,1054720,3035348512,42,2336768,4954112,4954112,4954112,7633920,7636480,7639040,16697344,16702464,13783296,13672448,13672704,13783040,19603456,20638752,20633488,20679680,20611584,0,50,17133824,17092608,17092864,17133568,19787776,20671488,20608384,2171520,20480,5120,71680,40960,544,0,0,0
.long 5370880,5373440,13488128,13598720,1065353216,20637208,20666136,19965440,67108864,1054720,3035348512,43,2337792,4957184,4957184,4957184,7641600,7644160,7646720,16738304,16743424,13699072,13699328,13809664,13809920,19670016,20639008,20633496,20681216,20611584,0,51,17102848,17103104,17143808,17144064,19813376,20672000,20608448,2192000,40960,25600,10240,61440,544,0,0,0
.long 536576,537600,9199616,9310208,1051011932,20617344,20666368,17656576,20678680,762880,350895680,44,45056,2658304,2658304,2658304,5335040,5337600,5340160,16744448,16752640,8528128,8638464,8638720,8527872,17944576,20613168,20635520,20676608,20611072,0,12,15188224,15228928,15229184,15187968,18221056,20645904,20596352,245888,61440,46080,30720,0,928,0,0,0
.long 798720,799744,9203712,9314304,1051011932,20617352,20666376,18414336,67108864,762880,350895680,45,46080,2661376,2661376,2661376,5342720,5345280,5347840,16785408,16793600,8667136,8667392,8556544,8556800,18016256,20613552,20635528,20678144,20611072,0,13,15239168,15239424,15198208,15198464,18246656,20646416,20596416,266368,0,66560,51200,20480,928,0,0,0
.long 538624,539648,9420800,9531392,1051011932,20617360,20666384,19172096,67108864,773120,350895712,46,47104,2664448,2664448,2664448,5350400,5352960,5355520,16826368,16834560,8696064,8585216,8585472,8695808,18087936,20614192,20635536,20679680,20611072,0,14,15249664,15208448,15208704,15249408,18272256,20646928,20596608,286848,20480,5120,71680,40960,928,0,0,0
.long 800768,801792,9424896,9535488,1051011932,20617368,20666392,19929856,67108864,773120,350895712,47,48128,2667520,2667520,2667520,5358080,5360640,5363200,16867328,16875520,8611840,8612096,8722432,8722688,18154496,20614448,20635544,20681216,20611072,0,15,15218688,15218944,15259648,15259904,18297856,20647440,20596672,307328,40960,25600,10240,61440,928,0,0,0
.long 569344,570368,12738560,12849152,1051011932,20633728,20666624,17661696,20678808,803840,350895680,44,372736,2985984,2985984,2985984,5662720,5665280,5667840,16748544,16753664,8528128,8638464,8638720,8527872,19460096,20613168,20635520,20676608,20611072,0,44,15188224,15228928,15229184,15187968,19736576,20645904,20596352,246400,61440,46080,30720,0,544,0,0,0
.long 831488,832512,12742656,12853248,1051011932,20633736,20666632,18419456,67108864,803840,350895680,45,373760,2989056,2989056,2989056,5670400,5672960,5675520,16789504,16794624,8667136,8667392,8556544,8556800,19531776,20613552,20635528,20678144,20611072,0,45,15239168,15239424,15198208,15198464,19762176,20646416,20596416,266880,0,66560,51200,20480,544,0,0,0
.long 571392,572416,12959744,13070336,1051011932,20633744,20666640,19177216,67108864,814080,350895712,46,374784,2992128,2992128,2992128,5678080,5680640,5683200,16830464,16835584,8696064,8585216,8585472,8695808,19603456,20614192,20635536,20679680,20611072,0,46,15249664,15208448,15208704,15249408,19787776,20646928,20596608,287360,20480,5120,71680,40960,544,0,0,0
.long 833536,834560,12963840,13074432,1051011932,20633752,20666648,19934976,67108864,814080,350895712,47,375808,2995200,2995200,2995200,5685760,5688320,5690880,16871424,16876544,8611840,8612096,8722432,8722688,19670016,20614448,20635544,20681216,20611072,0,47,15218688,15218944,15259648,15259904,19813376,20647440,20596672,307840,40960,25600,10240,61440,544,0,0,0
.long 2625536,2626560,67108864,67108864,1065353216,20613760,20666880,17666816,20678936,844800,3840589376,44,700416,3313664,3313664,3313664,5990400,5992960,5995520,16754688,16762880,10297600,10407936,10408192,10297344,17944576,20621360,20635520,20676608,20611200,0,4,15843584,15884288,15884544,15843328,18221056,20654096,20600448,901248,61440,46080,30720,0,928,0,0,0
.long 2887680,2888704,67108864,67108864,1065353216,20613768,20666888,18424576,67108864,844800,3840589376,45,701440,3316736,3316736,3316736,5998080,6000640,6003200,16795648,16803840,10436608,10436864,10326016,10326272,18016256,20621744,20635528,20678144,20611200,0,5,15894528,15894784,15853568,15853824,18246656,20654608,20600512,921728,0,66560,51200,20480,928,0,0,0
.long 2627584,2628608,67108864,67108864,1065353216,20613776,20666896,19182336,67108864,855040,3840589408,46,702464,3319808,3319808,3319808,6005760,6008320,6010880,16836608,16844800,10465536,10354688,10354944,10465280,18087936,20622384,20635536,20679680,20611200,0,6,15905024,15863808,15864064,15904768,18272256,20655120,20600704,942208,20480,5120,71680,40960,928,0,0,0
.long 2889728,2890752,67108864,67108864,1065353216,20613784,20666904,19940096,67108864,855040,3840589408,47,703488,3322880,3322880,3322880,6013440,6016000,6018560,16877568,16885760,10381312,10381568,10491904,10492160,18154496,20622640,20635544,20681216,20611200,0,7,15874048,15874304,15915008,15915264,18297856,20655632,20600768,962688,40960,25600,10240,61440,928,0,0,0
.long 2658304,2659328,67108864,67108864,1065353216,20630144,20667136,17671936,20679064,885760,3840589376,44,1028096,3641344,3641344,3641344,6318080,6320640,6323200,16758784,16763904,10297600,10407936,10408192,10297344,19460096,20621360,20635520,20676608,20611200,128,36,15843584,15884288,15884544,15843328,19736576,20654096,20600448,901760,61440,46080,30720,0,544,0,0,0
.long 2920448,2921472,67108864,67108864,1065353216,20630152,20667144,18429696,67108864,885760,3840589376,45,1029120,3644416,3644416,3644416,6325760,6328320,6330880,16799744,16804864,10436608,10436864,10326016,10326272,19531776,20621744,20635528,20678144,20611200,128,37,15894528,15894784,15853568,15853824,19762176,20654608,20600512,922240,0,66560,51200,20480,544,0,0,0
.long 2660352,2661376,67108864,67108864,1065353216,20630160,20667152,19187456,67108864,896000,3840589408,46,1030144,3647488,3647488,3647488,6333440,6336000,6338560,16840704,16845824,10465536,10354688,10354944,10465280,19603456,20622384,20635536,20679680,20611200,128,38,15905024,15863808,15864064,15904768,19787776,20655120,20600704,942720,20480,5120,71680,40960,544,0,0,0
.long 2922496,2923520,67108864,67108864,1065353216,20630168,20667160,19945216,67108864,896000,3840589408,47,1031168,3650560,3650560,3650560,6341120,6343680,6346240,16881664,16886784,10381312,10381568,10491904,10492160,19670016,20622640,20635544,20681216,20611200,128,39,15874048,15874304,15915008,15915264,19813376,20655632,20600768,963200,40960,25600,10240,61440,544,0,0,0
.long 4222976,4224000,11026432,11137024,1065353216,20626432,20667392,17677056,20679192,926720,2230009408,44,1355776,3969024,3969024,3969024,6645760,6648320,6650880,16764928,16773120,12067072,12177408,12177664,12066816,17944576,20629552,20635520,20676608,20611328,0,28,16498944,16539648,16539904,16498688,18221056,20662288,20604544,1556608,61440,46080,30720,0,928,0,0,0
.long 4485120,4486144,11030528,11141120,1065353216,20626440,20667400,18434816,67108864,926720,2230009408,45,1356800,3972096,3972096,3972096,6653440,6656000,6658560,16805888,16814080,12206080,12206336,12095488,12095744,18016256,20629936,20635528,20678144,20611328,0,29,16549888,16550144,16508928,16509184,18246656,20662800,20604608,1577088,0,66560,51200,20480,928,0,0,0
.long 4225024,4226048,11247616,11358208,1065353216,20626448,20667408,19192576,67108864,936960,2230009440,46,1357824,3975168,3975168,3975168,6661120,6663680,6666240,16846848,16855040,12235008,12124160,12124416,12234752,18087936,20630576,20635536,20679680,20611328,0,30,16560384,16519168,16519424,16560128,18272256,20663312,20604800,1597568,20480,5120,71680,40960,928,0,0,0
.long 4487168,4488192,11251712,11362304,1065353216,20626456,20667416,19950336,67108864,936960,2230009440,47,1358848,3978240,3978240,3978240,6668800,6671360,6673920,16887808,16896000,12150784,12151040,12261376,12261632,18154496,20630832,20635544,20681216,20611328,0,31,16529408,16529664,16570368,16570624,18297856,20663824,20604864,1618048,40960,25600,10240,61440,928,0,0,0
.long 4255744,4256768,14565376,14675968,1065353216,20642816,20667648,17682176,20679320,967680,2230009408,44,1683456,4296704,4296704,4296704,6973440,6976000,6978560,16769024,16774144,12067072,12177408,12177664,12066816,19460096,20629552,20635520,20676608,20611456,0,60,16498944,16539648,16539904,16498688,19736576,20662288,20604544,1557120,61440,46080,30720,0,544,0,0,0
.long 4517888,4518912,14569472,14680064,1065353216,20642824,20667656,18439936,67108864,967680,2230009408,45,1684480,4299776,4299776,4299776,6981120,6983680,6986240,16809984,16815104,12206080,12206336,12095488,12095744,19531776,20629936,20635528,20678144,20611456,0,61,16549888,16550144,16508928,16509184,19762176,20662800,20604608,1577600,0,66560,51200,20480,544,0,0,0
.long 4257792,4258816,14786560,14897152,1065353216,20642832,20667664,19197696,67108864,977920,2230009440,46,1685504,4302848,4302848,4302848,6988800,6991360,6993920,16850944,16856064,12235008,12124160,12124416,12234752,19603456,20630576,20635536,20679680,20611456,0,62,16560384,16519168,16519424,16560128,19787776,20663312,20604800,1598080,20480,5120,71680,40960,544,0,0,0
.long 4519936,4520960,14790656,14901248,1065353216,20642840,20667672,19955456,67108864,977920,2230009440,47,1686528,4305920,4305920,4305920,6996480,6999040,7001600,16891904,16897024,12150784,12151040,12261376,12261632,19670016,20630832,20635544,20681216,20611456,0,63,16529408,16529664,16570368,16570624,19813376,20663824,20604864,1618560,40960,25600,10240,61440,544,0,0,0
.long 5294080,5296640,10166272,10276864,1065353216,20622848,20667904,17687296,20679448,1008640,3035348544,44,2011136,4624384,4624384,4624384,7301120,7303680,7306240,16775168,16783360,13836544,13946880,13947136,13836288,17944576,20637744,20635520,20676608,20611456,128,20,17154304,17195008,17195264,17154048,18221056,20670480,20608640,2211968,61440,46080,30720,0,928,0,0,0
.long 5294080,5296640,10170368,10280960,1065353216,20622856,20667912,18445056,67108864,1008640,3035348544,45,2012160,4627456,4627456,4627456,7308800,7311360,7313920,16816128,16824320,13975552,13975808,13864960,13865216,18016256,20638128,20635528,20678144,20611456,128,21,17205248,17205504,17164288,17164544,18246656,20670992,20608704,2232448,0,66560,51200,20480,928,0,0,0
.long 5299200,5301760,10387456,10498048,1065353216,20622864,20667920,19202816,67108864,1018880,3035348576,46,2013184,4630528,4630528,4630528,7316480,7319040,7321600,16857088,16865280,14004480,13893632,13893888,14004224,18087936,20638768,20635536,20679680,20611456,128,22,17215744,17174528,17174784,17215488,18272256,20671504,20608896,2252928,20480,5120,71680,40960,928,0,0,0
.long 5299200,5301760,10391552,10502144,1065353216,20622872,20667928,19960576,67108864,1018880,3035348576,47,2014208,4633600,4633600,4633600,7324160,7326720,7329280,16898048,16906240,13920256,13920512,14030848,14031104,18154496,20639024,20635544,20681216,20611456,128,23,17184768,17185024,17225728,17225984,18297856,20672016,20608960,2273408,40960,25600,10240,61440,928,0,0,0
.long 5376000,5378560,13705216,13815808,1065353216,20639232,20668160,17692416,20679576,1049600,3035348544,44,2338816,4952064,4952064,4952064,7628800,7631360,7633920,16779264,16784384,13836544,13946880,13947136,13836288,19460096,20637744,20635520,20676608,20611584,0,52,17154304,17195008,17195264,17154048,19736576,20670480,20608640,2212480,61440,46080,30720,0,544,0,0,0
.long 5376000,5378560,13709312,13819904,1065353216,20639240,20668168,18450176,67108864,1049600,3035348544,45,2339840,4955136,4955136,4955136,7636480,7639040,7641600,16820224,16825344,13975552,13975808,13864960,13865216,19531776,20638128,20635528,20678144,20611584,0,53,17205248,17205504,17164288,17164544,19762176,20670992,20608704,2232960,0,66560,51200,20480,544,0,0,0
.long 5381120,5383680,13926400,14036992,1065353216,20639248,20668176,19207936,67108864,1059840,3035348576,46,2340864,4958208,4958208,4958208,7644160,7646720,7649280,16861184,16866304,14004480,13893632,13893888,14004224,19603456,20638768,20635536,20679680,20611584,0,54,17215744,17174528,17174784,17215488,19787776,20671504,20608896,2253440,20480,5120,71680,40960,544,0,0,0
.long 5381120,5383680,13930496,14041088,1065353216,20639256,20668184,19965696,67108864,1059840,3035348576,47,2341888,4961280,4961280,4961280,7651840,7654400,7656960,16902144,16907264,13920256,13920512,14030848,14031104,19670016,20639024,20635544,20681216,20611584,0,55,17184768,17185024,17225728,17225984,19813376,20672016,20608960,2273920,40960,25600,10240,61440,544,0,0,0
.long 540672,541696,67108864,67108864,1051011932,20619392,20668416,17707008,20679680,1146880,3840564736,48,49152,2662400,2662400,2662400,5345280,5347840,5350400,16908288,16916480,8749312,8859648,8859904,8749056,17944576,20615200,20637568,20676608,20611072,0,16,15270144,15310848,15311104,15269888,18221056,20647936,20596864,327808,61440,46080,30720,0,928,0,0,0
.long 802816,803840,67108864,67108864,1051011932,20619400,20668424,18464768,67108864,1146880,3840564736,49,50176,2665472,2665472,2665472,5352960,5355520,5358080,16949248,16957440,8888320,8888576,8777728,8777984,18016256,20615584,20637576,20678144,20611072,0,17,15321088,15321344,15280128,15280384,18246656,20648448,20596928,348288,0,66560,51200,20480,928,0,0,0
.long 542720,543744,67108864,67108864,1051011932,20619408,20668432,19222528,67108864,1157120,3840564768,50,51200,2668544,2668544,2668544,5360640,5363200,5365760,16990208,16998400,8917248,8806400,8806656,8916992,18087936,20616096,20637584,20679680,20611072,0,18,15331584,15290368,15290624,15331328,18272256,20648960,20597120,368768,20480,5120,71680,40960,928,0,0,0
.long 804864,805888,67108864,67108864,1051011932,20619416,20668440,19980288,67108864,1157120,3840564768,51,52224,2671616,2671616,2671616,5368320,5370880,5373440,17031168,17039360,8833024,8833280,8943616,8943872,18154496,20616480,20637592,20681216,20611072,0,19,15300608,15300864,15341568,15341824,18297856,20649472,20597184,389248,40960,25600,10240,61440,928,0,0,0
.long 573440,574464,67108864,67108864,1051011932,20635776,20668672,17712128,20679808,1187840,3840564736,48,376832,2990080,2990080,2990080,5672960,5675520,5678080,16912384,16917504,8749312,8859648,8859904,8749056,19460096,20615200,20637568,20676608,20611072,0,48,15270144,15310848,15311104,15269888,19736576,20647936,20596864,328320,61440,46080,30720,0,544,0,0,0
.long 835584,836608,67108864,67108864,1051011932,20635784,20668680,18469888,67108864,1187840,3840564736,49,377856,2993152,2993152,2993152,5680640,5683200,5685760,16953344,16958464,8888320,8888576,8777728,8777984,19531776,20615584,20637576,20678144,20611072,0,49,15321088,15321344,15280128,15280384,19762176,20648448,20596928,348800,0,66560,51200,20480,544,0,0,0
.long 575488,576512,67108864,67108864,1051011932,20635792,20668688,19227648,67108864,1198080,3840564768,50,378880,2996224,2996224,2996224,5688320,5690880,5693440,16994304,16999424,8917248,8806400,8806656,8916992,19603456,20616096,20637584,20679680,20611072,0,50,15331584,15290368,15290624,15331328,19787776,20648960,20597120,369280,20480,5120,71680,40960,544,0,0,0
.long 837632,838656,67108864,67108864,1051011932,20635800,20668696,19985408,67108864,1198080,3840564768,51,379904,2999296,2999296,2999296,5696000,5698560,5701120,17035264,17040384,8833024,8833280,8943616,8943872,19670016,20616480,20637592,20681216,20611072,0,51,15300608,15300864,15341568,15341824,19813376,20649472,20597184,389760,40960,25600,10240,61440,544,0,0,0
.long 2629632,2630656,8790016,8900608,1065353216,20615808,20668928,17717248,20679936,1228800,1424678400,48,704512,3317760,3317760,3317760,6000640,6003200,6005760,16918528,16926720,10518784,10629120,10629376,10518528,17944576,20623392,20637568,20676608,20611200,0,8,15925504,15966208,15966464,15925248,18221056,20656128,20600960,983168,61440,46080,30720,0,928,0,0,0
.long 2891776,2892800,8794112,8904704,1065353216,20615816,20668936,18475008,67108864,1228800,1424678400,49,705536,3320832,3320832,3320832,6008320,6010880,6013440,16959488,16967680,10657792,10658048,10547200,10547456,18016256,20623776,20637576,20678144,20611200,0,9,15976448,15976704,15935488,15935744,18246656,20656640,20601024,1003648,0,66560,51200,20480,928,0,0,0
.long 2631680,2632704,9011200,9121792,1065353216,20615824,20668944,19232768,67108864,1239040,1424678432,50,706560,3323904,3323904,3323904,6016000,6018560,6021120,17000448,17008640,10686720,10575872,10576128,10686464,18087936,20624288,20637584,20679680,20611200,0,10,15986944,15945728,15945984,15986688,18272256,20657152,20601216,1024128,20480,5120,71680,40960,928,0,0,0
.long 2893824,2894848,9015296,9125888,1065353216,20615832,20668952,19990528,67108864,1239040,1424678432,51,707584,3326976,3326976,3326976,6023680,6026240,6028800,17041408,17049600,10602496,10602752,10713088,10713344,18154496,20624672,20637592,20681216,20611200,0,11,15955968,15956224,15996928,15997184,18297856,20657664,20601280,1044608,40960,25600,10240,61440,928,0,0,0
.long 2662400,2663424,12328960,12439552,1065353216,20632192,20669184,17722368,20680064,1269760,1424678400,48,1032192,3645440,3645440,3645440,6328320,6330880,6333440,16922624,16927744,10518784,10629120,10629376,10518528,19460096,20623392,20637568,20676608,20611200,128,40,15925504,15966208,15966464,15925248,19736576,20656128,20600960,983680,61440,46080,30720,0,544,0,0,0
.long 2924544,2925568,12333056,12443648,1065353216,20632200,20669192,18480128,67108864,1269760,1424678400,49,1033216,3648512,3648512,3648512,6336000,6338560,6341120,16963584,16968704,10657792,10658048,10547200,10547456,19531776,20623776,20637576,20678144,20611200,128,41,15976448,15976704,15935488,15935744,19762176,20656640,20601024,1004160,0,66560,51200,20480,544,0,0,0
.long 2664448,2665472,12550144,12660736,1065353216,20632208,20669200,19237888,67108864,1280000,1424678432,50,1034240,3651584,3651584,3651584,6343680,6346240,6348800,17004544,17009664,10686720,10575872,10576128,10686464,19603456,20624288,20637584,20679680,20611200,128,42,15986944,15945728,15945984,15986688,19787776,20657152,20601216,1024640,20480,5120,71680,40960,544,0,0,0
.long 2926592,2927616,12554240,12664832,1065353216,20632216,20669208,19995648,67108864,1280000,1424678432,51,1035264,3654656,3654656,3654656,6351360,6353920,6356480,17045504,17050624,10602496,10602752,10713088,10713344,19670016,20624672,20637592,20681216,20611200,128,43,15955968,15956224,15996928,15997184,19813376,20657664,20601280,1045120,40960,25600,10240,61440,544,0,0,0
.long 4718592,4719616,7929856,8040448,1065353216,20612224,20669440,17727488,20680192,1310720,2230017536,48,1359872,3973120,3973120,3973120,6656000,6658560,6661120,16928768,16936960,12288256,12398592,12398848,12288000,17944576,20631584,20637568,20676608,20611328,0,0,16580864,16621568,16621824,16580608,18221056,20664320,20605056,1638528,61440,46080,30720,0,928,0,0,0
.long 4980736,4981760,7933952,8044544,1065353216,20612232,20669448,18485248,67108864,1310720,2230017536,49,1360896,3976192,3976192,3976192,6663680,6666240,6668800,16969728,16977920,12427264,12427520,12316672,12316928,18016256,20631968,20637576,20678144,20611328,0,1,16631808,16632064,16590848,16591104,18246656,20664832,20605120,1659008,0,66560,51200,20480,928,0,0,0
.long 4720640,4721664,8151040,8261632,1065353216,20612240,20669456,19243008,67108864,1320960,2230017568,50,1361920,3979264,3979264,3979264,6671360,6673920,6676480,17010688,17018880,12456192,12345344,12345600,12455936,18087936,20632480,20637584,20679680,20611328,0,2,16642304,16601088,16601344,16642048,18272256,20665344,20605312,1679488,20480,5120,71680,40960,928,0,0,0
.long 4982784,4983808,8155136,8265728,1065353216,20612248,20669464,20000768,67108864,1320960,2230017568,51,1362944,3982336,3982336,3982336,6679040,6681600,6684160,17051648,17059840,12371968,12372224,12482560,12482816,18154496,20632864,20637592,20681216,20611328,0,3,16611328,16611584,16652288,16652544,18297856,20665856,20605376,1699968,40960,25600,10240,61440,928,0,0,0
.long 4751360,4752384,11468800,11579392,1065353216,20628608,20669696,17732608,20680320,1351680,2230017536,48,1687552,4300800,4300800,4300800,6983680,6986240,6988800,16932864,16937984,12288256,12398592,12398848,12288000,19460096,20631584,20637568,20676608,20611456,0,32,16580864,16621568,16621824,16580608,19736576,20664320,20605056,1639040,61440,46080,30720,0,544,0,0,0
.long 5013504,5014528,11472896,11583488,1065353216,20628616,20669704,18490368,67108864,1351680,2230017536,49,1688576,4303872,4303872,4303872,6991360,6993920,6996480,16973824,16978944,12427264,12427520,12316672,12316928,19531776,20631968,20637576,20678144,20611456,0,33,16631808,16632064,16590848,16591104,19762176,20664832,20605120,1659520,0,66560,51200,20480,544,0,0,0
.long 4753408,4754432,11689984,11800576,1065353216,20628624,20669712,19248128,67108864,1361920,2230017568,50,1689600,4306944,4306944,4306944,6999040,7001600,7004160,17014784,17019904,12456192,12345344,12345600,12455936,19603456,20632480,20637584,20679680,20611456,0,34,16642304,16601088,16601344,16642048,19787776,20665344,20605312,1680000,20480,5120,71680,40960,544,0,0,0
.long 5015552,5016576,11694080,11804672,1065353216,20628632,20669720,20005888,67108864,1361920,2230017568,51,1690624,4310016,4310016,4310016,7006720,7009280,7011840,17055744,17060864,12371968,12372224,12482560,12482816,19670016,20632864,20637592,20681216,20611456,0,35,16611328,16611584,16652288,16652544,19813376,20665856,20605376,1700480,40960,25600,10240,61440,544,0,0,0
.long 5304320,5306880,10608640,10719232,1065353216,20624896,20669952,17737728,20680448,1392640,3035356672,48,2015232,4628480,4628480,4628480,7311360,7313920,7316480,16939008,16947200,14057728,14168064,14168320,14057472,17944576,20639776,20637568,20676608,20611456,128,24,17236224,17276928,17277184,17235968,18221056,20672512,20609152,2293888,61440,46080,30720,0,928,0,0,0
.long 5304320,5306880,10612736,10723328,1065353216,20624904,20669960,18495488,67108864,1392640,3035356672,49,2016256,4631552,4631552,4631552,7319040,7321600,7324160,16979968,16988160,14196736,14196992,14086144,14086400,18016256,20640160,20637576,20678144,20611456,128,25,17287168,17287424,17246208,17246464,18246656,20673024,20609216,2314368,0,66560,51200,20480,928,0,0,0
.long 5309440,5312000,10829824,10940416,1065353216,20624912,20669968,19253248,67108864,1402880,3035356704,50,2017280,4634624,4634624,4634624,7326720,7329280,7331840,17020928,17029120,14225664,14114816,14115072,14225408,18087936,20640672,20637584,20679680,20611456,128,26,17297664,17256448,17256704,17297408,18272256,20673536,20609408,2334848,20480,5120,71680,40960,928,0,0,0
.long 5309440,5312000,10833920,10944512,1065353216,20624920,20669976,20011008,67108864,1402880,3035356704,51,2018304,4637696,4637696,4637696,7334400,7336960,7339520,17061888,17070080,14141440,14141696,14252032,14252288,18154496,20641056,20637592,20681216,20611456,128,27,17266688,17266944,17307648,17307904,18297856,20674048,20609472,2355328,40960,25600,10240,61440,928,0,0,0
.long 5386240,5388800,14147584,14258176,1065353216,20641280,20670208,17742848,20680576,1433600,3035356672,48,2342912,4956160,4956160,4956160,7639040,7641600,7644160,16943104,16948224,14057728,14168064,14168320,14057472,19460096,20639776,20637568,20676608,20611584,0,56,17236224,17276928,17277184,17235968,19736576,20672512,20609152,2294400,61440,46080,30720,0,544,0,0,0
.long 5386240,5388800,14151680,14262272,1065353216,20641288,20670216,18500608,67108864,1433600,3035356672,49,2343936,4959232,4959232,4959232,7646720,7649280,7651840,16984064,16989184,14196736,14196992,14086144,14086400,19531776,20640160,20637576,20678144,20611584,0,57,17287168,17287424,17246208,17246464,19762176,20673024,20609216,2314880,0,66560,51200,20480,544,0,0,0
.long 5391360,5393920,14368768,14479360,1065353216,20641296,20670224,19258368,67108864,1443840,3035356704,50,2344960,4962304,4962304,4962304,7654400,7656960,7659520,17025024,17030144,14225664,14114816,14115072,14225408,19603456,20640672,20637584,20679680,20611584,0,58,17297664,17256448,17256704,17297408,19787776,20673536,20609408,2335360,20480,5120,71680,40960,544,0,0,0
.long 5391360,5393920,14372864,14483456,1065353216,20641304,20670232,20016128,67108864,1443840,3035356704,51,2345984,4965376,4965376,4965376,7662080,7664640,7667200,17065984,17071104,14141440,14141696,14252032,14252288,19670016,20641056,20637592,20681216,20611584,0,59,17266688,17266944,17307648,17307904,19813376,20674048,20609472,2355840,40960,25600,10240,61440,544,0,0,0
.long 544768,545792,10084352,10194944,1051011932,20621440,20670464,17707264,20679688,1152000,350903872,52,53248,2666496,2666496,2666496,5355520,5358080,5360640,17072128,17080320,8970496,9080832,9081088,8970240,17944576,20615216,20639616,20676608,20611072,0,20,15352064,15392768,15393024,15351808,18221056,20647952,20597376,409728,61440,46080,30720,0,928,0,0,0
.long 806912,807936,10088448,10199040,1051011932,20621448,20670472,18465024,67108864,1152000,350903872,53,54272,2669568,2669568,2669568,5363200,5365760,5368320,17113088,17121280,9109504,9109760,8998912,8999168,18016256,20615600,20639624,20678144,20611072,0,21,15403008,15403264,15362048,15362304,18246656,20648464,20597440,430208,0,66560,51200,20480,928,0,0,0
.long 546816,547840,10305536,10416128,1051011932,20621456,20670480,19222784,67108864,1162240,350903904,54,55296,2672640,2672640,2672640,5370880,5373440,5376000,17154048,17162240,9138432,9027584,9027840,9138176,18087936,20616112,20639632,20679680,20611072,0,22,15413504,15372288,15372544,15413248,18272256,20648976,20597632,450688,20480,5120,71680,40960,928,0,0,0
.long 808960,809984,10309632,10420224,1051011932,20621464,20670488,19980544,67108864,1162240,350903904,55,56320,2675712,2675712,2675712,5378560,5381120,5383680,17195008,17203200,9054208,9054464,9164800,9165056,18154496,20616496,20639640,20681216,20611072,0,23,15382528,15382784,15423488,15423744,18297856,20649488,20597696,471168,40960,25600,10240,61440,928,0,0,0
.long 577536,578560,13623296,13733888,1051011932,20637824,20670720,17712384,20679816,1192960,350903872,52,380928,2994176,2994176,2994176,5683200,5685760,5688320,17076224,17081344,8970496,9080832,9081088,8970240,19460096,20615216,20639616,20676608,20611072,0,52,15352064,15392768,15393024,15351808,19736576,20647952,20597376,410240,61440,46080,30720,0,544,0,0,0
.long 839680,840704,13627392,13737984,1051011932,20637832,20670728,18470144,67108864,1192960,350903872,53,381952,2997248,2997248,2997248,5690880,5693440,5696000,17117184,17122304,9109504,9109760,8998912,8999168,19531776,20615600,20639624,20678144,20611072,0,53,15403008,15403264,15362048,15362304,19762176,20648464,20597440,430720,0,66560,51200,20480,544,0,0,0
.long 579584,580608,13844480,13955072,1051011932,20637840,20670736,19227904,67108864,1203200,350903904,54,382976,3000320,3000320,3000320,5698560,5701120,5703680,17158144,17163264,9138432,9027584,9027840,9138176,19603456,20616112,20639632,20679680,20611072,0,54,15413504,15372288,15372544,15413248,19787776,20648976,20597632,451200,20480,5120,71680,40960,544,0,0,0
.long 841728,842752,13848576,13959168,1051011932,20637848,20670744,19985664,67108864,1203200,350903904,55,384000,3003392,3003392,3003392,5706240,5708800,5711360,17199104,17204224,9054208,9054464,9164800,9165056,19670016,20616496,20639640,20681216,20611072,0,55,15382528,15382784,15423488,15423744,19813376,20649488,20597696,471680,40960,25600,10240,61440,544,0,0,0
.long 2633728,2634752,9232384,9342976,1065353216,20617856,20670976,17717504,20679944,1233920,1424678464,52,708608,3321856,3321856,3321856,6010880,6013440,6016000,17082368,17090560,10739968,10850304,10850560,10739712,17944576,20623408,20639616,20676608,20611200,0,12,16007424,16048128,16048384,16007168,18221056,20656144,20601472,1065088,61440,46080,30720,0,928,0,0,0
.long 2895872,2896896,9236480,9347072,1065353216,20617864,20670984,18475264,67108864,1233920,1424678464,53,709632,3324928,3324928,3324928,6018560,6021120,6023680,17123328,17131520,10878976,10879232,10768384,10768640,18016256,20623792,20639624,20678144,20611200,0,13,16058368,16058624,16017408,16017664,18246656,20656656,20601536,1085568,0,66560,51200,20480,928,0,0,0
.long 2635776,2636800,9453568,9564160,1065353216,20617872,20670992,19233024,67108864,1244160,1424678496,54,710656,3328000,3328000,3328000,6026240,6028800,6031360,17164288,17172480,10907904,10797056,10797312,10907648,18087936,20624304,20639632,20679680,20611200,0,14,16068864,16027648,16027904,16068608,18272256,20657168,20601728,1106048,20480,5120,71680,40960,928,0,0,0
.long 2897920,2898944,9457664,9568256,1065353216,20617880,20671000,19990784,67108864,1244160,1424678496,55,711680,3331072,3331072,3331072,6033920,6036480,6039040,17205248,17213440,10823680,10823936,10934272,10934528,18154496,20624688,20639640,20681216,20611200,0,15,16037888,16038144,16078848,16079104,18297856,20657680,20601792,1126528,40960,25600,10240,61440,928,0,0,0
.long 2666496,2667520,12771328,12881920,1065353216,20634240,20671232,17722624,20680072,1274880,1424678464,52,1036288,3649536,3649536,3649536,6338560,6341120,6343680,17086464,17091584,10739968,10850304,10850560,10739712,19460096,20623408,20639616,20676608,20611200,128,44,16007424,16048128,16048384,16007168,19736576,20656144,20601472,1065600,61440,46080,30720,0,544,0,0,0
.long 2928640,2929664,12775424,12886016,1065353216,20634248,20671240,18480384,67108864,1274880,1424678464,53,1037312,3652608,3652608,3652608,6346240,6348800,6351360,17127424,17132544,10878976,10879232,10768384,10768640,19531776,20623792,20639624,20678144,20611200,128,45,16058368,16058624,16017408,16017664,19762176,20656656,20601536,1086080,0,66560,51200,20480,544,0,0,0
.long 2668544,2669568,12992512,13103104,1065353216,20634256,20671248,19238144,67108864,1285120,1424678496,54,1038336,3655680,3655680,3655680,6353920,6356480,6359040,17168384,17173504,10907904,10797056,10797312,10907648,19603456,20624304,20639632,20679680,20611200,128,46,16068864,16027648,16027904,16068608,19787776,20657168,20601728,1106560,20480,5120,71680,40960,544,0,0,0
.long 2930688,2931712,12996608,13107200,1065353216,20634264,20671256,19995904,67108864,1285120,1424678496,55,1039360,3658752,3658752,3658752,6361600,6364160,6366720,17209344,17214464,10823680,10823936,10934272,10934528,19670016,20624688,20639640,20681216,20611200,128,47,16037888,16038144,16078848,16079104,19813376,20657680,20601792,1127040,40960,25600,10240,61440,544,0,0,0
.long 4722688,4723712,8372224,8482816,1065353216,20614272,20671488,17727744,20680200,1315840,2230017600,52,1363968,3977216,3977216,3977216,6666240,6668800,6671360,17092608,17100800,12509440,12619776,12620032,12509184,17944576,20631600,20639616,20676608,20611328,0,4,16662784,16703488,16703744,16662528,18221056,20664336,20605568,1720448,61440,46080,30720,0,928,0,0,0
.long 4984832,4985856,8376320,8486912,1065353216,20614280,20671496,18485504,67108864,1315840,2230017600,53,1364992,3980288,3980288,3980288,6673920,6676480,6679040,17133568,17141760,12648448,12648704,12537856,12538112,18016256,20631984,20639624,20678144,20611328,0,5,16713728,16713984,16672768,16673024,18246656,20664848,20605632,1740928,0,66560,51200,20480,928,0,0,0
.long 4724736,4725760,8593408,8704000,1065353216,20614288,20671504,19243264,67108864,1326080,2230017632,54,1366016,3983360,3983360,3983360,6681600,6684160,6686720,17174528,17182720,12677376,12566528,12566784,12677120,18087936,20632496,20639632,20679680,20611328,0,6,16724224,16683008,16683264,16723968,18272256,20665360,20605824,1761408,20480,5120,71680,40960,928,0,0,0
.long 4986880,4987904,8597504,8708096,1065353216,20614296,20671512,20001024,67108864,1326080,2230017632,55,1367040,3986432,3986432,3986432,6689280,6691840,6694400,17215488,17223680,12593152,12593408,12703744,12704000,18154496,20632880,20639640,20681216,20611328,0,7,16693248,16693504,16734208,16734464,18297856,20665872,20605888,1781888,40960,25600,10240,61440,928,0,0,0
.long 4755456,4756480,11911168,12021760,1065353216,20630656,20671744,17732864,20680328,1356800,2230017600,52,1691648,4304896,4304896,4304896,6993920,6996480,6999040,17096704,17101824,12509440,12619776,12620032,12509184,19460096,20631600,20639616,20676608,20611456,0,36,16662784,16703488,16703744,16662528,19736576,20664336,20605568,1720960,61440,46080,30720,0,544,0,0,0
.long 5017600,5018624,11915264,12025856,1065353216,20630664,20671752,18490624,67108864,1356800,2230017600,53,1692672,4307968,4307968,4307968,7001600,7004160,7006720,17137664,17142784,12648448,12648704,12537856,12538112,19531776,20631984,20639624,20678144,20611456,0,37,16713728,16713984,16672768,16673024,19762176,20664848,20605632,1741440,0,66560,51200,20480,544,0,0,0
.long 4757504,4758528,12132352,12242944,1065353216,20630672,20671760,19248384,67108864,1367040,2230017632,54,1693696,4311040,4311040,4311040,7009280,7011840,7014400,17178624,17183744,12677376,12566528,12566784,12677120,19603456,20632496,20639632,20679680,20611456,0,38,16724224,16683008,16683264,16723968,19787776,20665360,20605824,1761920,20480,5120,71680,40960,544,0,0,0
.long 5019648,5020672,12136448,12247040,1065353216,20630680,20671768,20006144,67108864,1367040,2230017632,55,1694720,4314112,4314112,4314112,7016960,7019520,7022080,17219584,17224704,12593152,12593408,12703744,12704000,19670016,20632880,20639640,20681216,20611456,0,39,16693248,16693504,16734208,16734464,19813376,20665872,20605888,1782400,40960,25600,10240,61440,544,0,0,0
.long 5314560,5317120,11059200,11169792,1065353216,20626944,20672000,17737984,20680456,1397760,3303792192,52,2019328,4632576,4632576,4632576,7321600,7324160,7326720,17102848,17111040,14278912,14389248,14389504,14278656,17944576,20639792,20639616,20676608,20611456,128,28,17318144,17358848,17359104,17317888,18221056,20672528,20609664,2375808,61440,46080,30720,0,928,0,0,0
.long 5314560,5317120,11063296,11173888,1065353216,20626952,20672008,18495744,67108864,1397760,3303792192,53,2020352,4635648,4635648,4635648,7329280,7331840,7334400,17143808,17152000,14417920,14418176,14307328,14307584,18016256,20640176,20639624,20678144,20611456,128,29,17369088,17369344,17328128,17328384,18246656,20673040,20609728,2396288,0,66560,51200,20480,928,0,0,0
.long 5319680,5322240,11280384,11390976,1065353216,20626960,20672016,19253504,67108864,1408000,3303792224,54,2021376,4638720,4638720,4638720,7336960,7339520,7342080,17184768,17192960,14446848,14336000,14336256,14446592,18087936,20640688,20639632,20679680,20611456,128,30,17379584,17338368,17338624,17379328,18272256,20673552,20609920,2416768,20480,5120,71680,40960,928,0,0,0
.long 5319680,5322240,11284480,11395072,1065353216,20626968,20672024,20011264,67108864,1408000,3303792224,55,2022400,4641792,4641792,4641792,7344640,7347200,7349760,17225728,17233920,14362624,14362880,14473216,14473472,18154496,20641072,20639640,20681216,20611456,128,31,17348608,17348864,17389568,17389824,18297856,20674064,20609984,2437248,40960,25600,10240,61440,928,0,0,0
.long 5396480,5399040,14598144,14708736,1065353216,20643328,20672256,17743104,20680584,1438720,3303792192,52,2347008,4960256,4960256,4960256,7649280,7651840,7654400,17106944,17112064,14278912,14389248,14389504,14278656,19460096,20639792,20639616,20676608,20611584,0,60,17318144,17358848,17359104,17317888,19736576,20672528,20609664,2376320,61440,46080,30720,0,544,0,0,0
.long 5396480,5399040,14602240,14712832,1065353216,20643336,20672264,18500864,67108864,1438720,3303792192,53,2348032,4963328,4963328,4963328,7656960,7659520,7662080,17147904,17153024,14417920,14418176,14307328,14307584,19531776,20640176,20639624,20678144,20611584,0,61,17369088,17369344,17328128,17328384,19762176,20673040,20609728,2396800,0,66560,51200,20480,544,0,0,0
.long 5401600,5404160,14819328,14929920,1065353216,20643344,20672272,19258624,67108864,1448960,3303792224,54,2349056,4966400,4966400,4966400,7664640,7667200,7669760,17188864,17193984,14446848,14336000,14336256,14446592,19603456,20640688,20639632,20679680,20611584,0,62,17379584,17338368,17338624,17379328,19787776,20673552,20609920,2417280,20480,5120,71680,40960,544,0,0,0
.long 5401600,5404160,14823424,14934016,1065353216,20643352,20672280,20016384,67108864,1448960,3303792224,55,2350080,4969472,4969472,4969472,7672320,7674880,7677440,17229824,17234944,14362624,14362880,14473216,14473472,19670016,20641072,20639640,20681216,20611584,0,63,17348608,17348864,17389568,17389824,19813376,20674064,20609984,2437760,40960,25600,10240,61440,544,0,0,0
.long 548864,549888,10526720,10637312,1051011932,20623488,20672512,17707520,20679696,1167360,350912000,56,57344,2670592,2670592,2670592,5365760,5368320,5370880,17235968,17244160,9191680,9302016,9302272,9191424,17944576,20617248,20641664,20676608,20611072,0,24,15433984,15474688,15474944,15433728,18221056,20649984,20597888,491648,61440,46080,30720,0,928,0,0,0
.long 811008,812032,10530816,10641408,1051011932,20623496,20672520,18465280,67108864,1167360,350912000,57,58368,2673664,2673664,2673664,5373440,5376000,5378560,17276928,17285120,9330688,9330944,9220096,9220352,18016256,20617632,20641672,20678144,20611072,0,25,15484928,15485184,15443968,15444224,18246656,20650496,20597952,512128,0,66560,51200,20480,928,0,0,0
.long 550912,551936,10747904,10858496,1051011932,20623504,20672528,19223040,67108864,1177600,350912032,58,59392,2676736,2676736,2676736,5381120,5383680,5386240,17317888,17326080,9359616,9248768,9249024,9359360,18087936,20618144,20641680,20679680,20611072,0,26,15495424,15454208,15454464,15495168,18272256,20651008,20598144,532608,20480,5120,71680,40960,928,0,0,0
.long 813056,814080,10752000,10862592,1051011932,20623512,20672536,19980800,67108864,1177600,350912032,59,60416,2679808,2679808,2679808,5388800,5391360,5393920,17358848,17367040,9275392,9275648,9385984,9386240,18154496,20618528,20641688,20681216,20611072,0,27,15464448,15464704,15505408,15505664,18297856,20651520,20598208,553088,40960,25600,10240,61440,928,0,0,0
.long 581632,582656,14065664,14176256,1051011932,20639872,20672768,17712640,20679824,1208320,350912000,56,385024,2998272,2998272,2998272,5693440,5696000,5698560,17240064,17245184,9191680,9302016,9302272,9191424,19460096,20617248,20641664,20676608,20611072,0,56,15433984,15474688,15474944,15433728,19736576,20649984,20597888,492160,61440,46080,30720,0,544,0,0,0
.long 843776,844800,14069760,14180352,1051011932,20639880,20672776,18470400,67108864,1208320,350912000,57,386048,3001344,3001344,3001344,5701120,5703680,5706240,17281024,17286144,9330688,9330944,9220096,9220352,19531776,20617632,20641672,20678144,20611072,0,57,15484928,15485184,15443968,15444224,19762176,20650496,20597952,512640,0,66560,51200,20480,544,0,0,0
.long 583680,584704,14286848,14397440,1051011932,20639888,20672784,19228160,67108864,1218560,350912032,58,387072,3004416,3004416,3004416,5708800,5711360,5713920,17321984,17327104,9359616,9248768,9249024,9359360,19603456,20618144,20641680,20679680,20611072,0,58,15495424,15454208,15454464,15495168,19787776,20651008,20598144,533120,20480,5120,71680,40960,544,0,0,0
.long 845824,846848,14290944,14401536,1051011932,20639896,20672792,19985920,67108864,1218560,350912032,59,388096,3007488,3007488,3007488,5716480,5719040,5721600,17362944,17368064,9275392,9275648,9385984,9386240,19670016,20618528,20641688,20681216,20611072,0,59,15464448,15464704,15505408,15505664,19813376,20651520,20598208,553600,40960,25600,10240,61440,544,0,0,0
.long 2637824,2638848,9666560,9777152,1065353216,20619904,20673024,17717760,20679952,1249280,1156251136,56,712704,3325952,3325952,3325952,6021120,6023680,6026240,17246208,17254400,10961152,11071488,11071744,10960896,17944576,20625440,20641664,20676608,20611200,0,16,16089344,16130048,16130304,16089088,18221056,20658176,20601984,1147008,61440,46080,30720,0,928,0,0,0
.long 2899968,2900992,9670656,9781248,1065353216,20619912,20673032,18475520,67108864,1249280,1156251136,57,713728,3329024,3329024,3329024,6028800,6031360,6033920,17287168,17295360,11100160,11100416,10989568,10989824,18016256,20625824,20641672,20678144,20611200,0,17,16140288,16140544,16099328,16099584,18246656,20658688,20602048,1167488,0,66560,51200,20480,928,0,0,0
.long 2639872,2640896,9887744,9998336,1065353216,20619920,20673040,19233280,67108864,1259520,1156251168,58,714752,3332096,3332096,3332096,6036480,6039040,6041600,17328128,17336320,11129088,11018240,11018496,11128832,18087936,20626336,20641680,20679680,20611200,0,18,16150784,16109568,16109824,16150528,18272256,20659200,20602240,1187968,20480,5120,71680,40960,928,0,0,0
.long 2902016,2903040,9891840,10002432,1065353216,20619928,20673048,19991040,67108864,1259520,1156251168,59,715776,3335168,3335168,3335168,6044160,6046720,6049280,17369088,17377280,11044864,11045120,11155456,11155712,18154496,20626720,20641688,20681216,20611200,0,19,16119808,16120064,16160768,16161024,18297856,20659712,20602304,1208448,40960,25600,10240,61440,928,0,0,0
.long 2670592,2671616,13205504,13316096,1065353216,20636288,20673280,17722880,20680080,1290240,1156251136,56,1040384,3653632,3653632,3653632,6348800,6351360,6353920,17250304,17255424,10961152,11071488,11071744,10960896,19460096,20625440,20641664,20676608,20611200,128,48,16089344,16130048,16130304,16089088,19736576,20658176,20601984,1147520,61440,46080,30720,0,544,0,0,0
.long 2932736,2933760,13209600,13320192,1065353216,20636296,20673288,18480640,67108864,1290240,1156251136,57,1041408,3656704,3656704,3656704,6356480,6359040,6361600,17291264,17296384,11100160,11100416,10989568,10989824,19531776,20625824,20641672,20678144,20611200,128,49,16140288,16140544,16099328,16099584,19762176,20658688,20602048,1168000,0,66560,51200,20480,544,0,0,0
.long 2672640,2673664,13426688,13537280,1065353216,20636304,20673296,19238400,67108864,1300480,1156251168,58,1042432,3659776,3659776,3659776,6364160,6366720,6369280,17332224,17337344,11129088,11018240,11018496,11128832,19603456,20626336,20641680,20679680,20611200,128,50,16150784,16109568,16109824,16150528,19787776,20659200,20602240,1188480,20480,5120,71680,40960,544,0,0,0
.long 2934784,2935808,13430784,13541376,1065353216,20636312,20673304,19996160,67108864,1300480,1156251168,59,1043456,3662848,3662848,3662848,6371840,6374400,6376960,17373184,17378304,11044864,11045120,11155456,11155712,19670016,20626720,20641688,20681216,20611200,128,51,16119808,16120064,16160768,16161024,19813376,20659712,20602304,1208960,40960,25600,10240,61440,544,0,0,0
.long 4726784,4727808,67108864,67108864,1065353216,20616320,20673536,17728000,20680208,1331200,3840638464,56,1368064,3981312,3981312,3981312,6676480,6679040,6681600,17256448,17264640,12730624,12840960,12841216,12730368,17944576,20633632,20641664,20676608,20611328,0,8,16744704,16785408,16785664,16744448,18221056,20666368,20606080,1802368,61440,46080,30720,0,928,0,0,0
.long 4988928,4989952,67108864,67108864,1065353216,20616328,20673544,18485760,67108864,1331200,3840638464,57,1369088,3984384,3984384,3984384,6684160,6686720,6689280,17297408,17305600,12869632,12869888,12759040,12759296,18016256,20634016,20641672,20678144,20611328,0,9,16795648,16795904,16754688,16754944,18246656,20666880,20606144,1822848,0,66560,51200,20480,928,0,0,0
.long 4728832,4729856,67108864,67108864,1065353216,20616336,20673552,19243520,67108864,1341440,3840638496,58,1370112,3987456,3987456,3987456,6691840,6694400,6696960,17338368,17346560,12898560,12787712,12787968,12898304,18087936,20634528,20641680,20679680,20611328,0,10,16806144,16764928,16765184,16805888,18272256,20667392,20606336,1843328,20480,5120,71680,40960,928,0,0,0
.long 4990976,4992000,67108864,67108864,1065353216,20616344,20673560,20001280,67108864,1341440,3840638496,59,1371136,3990528,3990528,3990528,6699520,6702080,6704640,17379328,17387520,12814336,12814592,12924928,12925184,18154496,20634912,20641688,20681216,20611328,0,11,16775168,16775424,16816128,16816384,18297856,20667904,20606400,1863808,40960,25600,10240,61440,928,0,0,0
.long 4759552,4760576,67108864,67108864,1065353216,20632704,20673792,17733120,20680336,1372160,3840638464,56,1695744,4308992,4308992,4308992,7004160,7006720,7009280,17260544,17265664,12730624,12840960,12841216,12730368,19460096,20633632,20641664,20676608,20611456,0,40,16744704,16785408,16785664,16744448,19736576,20666368,20606080,1802880,61440,46080,30720,0,544,0,0,0
.long 5021696,5022720,67108864,67108864,1065353216,20632712,20673800,18490880,67108864,1372160,3840638464,57,1696768,4312064,4312064,4312064,7011840,7014400,7016960,17301504,17306624,12869632,12869888,12759040,12759296,19531776,20634016,20641672,20678144,20611456,0,41,16795648,16795904,16754688,16754944,19762176,20666880,20606144,1823360,0,66560,51200,20480,544,0,0,0
.long 4761600,4762624,67108864,67108864,1065353216,20632720,20673808,19248640,67108864,1382400,3840638496,58,1697792,4315136,4315136,4315136,7019520,7022080,7024640,17342464,17347584,12898560,12787712,12787968,12898304,19603456,20634528,20641680,20679680,20611456,0,42,16806144,16764928,16765184,16805888,19787776,20667392,20606336,1843840,20480,5120,71680,40960,544,0,0,0
.long 5023744,5024768,67108864,67108864,1065353216,20632728,20673816,20006400,67108864,1382400,3840638496,59,1698816,4318208,4318208,4318208,7027200,7029760,7032320,17383424,17388544,12814336,12814592,12924928,12925184,19670016,20634912,20641688,20681216,20611456,0,43,16775168,16775424,16816128,16816384,19813376,20667904,20606400,1864320,40960,25600,10240,61440,544,0,0,0
.long 5242880,5245440,7962624,8073216,1065353216,20612736,20674048,17738240,20680464,1413120,3303800320,56,2023424,4636672,4636672,4636672,7331840,7334400,7336960,17266688,17274880,14500096,14610432,14610688,14499840,17944576,20641824,20641664,20676608,20611456,128,0,17400064,17440768,17441024,17399808,18221056,20674560,20610176,2457728,61440,46080,30720,0,928,0,0,0
.long 5242880,5245440,7966720,8077312,1065353216,20612744,20674056,18496000,67108864,1413120,3303800320,57,2024448,4639744,4639744,4639744,7339520,7342080,7344640,17307648,17315840,14639104,14639360,14528512,14528768,18016256,20642208,20641672,20678144,20611456,128,1,17451008,17451264,17410048,17410304,18246656,20675072,20610240,2478208,0,66560,51200,20480,928,0,0,0
.long 5248000,5250560,8183808,8294400,1065353216,20612752,20674064,19253760,67108864,1423360,3303800352,58,2025472,4642816,4642816,4642816,7347200,7349760,7352320,17348608,17356800,14668032,14557184,14557440,14667776,18087936,20642720,20641680,20679680,20611456,128,2,17461504,17420288,17420544,17461248,18272256,20675584,20610432,2498688,20480,5120,71680,40960,928,0,0,0
.long 5248000,5250560,8187904,8298496,1065353216,20612760,20674072,20011520,67108864,1423360,3303800352,59,2026496,4645888,4645888,4645888,7354880,7357440,7360000,17389568,17397760,14583808,14584064,14694400,14694656,18154496,20643104,20641688,20681216,20611456,128,3,17430528,17430784,17471488,17471744,18297856,20676096,20610496,2519168,40960,25600,10240,61440,928,0,0,0
.long 5324800,5327360,11501568,11612160,1065353216,20629120,20674304,17743360,20680592,1454080,3303800320,56,2351104,4964352,4964352,4964352,7659520,7662080,7664640,17270784,17275904,14500096,14610432,14610688,14499840,19460096,20641824,20641664,20676608,20611584,0,32,17400064,17440768,17441024,17399808,19736576,20674560,20610176,2458240,61440,46080,30720,0,544,0,0,0
.long 5324800,5327360,11505664,11616256,1065353216,20629128,20674312,18501120,67108864,1454080,3303800320,57,2352128,4967424,4967424,4967424,7667200,7669760,7672320,17311744,17316864,14639104,14639360,14528512,14528768,19531776,20642208,20641672,20678144,20611584,0,33,17451008,17451264,17410048,17410304,19762176,20675072,20610240,2478720,0,66560,51200,20480,544,0,0,0
.long 5329920,5332480,11722752,11833344,1065353216,20629136,20674320,19258880,67108864,1464320,3303800352,58,2353152,4970496,4970496,4970496,7674880,7677440,7680000,17352704,17357824,14668032,14557184,14557440,14667776,19603456,20642720,20641680,20679680,20611584,0,34,17461504,17420288,17420544,17461248,19787776,20675584,20610432,2499200,20480,5120,71680,40960,544,0,0,0
.long 5329920,5332480,11726848,11837440,1065353216,20629144,20674328,20016640,67108864,1464320,3303800352,59,2354176,4973568,4973568,4973568,7682560,7685120,7687680,17393664,17398784,14583808,14584064,14694400,14694656,19670016,20643104,20641688,20681216,20611584,0,35,17430528,17430784,17471488,17471744,19813376,20676096,20610496,2519680,40960,25600,10240,61440,544,0,0,0
.long 552960,553984,10969088,11079680,1051011932,20625536,20674560,17707776,20679704,1172480,350912064,60,61440,2674688,2674688,2674688,5376000,5378560,5381120,17399808,17408000,9412864,9523200,9523456,9412608,17944576,20617264,20643712,20676608,20611072,0,28,15515904,15556608,15556864,15515648,18221056,20650000,20598400,573568,61440,46080,30720,0,928,0,0,0
.long 815104,816128,10973184,11083776,1051011932,20625544,20674568,18465536,67108864,1172480,350912064,61,62464,2677760,2677760,2677760,5383680,5386240,5388800,17440768,17448960,9551872,9552128,9441280,9441536,18016256,20617648,20643720,20678144,20611072,0,29,15566848,15567104,15525888,15526144,18246656,20650512,20598464,594048,0,66560,51200,20480,928,0,0,0
.long 555008,556032,11190272,11300864,1051011932,20625552,20674576,19223296,67108864,1182720,350912096,62,63488,2680832,2680832,2680832,5391360,5393920,5396480,17481728,17489920,9580800,9469952,9470208,9580544,18087936,20618160,20643728,20679680,20611072,0,30,15577344,15536128,15536384,15577088,18272256,20651024,20598656,614528,20480,5120,71680,40960,928,0,0,0
.long 817152,818176,11194368,11304960,1051011932,20625560,20674584,19981056,67108864,1182720,350912096,63,64512,2683904,2683904,2683904,5399040,5401600,5404160,17522688,17530880,9496576,9496832,9607168,9607424,18154496,20618544,20643736,20681216,20611072,0,31,15546368,15546624,15587328,15587584,18297856,20651536,20598720,635008,40960,25600,10240,61440,928,0,0,0
.long 585728,586752,14508032,14618624,1051011932,20641920,20674816,17712896,20679832,1213440,350912064,60,389120,3002368,3002368,3002368,5703680,5706240,5708800,17403904,17409024,9412864,9523200,9523456,9412608,19460096,20617264,20643712,20676608,20611072,0,60,15515904,15556608,15556864,15515648,19736576,20650000,20598400,574080,61440,46080,30720,0,544,0,0,0
.long 847872,848896,14512128,14622720,1051011932,20641928,20674824,18470656,67108864,1213440,350912064,61,390144,3005440,3005440,3005440,5711360,5713920,5716480,17444864,17449984,9551872,9552128,9441280,9441536,19531776,20617648,20643720,20678144,20611072,0,61,15566848,15567104,15525888,15526144,19762176,20650512,20598464,594560,0,66560,51200,20480,544,0,0,0
.long 587776,588800,14729216,14839808,1051011932,20641936,20674832,19228416,67108864,1223680,350912096,62,391168,3008512,3008512,3008512,5719040,5721600,5724160,17485824,17490944,9580800,9469952,9470208,9580544,19603456,20618160,20643728,20679680,20611072,0,62,15577344,15536128,15536384,15577088,19787776,20651024,20598656,615040,20480,5120,71680,40960,544,0,0,0
.long 849920,850944,14733312,14843904,1051011932,20641944,20674840,19986176,67108864,1223680,350912096,63,392192,3011584,3011584,3011584,5726720,5729280,5731840,17526784,17531904,9496576,9496832,9607168,9607424,19670016,20618544,20643736,20681216,20611072,0,63,15546368,15546624,15587328,15587584,19813376,20651536,20598720,635520,40960,25600,10240,61440,544,0,0,0
.long 2641920,2642944,67108864,67108864,1065353216,20621952,20675072,17718016,20679960,1254400,3840605760,60,716800,3330048,3330048,3330048,6031360,6033920,6036480,17410048,17418240,11182336,11292672,11292928,11182080,17944576,20625456,20643712,20676608,20611200,0,20,16171264,16211968,16212224,16171008,18221056,20658192,20602496,1228928,61440,46080,30720,0,928,0,0,0
.long 2904064,2905088,67108864,67108864,1065353216,20621960,20675080,18475776,67108864,1254400,3840605760,61,717824,3333120,3333120,3333120,6039040,6041600,6044160,17451008,17459200,11321344,11321600,11210752,11211008,18016256,20625840,20643720,20678144,20611200,0,21,16222208,16222464,16181248,16181504,18246656,20658704,20602560,1249408,0,66560,51200,20480,928,0,0,0
.long 2643968,2644992,67108864,67108864,1065353216,20621968,20675088,19233536,67108864,1264640,3840605792,62,718848,3336192,3336192,3336192,6046720,6049280,6051840,17491968,17500160,11350272,11239424,11239680,11350016,18087936,20626352,20643728,20679680,20611200,0,22,16232704,16191488,16191744,16232448,18272256,20659216,20602752,1269888,20480,5120,71680,40960,928,0,0,0
.long 2906112,2907136,67108864,67108864,1065353216,20621976,20675096,19991296,67108864,1264640,3840605792,63,719872,3339264,3339264,3339264,6054400,6056960,6059520,17532928,17541120,11266048,11266304,11376640,11376896,18154496,20626736,20643736,20681216,20611200,0,23,16201728,16201984,16242688,16242944,18297856,20659728,20602816,1290368,40960,25600,10240,61440,928,0,0,0
.long 2674688,2675712,67108864,67108864,1065353216,20638336,20675328,17723136,20680088,1295360,3840605760,60,1044480,3657728,3657728,3657728,6359040,6361600,6364160,17414144,17419264,11182336,11292672,11292928,11182080,19460096,20625456,20643712,20676608,20611200,128,52,16171264,16211968,16212224,16171008,19736576,20658192,20602496,1229440,61440,46080,30720,0,544,0,0,0
.long 2936832,2937856,67108864,67108864,1065353216,20638344,20675336,18480896,67108864,1295360,3840605760,61,1045504,3660800,3660800,3660800,6366720,6369280,6371840,17455104,17460224,11321344,11321600,11210752,11211008,19531776,20625840,20643720,20678144,20611200,128,53,16222208,16222464,16181248,16181504,19762176,20658704,20602560,1249920,0,66560,51200,20480,544,0,0,0
.long 2676736,2677760,67108864,67108864,1065353216,20638352,20675344,19238656,67108864,1305600,3840605792,62,1046528,3663872,3663872,3663872,6374400,6376960,6379520,17496064,17501184,11350272,11239424,11239680,11350016,19603456,20626352,20643728,20679680,20611200,128,54,16232704,16191488,16191744,16232448,19787776,20659216,20602752,1270400,20480,5120,71680,40960,544,0,0,0
.long 2938880,2939904,67108864,67108864,1065353216,20638360,20675352,19996416,67108864,1305600,3840605792,63,1047552,3666944,3666944,3666944,6382080,6384640,6387200,17537024,17542144,11266048,11266304,11376640,11376896,19670016,20626736,20643736,20681216,20611200,128,55,16201728,16201984,16242688,16242944,19813376,20659728,20602816,1290880,40960,25600,10240,61440,544,0,0,0
.long 4730880,4731904,9265152,9375744,1065353216,20618368,20675584,17728256,20680216,1336320,2498461248,60,1372160,3985408,3985408,3985408,6686720,6689280,6691840,17420288,17428480,12951808,13062144,13062400,12951552,17944576,20633648,20643712,20676608,20611328,0,12,16826624,16867328,16867584,16826368,18221056,20666384,20606592,1884288,61440,46080,30720,0,928,0,0,0
.long 4993024,4994048,9269248,9379840,1065353216,20618376,20675592,18486016,67108864,1336320,2498461248,61,1373184,3988480,3988480,3988480,6694400,6696960,6699520,17461248,17469440,13090816,13091072,12980224,12980480,18016256,20634032,20643720,20678144,20611328,0,13,16877568,16877824,16836608,16836864,18246656,20666896,20606656,1904768,0,66560,51200,20480,928,0,0,0
.long 4732928,4733952,9486336,9596928,1065353216,20618384,20675600,19243776,67108864,1346560,2498461280,62,1374208,3991552,3991552,3991552,6702080,6704640,6707200,17502208,17510400,13119744,13008896,13009152,13119488,18087936,20634544,20643728,20679680,20611328,0,14,16888064,16846848,16847104,16887808,18272256,20667408,20606848,1925248,20480,5120,71680,40960,928,0,0,0
.long 4995072,4996096,9490432,9601024,1065353216,20618392,20675608,20001536,67108864,1346560,2498461280,63,1375232,3994624,3994624,3994624,6709760,6712320,6714880,17543168,17551360,13035520,13035776,13146112,13146368,18154496,20634928,20643736,20681216,20611328,0,15,16857088,16857344,16898048,16898304,18297856,20667920,20606912,1945728,40960,25600,10240,61440,928,0,0,0
.long 4763648,4764672,12804096,12914688,1065353216,20634752,20675840,17733376,20680344,1377280,2498461248,60,1699840,4313088,4313088,4313088,7014400,7016960,7019520,17424384,17429504,12951808,13062144,13062400,12951552,19460096,20633648,20643712,20676608,20611456,0,44,16826624,16867328,16867584,16826368,19736576,20666384,20606592,1884800,61440,46080,30720,0,544,0,0,0
.long 5025792,5026816,12808192,12918784,1065353216,20634760,20675848,18491136,67108864,1377280,2498461248,61,1700864,4316160,4316160,4316160,7022080,7024640,7027200,17465344,17470464,13090816,13091072,12980224,12980480,19531776,20634032,20643720,20678144,20611456,0,45,16877568,16877824,16836608,16836864,19762176,20666896,20606656,1905280,0,66560,51200,20480,544,0,0,0
.long 4765696,4766720,13025280,13135872,1065353216,20634768,20675856,19248896,67108864,1387520,2498461280,62,1701888,4319232,4319232,4319232,7029760,7032320,7034880,17506304,17511424,13119744,13008896,13009152,13119488,19603456,20634544,20643728,20679680,20611456,0,46,16888064,16846848,16847104,16887808,19787776,20667408,20606848,1925760,20480,5120,71680,40960,544,0,0,0
.long 5027840,5028864,13029376,13139968,1065353216,20634776,20675864,20006656,67108864,1387520,2498461280,63,1702912,4322304,4322304,4322304,7037440,7040000,7042560,17547264,17552384,13035520,13035776,13146112,13146368,19670016,20634928,20643736,20681216,20611456,0,47,16857088,16857344,16898048,16898304,19813376,20667920,20606912,1946240,40960,25600,10240,61440,544,0,0,0
.long 5253120,5255680,8404992,8515584,1065353216,20614784,20676096,17738496,20680472,1418240,3303800384,60,2027520,4640768,4640768,4640768,7342080,7344640,7347200,17430528,17438720,14721280,14831616,14831872,14721024,17944576,20641840,20643712,20676608,20611456,128,4,17481984,17522688,17522944,17481728,18221056,20674576,20610688,2539648,61440,46080,30720,0,928,0,0,0
.long 5253120,5255680,8409088,8519680,1065353216,20614792,20676104,18496256,67108864,1418240,3303800384,61,2028544,4643840,4643840,4643840,7349760,7352320,7354880,17471488,17479680,14860288,14860544,14749696,14749952,18016256,20642224,20643720,20678144,20611456,128,5,17532928,17533184,17491968,17492224,18246656,20675088,20610752,2560128,0,66560,51200,20480,928,0,0,0
.long 5258240,5260800,8626176,8736768,1065353216,20614800,20676112,19254016,67108864,1428480,3303800416,62,2029568,4646912,4646912,4646912,7357440,7360000,7362560,17512448,17520640,14889216,14778368,14778624,14888960,18087936,20642736,20643728,20679680,20611456,128,6,17543424,17502208,17502464,17543168,18272256,20675600,20610944,2580608,20480,5120,71680,40960,928,0,0,0
.long 5258240,5260800,8630272,8740864,1065353216,20614808,20676120,20011776,67108864,1428480,3303800416,63,2030592,4649984,4649984,4649984,7365120,7367680,7370240,17553408,17561600,14804992,14805248,14915584,14915840,18154496,20643120,20643736,20681216,20611456,128,7,17512448,17512704,17553408,17553664,18297856,20676112,20611008,2601088,40960,25600,10240,61440,928,0,0,0
.long 5335040,5337600,11943936,12054528,1065353216,20631168,20676352,17743616,20680600,1459200,3303800384,60,2355200,4968448,4968448,4968448,7669760,7672320,7674880,17434624,17439744,14721280,14831616,14831872,14721024,19460096,20641840,20643712,20676608,20611584,0,36,17481984,17522688,17522944,17481728,19736576,20674576,20610688,2540160,61440,46080,30720,0,544,0,0,0
.long 5335040,5337600,11948032,12058624,1065353216,20631176,20676360,18501376,67108864,1459200,3303800384,61,2356224,4971520,4971520,4971520,7677440,7680000,7682560,17475584,17480704,14860288,14860544,14749696,14749952,19531776,20642224,20643720,20678144,20611584,0,37,17532928,17533184,17491968,17492224,19762176,20675088,20610752,2560640,0,66560,51200,20480,544,0,0,0
.long 5340160,5342720,12165120,12275712,1065353216,20631184,20676368,19259136,67108864,1469440,3303800416,62,2357248,4974592,4974592,4974592,7685120,7687680,7690240,17516544,17521664,14889216,14778368,14778624,14888960,19603456,20642736,20643728,20679680,20611584,0,38,17543424,17502208,17502464,17543168,19787776,20675600,20610944,2581120,20480,5120,71680,40960,544,0,0,0
.long 5340160,5342720,12169216,12279808,1065353216,20631192,20676376,20016896,67108864,1469440,3303800416,63,2358272,4977664,4977664,4977664,7692800,7695360,7697920,17557504,17562624,14804992,14805248,14915584,14915840,19670016,20643120,20643736,20681216,20611584,0,39,17512448,17512704,17553408,17553664,19813376,20676112,20611008,2601600,40960,25600,10240,61440,544,0,0,0
.long 1048576,1049600,7872512,7983104,1051011932,20611328,20643968,17747968,20680704,1474560,350887425,0,131072,67108864,67108864,67108864,67108864,67108864,67108864,14944256,14950912,7864576,7974912,7975168,7864320,18323456,20611104,20612992,20676608,20611072,0,0,14942464,14983168,14983424,14942208,18599936,20643840,20594816,256,61440,46080,30720,0,832,0,0,0
.long 1310720,1311744,7876608,7987200,1051011932,20611336,20643976,18505728,67108864,1474560,350887425,1,132096,67108864,67108864,67108864,67108864,67108864,67108864,14985216,14991872,8003584,8003840,7892992,7893248,18395136,20611616,20613000,20678144,20611072,0,1,14993408,14993664,14952448,14952704,18625536,20644352,20594880,20736,0,66560,51200,20480,832,0,0,0
.long 1050624,1051648,8093696,8204288,1051011932,20611344,20643984,19263488,67108864,1484800,350887457,2,133120,67108864,67108864,2750464,67108864,67108864,5406720,15026176,15032832,8032512,7921664,7921920,8032256,18466816,20612128,20613008,20679680,20611072,0,2,15003904,14962688,14962944,15003648,18651136,20644864,20595072,41216,20480,5120,71680,40960,832,0,0,0
.long 1312768,1313792,8097792,8208384,1051011932,20611352,20643992,20021248,67108864,1484800,350887457,3,134144,2753536,2753536,2753536,5409280,5411840,5414400,15067136,15073792,7948288,7948544,8058880,8059136,18533376,20612384,20613016,20681216,20611072,0,3,14972928,14973184,15013888,15014144,18676736,20645376,20595136,61696,40960,25600,10240,61440,832,0,0,0
.long 1081344,1082368,11411456,11522048,1051011932,20627712,20644224,17753088,20680832,1515520,350887425,0,458752,67108864,67108864,67108864,67108864,67108864,67108864,14948352,14951936,7864576,7974912,7975168,7864320,19838976,20611104,20612992,20676608,20611072,128,32,14942464,14983168,14983424,14942208,20115456,20643840,20594816,768,61440,46080,30720,0,448,0,0,0
.long 1343488,1344512,11415552,11526144,1051011932,20627720,20644232,18510848,67108864,1515520,350887425,1,459776,67108864,67108864,67108864,67108864,67108864,67108864,14989312,14992896,8003584,8003840,7892992,7893248,19910656,20611616,20613000,20678144,20611072,128,33,14993408,14993664,14952448,14952704,20141056,20644352,20594880,21248,0,66560,51200,20480,448,0,0,0
.long 1083392,1084416,11632640,11743232,1051011932,20627728,20644240,19268608,67108864,1525760,350887457,2,460800,67108864,67108864,3078144,67108864,67108864,5734400,15030272,15033856,8032512,7921664,7921920,8032256,19982336,20612128,20613008,20679680,20611072,128,34,15003904,14962688,14962944,15003648,20166656,20644864,20595072,41728,20480,5120,71680,40960,448,0,0,0
.long 1345536,1346560,11636736,11747328,1051011932,20627736,20644248,20026368,67108864,1525760,350887457,3,461824,3081216,3081216,3081216,5736960,5739520,5742080,15071232,15074816,7948288,7948544,8058880,8059136,20048896,20612384,20613016,20681216,20611072,128,35,14972928,14973184,15013888,15014144,20192256,20645376,20595136,62208,40960,25600,10240,61440,448,0,0,0
.long 2646016,2647040,10559488,10670080,1065353216,20624000,20644480,17758208,20680960,1556480,1424662017,0,786432,67108864,67108864,67108864,67108864,67108864,67108864,14954496,14961152,9634048,9744384,9744640,9633792,18323456,20619296,20612992,20676608,20611200,0,24,15597824,15638528,15638784,15597568,18599936,20652032,20598912,655616,61440,46080,30720,0,832,0,0,0
.long 2908160,2909184,10563584,10674176,1065353216,20624008,20644488,18515968,67108864,1556480,1424662017,1,787456,67108864,67108864,67108864,67108864,67108864,67108864,14995456,15002112,9773056,9773312,9662464,9662720,18395136,20619808,20613000,20678144,20611200,0,25,15648768,15649024,15607808,15608064,18625536,20652544,20598976,676096,0,66560,51200,20480,832,0,0,0
.long 2648064,2649088,10780672,10891264,1065353216,20624016,20644496,19273728,67108864,1566720,1424662049,2,788480,67108864,67108864,3405824,67108864,67108864,6062080,15036416,15043072,9801984,9691136,9691392,9801728,18466816,20620320,20613008,20679680,20611200,0,26,15659264,15618048,15618304,15659008,18651136,20653056,20599168,696576,20480,5120,71680,40960,832,0,0,0
.long 2910208,2911232,10784768,10895360,1065353216,20624024,20644504,20031488,67108864,1566720,1424662049,3,789504,3408896,3408896,3408896,6064640,6067200,6069760,15077376,15084032,9717760,9718016,9828352,9828608,18533376,20620576,20613016,20681216,20611200,0,27,15628288,15628544,15669248,15669504,18676736,20653568,20599232,717056,40960,25600,10240,61440,832,0,0,0
.long 2678784,2679808,14098432,14209024,1065353216,20640384,20644736,17763328,20681088,1597440,1424662017,0,1114112,67108864,67108864,67108864,67108864,67108864,67108864,14958592,14962176,9634048,9744384,9744640,9633792,19838976,20619296,20612992,20676608,20611328,0,56,15597824,15638528,15638784,15597568,20115456,20652032,20598912,656128,61440,46080,30720,0,448,0,0,0
.long 2940928,2941952,14102528,14213120,1065353216,20640392,20644744,18521088,67108864,1597440,1424662017,1,1115136,67108864,67108864,67108864,67108864,67108864,67108864,14999552,15003136,9773056,9773312,9662464,9662720,19910656,20619808,20613000,20678144,20611328,0,57,15648768,15649024,15607808,15608064,20141056,20652544,20598976,676608,0,66560,51200,20480,448,0,0,0
.long 2680832,2681856,14319616,14430208,1065353216,20640400,20644752,19278848,67108864,1607680,1424662049,2,1116160,67108864,67108864,3733504,67108864,67108864,6389760,15040512,15044096,9801984,9691136,9691392,9801728,19982336,20620320,20613008,20679680,20611328,0,58,15659264,15618048,15618304,15659008,20166656,20653056,20599168,697088,20480,5120,71680,40960,448,0,0,0
.long 2942976,2944000,14323712,14434304,1065353216,20640408,20644760,20036608,67108864,1607680,1424662049,3,1117184,3736576,3736576,3736576,6392320,6394880,6397440,15081472,15085056,9717760,9718016,9828352,9828608,20048896,20620576,20613016,20681216,20611328,0,59,15628288,15628544,15669248,15669504,20192256,20653568,20599232,717568,40960,25600,10240,61440,448,0,0,0
.long 4734976,4736000,9699328,9809920,1065353216,20620416,20644992,17773568,20681216,1679360,2230001153,0,1441792,67108864,67108864,67108864,67108864,67108864,67108864,14964736,14971392,11403520,11513856,11514112,11403264,18323456,20627488,20612992,20676608,20611328,128,16,16253184,16293888,16294144,16252928,18599936,20660224,20603008,1310976,61440,46080,30720,0,832,0,0,0
.long 4997120,4998144,9703424,9814016,1065353216,20620424,20645000,18531328,67108864,1679360,2230001153,1,1442816,67108864,67108864,67108864,67108864,67108864,67108864,15005696,15012352,11542528,11542784,11431936,11432192,18395136,20628000,20613000,20678144,20611328,128,17,16304128,16304384,16263168,16263424,18625536,20660736,20603072,1331456,0,66560,51200,20480,832,0,0,0
.long 4737024,4738048,9920512,10031104,1065353216,20620432,20645008,19289088,67108864,1689600,2230001185,2,1443840,67108864,67108864,4061184,67108864,67108864,6717440,15046656,15053312,11571456,11460608,11460864,11571200,18466816,20628512,20613008,20679680,20611328,128,18,16314624,16273408,16273664,16314368,18651136,20661248,20603264,1351936,20480,5120,71680,40960,832,0,0,0
.long 4999168,5000192,9924608,10035200,1065353216,20620440,20645016,20046848,67108864,1689600,2230001185,3,1444864,4064256,4064256,4064256,6720000,6722560,6725120,15087616,15094272,11487232,11487488,11597824,11598080,18533376,20628768,20613016,20681216,20611328,128,19,16283648,16283904,16324608,16324864,18676736,20661760,20603328,1372416,40960,25600,10240,61440,832,0,0,0
.long 4767744,4768768,13238272,13348864,1065353216,20636800,20645248,17778688,20681344,1720320,2230001153,0,1769472,67108864,67108864,67108864,67108864,67108864,67108864,14968832,14972416,11403520,11513856,11514112,11403264,19838976,20627488,20612992,20676608,20611456,0,48,16253184,16293888,16294144,16252928,20115456,20660224,20603008,1311488,61440,46080,30720,0,448,0,0,0
.long 5029888,5030912,13242368,13352960,1065353216,20636808,20645256,18536448,67108864,1720320,2230001153,1,1770496,67108864,67108864,67108864,67108864,67108864,67108864,15009792,15013376,11542528,11542784,11431936,11432192,19910656,20628000,20613000,20678144,20611456,0,49,16304128,16304384,16263168,16263424,20141056,20660736,20603072,1331968,0,66560,51200,20480,448,0,0,0
.long 4769792,4770816,13459456,13570048,1065353216,20636816,20645264,19294208,67108864,1730560,2230001185,2,1771520,67108864,67108864,4388864,67108864,67108864,7045120,15050752,15054336,11571456,11460608,11460864,11571200,19982336,20628512,20613008,20679680,20611456,0,50,16314624,16273408,16273664,16314368,20166656,20661248,20603264,1352448,20480,5120,71680,40960,448,0,0,0
.long 5031936,5032960,13463552,13574144,1065353216,20636824,20645272,20051968,67108864,1730560,2230001185,3,1772544,4391936,4391936,4391936,7047680,7050240,7052800,15091712,15095296,11487232,11487488,11597824,11598080,20048896,20628768,20613016,20681216,20611456,0,51,16283648,16283904,16324608,16324864,20192256,20661760,20603328,1372928,40960,25600,10240,61440,448,0,0,0
.long 5263360,5265920,8847360,8957952,1065353216,20616832,20645504,17783808,20681472,1761280,3303775745,0,2097152,67108864,67108864,67108864,67108864,67108864,67108864,14974976,14981632,13172992,13283328,13283584,13172736,18323456,20635680,20612992,20676608,20611584,0,8,16908544,16949248,16949504,16908288,18599936,20668416,20607104,1966336,61440,46080,30720,0,832,0,0,0
.long 5263360,5265920,8851456,8962048,1065353216,20616840,20645512,18541568,67108864,1761280,3303775745,1,2098176,67108864,67108864,67108864,67108864,67108864,67108864,15015936,15022592,13312000,13312256,13201408,13201664,18395136,20636192,20613000,20678144,20611584,0,9,16959488,16959744,16918528,16918784,18625536,20668928,20607168,1986816,0,66560,51200,20480,832,0,0,0
.long 5268480,5271040,9068544,9179136,1065353216,20616848,20645520,19299328,67108864,1771520,3303775777,2,2099200,67108864,67108864,4716544,67108864,67108864,7372800,15056896,15063552,13340928,13230080,13230336,13340672,18466816,20636704,20613008,20679680,20611584,0,10,16969984,16928768,16929024,16969728,18651136,20669440,20607360,2007296,20480,5120,71680,40960,832,0,0,0
.long 5268480,5271040,9072640,9183232,1065353216,20616856,20645528,20057088,67108864,1771520,3303775777,3,2100224,4719616,4719616,4719616,7375360,7377920,7380480,15097856,15104512,13256704,13256960,13367296,13367552,18533376,20636960,20613016,20681216,20611584,0,11,16939008,16939264,16979968,16980224,18676736,20669952,20607424,2027776,40960,25600,10240,61440,832,0,0,0
.long 5345280,5347840,12386304,12496896,1065353216,20633216,20645760,17788928,20681600,1802240,3303775745,0,2424832,67108864,67108864,67108864,67108864,67108864,67108864,14979072,14982656,13172992,13283328,13283584,13172736,19838976,20635680,20612992,20676608,20611584,0,40,16908544,16949248,16949504,16908288,20115456,20668416,20607104,1966848,61440,46080,30720,0,448,0,0,0
.long 5345280,5347840,12390400,12500992,1065353216,20633224,20645768,18546688,67108864,1802240,3303775745,1,2425856,67108864,67108864,67108864,67108864,67108864,67108864,15020032,15023616,13312000,13312256,13201408,13201664,19910656,20636192,20613000,20678144,20611584,0,41,16959488,16959744,16918528,16918784,20141056,20668928,20607168,1987328,0,66560,51200,20480,448,0,0,0
.long 5350400,5352960,12607488,12718080,1065353216,20633232,20645776,19304448,67108864,1812480,3303775777,2,2426880,67108864,67108864,5044224,67108864,67108864,7700480,15060992,15064576,13340928,13230080,13230336,13340672,19982336,20636704,20613008,20679680,20611584,0,42,16969984,16928768,16929024,16969728,20166656,20669440,20607360,2007808,20480,5120,71680,40960,448,0,0,0
.long 5350400,5352960,12611584,12722176,1065353216,20633240,20645784,20062208,67108864,1812480,3303775777,3,2427904,5047296,5047296,5047296,7703040,7705600,7708160,15101952,15105536,13256704,13256960,13367296,13367552,20048896,20636960,20613016,20681216,20611584,0,43,16939008,16939264,16979968,16980224,20192256,20669952,20607424,2028288,40960,25600,10240,61440,448,0,0,0
.long 1052672,1053696,8323072,8433664,1051011932,20613376,20646016,17748224,20680712,1479680,619322945,4,135168,67108864,67108864,67108864,67108864,67108864,67108864,15108096,15114752,8085760,8196096,8196352,8085504,18323456,20611120,20615040,20676608,20611072,0,4,15024384,15065088,15065344,15024128,18599936,20643856,20595328,82176,61440,46080,30720,0,832,0,0,0
.long 1314816,1315840,8327168,8437760,1051011932,20613384,20646024,18505984,67108864,1479680,619322945,5,136192,67108864,2751488,2751488,67108864,5406720,5409280,15149056,15155712,8224768,8225024,8114176,8114432,18395136,20611632,20615048,20678144,20611072,0,5,15075328,15075584,15034368,15034624,18625536,20644368,20595392,102656,0,66560,51200,20480,832,0,0,0
.long 1054720,1055744,8544256,8654848,1051011932,20613392,20646032,19263744,67108864,1489920,619322977,6,137216,2754560,2754560,2754560,5411840,5414400,5416960,15190016,15196672,8253696,8142848,8143104,8253440,18466816,20612144,20615056,20679680,20611072,0,6,15085824,15044608,15044864,15085568,18651136,20644880,20595584,123136,20480,5120,71680,40960,832,0,0,0
.long 1316864,1317888,8548352,8658944,1051011932,20613400,20646040,20021504,67108864,1489920,619322977,7,138240,2757632,2757632,2757632,5419520,5422080,5424640,15230976,15237632,8169472,8169728,8280064,8280320,18533376,20612400,20615064,20681216,20611072,0,7,15054848,15055104,15095808,15096064,18676736,20645392,20595648,143616,40960,25600,10240,61440,832,0,0,0
.long 1085440,1086464,11862016,11972608,1051011932,20629760,20646272,17753344,20680840,1520640,619322945,4,462848,67108864,67108864,67108864,67108864,67108864,67108864,15112192,15115776,8085760,8196096,8196352,8085504,19838976,20611120,20615040,20676608,20611072,128,36,15024384,15065088,15065344,15024128,20115456,20643856,20595328,82688,61440,46080,30720,0,448,0,0,0
.long 1347584,1348608,11866112,11976704,1051011932,20629768,20646280,18511104,67108864,1520640,619322945,5,463872,67108864,3079168,3079168,67108864,5734400,5736960,15153152,15156736,8224768,8225024,8114176,8114432,19910656,20611632,20615048,20678144,20611072,128,37,15075328,15075584,15034368,15034624,20141056,20644368,20595392,103168,0,66560,51200,20480,448,0,0,0
.long 1087488,1088512,12083200,12193792,1051011932,20629776,20646288,19268864,67108864,1530880,619322977,6,464896,3082240,3082240,3082240,5739520,5742080,5744640,15194112,15197696,8253696,8142848,8143104,8253440,19982336,20612144,20615056,20679680,20611072,128,38,15085824,15044608,15044864,15085568,20166656,20644880,20595584,123648,20480,5120,71680,40960,448,0,0,0
.long 1349632,1350656,12087296,12197888,1051011932,20629784,20646296,20026624,67108864,1530880,619322977,7,465920,3085312,3085312,3085312,5747200,5749760,5752320,15235072,15238656,8169472,8169728,8280064,8280320,20048896,20612400,20615064,20681216,20611072,128,39,15054848,15055104,15095808,15096064,20192256,20645392,20595648,144128,40960,25600,10240,61440,448,0,0,0
.long 2650112,2651136,11001856,11112448,1065353216,20626048,20646528,17758464,20680968,1561600,1424662081,4,790528,67108864,67108864,67108864,67108864,67108864,67108864,15118336,15124992,9855232,9965568,9965824,9854976,18323456,20619312,20615040,20676608,20611200,0,28,15679744,15720448,15720704,15679488,18599936,20652048,20599424,737536,61440,46080,30720,0,832,0,0,0
.long 2912256,2913280,11005952,11116544,1065353216,20626056,20646536,18516224,67108864,1561600,1424662081,5,791552,67108864,3406848,3406848,67108864,6062080,6064640,15159296,15165952,9994240,9994496,9883648,9883904,18395136,20619824,20615048,20678144,20611200,0,29,15730688,15730944,15689728,15689984,18625536,20652560,20599488,758016,0,66560,51200,20480,832,0,0,0
.long 2652160,2653184,11223040,11333632,1065353216,20626064,20646544,19273984,67108864,1571840,1424662113,6,792576,3409920,3409920,3409920,6067200,6069760,6072320,15200256,15206912,10023168,9912320,9912576,10022912,18466816,20620336,20615056,20679680,20611200,0,30,15741184,15699968,15700224,15740928,18651136,20653072,20599680,778496,20480,5120,71680,40960,832,0,0,0
.long 2914304,2915328,11227136,11337728,1065353216,20626072,20646552,20031744,67108864,1571840,1424662113,7,793600,3412992,3412992,3412992,6074880,6077440,6080000,15241216,15247872,9938944,9939200,10049536,10049792,18533376,20620592,20615064,20681216,20611200,0,31,15710208,15710464,15751168,15751424,18676736,20653584,20599744,798976,40960,25600,10240,61440,832,0,0,0
.long 2682880,2683904,14540800,14651392,1065353216,20642432,20646784,17763584,20681096,1602560,1424662081,4,1118208,67108864,67108864,67108864,67108864,67108864,67108864,15122432,15126016,9855232,9965568,9965824,9854976,19838976,20619312,20615040,20676608,20611328,0,60,15679744,15720448,15720704,15679488,20115456,20652048,20599424,738048,61440,46080,30720,0,448,0,0,0
.long 2945024,2946048,14544896,14655488,1065353216,20642440,20646792,18521344,67108864,1602560,1424662081,5,1119232,67108864,3734528,3734528,67108864,6389760,6392320,15163392,15166976,9994240,9994496,9883648,9883904,19910656,20619824,20615048,20678144,20611328,0,61,15730688,15730944,15689728,15689984,20141056,20652560,20599488,758528,0,66560,51200,20480,448,0,0,0
.long 2684928,2685952,14761984,14872576,1065353216,20642448,20646800,19279104,67108864,1612800,1424662113,6,1120256,3737600,3737600,3737600,6394880,6397440,6400000,15204352,15207936,10023168,9912320,9912576,10022912,19982336,20620336,20615056,20679680,20611328,0,62,15741184,15699968,15700224,15740928,20166656,20653072,20599680,779008,20480,5120,71680,40960,448,0,0,0
.long 2947072,2948096,14766080,14876672,1065353216,20642456,20646808,20036864,67108864,1612800,1424662113,7,1121280,3740672,3740672,3740672,6402560,6405120,6407680,15245312,15248896,9938944,9939200,10049536,10049792,20048896,20620592,20615064,20681216,20611328,0,63,15710208,15710464,15751168,15751424,20192256,20653584,20599744,799488,40960,25600,10240,61440,448,0,0,0
.long 4739072,4740096,10141696,10252288,1065353216,20622464,20647040,17773824,20681224,1684480,2230001217,4,1445888,67108864,67108864,67108864,67108864,67108864,67108864,15128576,15135232,11624704,11735040,11735296,11624448,18323456,20627504,20615040,20676608,20611328,128,20,16335104,16375808,16376064,16334848,18599936,20660240,20603520,1392896,61440,46080,30720,0,832,0,0,0
.long 5001216,5002240,10145792,10256384,1065353216,20622472,20647048,18531584,67108864,1684480,2230001217,5,1446912,67108864,4062208,4062208,67108864,6717440,6720000,15169536,15176192,11763712,11763968,11653120,11653376,18395136,20628016,20615048,20678144,20611328,128,21,16386048,16386304,16345088,16345344,18625536,20660752,20603584,1413376,0,66560,51200,20480,832,0,0,0
.long 4741120,4742144,10362880,10473472,1065353216,20622480,20647056,19289344,67108864,1694720,2230001249,6,1447936,4065280,4065280,4065280,6722560,6725120,6727680,15210496,15217152,11792640,11681792,11682048,11792384,18466816,20628528,20615056,20679680,20611328,128,22,16396544,16355328,16355584,16396288,18651136,20661264,20603776,1433856,20480,5120,71680,40960,832,0,0,0
.long 5003264,5004288,10366976,10477568,1065353216,20622488,20647064,20047104,67108864,1694720,2230001249,7,1448960,4068352,4068352,4068352,6730240,6732800,6735360,15251456,15258112,11708416,11708672,11819008,11819264,18533376,20628784,20615064,20681216,20611328,128,23,16365568,16365824,16406528,16406784,18676736,20661776,20603840,1454336,40960,25600,10240,61440,832,0,0,0
.long 4771840,4772864,13680640,13791232,1065353216,20638848,20647296,17778944,20681352,1725440,2230001217,4,1773568,67108864,67108864,67108864,67108864,67108864,67108864,15132672,15136256,11624704,11735040,11735296,11624448,19838976,20627504,20615040,20676608,20611456,0,52,16335104,16375808,16376064,16334848,20115456,20660240,20603520,1393408,61440,46080,30720,0,448,0,0,0
.long 5033984,5035008,13684736,13795328,1065353216,20638856,20647304,18536704,67108864,1725440,2230001217,5,1774592,67108864,4389888,4389888,67108864,7045120,7047680,15173632,15177216,11763712,11763968,11653120,11653376,19910656,20628016,20615048,20678144,20611456,0,53,16386048,16386304,16345088,16345344,20141056,20660752,20603584,1413888,0,66560,51200,20480,448,0,0,0
.long 4773888,4774912,13901824,14012416,1065353216,20638864,20647312,19294464,67108864,1735680,2230001249,6,1775616,4392960,4392960,4392960,7050240,7052800,7055360,15214592,15218176,11792640,11681792,11682048,11792384,19982336,20628528,20615056,20679680,20611456,0,54,16396544,16355328,16355584,16396288,20166656,20661264,20603776,1434368,20480,5120,71680,40960,448,0,0,0
.long 5036032,5037056,13905920,14016512,1065353216,20638872,20647320,20052224,67108864,1735680,2230001249,7,1776640,4396032,4396032,4396032,7057920,7060480,7063040,15255552,15259136,11708416,11708672,11819008,11819264,20048896,20628784,20615064,20681216,20611456,0,55,16365568,16365824,16406528,16406784,20192256,20661776,20603840,1454848,40960,25600,10240,61440,448,0,0,0
.long 5273600,5276160,67108864,67108864,1065353216,20618880,20647552,17784064,20681480,1766400,3840646721,4,2101248,67108864,67108864,67108864,67108864,67108864,67108864,15138816,15145472,13394176,13504512,13504768,13393920,18323456,20635696,20615040,20676608,20611584,0,12,16990464,17031168,17031424,16990208,18599936,20668432,20607616,2048256,61440,46080,30720,0,832,0,0,0
.long 5273600,5276160,67108864,67108864,1065353216,20618888,20647560,18541824,67108864,1766400,3840646721,5,2102272,67108864,4717568,4717568,67108864,7372800,7375360,15179776,15186432,13533184,13533440,13422592,13422848,18395136,20636208,20615048,20678144,20611584,0,13,17041408,17041664,17000448,17000704,18625536,20668944,20607680,2068736,0,66560,51200,20480,832,0,0,0
.long 5278720,5281280,67108864,67108864,1065353216,20618896,20647568,19299584,67108864,1776640,3840646753,6,2103296,4720640,4720640,4720640,7377920,7380480,7383040,15220736,15227392,13562112,13451264,13451520,13561856,18466816,20636720,20615056,20679680,20611584,0,14,17051904,17010688,17010944,17051648,18651136,20669456,20607872,2089216,20480,5120,71680,40960,832,0,0,0
.long 5278720,5281280,67108864,67108864,1065353216,20618904,20647576,20057344,67108864,1776640,3840646753,7,2104320,4723712,4723712,4723712,7385600,7388160,7390720,15261696,15268352,13477888,13478144,13588480,13588736,18533376,20636976,20615064,20681216,20611584,0,15,17020928,17021184,17061888,17062144,18676736,20669968,20607936,2109696,40960,25600,10240,61440,832,0,0,0
.long 5355520,5358080,67108864,67108864,1065353216,20635264,20647808,17789184,20681608,1807360,3840646721,4,2428928,67108864,67108864,67108864,67108864,67108864,67108864,15142912,15146496,13394176,13504512,13504768,13393920,19838976,20635696,20615040,20676608,20611584,0,44,16990464,17031168,17031424,16990208,20115456,20668432,20607616,2048768,61440,46080,30720,0,448,0,0,0
.long 5355520,5358080,67108864,67108864,1065353216,20635272,20647816,18546944,67108864,1807360,3840646721,5,2429952,67108864,5045248,5045248,67108864,7700480,7703040,15183872,15187456,13533184,13533440,13422592,13422848,19910656,20636208,20615048,20678144,20611584,0,45,17041408,17041664,17000448,17000704,20141056,20668944,20607680,2069248,0,66560,51200,20480,448,0,0,0
.long 5360640,5363200,67108864,67108864,1065353216,20635280,20647824,19304704,67108864,1817600,3840646753,6,2430976,5048320,5048320,5048320,7705600,7708160,7710720,15224832,15228416,13562112,13451264,13451520,13561856,19982336,20636720,20615056,20679680,20611584,0,46,17051904,17010688,17010944,17051648,20166656,20669456,20607872,2089728,20480,5120,71680,40960,448,0,0,0
.long 5360640,5363200,67108864,67108864,1065353216,20635288,20647832,20062464,67108864,1817600,3840646753,7,2432000,5051392,5051392,5051392,7713280,7715840,7718400,15265792,15269376,13477888,13478144,13588480,13588736,20048896,20636976,20615064,20681216,20611584,0,47,17020928,17021184,17061888,17062144,20192256,20669968,20607936,2110208,40960,25600,10240,61440,448,0,0,0
.long 1056768,1057792,8765440,8876032,1051011932,20615424,20648064,17748480,20680720,1495040,619331073,8,139264,2752512,2752512,2752512,5406720,5409280,5411840,15271936,15278592,8306944,8417280,8417536,8306688,18323456,20613152,20617088,20676608,20611072,0,8,15106304,15147008,15147264,15106048,18599936,20645888,20595840,164096,61440,46080,30720,0,832,0,0,0
.long 1318912,1319936,8769536,8880128,1051011932,20615432,20648072,18506240,67108864,1495040,619331073,9,140288,2755584,2755584,2755584,5414400,5416960,5419520,15312896,15319552,8445952,8446208,8335360,8335616,18395136,20613536,20617096,20678144,20611072,0,9,15157248,15157504,15116288,15116544,18625536,20646400,20595904,184576,0,66560,51200,20480,832,0,0,0
.long 1058816,1059840,8986624,9097216,1051011932,20615440,20648080,19264000,67108864,1505280,619331105,10,141312,2758656,2758656,2758656,5422080,5424640,5427200,15353856,15360512,8474880,8364032,8364288,8474624,18466816,20614176,20617104,20679680,20611072,0,10,15167744,15126528,15126784,15167488,18651136,20646912,20596096,205056,20480,5120,71680,40960,832,0,0,0
.long 1320960,1321984,8990720,9101312,1051011932,20615448,20648088,20021760,67108864,1505280,619331105,11,142336,2761728,2761728,2761728,5429760,5432320,5434880,15394816,15401472,8390656,8390912,8501248,8501504,18533376,20614432,20617112,20681216,20611072,0,11,15136768,15137024,15177728,15177984,18676736,20647424,20596160,225536,40960,25600,10240,61440,832,0,0,0
.long 1089536,1090560,12304384,12414976,1051011932,20631808,20648320,17753600,20680848,1536000,619331073,8,466944,3080192,3080192,3080192,5734400,5736960,5739520,15276032,15279616,8306944,8417280,8417536,8306688,19838976,20613152,20617088,20676608,20611072,128,40,15106304,15147008,15147264,15106048,20115456,20645888,20595840,164608,61440,46080,30720,0,448,0,0,0
.long 1351680,1352704,12308480,12419072,1051011932,20631816,20648328,18511360,67108864,1536000,619331073,9,467968,3083264,3083264,3083264,5742080,5744640,5747200,15316992,15320576,8445952,8446208,8335360,8335616,19910656,20613536,20617096,20678144,20611072,128,41,15157248,15157504,15116288,15116544,20141056,20646400,20595904,185088,0,66560,51200,20480,448,0,0,0
.long 1091584,1092608,12525568,12636160,1051011932,20631824,20648336,19269120,67108864,1546240,619331105,10,468992,3086336,3086336,3086336,5749760,5752320,5754880,15357952,15361536,8474880,8364032,8364288,8474624,19982336,20614176,20617104,20679680,20611072,128,42,15167744,15126528,15126784,15167488,20166656,20646912,20596096,205568,20480,5120,71680,40960,448,0,0,0
.long 1353728,1354752,12529664,12640256,1051011932,20631832,20648344,20026880,67108864,1546240,619331105,11,470016,3089408,3089408,3089408,5757440,5760000,5762560,15398912,15402496,8390656,8390912,8501248,8501504,20048896,20614432,20617112,20681216,20611072,128,43,15136768,15137024,15177728,15177984,20192256,20647424,20596160,226048,40960,25600,10240,61440,448,0,0,0
.long 3145728,3146752,7905280,8015872,1065353216,20611840,20648576,17758720,20680976,1576960,1424670209,8,794624,3407872,3407872,3407872,6062080,6064640,6067200,15282176,15288832,10076416,10186752,10187008,10076160,18323456,20621344,20617088,20676608,20611200,0,0,15761664,15802368,15802624,15761408,18599936,20654080,20599936,819456,61440,46080,30720,0,832,0,0,0
.long 3407872,3408896,7909376,8019968,1065353216,20611848,20648584,18516480,67108864,1576960,1424670209,9,795648,3410944,3410944,3410944,6069760,6072320,6074880,15323136,15329792,10215424,10215680,10104832,10105088,18395136,20621728,20617096,20678144,20611200,0,1,15812608,15812864,15771648,15771904,18625536,20654592,20600000,839936,0,66560,51200,20480,832,0,0,0
.long 3147776,3148800,8126464,8237056,1065353216,20611856,20648592,19274240,67108864,1587200,1424670241,10,796672,3414016,3414016,3414016,6077440,6080000,6082560,15364096,15370752,10244352,10133504,10133760,10244096,18466816,20622368,20617104,20679680,20611200,0,2,15823104,15781888,15782144,15822848,18651136,20655104,20600192,860416,20480,5120,71680,40960,832,0,0,0
.long 3409920,3410944,8130560,8241152,1065353216,20611864,20648600,20032000,67108864,1587200,1424670241,11,797696,3417088,3417088,3417088,6085120,6087680,6090240,15405056,15411712,10160128,10160384,10270720,10270976,18533376,20622624,20617112,20681216,20611200,0,3,15792128,15792384,15833088,15833344,18676736,20655616,20600256,880896,40960,25600,10240,61440,832,0,0,0
.long 3178496,3179520,11444224,11554816,1065353216,20628224,20648832,17763840,20681104,1617920,1424670209,8,1122304,3735552,3735552,3735552,6389760,6392320,6394880,15286272,15289856,10076416,10186752,10187008,10076160,19838976,20621344,20617088,20676608,20611328,0,32,15761664,15802368,15802624,15761408,20115456,20654080,20599936,819968,61440,46080,30720,0,448,0,0,0
.long 3440640,3441664,11448320,11558912,1065353216,20628232,20648840,18521600,67108864,1617920,1424670209,9,1123328,3738624,3738624,3738624,6397440,6400000,6402560,15327232,15330816,10215424,10215680,10104832,10105088,19910656,20621728,20617096,20678144,20611328,0,33,15812608,15812864,15771648,15771904,20141056,20654592,20600000,840448,0,66560,51200,20480,448,0,0,0
.long 3180544,3181568,11665408,11776000,1065353216,20628240,20648848,19279360,67108864,1628160,1424670241,10,1124352,3741696,3741696,3741696,6405120,6407680,6410240,15368192,15371776,10244352,10133504,10133760,10244096,19982336,20622368,20617104,20679680,20611328,0,34,15823104,15781888,15782144,15822848,20166656,20655104,20600192,860928,20480,5120,71680,40960,448,0,0,0
.long 3442688,3443712,11669504,11780096,1065353216,20628248,20648856,20037120,67108864,1628160,1424670241,11,1125376,3744768,3744768,3744768,6412800,6415360,6417920,15409152,15412736,10160128,10160384,10270720,10270976,20048896,20622624,20617112,20681216,20611328,0,35,15792128,15792384,15833088,15833344,20192256,20655616,20600256,881408,40960,25600,10240,61440,448,0,0,0
.long 4743168,4744192,67108864,67108864,1065353216,20624512,20649088,17774080,20681232,1699840,3840622081,8,1449984,4063232,4063232,4063232,6717440,6720000,6722560,15292416,15299072,11845888,11956224,11956480,11845632,18323456,20629536,20617088,20676608,20611328,128,24,16417024,16457728,16457984,16416768,18599936,20662272,20604032,1474816,61440,46080,30720,0,832,0,0,0
.long 5005312,5006336,67108864,67108864,1065353216,20624520,20649096,18531840,67108864,1699840,3840622081,9,1451008,4066304,4066304,4066304,6725120,6727680,6730240,15333376,15340032,11984896,11985152,11874304,11874560,18395136,20629920,20617096,20678144,20611328,128,25,16467968,16468224,16427008,16427264,18625536,20662784,20604096,1495296,0,66560,51200,20480,832,0,0,0
.long 4745216,4746240,67108864,67108864,1065353216,20624528,20649104,19289600,67108864,1710080,3840622113,10,1452032,4069376,4069376,4069376,6732800,6735360,6737920,15374336,15380992,12013824,11902976,11903232,12013568,18466816,20630560,20617104,20679680,20611328,128,26,16478464,16437248,16437504,16478208,18651136,20663296,20604288,1515776,20480,5120,71680,40960,832,0,0,0
.long 5007360,5008384,67108864,67108864,1065353216,20624536,20649112,20047360,67108864,1710080,3840622113,11,1453056,4072448,4072448,4072448,6740480,6743040,6745600,15415296,15421952,11929600,11929856,12040192,12040448,18533376,20630816,20617112,20681216,20611328,128,27,16447488,16447744,16488448,16488704,18676736,20663808,20604352,1536256,40960,25600,10240,61440,832,0,0,0
.long 4775936,4776960,67108864,67108864,1065353216,20640896,20649344,17779200,20681360,1740800,3840622081,8,1777664,4390912,4390912,4390912,7045120,7047680,7050240,15296512,15300096,11845888,11956224,11956480,11845632,19838976,20629536,20617088,20676608,20611456,0,56,16417024,16457728,16457984,16416768,20115456,20662272,20604032,1475328,61440,46080,30720,0,448,0,0,0
.long 5038080,5039104,67108864,67108864,1065353216,20640904,20649352,18536960,67108864,1740800,3840622081,9,1778688,4393984,4393984,4393984,7052800,7055360,7057920,15337472,15341056,11984896,11985152,11874304,11874560,19910656,20629920,20617096,20678144,20611456,0,57,16467968,16468224,16427008,16427264,20141056,20662784,20604096,1495808,0,66560,51200,20480,448,0,0,0
.long 4777984,4779008,67108864,67108864,1065353216,20640912,20649360,19294720,67108864,1751040,3840622113,10,1779712,4397056,4397056,4397056,7060480,7063040,7065600,15378432,15382016,12013824,11902976,11903232,12013568,19982336,20630560,20617104,20679680,20611456,0,58,16478464,16437248,16437504,16478208,20166656,20663296,20604288,1516288,20480,5120,71680,40960,448,0,0,0
.long 5040128,5041152,67108864,67108864,1065353216,20640920,20649368,20052480,67108864,1751040,3840622113,11,1780736,4400128,4400128,4400128,7068160,7070720,7073280,15419392,15422976,11929600,11929856,12040192,12040448,20048896,20630816,20617112,20681216,20611456,0,59,16447488,16447744,16488448,16488704,20192256,20663808,20604352,1536768,40960,25600,10240,61440,448,0,0,0
.long 5283840,5286400,9732096,9842688,1065353216,20620928,20649600,17784320,20681488,1781760,3303783937,8,2105344,4718592,4718592,4718592,7372800,7375360,7377920,15302656,15309312,13615360,13725696,13725952,13615104,18323456,20637728,20617088,20676608,20611584,0,16,17072384,17113088,17113344,17072128,18599936,20670464,20608128,2130176,61440,46080,30720,0,832,0,0,0
.long 5283840,5286400,9736192,9846784,1065353216,20620936,20649608,18542080,67108864,1781760,3303783937,9,2106368,4721664,4721664,4721664,7380480,7383040,7385600,15343616,15350272,13754368,13754624,13643776,13644032,18395136,20638112,20617096,20678144,20611584,0,17,17123328,17123584,17082368,17082624,18625536,20670976,20608192,2150656,0,66560,51200,20480,832,0,0,0
.long 5288960,5291520,9953280,10063872,1065353216,20620944,20649616,19299840,67108864,1792000,3303783969,10,2107392,4724736,4724736,4724736,7388160,7390720,7393280,15384576,15391232,13783296,13672448,13672704,13783040,18466816,20638752,20617104,20679680,20611584,0,18,17133824,17092608,17092864,17133568,18651136,20671488,20608384,2171136,20480,5120,71680,40960,832,0,0,0
.long 5288960,5291520,9957376,10067968,1065353216,20620952,20649624,20057600,67108864,1792000,3303783969,11,2108416,4727808,4727808,4727808,7395840,7398400,7400960,15425536,15432192,13699072,13699328,13809664,13809920,18533376,20639008,20617112,20681216,20611584,0,19,17102848,17103104,17143808,17144064,18676736,20672000,20608448,2191616,40960,25600,10240,61440,832,0,0,0
.long 5365760,5368320,13271040,13381632,1065353216,20637312,20649856,17789440,20681616,1822720,3303783937,8,2433024,5046272,5046272,5046272,7700480,7703040,7705600,15306752,15310336,13615360,13725696,13725952,13615104,19838976,20637728,20617088,20676608,20611584,0,48,17072384,17113088,17113344,17072128,20115456,20670464,20608128,2130688,61440,46080,30720,0,448,0,0,0
.long 5365760,5368320,13275136,13385728,1065353216,20637320,20649864,18547200,67108864,1822720,3303783937,9,2434048,5049344,5049344,5049344,7708160,7710720,7713280,15347712,15351296,13754368,13754624,13643776,13644032,19910656,20638112,20617096,20678144,20611584,0,49,17123328,17123584,17082368,17082624,20141056,20670976,20608192,2151168,0,66560,51200,20480,448,0,0,0
.long 5370880,5373440,13492224,13602816,1065353216,20637328,20649872,19304960,67108864,1832960,3303783969,10,2435072,5052416,5052416,5052416,7715840,7718400,7720960,15388672,15392256,13783296,13672448,13672704,13783040,19982336,20638752,20617104,20679680,20611584,0,50,17133824,17092608,17092864,17133568,20166656,20671488,20608384,2171648,20480,5120,71680,40960,448,0,0,0
.long 5370880,5373440,13496320,13606912,1065353216,20637336,20649880,20062720,67108864,1832960,3303783969,11,2436096,5055488,5055488,5055488,7723520,7726080,7728640,15429632,15433216,13699072,13699328,13809664,13809920,20048896,20639008,20617112,20681216,20611584,0,51,17102848,17103104,17143808,17144064,20192256,20672000,20608448,2192128,40960,25600,10240,61440,448,0,0,0
.long 1060864,1061888,9207808,9318400,1051011932,20617472,20650112,17748736,20680728,1500160,619331137,12,143360,2756608,2756608,2756608,5416960,5419520,5422080,15435776,15442432,8528128,8638464,8638720,8527872,18323456,20613168,20619136,20676608,20611072,0,12,15188224,15228928,15229184,15187968,18599936,20645904,20596352,246016,61440,46080,30720,0,832,0,0,0
.long 1323008,1324032,9211904,9322496,1051011932,20617480,20650120,18506496,67108864,1500160,619331137,13,144384,2759680,2759680,2759680,5424640,5427200,5429760,15476736,15483392,8667136,8667392,8556544,8556800,18395136,20613552,20619144,20678144,20611072,0,13,15239168,15239424,15198208,15198464,18625536,20646416,20596416,266496,0,66560,51200,20480,832,0,0,0
.long 1062912,1063936,9428992,9539584,1051011932,20617488,20650128,19264256,67108864,1510400,619331169,14,145408,2762752,2762752,2762752,5432320,5434880,5437440,15517696,15524352,8696064,8585216,8585472,8695808,18466816,20614192,20619152,20679680,20611072,0,14,15249664,15208448,15208704,15249408,18651136,20646928,20596608,286976,20480,5120,71680,40960,832,0,0,0
.long 1325056,1326080,9433088,9543680,1051011932,20617496,20650136,20022016,67108864,1510400,619331169,15,146432,2765824,2765824,2765824,5440000,5442560,5445120,15558656,15565312,8611840,8612096,8722432,8722688,18533376,20614448,20619160,20681216,20611072,0,15,15218688,15218944,15259648,15259904,18676736,20647440,20596672,307456,40960,25600,10240,61440,832,0,0,0
.long 1093632,1094656,12746752,12857344,1051011932,20633856,20650368,17753856,20680856,1541120,619331137,12,471040,3084288,3084288,3084288,5744640,5747200,5749760,15439872,15443456,8528128,8638464,8638720,8527872,19838976,20613168,20619136,20676608,20611072,128,44,15188224,15228928,15229184,15187968,20115456,20645904,20596352,246528,61440,46080,30720,0,448,0,0,0
.long 1355776,1356800,12750848,12861440,1051011932,20633864,20650376,18511616,67108864,1541120,619331137,13,472064,3087360,3087360,3087360,5752320,5754880,5757440,15480832,15484416,8667136,8667392,8556544,8556800,19910656,20613552,20619144,20678144,20611072,128,45,15239168,15239424,15198208,15198464,20141056,20646416,20596416,267008,0,66560,51200,20480,448,0,0,0
.long 1095680,1096704,12967936,13078528,1051011932,20633872,20650384,19269376,67108864,1551360,619331169,14,473088,3090432,3090432,3090432,5760000,5762560,5765120,15521792,15525376,8696064,8585216,8585472,8695808,19982336,20614192,20619152,20679680,20611072,128,46,15249664,15208448,15208704,15249408,20166656,20646928,20596608,287488,20480,5120,71680,40960,448,0,0,0
.long 1357824,1358848,12972032,13082624,1051011932,20633880,20650392,20027136,67108864,1551360,619331169,15,474112,3093504,3093504,3093504,5767680,5770240,5772800,15562752,15566336,8611840,8612096,8722432,8722688,20048896,20614448,20619160,20681216,20611072,128,47,15218688,15218944,15259648,15259904,20192256,20647440,20596672,307968,40960,25600,10240,61440,448,0,0,0
.long 3149824,3150848,8347648,8458240,1065353216,20613888,20650624,17758976,20680984,1582080,1424670273,12,798720,3411968,3411968,3411968,6072320,6074880,6077440,15446016,15452672,10297600,10407936,10408192,10297344,18323456,20621360,20619136,20676608,20611200,0,4,15843584,15884288,15884544,15843328,18599936,20654096,20600448,901376,61440,46080,30720,0,832,0,0,0
.long 3411968,3412992,8351744,8462336,1065353216,20613896,20650632,18516736,67108864,1582080,1424670273,13,799744,3415040,3415040,3415040,6080000,6082560,6085120,15486976,15493632,10436608,10436864,10326016,10326272,18395136,20621744,20619144,20678144,20611200,0,5,15894528,15894784,15853568,15853824,18625536,20654608,20600512,921856,0,66560,51200,20480,832,0,0,0
.long 3151872,3152896,8568832,8679424,1065353216,20613904,20650640,19274496,67108864,1592320,1424670305,14,800768,3418112,3418112,3418112,6087680,6090240,6092800,15527936,15534592,10465536,10354688,10354944,10465280,18466816,20622384,20619152,20679680,20611200,0,6,15905024,15863808,15864064,15904768,18651136,20655120,20600704,942336,20480,5120,71680,40960,832,0,0,0
.long 3414016,3415040,8572928,8683520,1065353216,20613912,20650648,20032256,67108864,1592320,1424670305,15,801792,3421184,3421184,3421184,6095360,6097920,6100480,15568896,15575552,10381312,10381568,10491904,10492160,18533376,20622640,20619160,20681216,20611200,0,7,15874048,15874304,15915008,15915264,18676736,20655632,20600768,962816,40960,25600,10240,61440,832,0,0,0
.long 3182592,3183616,11886592,11997184,1065353216,20630272,20650880,17764096,20681112,1623040,1424670273,12,1126400,3739648,3739648,3739648,6400000,6402560,6405120,15450112,15453696,10297600,10407936,10408192,10297344,19838976,20621360,20619136,20676608,20611328,0,36,15843584,15884288,15884544,15843328,20115456,20654096,20600448,901888,61440,46080,30720,0,448,0,0,0
.long 3444736,3445760,11890688,12001280,1065353216,20630280,20650888,18521856,67108864,1623040,1424670273,13,1127424,3742720,3742720,3742720,6407680,6410240,6412800,15491072,15494656,10436608,10436864,10326016,10326272,19910656,20621744,20619144,20678144,20611328,0,37,15894528,15894784,15853568,15853824,20141056,20654608,20600512,922368,0,66560,51200,20480,448,0,0,0
.long 3184640,3185664,12107776,12218368,1065353216,20630288,20650896,19279616,67108864,1633280,1424670305,14,1128448,3745792,3745792,3745792,6415360,6417920,6420480,15532032,15535616,10465536,10354688,10354944,10465280,19982336,20622384,20619152,20679680,20611328,0,38,15905024,15863808,15864064,15904768,20166656,20655120,20600704,942848,20480,5120,71680,40960,448,0,0,0
.long 3446784,3447808,12111872,12222464,1065353216,20630296,20650904,20037376,67108864,1633280,1424670305,15,1129472,3748864,3748864,3748864,6423040,6425600,6428160,15572992,15576576,10381312,10381568,10491904,10492160,20048896,20622640,20619160,20681216,20611328,0,39,15874048,15874304,15915008,15915264,20192256,20655632,20600768,963328,40960,25600,10240,61440,448,0,0,0
.long 4747264,4748288,11034624,11145216,1065353216,20626560,20651136,17774336,20681240,1704960,2498444865,12,1454080,4067328,4067328,4067328,6727680,6730240,6732800,15456256,15462912,12067072,12177408,12177664,12066816,18323456,20629552,20619136,20676608,20611328,128,28,16498944,16539648,16539904,16498688,18599936,20662288,20604544,1556736,61440,46080,30720,0,832,0,0,0
.long 5009408,5010432,11038720,11149312,1065353216,20626568,20651144,18532096,67108864,1704960,2498444865,13,1455104,4070400,4070400,4070400,6735360,6737920,6740480,15497216,15503872,12206080,12206336,12095488,12095744,18395136,20629936,20619144,20678144,20611328,128,29,16549888,16550144,16508928,16509184,18625536,20662800,20604608,1577216,0,66560,51200,20480,832,0,0,0
.long 4749312,4750336,11255808,11366400,1065353216,20626576,20651152,19289856,67108864,1715200,2498444897,14,1456128,4073472,4073472,4073472,6743040,6745600,6748160,15538176,15544832,12235008,12124160,12124416,12234752,18466816,20630576,20619152,20679680,20611328,128,30,16560384,16519168,16519424,16560128,18651136,20663312,20604800,1597696,20480,5120,71680,40960,832,0,0,0
.long 5011456,5012480,11259904,11370496,1065353216,20626584,20651160,20047616,67108864,1715200,2498444897,15,1457152,4076544,4076544,4076544,6750720,6753280,6755840,15579136,15585792,12150784,12151040,12261376,12261632,18533376,20630832,20619160,20681216,20611328,128,31,16529408,16529664,16570368,16570624,18676736,20663824,20604864,1618176,40960,25600,10240,61440,832,0,0,0
.long 4780032,4781056,14573568,14684160,1065353216,20642944,20651392,17779456,20681368,1745920,2498444865,12,1781760,4395008,4395008,4395008,7055360,7057920,7060480,15460352,15463936,12067072,12177408,12177664,12066816,19838976,20629552,20619136,20676608,20611456,0,60,16498944,16539648,16539904,16498688,20115456,20662288,20604544,1557248,61440,46080,30720,0,448,0,0,0
.long 5042176,5043200,14577664,14688256,1065353216,20642952,20651400,18537216,67108864,1745920,2498444865,13,1782784,4398080,4398080,4398080,7063040,7065600,7068160,15501312,15504896,12206080,12206336,12095488,12095744,19910656,20629936,20619144,20678144,20611456,0,61,16549888,16550144,16508928,16509184,20141056,20662800,20604608,1577728,0,66560,51200,20480,448,0,0,0
.long 4782080,4783104,14794752,14905344,1065353216,20642960,20651408,19294976,67108864,1756160,2498444897,14,1783808,4401152,4401152,4401152,7070720,7073280,7075840,15542272,15545856,12235008,12124160,12124416,12234752,19982336,20630576,20619152,20679680,20611456,0,62,16560384,16519168,16519424,16560128,20166656,20663312,20604800,1598208,20480,5120,71680,40960,448,0,0,0
.long 5044224,5045248,14798848,14909440,1065353216,20642968,20651416,20052736,67108864,1756160,2498444897,15,1784832,4404224,4404224,4404224,7078400,7080960,7083520,15583232,15586816,12150784,12151040,12261376,12261632,20048896,20630832,20619160,20681216,20611456,0,63,16529408,16529664,16570368,16570624,20192256,20663824,20604864,1618688,40960,25600,10240,61440,448,0,0,0
.long 5294080,5296640,10174464,10285056,1065353216,20622976,20651648,17784576,20681496,1786880,3303784001,12,2109440,4722688,4722688,4722688,7383040,7385600,7388160,15466496,15473152,13836544,13946880,13947136,13836288,18323456,20637744,20619136,20676608,20611584,0,20,17154304,17195008,17195264,17154048,18599936,20670480,20608640,2212096,61440,46080,30720,0,832,0,0,0
.long 5294080,5296640,10178560,10289152,1065353216,20622984,20651656,18542336,67108864,1786880,3303784001,13,2110464,4725760,4725760,4725760,7390720,7393280,7395840,15507456,15514112,13975552,13975808,13864960,13865216,18395136,20638128,20619144,20678144,20611584,0,21,17205248,17205504,17164288,17164544,18625536,20670992,20608704,2232576,0,66560,51200,20480,832,0,0,0
.long 5299200,5301760,10395648,10506240,1065353216,20622992,20651664,19300096,67108864,1797120,3303784033,14,2111488,4728832,4728832,4728832,7398400,7400960,7403520,15548416,15555072,14004480,13893632,13893888,14004224,18466816,20638768,20619152,20679680,20611584,0,22,17215744,17174528,17174784,17215488,18651136,20671504,20608896,2253056,20480,5120,71680,40960,832,0,0,0
.long 5299200,5301760,10399744,10510336,1065353216,20623000,20651672,20057856,67108864,1797120,3303784033,15,2112512,4731904,4731904,4731904,7406080,7408640,7411200,15589376,15596032,13920256,13920512,14030848,14031104,18533376,20639024,20619160,20681216,20611584,0,23,17184768,17185024,17225728,17225984,18676736,20672016,20608960,2273536,40960,25600,10240,61440,832,0,0,0
.long 5376000,5378560,13713408,13824000,1065353216,20639360,20651904,17789696,20681624,1827840,3303784001,12,2437120,5050368,5050368,5050368,7710720,7713280,7715840,15470592,15474176,13836544,13946880,13947136,13836288,19838976,20637744,20619136,20676608,20611584,0,52,17154304,17195008,17195264,17154048,20115456,20670480,20608640,2212608,61440,46080,30720,0,448,0,0,0
.long 5376000,5378560,13717504,13828096,1065353216,20639368,20651912,18547456,67108864,1827840,3303784001,13,2438144,5053440,5053440,5053440,7718400,7720960,7723520,15511552,15515136,13975552,13975808,13864960,13865216,19910656,20638128,20619144,20678144,20611584,0,53,17205248,17205504,17164288,17164544,20141056,20670992,20608704,2233088,0,66560,51200,20480,448,0,0,0
.long 5381120,5383680,13934592,14045184,1065353216,20639376,20651920,19305216,67108864,1838080,3303784033,14,2439168,5056512,5056512,5056512,7726080,7728640,7731200,15552512,15556096,14004480,13893632,13893888,14004224,19982336,20638768,20619152,20679680,20611584,0,54,17215744,17174528,17174784,17215488,20166656,20671504,20608896,2253568,20480,5120,71680,40960,448,0,0,0
.long 5381120,5383680,13938688,14049280,1065353216,20639384,20651928,20062976,67108864,1838080,3303784033,15,2440192,5059584,5059584,5059584,7733760,7736320,7738880,15593472,15597056,13920256,13920512,14030848,14031104,20048896,20639024,20619160,20681216,20611584,0,55,17184768,17185024,17225728,17225984,20192256,20672016,20608960,2274048,40960,25600,10240,61440,448,0,0,0
.long 1064960,1065984,9641984,9752576,1051011932,20619520,20652160,17794048,20681728,1843200,350903809,16,147456,2760704,2760704,2760704,5427200,5429760,5432320,15599616,15606272,8749312,8859648,8859904,8749056,18323456,20615200,20621184,20676608,20611072,0,16,15270144,15310848,15311104,15269888,18599936,20647936,20596864,327936,61440,46080,30720,0,832,0,0,0
.long 1327104,1328128,9646080,9756672,1051011932,20619528,20652168,18551808,67108864,1843200,350903809,17,148480,2763776,2763776,2763776,5434880,5437440,5440000,15640576,15647232,8888320,8888576,8777728,8777984,18395136,20615584,20621192,20678144,20611072,0,17,15321088,15321344,15280128,15280384,18625536,20648448,20596928,348416,0,66560,51200,20480,832,0,0,0
.long 1067008,1068032,9863168,9973760,1051011932,20619536,20652176,19309568,67108864,1853440,350903841,18,149504,2766848,2766848,2766848,5442560,5445120,5447680,15681536,15688192,8917248,8806400,8806656,8916992,18466816,20616096,20621200,20679680,20611072,0,18,15331584,15290368,15290624,15331328,18651136,20648960,20597120,368896,20480,5120,71680,40960,832,0,0,0
.long 1329152,1330176,9867264,9977856,1051011932,20619544,20652184,20067328,67108864,1853440,350903841,19,150528,2769920,2769920,2769920,5450240,5452800,5455360,15722496,15729152,8833024,8833280,8943616,8943872,18533376,20616480,20621208,20681216,20611072,0,19,15300608,15300864,15341568,15341824,18676736,20649472,20597184,389376,40960,25600,10240,61440,832,0,0,0
.long 1097728,1098752,13180928,13291520,1051011932,20635904,20652416,17799168,20681856,1884160,350903809,16,475136,3088384,3088384,3088384,5754880,5757440,5760000,15603712,15607296,8749312,8859648,8859904,8749056,19838976,20615200,20621184,20676608,20611072,128,48,15270144,15310848,15311104,15269888,20115456,20647936,20596864,328448,61440,46080,30720,0,448,0,0,0
.long 1359872,1360896,13185024,13295616,1051011932,20635912,20652424,18556928,67108864,1884160,350903809,17,476160,3091456,3091456,3091456,5762560,5765120,5767680,15644672,15648256,8888320,8888576,8777728,8777984,19910656,20615584,20621192,20678144,20611072,128,49,15321088,15321344,15280128,15280384,20141056,20648448,20596928,348928,0,66560,51200,20480,448,0,0,0
.long 1099776,1100800,13402112,13512704,1051011932,20635920,20652432,19314688,67108864,1894400,350903841,18,477184,3094528,3094528,3094528,5770240,5772800,5775360,15685632,15689216,8917248,8806400,8806656,8916992,19982336,20616096,20621200,20679680,20611072,128,50,15331584,15290368,15290624,15331328,20166656,20648960,20597120,369408,20480,5120,71680,40960,448,0,0,0
.long 1361920,1362944,13406208,13516800,1051011932,20635928,20652440,20072448,67108864,1894400,350903841,19,478208,3097600,3097600,3097600,5777920,5780480,5783040,15726592,15730176,8833024,8833280,8943616,8943872,20048896,20616480,20621208,20681216,20611072,128,51,15300608,15300864,15341568,15341824,20192256,20649472,20597184,389888,40960,25600,10240,61440,448,0,0,0
.long 3153920,3154944,8798208,8908800,1065353216,20615936,20652672,17804288,20681984,1925120,1693113857,16,802816,3416064,3416064,3416064,6082560,6085120,6087680,15609856,15616512,10518784,10629120,10629376,10518528,18323456,20623392,20621184,20676608,20611200,0,8,15925504,15966208,15966464,15925248,18599936,20656128,20600960,983296,61440,46080,30720,0,832,0,0,0
.long 3416064,3417088,8802304,8912896,1065353216,20615944,20652680,18562048,67108864,1925120,1693113857,17,803840,3419136,3419136,3419136,6090240,6092800,6095360,15650816,15657472,10657792,10658048,10547200,10547456,18395136,20623776,20621192,20678144,20611200,0,9,15976448,15976704,15935488,15935744,18625536,20656640,20601024,1003776,0,66560,51200,20480,832,0,0,0
.long 3155968,3156992,9019392,9129984,1065353216,20615952,20652688,19319808,67108864,1935360,1693113889,18,804864,3422208,3422208,3422208,6097920,6100480,6103040,15691776,15698432,10686720,10575872,10576128,10686464,18466816,20624288,20621200,20679680,20611200,0,10,15986944,15945728,15945984,15986688,18651136,20657152,20601216,1024256,20480,5120,71680,40960,832,0,0,0
.long 3418112,3419136,9023488,9134080,1065353216,20615960,20652696,20077568,67108864,1935360,1693113889,19,805888,3425280,3425280,3425280,6105600,6108160,6110720,15732736,15739392,10602496,10602752,10713088,10713344,18533376,20624672,20621208,20681216,20611200,0,11,15955968,15956224,15996928,15997184,18676736,20657664,20601280,1044736,40960,25600,10240,61440,832,0,0,0
.long 3186688,3187712,12337152,12447744,1065353216,20632320,20652928,17809408,20682112,1966080,1693113857,16,1130496,3743744,3743744,3743744,6410240,6412800,6415360,15613952,15617536,10518784,10629120,10629376,10518528,19838976,20623392,20621184,20676608,20611328,0,40,15925504,15966208,15966464,15925248,20115456,20656128,20600960,983808,61440,46080,30720,0,448,0,0,0
.long 3448832,3449856,12341248,12451840,1065353216,20632328,20652936,18567168,67108864,1966080,1693113857,17,1131520,3746816,3746816,3746816,6417920,6420480,6423040,15654912,15658496,10657792,10658048,10547200,10547456,19910656,20623776,20621192,20678144,20611328,0,41,15976448,15976704,15935488,15935744,20141056,20656640,20601024,1004288,0,66560,51200,20480,448,0,0,0
.long 3188736,3189760,12558336,12668928,1065353216,20632336,20652944,19324928,67108864,1976320,1693113889,18,1132544,3749888,3749888,3749888,6425600,6428160,6430720,15695872,15699456,10686720,10575872,10576128,10686464,19982336,20624288,20621200,20679680,20611328,0,42,15986944,15945728,15945984,15986688,20166656,20657152,20601216,1024768,20480,5120,71680,40960,448,0,0,0
.long 3450880,3451904,12562432,12673024,1065353216,20632344,20652952,20082688,67108864,1976320,1693113889,19,1133568,3752960,3752960,3752960,6433280,6435840,6438400,15736832,15740416,10602496,10602752,10713088,10713344,20048896,20624672,20621208,20681216,20611328,0,43,15955968,15956224,15996928,15997184,20192256,20657664,20601280,1045248,40960,25600,10240,61440,448,0,0,0
.long 5242880,5245440,7938048,8048640,1065353216,20612352,20653184,17814528,20682240,2007040,2498452993,16,1458176,4071424,4071424,4071424,6737920,6740480,6743040,15620096,15626752,12288256,12398592,12398848,12288000,18323456,20631584,20621184,20676608,20611328,128,0,16580864,16621568,16621824,16580608,18599936,20664320,20605056,1638656,61440,46080,30720,0,832,0,0,0
.long 5242880,5245440,7942144,8052736,1065353216,20612360,20653192,18572288,67108864,2007040,2498452993,17,1459200,4074496,4074496,4074496,6745600,6748160,6750720,15661056,15667712,12427264,12427520,12316672,12316928,18395136,20631968,20621192,20678144,20611328,128,1,16631808,16632064,16590848,16591104,18625536,20664832,20605120,1659136,0,66560,51200,20480,832,0,0,0
.long 5248000,5250560,8159232,8269824,1065353216,20612368,20653200,19330048,67108864,2017280,2498453025,18,1460224,4077568,4077568,4077568,6753280,6755840,6758400,15702016,15708672,12456192,12345344,12345600,12455936,18466816,20632480,20621200,20679680,20611328,128,2,16642304,16601088,16601344,16642048,18651136,20665344,20605312,1679616,20480,5120,71680,40960,832,0,0,0
.long 5248000,5250560,8163328,8273920,1065353216,20612376,20653208,20087808,67108864,2017280,2498453025,19,1461248,4080640,4080640,4080640,6760960,6763520,6766080,15742976,15749632,12371968,12372224,12482560,12482816,18533376,20632864,20621208,20681216,20611328,128,3,16611328,16611584,16652288,16652544,18676736,20665856,20605376,1700096,40960,25600,10240,61440,832,0,0,0
.long 5324800,5327360,11476992,11587584,1065353216,20628736,20653440,17819648,20682368,2048000,2498452993,16,1785856,4399104,4399104,4399104,7065600,7068160,7070720,15624192,15627776,12288256,12398592,12398848,12288000,19838976,20631584,20621184,20676608,20611456,0,32,16580864,16621568,16621824,16580608,20115456,20664320,20605056,1639168,61440,46080,30720,0,448,0,0,0
.long 5324800,5327360,11481088,11591680,1065353216,20628744,20653448,18577408,67108864,2048000,2498452993,17,1786880,4402176,4402176,4402176,7073280,7075840,7078400,15665152,15668736,12427264,12427520,12316672,12316928,19910656,20631968,20621192,20678144,20611456,0,33,16631808,16632064,16590848,16591104,20141056,20664832,20605120,1659648,0,66560,51200,20480,448,0,0,0
.long 5329920,5332480,11698176,11808768,1065353216,20628752,20653456,19335168,67108864,2058240,2498453025,18,1787904,4405248,4405248,4405248,7080960,7083520,7086080,15706112,15709696,12456192,12345344,12345600,12455936,19982336,20632480,20621200,20679680,20611456,0,34,16642304,16601088,16601344,16642048,20166656,20665344,20605312,1680128,20480,5120,71680,40960,448,0,0,0
.long 5329920,5332480,11702272,11812864,1065353216,20628760,20653464,20092928,67108864,2058240,2498453025,19,1788928,4408320,4408320,4408320,7088640,7091200,7093760,15747072,15750656,12371968,12372224,12482560,12482816,20048896,20632864,20621208,20681216,20611456,0,35,16611328,16611584,16652288,16652544,20192256,20665856,20605376,1700608,40960,25600,10240,61440,448,0,0,0
.long 5304320,5306880,10616832,10727424,1065353216,20625024,20653696,17824768,20682496,2088960,3303792129,16,2113536,4726784,4726784,4726784,7393280,7395840,7398400,15630336,15636992,14057728,14168064,14168320,14057472,18323456,20639776,20621184,20676608,20611584,0,24,17236224,17276928,17277184,17235968,18599936,20672512,20609152,2294016,61440,46080,30720,0,832,0,0,0
.long 5304320,5306880,10620928,10731520,1065353216,20625032,20653704,18582528,67108864,2088960,3303792129,17,2114560,4729856,4729856,4729856,7400960,7403520,7406080,15671296,15677952,14196736,14196992,14086144,14086400,18395136,20640160,20621192,20678144,20611584,0,25,17287168,17287424,17246208,17246464,18625536,20673024,20609216,2314496,0,66560,51200,20480,832,0,0,0
.long 5309440,5312000,10838016,10948608,1065353216,20625040,20653712,19340288,67108864,2099200,3303792161,18,2115584,4732928,4732928,4732928,7408640,7411200,7413760,15712256,15718912,14225664,14114816,14115072,14225408,18466816,20640672,20621200,20679680,20611584,0,26,17297664,17256448,17256704,17297408,18651136,20673536,20609408,2334976,20480,5120,71680,40960,832,0,0,0
.long 5309440,5312000,10842112,10952704,1065353216,20625048,20653720,20098048,67108864,2099200,3303792161,19,2116608,4736000,4736000,4736000,7416320,7418880,7421440,15753216,15759872,14141440,14141696,14252032,14252288,18533376,20641056,20621208,20681216,20611584,0,27,17266688,17266944,17307648,17307904,18676736,20674048,20609472,2355456,40960,25600,10240,61440,832,0,0,0
.long 5386240,5388800,14155776,14266368,1065353216,20641408,20653952,17829888,20682624,2129920,3303792129,16,2441216,5054464,5054464,5054464,7720960,7723520,7726080,15634432,15638016,14057728,14168064,14168320,14057472,19838976,20639776,20621184,20676608,20611584,0,56,17236224,17276928,17277184,17235968,20115456,20672512,20609152,2294528,61440,46080,30720,0,448,0,0,0
.long 5386240,5388800,14159872,14270464,1065353216,20641416,20653960,18587648,67108864,2129920,3303792129,17,2442240,5057536,5057536,5057536,7728640,7731200,7733760,15675392,15678976,14196736,14196992,14086144,14086400,19910656,20640160,20621192,20678144,20611584,0,57,17287168,17287424,17246208,17246464,20141056,20673024,20609216,2315008,0,66560,51200,20480,448,0,0,0
.long 5391360,5393920,14376960,14487552,1065353216,20641424,20653968,19345408,67108864,2140160,3303792161,18,2443264,5060608,5060608,5060608,7736320,7738880,7741440,15716352,15719936,14225664,14114816,14115072,14225408,19982336,20640672,20621200,20679680,20611584,0,58,17297664,17256448,17256704,17297408,20166656,20673536,20609408,2335488,20480,5120,71680,40960,448,0,0,0
.long 5391360,5393920,14381056,14491648,1065353216,20641432,20653976,20103168,67108864,2140160,3303792161,19,2444288,5063680,5063680,5063680,7744000,7746560,7749120,15757312,15760896,14141440,14141696,14252032,14252288,20048896,20641056,20621208,20681216,20611584,0,59,17266688,17266944,17307648,17307904,20192256,20674048,20609472,2355968,40960,25600,10240,61440,448,0,0,0
.long 1069056,1070080,10092544,10203136,1051011932,20621568,20654208,17794304,20681736,1848320,619339329,20,151552,2764800,2764800,2764800,5437440,5440000,5442560,15763456,15770112,8970496,9080832,9081088,8970240,18323456,20615216,20623232,20676608,20611072,0,20,15352064,15392768,15393024,15351808,18599936,20647952,20597376,409856,61440,46080,30720,0,832,0,0,0
.long 1331200,1332224,10096640,10207232,1051011932,20621576,20654216,18552064,67108864,1848320,619339329,21,152576,2767872,2767872,2767872,5445120,5447680,5450240,15804416,15811072,9109504,9109760,8998912,8999168,18395136,20615600,20623240,20678144,20611072,0,21,15403008,15403264,15362048,15362304,18625536,20648464,20597440,430336,0,66560,51200,20480,832,0,0,0
.long 1071104,1072128,10313728,10424320,1051011932,20621584,20654224,19309824,67108864,1858560,619339361,22,153600,2770944,2770944,2770944,5452800,5455360,5457920,15845376,15852032,9138432,9027584,9027840,9138176,18466816,20616112,20623248,20679680,20611072,0,22,15413504,15372288,15372544,15413248,18651136,20648976,20597632,450816,20480,5120,71680,40960,832,0,0,0
.long 1333248,1334272,10317824,10428416,1051011932,20621592,20654232,20067584,67108864,1858560,619339361,23,154624,2774016,2774016,2774016,5460480,5463040,5465600,15886336,15892992,9054208,9054464,9164800,9165056,18533376,20616496,20623256,20681216,20611072,0,23,15382528,15382784,15423488,15423744,18676736,20649488,20597696,471296,40960,25600,10240,61440,832,0,0,0
.long 1101824,1102848,13631488,13742080,1051011932,20637952,20654464,17799424,20681864,1889280,619339329,20,479232,3092480,3092480,3092480,5765120,5767680,5770240,15767552,15771136,8970496,9080832,9081088,8970240,19838976,20615216,20623232,20676608,20611072,128,52,15352064,15392768,15393024,15351808,20115456,20647952,20597376,410368,61440,46080,30720,0,448,0,0,0
.long 1363968,1364992,13635584,13746176,1051011932,20637960,20654472,18557184,67108864,1889280,619339329,21,480256,3095552,3095552,3095552,5772800,5775360,5777920,15808512,15812096,9109504,9109760,8998912,8999168,19910656,20615600,20623240,20678144,20611072,128,53,15403008,15403264,15362048,15362304,20141056,20648464,20597440,430848,0,66560,51200,20480,448,0,0,0
.long 1103872,1104896,13852672,13963264,1051011932,20637968,20654480,19314944,67108864,1899520,619339361,22,481280,3098624,3098624,3098624,5780480,5783040,5785600,15849472,15853056,9138432,9027584,9027840,9138176,19982336,20616112,20623248,20679680,20611072,128,54,15413504,15372288,15372544,15413248,20166656,20648976,20597632,451328,20480,5120,71680,40960,448,0,0,0
.long 1366016,1367040,13856768,13967360,1051011932,20637976,20654488,20072704,67108864,1899520,619339361,23,482304,3101696,3101696,3101696,5788160,5790720,5793280,15890432,15894016,9054208,9054464,9164800,9165056,20048896,20616496,20623256,20681216,20611072,128,55,15382528,15382784,15423488,15423744,20192256,20649488,20597696,471808,40960,25600,10240,61440,448,0,0,0
.long 3158016,3159040,9240576,9351168,1065353216,20617984,20654720,17804544,20681992,1930240,1693113921,20,806912,3420160,3420160,3420160,6092800,6095360,6097920,15773696,15780352,10739968,10850304,10850560,10739712,18323456,20623408,20623232,20676608,20611200,0,12,16007424,16048128,16048384,16007168,18599936,20656144,20601472,1065216,61440,46080,30720,0,832,0,0,0
.long 3420160,3421184,9244672,9355264,1065353216,20617992,20654728,18562304,67108864,1930240,1693113921,21,807936,3423232,3423232,3423232,6100480,6103040,6105600,15814656,15821312,10878976,10879232,10768384,10768640,18395136,20623792,20623240,20678144,20611200,0,13,16058368,16058624,16017408,16017664,18625536,20656656,20601536,1085696,0,66560,51200,20480,832,0,0,0
.long 3160064,3161088,9461760,9572352,1065353216,20618000,20654736,19320064,67108864,1940480,1693113953,22,808960,3426304,3426304,3426304,6108160,6110720,6113280,15855616,15862272,10907904,10797056,10797312,10907648,18466816,20624304,20623248,20679680,20611200,0,14,16068864,16027648,16027904,16068608,18651136,20657168,20601728,1106176,20480,5120,71680,40960,832,0,0,0
.long 3422208,3423232,9465856,9576448,1065353216,20618008,20654744,20077824,67108864,1940480,1693113953,23,809984,3429376,3429376,3429376,6115840,6118400,6120960,15896576,15903232,10823680,10823936,10934272,10934528,18533376,20624688,20623256,20681216,20611200,0,15,16037888,16038144,16078848,16079104,18676736,20657680,20601792,1126656,40960,25600,10240,61440,832,0,0,0
.long 3190784,3191808,12779520,12890112,1065353216,20634368,20654976,17809664,20682120,1971200,1693113921,20,1134592,3747840,3747840,3747840,6420480,6423040,6425600,15777792,15781376,10739968,10850304,10850560,10739712,19838976,20623408,20623232,20676608,20611328,0,44,16007424,16048128,16048384,16007168,20115456,20656144,20601472,1065728,61440,46080,30720,0,448,0,0,0
.long 3452928,3453952,12783616,12894208,1065353216,20634376,20654984,18567424,67108864,1971200,1693113921,21,1135616,3750912,3750912,3750912,6428160,6430720,6433280,15818752,15822336,10878976,10879232,10768384,10768640,19910656,20623792,20623240,20678144,20611328,0,45,16058368,16058624,16017408,16017664,20141056,20656656,20601536,1086208,0,66560,51200,20480,448,0,0,0
.long 3192832,3193856,13000704,13111296,1065353216,20634384,20654992,19325184,67108864,1981440,1693113953,22,1136640,3753984,3753984,3753984,6435840,6438400,6440960,15859712,15863296,10907904,10797056,10797312,10907648,19982336,20624304,20623248,20679680,20611328,0,46,16068864,16027648,16027904,16068608,20166656,20657168,20601728,1106688,20480,5120,71680,40960,448,0,0,0
.long 3454976,3456000,13004800,13115392,1065353216,20634392,20655000,20082944,67108864,1981440,1693113953,23,1137664,3757056,3757056,3757056,6443520,6446080,6448640,15900672,15904256,10823680,10823936,10934272,10934528,20048896,20624688,20623256,20681216,20611328,0,47,16037888,16038144,16078848,16079104,20192256,20657680,20601792,1127168,40960,25600,10240,61440,448,0,0,0
.long 5253120,5255680,8380416,8491008,1065353216,20614400,20655232,17814784,20682248,2012160,2498453057,20,1462272,4075520,4075520,4075520,6748160,6750720,6753280,15783936,15790592,12509440,12619776,12620032,12509184,18323456,20631600,20623232,20676608,20611328,128,4,16662784,16703488,16703744,16662528,18599936,20664336,20605568,1720576,61440,46080,30720,0,832,0,0,0
.long 5253120,5255680,8384512,8495104,1065353216,20614408,20655240,18572544,67108864,2012160,2498453057,21,1463296,4078592,4078592,4078592,6755840,6758400,6760960,15824896,15831552,12648448,12648704,12537856,12538112,18395136,20631984,20623240,20678144,20611328,128,5,16713728,16713984,16672768,16673024,18625536,20664848,20605632,1741056,0,66560,51200,20480,832,0,0,0
.long 5258240,5260800,8601600,8712192,1065353216,20614416,20655248,19330304,67108864,2022400,2498453089,22,1464320,4081664,4081664,4081664,6763520,6766080,6768640,15865856,15872512,12677376,12566528,12566784,12677120,18466816,20632496,20623248,20679680,20611328,128,6,16724224,16683008,16683264,16723968,18651136,20665360,20605824,1761536,20480,5120,71680,40960,832,0,0,0
.long 5258240,5260800,8605696,8716288,1065353216,20614424,20655256,20088064,67108864,2022400,2498453089,23,1465344,4084736,4084736,4084736,6771200,6773760,6776320,15906816,15913472,12593152,12593408,12703744,12704000,18533376,20632880,20623256,20681216,20611328,128,7,16693248,16693504,16734208,16734464,18676736,20665872,20605888,1782016,40960,25600,10240,61440,832,0,0,0
.long 5335040,5337600,11919360,12029952,1065353216,20630784,20655488,17819904,20682376,2053120,2498453057,20,1789952,4403200,4403200,4403200,7075840,7078400,7080960,15788032,15791616,12509440,12619776,12620032,12509184,19838976,20631600,20623232,20676608,20611456,0,36,16662784,16703488,16703744,16662528,20115456,20664336,20605568,1721088,61440,46080,30720,0,448,0,0,0
.long 5335040,5337600,11923456,12034048,1065353216,20630792,20655496,18577664,67108864,2053120,2498453057,21,1790976,4406272,4406272,4406272,7083520,7086080,7088640,15828992,15832576,12648448,12648704,12537856,12538112,19910656,20631984,20623240,20678144,20611456,0,37,16713728,16713984,16672768,16673024,20141056,20664848,20605632,1741568,0,66560,51200,20480,448,0,0,0
.long 5340160,5342720,12140544,12251136,1065353216,20630800,20655504,19335424,67108864,2063360,2498453089,22,1792000,4409344,4409344,4409344,7091200,7093760,7096320,15869952,15873536,12677376,12566528,12566784,12677120,19982336,20632496,20623248,20679680,20611456,0,38,16724224,16683008,16683264,16723968,20166656,20665360,20605824,1762048,20480,5120,71680,40960,448,0,0,0
.long 5340160,5342720,12144640,12255232,1065353216,20630808,20655512,20093184,67108864,2063360,2498453089,23,1793024,4412416,4412416,4412416,7098880,7101440,7104000,15910912,15914496,12593152,12593408,12703744,12704000,20048896,20632880,20623256,20681216,20611456,0,39,16693248,16693504,16734208,16734464,20192256,20665872,20605888,1782528,40960,25600,10240,61440,448,0,0,0
.long 5314560,5317120,67108864,67108864,1065353216,20627072,20655744,17825024,20682504,2094080,3840663105,20,2117632,4730880,4730880,4730880,7403520,7406080,7408640,15794176,15800832,14278912,14389248,14389504,14278656,18323456,20639792,20623232,20676608,20611584,0,28,17318144,17358848,17359104,17317888,18599936,20672528,20609664,2375936,61440,46080,30720,0,832,0,0,0
.long 5314560,5317120,67108864,67108864,1065353216,20627080,20655752,18582784,67108864,2094080,3840663105,21,2118656,4733952,4733952,4733952,7411200,7413760,7416320,15835136,15841792,14417920,14418176,14307328,14307584,18395136,20640176,20623240,20678144,20611584,0,29,17369088,17369344,17328128,17328384,18625536,20673040,20609728,2396416,0,66560,51200,20480,832,0,0,0
.long 5319680,5322240,67108864,67108864,1065353216,20627088,20655760,19340544,67108864,2104320,3840663137,22,2119680,4737024,4737024,4737024,7418880,7421440,7424000,15876096,15882752,14446848,14336000,14336256,14446592,18466816,20640688,20623248,20679680,20611584,0,30,17379584,17338368,17338624,17379328,18651136,20673552,20609920,2416896,20480,5120,71680,40960,832,0,0,0
.long 5319680,5322240,67108864,67108864,1065353216,20627096,20655768,20098304,67108864,2104320,3840663137,23,2120704,4740096,4740096,4740096,7426560,7429120,7431680,15917056,15923712,14362624,14362880,14473216,14473472,18533376,20641072,20623256,20681216,20611584,0,31,17348608,17348864,17389568,17389824,18676736,20674064,20609984,2437376,40960,25600,10240,61440,832,0,0,0
.long 5396480,5399040,67108864,67108864,1065353216,20643456,20656000,17830144,20682632,2135040,3840663105,20,2445312,5058560,5058560,5058560,7731200,7733760,7736320,15798272,15801856,14278912,14389248,14389504,14278656,19838976,20639792,20623232,20676608,20611584,0,60,17318144,17358848,17359104,17317888,20115456,20672528,20609664,2376448,61440,46080,30720,0,448,0,0,0
.long 5396480,5399040,67108864,67108864,1065353216,20643464,20656008,18587904,67108864,2135040,3840663105,21,2446336,5061632,5061632,5061632,7738880,7741440,7744000,15839232,15842816,14417920,14418176,14307328,14307584,19910656,20640176,20623240,20678144,20611584,0,61,17369088,17369344,17328128,17328384,20141056,20673040,20609728,2396928,0,66560,51200,20480,448,0,0,0
.long 5401600,5404160,67108864,67108864,1065353216,20643472,20656016,19345664,67108864,2145280,3840663137,22,2447360,5064704,5064704,5064704,7746560,7749120,7751680,15880192,15883776,14446848,14336000,14336256,14446592,19982336,20640688,20623248,20679680,20611584,0,62,17379584,17338368,17338624,17379328,20166656,20673552,20609920,2417408,20480,5120,71680,40960,448,0,0,0
.long 5401600,5404160,67108864,67108864,1065353216,20643480,20656024,20103424,67108864,2145280,3840663137,23,2448384,5067776,5067776,5067776,7754240,7756800,7759360,15921152,15924736,14362624,14362880,14473216,14473472,20048896,20641072,20623256,20681216,20611584,0,63,17348608,17348864,17389568,17389824,20192256,20674064,20609984,2437888,40960,25600,10240,61440,448,0,0,0
.long 1073152,1074176,10534912,10645504,1051011932,20623616,20656256,17794560,20681744,1863680,619347457,24,155648,2768896,2768896,2768896,5447680,5450240,5452800,15927296,15933952,9191680,9302016,9302272,9191424,18323456,20617248,20625280,20676608,20611072,0,24,15433984,15474688,15474944,15433728,18599936,20649984,20597888,491776,61440,46080,30720,0,832,0,0,0
.long 1335296,1336320,10539008,10649600,1051011932,20623624,20656264,18552320,67108864,1863680,619347457,25,156672,2771968,2771968,2771968,5455360,5457920,5460480,15968256,15974912,9330688,9330944,9220096,9220352,18395136,20617632,20625288,20678144,20611072,0,25,15484928,15485184,15443968,15444224,18625536,20650496,20597952,512256,0,66560,51200,20480,832,0,0,0
.long 1075200,1076224,10756096,10866688,1051011932,20623632,20656272,19310080,67108864,1873920,619347489,26,157696,2775040,2775040,2775040,5463040,5465600,5468160,16009216,16015872,9359616,9248768,9249024,9359360,18466816,20618144,20625296,20679680,20611072,0,26,15495424,15454208,15454464,15495168,18651136,20651008,20598144,532736,20480,5120,71680,40960,832,0,0,0
.long 1337344,1338368,10760192,10870784,1051011932,20623640,20656280,20067840,67108864,1873920,619347489,27,158720,2778112,2778112,2778112,5470720,5473280,5475840,16050176,16056832,9275392,9275648,9385984,9386240,18533376,20618528,20625304,20681216,20611072,0,27,15464448,15464704,15505408,15505664,18676736,20651520,20598208,553216,40960,25600,10240,61440,832,0,0,0
.long 1105920,1106944,14073856,14184448,1051011932,20640000,20656512,17799680,20681872,1904640,619347457,24,483328,3096576,3096576,3096576,5775360,5777920,5780480,15931392,15934976,9191680,9302016,9302272,9191424,19838976,20617248,20625280,20676608,20611072,128,56,15433984,15474688,15474944,15433728,20115456,20649984,20597888,492288,61440,46080,30720,0,448,0,0,0
.long 1368064,1369088,14077952,14188544,1051011932,20640008,20656520,18557440,67108864,1904640,619347457,25,484352,3099648,3099648,3099648,5783040,5785600,5788160,15972352,15975936,9330688,9330944,9220096,9220352,19910656,20617632,20625288,20678144,20611072,128,57,15484928,15485184,15443968,15444224,20141056,20650496,20597952,512768,0,66560,51200,20480,448,0,0,0
.long 1107968,1108992,14295040,14405632,1051011932,20640016,20656528,19315200,67108864,1914880,619347489,26,485376,3102720,3102720,3102720,5790720,5793280,5795840,16013312,16016896,9359616,9248768,9249024,9359360,19982336,20618144,20625296,20679680,20611072,128,58,15495424,15454208,15454464,15495168,20166656,20651008,20598144,533248,20480,5120,71680,40960,448,0,0,0
.long 1370112,1371136,14299136,14409728,1051011932,20640024,20656536,20072960,67108864,1914880,619347489,27,486400,3105792,3105792,3105792,5798400,5800960,5803520,16054272,16057856,9275392,9275648,9385984,9386240,20048896,20618528,20625304,20681216,20611072,128,59,15464448,15464704,15505408,15505664,20192256,20651520,20598208,553728,40960,25600,10240,61440,448,0,0,0
.long 3162112,3163136,9674752,9785344,1065353216,20620032,20656768,17804800,20682000,1945600,1424686593,24,811008,3424256,3424256,3424256,6103040,6105600,6108160,15937536,15944192,10961152,11071488,11071744,10960896,18323456,20625440,20625280,20676608,20611200,0,16,16089344,16130048,16130304,16089088,18599936,20658176,20601984,1147136,61440,46080,30720,0,832,0,0,0
.long 3424256,3425280,9678848,9789440,1065353216,20620040,20656776,18562560,67108864,1945600,1424686593,25,812032,3427328,3427328,3427328,6110720,6113280,6115840,15978496,15985152,11100160,11100416,10989568,10989824,18395136,20625824,20625288,20678144,20611200,0,17,16140288,16140544,16099328,16099584,18625536,20658688,20602048,1167616,0,66560,51200,20480,832,0,0,0
.long 3164160,3165184,9895936,10006528,1065353216,20620048,20656784,19320320,67108864,1955840,1424686625,26,813056,3430400,3430400,3430400,6118400,6120960,6123520,16019456,16026112,11129088,11018240,11018496,11128832,18466816,20626336,20625296,20679680,20611200,0,18,16150784,16109568,16109824,16150528,18651136,20659200,20602240,1188096,20480,5120,71680,40960,832,0,0,0
.long 3426304,3427328,9900032,10010624,1065353216,20620056,20656792,20078080,67108864,1955840,1424686625,27,814080,3433472,3433472,3433472,6126080,6128640,6131200,16060416,16067072,11044864,11045120,11155456,11155712,18533376,20626720,20625304,20681216,20611200,0,19,16119808,16120064,16160768,16161024,18676736,20659712,20602304,1208576,40960,25600,10240,61440,832,0,0,0
.long 3194880,3195904,13213696,13324288,1065353216,20636416,20657024,17809920,20682128,1986560,1424686593,24,1138688,3751936,3751936,3751936,6430720,6433280,6435840,15941632,15945216,10961152,11071488,11071744,10960896,19838976,20625440,20625280,20676608,20611328,0,48,16089344,16130048,16130304,16089088,20115456,20658176,20601984,1147648,61440,46080,30720,0,448,0,0,0
.long 3457024,3458048,13217792,13328384,1065353216,20636424,20657032,18567680,67108864,1986560,1424686593,25,1139712,3755008,3755008,3755008,6438400,6440960,6443520,15982592,15986176,11100160,11100416,10989568,10989824,19910656,20625824,20625288,20678144,20611328,0,49,16140288,16140544,16099328,16099584,20141056,20658688,20602048,1168128,0,66560,51200,20480,448,0,0,0
.long 3196928,3197952,13434880,13545472,1065353216,20636432,20657040,19325440,67108864,1996800,1424686625,26,1140736,3758080,3758080,3758080,6446080,6448640,6451200,16023552,16027136,11129088,11018240,11018496,11128832,19982336,20626336,20625296,20679680,20611328,0,50,16150784,16109568,16109824,16150528,20166656,20659200,20602240,1188608,20480,5120,71680,40960,448,0,0,0
.long 3459072,3460096,13438976,13549568,1065353216,20636440,20657048,20083200,67108864,1996800,1424686625,27,1141760,3761152,3761152,3761152,6453760,6456320,6458880,16064512,16068096,11044864,11045120,11155456,11155712,20048896,20626720,20625304,20681216,20611328,0,51,16119808,16120064,16160768,16161024,20192256,20659712,20602304,1209088,40960,25600,10240,61440,448,0,0,0
.long 5263360,5265920,8822784,8933376,1065353216,20616448,20657280,17815040,20682256,2027520,2498461185,24,1466368,4079616,4079616,4079616,6758400,6760960,6763520,15947776,15954432,12730624,12840960,12841216,12730368,18323456,20633632,20625280,20676608,20611328,128,8,16744704,16785408,16785664,16744448,18599936,20666368,20606080,1802496,61440,46080,30720,0,832,0,0,0
.long 5263360,5265920,8826880,8937472,1065353216,20616456,20657288,18572800,67108864,2027520,2498461185,25,1467392,4082688,4082688,4082688,6766080,6768640,6771200,15988736,15995392,12869632,12869888,12759040,12759296,18395136,20634016,20625288,20678144,20611328,128,9,16795648,16795904,16754688,16754944,18625536,20666880,20606144,1822976,0,66560,51200,20480,832,0,0,0
.long 5268480,5271040,9043968,9154560,1065353216,20616464,20657296,19330560,67108864,2037760,2498461217,26,1468416,4085760,4085760,4085760,6773760,6776320,6778880,16029696,16036352,12898560,12787712,12787968,12898304,18466816,20634528,20625296,20679680,20611328,128,10,16806144,16764928,16765184,16805888,18651136,20667392,20606336,1843456,20480,5120,71680,40960,832,0,0,0
.long 5268480,5271040,9048064,9158656,1065353216,20616472,20657304,20088320,67108864,2037760,2498461217,27,1469440,4088832,4088832,4088832,6781440,6784000,6786560,16070656,16077312,12814336,12814592,12924928,12925184,18533376,20634912,20625304,20681216,20611328,128,11,16775168,16775424,16816128,16816384,18676736,20667904,20606400,1863936,40960,25600,10240,61440,832,0,0,0
.long 5345280,5347840,12361728,12472320,1065353216,20632832,20657536,17820160,20682384,2068480,2498461185,24,1794048,4407296,4407296,4407296,7086080,7088640,7091200,15951872,15955456,12730624,12840960,12841216,12730368,19838976,20633632,20625280,20676608,20611456,0,40,16744704,16785408,16785664,16744448,20115456,20666368,20606080,1803008,61440,46080,30720,0,448,0,0,0
.long 5345280,5347840,12365824,12476416,1065353216,20632840,20657544,18577920,67108864,2068480,2498461185,25,1795072,4410368,4410368,4410368,7093760,7096320,7098880,15992832,15996416,12869632,12869888,12759040,12759296,19910656,20634016,20625288,20678144,20611456,0,41,16795648,16795904,16754688,16754944,20141056,20666880,20606144,1823488,0,66560,51200,20480,448,0,0,0
.long 5350400,5352960,12582912,12693504,1065353216,20632848,20657552,19335680,67108864,2078720,2498461217,26,1796096,4413440,4413440,4413440,7101440,7104000,7106560,16033792,16037376,12898560,12787712,12787968,12898304,19982336,20634528,20625296,20679680,20611456,0,42,16806144,16764928,16765184,16805888,20166656,20667392,20606336,1843968,20480,5120,71680,40960,448,0,0,0
.long 5350400,5352960,12587008,12697600,1065353216,20632856,20657560,20093440,67108864,2078720,2498461217,27,1797120,4416512,4416512,4416512,7109120,7111680,7114240,16074752,16078336,12814336,12814592,12924928,12925184,20048896,20634912,20625304,20681216,20611456,0,43,16775168,16775424,16816128,16816384,20192256,20667904,20606400,1864448,40960,25600,10240,61440,448,0,0,0
.long 5242880,5245440,7970816,8081408,1065353216,20612864,20657792,17825280,20682512,2109440,3572235777,24,2121728,4734976,4734976,4734976,7413760,7416320,7418880,15958016,15964672,14500096,14610432,14610688,14499840,18323456,20641824,20625280,20676608,20611584,0,0,17400064,17440768,17441024,17399808,18599936,20674560,20610176,2457856,61440,46080,30720,0,832,0,0,0
.long 5242880,5245440,67108864,67108864,1065353216,20612872,20657800,18583040,67108864,2109440,3572235777,25,2122752,4738048,4738048,4738048,7421440,7424000,7426560,15998976,16005632,14639104,14639360,14528512,14528768,18395136,20642208,20625288,20678144,20611584,0,1,17451008,17451264,17410048,17410304,18625536,20675072,20610240,2478336,0,66560,51200,20480,832,0,0,0
.long 5248000,5250560,8192000,8302592,1065353216,20612880,20657808,19340800,67108864,2119680,3572235809,26,2123776,4741120,4741120,4741120,7429120,7431680,7434240,16039936,16046592,14668032,14557184,14557440,14667776,18466816,20642720,20625296,20679680,20611584,0,2,17461504,17420288,17420544,17461248,18651136,20675584,20610432,2498816,20480,5120,71680,40960,832,0,0,0
.long 5248000,5250560,67108864,67108864,1065353216,20612888,20657816,20098560,67108864,2119680,3572235809,27,2124800,4744192,4744192,4744192,7436800,7439360,7441920,16080896,16087552,14583808,14584064,14694400,14694656,18533376,20643104,20625304,20681216,20611584,0,3,17430528,17430784,17471488,17471744,18676736,20676096,20610496,2519296,40960,25600,10240,61440,832,0,0,0
.long 5324800,5327360,11509760,11620352,1065353216,20629248,20658048,17830400,20682640,2150400,3572235777,24,2449408,5062656,5062656,5062656,7741440,7744000,7746560,15962112,15965696,14500096,14610432,14610688,14499840,19838976,20641824,20625280,20676608,20611584,0,32,17400064,17440768,17441024,17399808,20115456,20674560,20610176,2458368,61440,46080,30720,0,448,0,0,0
.long 5324800,5327360,67108864,67108864,1065353216,20629256,20658056,18588160,67108864,2150400,3572235777,25,2450432,5065728,5065728,5065728,7749120,7751680,7754240,16003072,16006656,14639104,14639360,14528512,14528768,19910656,20642208,20625288,20678144,20611584,0,33,17451008,17451264,17410048,17410304,20141056,20675072,20610240,2478848,0,66560,51200,20480,448,0,0,0
.long 5329920,5332480,11730944,11841536,1065353216,20629264,20658064,19345920,67108864,2160640,3572235809,26,2451456,5068800,5068800,5068800,7756800,7759360,7761920,16044032,16047616,14668032,14557184,14557440,14667776,19982336,20642720,20625296,20679680,20611584,0,34,17461504,17420288,17420544,17461248,20166656,20675584,20610432,2499328,20480,5120,71680,40960,448,0,0,0
.long 5329920,5332480,67108864,67108864,1065353216,20629272,20658072,20103680,67108864,2160640,3572235809,27,2452480,5071872,5071872,5071872,7764480,7767040,7769600,16084992,16088576,14583808,14584064,14694400,14694656,20048896,20643104,20625304,20681216,20611584,0,35,17430528,17430784,17471488,17471744,20192256,20676096,20610496,2519808,40960,25600,10240,61440,448,0,0,0
.long 1077248,1078272,10977280,11087872,1051011932,20625664,20658304,17794816,20681752,1868800,619347521,28,159744,2772992,2772992,2772992,5457920,5460480,5463040,16091136,16097792,9412864,9523200,9523456,9412608,18323456,20617264,20627328,20676608,20611072,0,28,15515904,15556608,15556864,15515648,18599936,20650000,20598400,573696,61440,46080,30720,0,832,0,0,0
.long 1339392,1340416,10981376,11091968,1051011932,20625672,20658312,18552576,67108864,1868800,619347521,29,160768,2776064,2776064,2776064,5465600,5468160,5470720,16132096,16138752,9551872,9552128,9441280,9441536,18395136,20617648,20627336,20678144,20611072,0,29,15566848,15567104,15525888,15526144,18625536,20650512,20598464,594176,0,66560,51200,20480,832,0,0,0
.long 1079296,1080320,11198464,11309056,1051011932,20625680,20658320,19310336,67108864,1879040,619347553,30,161792,2779136,2779136,2779136,5473280,5475840,5478400,16173056,16179712,9580800,9469952,9470208,9580544,18466816,20618160,20627344,20679680,20611072,0,30,15577344,15536128,15536384,15577088,18651136,20651024,20598656,614656,20480,5120,71680,40960,832,0,0,0
.long 1341440,1342464,11202560,11313152,1051011932,20625688,20658328,20068096,67108864,1879040,619347553,31,162816,2782208,2782208,2782208,5480960,5483520,5486080,16214016,16220672,9496576,9496832,9607168,9607424,18533376,20618544,20627352,20681216,20611072,0,31,15546368,15546624,15587328,15587584,18676736,20651536,20598720,635136,40960,25600,10240,61440,832,0,0,0
.long 1110016,1111040,14516224,14626816,1051011932,20642048,20658560,17799936,20681880,1909760,619347521,28,487424,3100672,3100672,3100672,5785600,5788160,5790720,16095232,16098816,9412864,9523200,9523456,9412608,19838976,20617264,20627328,20676608,20611072,128,60,15515904,15556608,15556864,15515648,20115456,20650000,20598400,574208,61440,46080,30720,0,448,0,0,0
.long 1372160,1373184,14520320,14630912,1051011932,20642056,20658568,18557696,67108864,1909760,619347521,29,488448,3103744,3103744,3103744,5793280,5795840,5798400,16136192,16139776,9551872,9552128,9441280,9441536,19910656,20617648,20627336,20678144,20611072,128,61,15566848,15567104,15525888,15526144,20141056,20650512,20598464,594688,0,66560,51200,20480,448,0,0,0
.long 1112064,1113088,14737408,14848000,1051011932,20642064,20658576,19315456,67108864,1920000,619347553,30,489472,3106816,3106816,3106816,5800960,5803520,5806080,16177152,16180736,9580800,9469952,9470208,9580544,19982336,20618160,20627344,20679680,20611072,128,62,15577344,15536128,15536384,15577088,20166656,20651024,20598656,615168,20480,5120,71680,40960,448,0,0,0
.long 1374208,1375232,14741504,14852096,1051011932,20642072,20658584,20073216,67108864,1920000,619347553,31,490496,3109888,3109888,3109888,5808640,5811200,5813760,16218112,16221696,9496576,9496832,9607168,9607424,20048896,20618544,20627352,20681216,20611072,128,63,15546368,15546624,15587328,15587584,20192256,20651536,20598720,635648,40960,25600,10240,61440,448,0,0,0
.long 3166208,3167232,10117120,10227712,1065353216,20622080,20658816,17805056,20682008,1950720,1424686657,28,815104,3428352,3428352,3428352,6113280,6115840,6118400,16101376,16108032,11182336,11292672,11292928,11182080,18323456,20625456,20627328,20676608,20611200,0,20,16171264,16211968,16212224,16171008,18599936,20658192,20602496,1229056,61440,46080,30720,0,832,0,0,0
.long 3428352,3429376,10121216,10231808,1065353216,20622088,20658824,18562816,67108864,1950720,1424686657,29,816128,3431424,3431424,3431424,6120960,6123520,6126080,16142336,16148992,11321344,11321600,11210752,11211008,18395136,20625840,20627336,20678144,20611200,0,21,16222208,16222464,16181248,16181504,18625536,20658704,20602560,1249536,0,66560,51200,20480,832,0,0,0
.long 3168256,3169280,10338304,10448896,1065353216,20622096,20658832,19320576,67108864,1960960,1424686689,30,817152,3434496,3434496,3434496,6128640,6131200,6133760,16183296,16189952,11350272,11239424,11239680,11350016,18466816,20626352,20627344,20679680,20611200,0,22,16232704,16191488,16191744,16232448,18651136,20659216,20602752,1270016,20480,5120,71680,40960,832,0,0,0
.long 3430400,3431424,10342400,10452992,1065353216,20622104,20658840,20078336,67108864,1960960,1424686689,31,818176,3437568,3437568,3437568,6136320,6138880,6141440,16224256,16230912,11266048,11266304,11376640,11376896,18533376,20626736,20627352,20681216,20611200,0,23,16201728,16201984,16242688,16242944,18676736,20659728,20602816,1290496,40960,25600,10240,61440,832,0,0,0
.long 3198976,3200000,13656064,13766656,1065353216,20638464,20659072,17810176,20682136,1991680,1424686657,28,1142784,3756032,3756032,3756032,6440960,6443520,6446080,16105472,16109056,11182336,11292672,11292928,11182080,19838976,20625456,20627328,20676608,20611328,0,52,16171264,16211968,16212224,16171008,20115456,20658192,20602496,1229568,61440,46080,30720,0,448,0,0,0
.long 3461120,3462144,13660160,13770752,1065353216,20638472,20659080,18567936,67108864,1991680,1424686657,29,1143808,3759104,3759104,3759104,6448640,6451200,6453760,16146432,16150016,11321344,11321600,11210752,11211008,19910656,20625840,20627336,20678144,20611328,0,53,16222208,16222464,16181248,16181504,20141056,20658704,20602560,1250048,0,66560,51200,20480,448,0,0,0
.long 3201024,3202048,13877248,13987840,1065353216,20638480,20659088,19325696,67108864,2001920,1424686689,30,1144832,3762176,3762176,3762176,6456320,6458880,6461440,16187392,16190976,11350272,11239424,11239680,11350016,19982336,20626352,20627344,20679680,20611328,0,54,16232704,16191488,16191744,16232448,20166656,20659216,20602752,1270528,20480,5120,71680,40960,448,0,0,0
.long 3463168,3464192,13881344,13991936,1065353216,20638488,20659096,20083456,67108864,2001920,1424686689,31,1145856,3765248,3765248,3765248,6464000,6466560,6469120,16228352,16231936,11266048,11266304,11376640,11376896,20048896,20626736,20627352,20681216,20611328,0,55,16201728,16201984,16242688,16242944,20192256,20659728,20602816,1291008,40960,25600,10240,61440,448,0,0,0
.long 5273600,5276160,9273344,9383936,1065353216,20618496,20659328,17815296,20682264,2032640,2766896705,28,1470464,4083712,4083712,4083712,6768640,6771200,6773760,16111616,16118272,12951808,13062144,13062400,12951552,18323456,20633648,20627328,20676608,20611328,128,12,16826624,16867328,16867584,16826368,18599936,20666384,20606592,1884416,61440,46080,30720,0,832,0,0,0
.long 5273600,5276160,9277440,9388032,1065353216,20618504,20659336,18573056,67108864,2032640,2766896705,29,1471488,4086784,4086784,4086784,6776320,6778880,6781440,16152576,16159232,13090816,13091072,12980224,12980480,18395136,20634032,20627336,20678144,20611328,128,13,16877568,16877824,16836608,16836864,18625536,20666896,20606656,1904896,0,66560,51200,20480,832,0,0,0
.long 5278720,5281280,9494528,9605120,1065353216,20618512,20659344,19330816,67108864,2042880,2766896737,30,1472512,4089856,4089856,4089856,6784000,6786560,6789120,16193536,16200192,13119744,13008896,13009152,13119488,18466816,20634544,20627344,20679680,20611328,128,14,16888064,16846848,16847104,16887808,18651136,20667408,20606848,1925376,20480,5120,71680,40960,832,0,0,0
.long 5278720,5281280,9498624,9609216,1065353216,20618520,20659352,20088576,67108864,2042880,2766896737,31,1473536,4092928,4092928,4092928,6791680,6794240,6796800,16234496,16241152,13035520,13035776,13146112,13146368,18533376,20634928,20627352,20681216,20611328,128,15,16857088,16857344,16898048,16898304,18676736,20667920,20606912,1945856,40960,25600,10240,61440,832,0,0,0
.long 5355520,5358080,12812288,12922880,1065353216,20634880,20659584,17820416,20682392,2073600,2766896705,28,1798144,4411392,4411392,4411392,7096320,7098880,7101440,16115712,16119296,12951808,13062144,13062400,12951552,19838976,20633648,20627328,20676608,20611456,0,44,16826624,16867328,16867584,16826368,20115456,20666384,20606592,1884928,61440,46080,30720,0,448,0,0,0
.long 5355520,5358080,12816384,12926976,1065353216,20634888,20659592,18578176,67108864,2073600,2766896705,29,1799168,4414464,4414464,4414464,7104000,7106560,7109120,16156672,16160256,13090816,13091072,12980224,12980480,19910656,20634032,20627336,20678144,20611456,0,45,16877568,16877824,16836608,16836864,20141056,20666896,20606656,1905408,0,66560,51200,20480,448,0,0,0
.long 5360640,5363200,13033472,13144064,1065353216,20634896,20659600,19335936,67108864,2083840,2766896737,30,1800192,4417536,4417536,4417536,7111680,7114240,7116800,16197632,16201216,13119744,13008896,13009152,13119488,19982336,20634544,20627344,20679680,20611456,0,46,16888064,16846848,16847104,16887808,20166656,20667408,20606848,1925888,20480,5120,71680,40960,448,0,0,0
.long 5360640,5363200,13037568,13148160,1065353216,20634904,20659608,20093696,67108864,2083840,2766896737,31,1801216,4420608,4420608,4420608,7119360,7121920,7124480,16238592,16242176,13035520,13035776,13146112,13146368,20048896,20634928,20627352,20681216,20611456,0,47,16857088,16857344,16898048,16898304,20192256,20667920,20606912,1946368,40960,25600,10240,61440,448,0,0,0
.long 5253120,5255680,8413184,8523776,1065353216,20614912,20659840,17825536,20682520,2114560,3572235841,28,2125824,4739072,4739072,4739072,7424000,7426560,7429120,16121856,16128512,14721280,14831616,14831872,14721024,18323456,20641840,20627328,20676608,20611584,0,4,17481984,17522688,17522944,17481728,18599936,20674576,20610688,2539776,61440,46080,30720,0,832,0,0,0
.long 5253120,5255680,67108864,67108864,1065353216,20614920,20659848,18583296,67108864,2114560,3572235841,29,2126848,4742144,4742144,4742144,7431680,7434240,7436800,16162816,16169472,14860288,14860544,14749696,14749952,18395136,20642224,20627336,20678144,20611584,0,5,17532928,17533184,17491968,17492224,18625536,20675088,20610752,2560256,0,66560,51200,20480,832,0,0,0
.long 5258240,5260800,8634368,8744960,1065353216,20614928,20659856,19341056,67108864,2124800,3572235873,30,2127872,4745216,4745216,4745216,7439360,7441920,7444480,16203776,16210432,14889216,14778368,14778624,14888960,18466816,20642736,20627344,20679680,20611584,0,6,17543424,17502208,17502464,17543168,18651136,20675600,20610944,2580736,20480,5120,71680,40960,832,0,0,0
.long 5258240,5260800,67108864,67108864,1065353216,20614936,20659864,20098816,67108864,2124800,3572235873,31,2128896,4748288,4748288,4748288,7447040,7449600,7452160,16244736,16251392,14804992,14805248,14915584,14915840,18533376,20643120,20627352,20681216,20611584,0,7,17512448,17512704,17553408,17553664,18676736,20676112,20611008,2601216,40960,25600,10240,61440,832,0,0,0
.long 5335040,5337600,11952128,12062720,1065353216,20631296,20660096,17830656,20682648,2155520,3572235841,28,2453504,5066752,5066752,5066752,7751680,7754240,7756800,16125952,16129536,14721280,14831616,14831872,14721024,19838976,20641840,20627328,20676608,20611584,0,36,17481984,17522688,17522944,17481728,20115456,20674576,20610688,2540288,61440,46080,30720,0,448,0,0,0
.long 5335040,5337600,67108864,67108864,1065353216,20631304,20660104,18588416,67108864,2155520,3572235841,29,2454528,5069824,5069824,5069824,7759360,7761920,7764480,16166912,16170496,14860288,14860544,14749696,14749952,19910656,20642224,20627336,20678144,20611584,0,37,17532928,17533184,17491968,17492224,20141056,20675088,20610752,2560768,0,66560,51200,20480,448,0,0,0
.long 5340160,5342720,12173312,12283904,1065353216,20631312,20660112,19346176,67108864,2165760,3572235873,30,2455552,5072896,5072896,5072896,7767040,7769600,7772160,16207872,16211456,14889216,14778368,14778624,14888960,19982336,20642736,20627344,20679680,20611584,0,38,17543424,17502208,17502464,17543168,20166656,20675600,20610944,2581248,20480,5120,71680,40960,448,0,0,0
.long 5340160,5342720,67108864,67108864,1065353216,20631320,20660120,20103936,67108864,2165760,3572235873,31,2456576,5075968,5075968,5075968,7774720,7777280,7779840,16248832,16252416,14804992,14805248,14915584,14915840,20048896,20643120,20627352,20681216,20611584,0,39,17512448,17512704,17553408,17553664,20192256,20676112,20611008,2601728,40960,25600,10240,61440,448,0,0,0
.long 1572864,1573888,7880704,7991296,1051011932,20611456,20660352,17840128,20682752,0,619322883,32,163840,2777088,2777088,2777088,5468160,5470720,5473280,16254976,16261632,7864576,7974912,7975168,7864320,18702336,20611104,20629376,20676608,20611072,0,0,14942464,14983168,14983424,14942208,18978816,20643840,20594816,384,61440,46080,30720,0,736,0,0,0
.long 1835008,1836032,7884800,7995392,1051011932,20611464,20660360,18597888,67108864,0,619322883,33,164864,2780160,2780160,2780160,5475840,5478400,5480960,16295936,16302592,8003584,8003840,7892992,7893248,18774016,20611616,20629384,20678144,20611072,0,1,14993408,14993664,14952448,14952704,19004416,20644352,20594880,20864,0,66560,51200,20480,736,0,0,0
.long 1574912,1575936,8101888,8212480,1051011932,20611472,20660368,19355648,67108864,10240,619322915,34,165888,2783232,2783232,2783232,5483520,5486080,5488640,16336896,16343552,8032512,7921664,7921920,8032256,18845696,20612128,20629392,20679680,20611072,0,2,15003904,14962688,14962944,15003648,19030016,20644864,20595072,41344,20480,5120,71680,40960,736,0,0,0
.long 1837056,1838080,8105984,8216576,1051011932,20611480,20660376,20113408,67108864,10240,619322915,35,166912,2786304,2786304,2786304,5491200,5493760,5496320,16377856,16384512,7948288,7948544,8058880,8059136,18912256,20612384,20629400,20681216,20611072,0,3,14972928,14973184,15013888,15014144,19055616,20645376,20595136,61824,40960,25600,10240,61440,736,0,0,0
.long 1605632,1606656,11419648,11530240,1051011932,20627840,20660608,17845248,20682880,51200,619322883,32,491520,3104768,3104768,3104768,5795840,5798400,5800960,16259072,16262656,7864576,7974912,7975168,7864320,20217856,20611104,20629376,20676608,20611072,128,32,14942464,14983168,14983424,14942208,20494336,20643840,20594816,896,61440,46080,30720,0,352,0,0,0
.long 1867776,1868800,11423744,11534336,1051011932,20627848,20660616,18603008,67108864,51200,619322883,33,492544,3107840,3107840,3107840,5803520,5806080,5808640,16300032,16303616,8003584,8003840,7892992,7893248,20289536,20611616,20629384,20678144,20611072,128,33,14993408,14993664,14952448,14952704,20519936,20644352,20594880,21376,0,66560,51200,20480,352,0,0,0
.long 1607680,1608704,11640832,11751424,1051011932,20627856,20660624,19360768,67108864,61440,619322915,34,493568,3110912,3110912,3110912,5811200,5813760,5816320,16340992,16344576,8032512,7921664,7921920,8032256,20361216,20612128,20629392,20679680,20611072,128,34,15003904,14962688,14962944,15003648,20545536,20644864,20595072,41856,20480,5120,71680,40960,352,0,0,0
.long 1869824,1870848,11644928,11755520,1051011932,20627864,20660632,20118528,67108864,61440,619322915,35,494592,3113984,3113984,3113984,5818880,5821440,5824000,16381952,16385536,7948288,7948544,8058880,8059136,20427776,20612384,20629400,20681216,20611072,128,35,14972928,14973184,15013888,15014144,20571136,20645376,20595136,62336,40960,25600,10240,61440,352,0,0,0
.long 3170304,3171328,10567680,10678272,1065353216,20624128,20660864,17850368,20683008,102400,1693097475,32,819200,3432448,3432448,3432448,6123520,6126080,6128640,16265216,16271872,9634048,9744384,9744640,9633792,18702336,20619296,20629376,20676608,20611200,0,24,15597824,15638528,15638784,15597568,18978816,20652032,20598912,655744,61440,46080,30720,0,736,0,0,0
.long 3432448,3433472,10571776,10682368,1065353216,20624136,20660872,18608128,67108864,102400,1693097475,33,820224,3435520,3435520,3435520,6131200,6133760,6136320,16306176,16312832,9773056,9773312,9662464,9662720,18774016,20619808,20629384,20678144,20611200,0,25,15648768,15649024,15607808,15608064,19004416,20652544,20598976,676224,0,66560,51200,20480,736,0,0,0
.long 3172352,3173376,10788864,10899456,1065353216,20624144,20660880,19365888,67108864,112640,1693097507,34,821248,3438592,3438592,3438592,6138880,6141440,6144000,16347136,16353792,9801984,9691136,9691392,9801728,18845696,20620320,20629392,20679680,20611200,0,26,15659264,15618048,15618304,15659008,19030016,20653056,20599168,696704,20480,5120,71680,40960,736,0,0,0
.long 3434496,3435520,10792960,10903552,1065353216,20624152,20660888,20123648,67108864,112640,1693097507,35,822272,3441664,3441664,3441664,6146560,6149120,6151680,16388096,16394752,9717760,9718016,9828352,9828608,18912256,20620576,20629400,20681216,20611200,0,27,15628288,15628544,15669248,15669504,19055616,20653568,20599232,717184,40960,25600,10240,61440,736,0,0,0
.long 3203072,3204096,14106624,14217216,1065353216,20640512,20661120,17865728,20683136,204800,1693097475,32,1146880,3760128,3760128,3760128,6451200,6453760,6456320,16269312,16272896,9634048,9744384,9744640,9633792,20217856,20619296,20629376,20676608,20611328,0,56,15597824,15638528,15638784,15597568,20494336,20652032,20598912,656256,61440,46080,30720,0,352,0,0,0
.long 3465216,3466240,14110720,14221312,1065353216,20640520,20661128,18623488,67108864,204800,1693097475,33,1147904,3763200,3763200,3763200,6458880,6461440,6464000,16310272,16313856,9773056,9773312,9662464,9662720,20289536,20619808,20629384,20678144,20611328,0,57,15648768,15649024,15607808,15608064,20519936,20652544,20598976,676736,0,66560,51200,20480,352,0,0,0
.long 3205120,3206144,14327808,14438400,1065353216,20640528,20661136,19381248,67108864,215040,1693097507,34,1148928,3766272,3766272,3766272,6466560,6469120,6471680,16351232,16354816,9801984,9691136,9691392,9801728,20361216,20620320,20629392,20679680,20611328,0,58,15659264,15618048,15618304,15659008,20545536,20653056,20599168,697216,20480,5120,71680,40960,352,0,0,0
.long 3467264,3468288,14331904,14442496,1065353216,20640536,20661144,20139008,67108864,215040,1693097507,35,1149952,3769344,3769344,3769344,6474240,6476800,6479360,16392192,16395776,9717760,9718016,9828352,9828608,20427776,20620576,20629400,20681216,20611328,0,59,15628288,15628544,15669248,15669504,20571136,20653568,20599232,717696,40960,25600,10240,61440,352,0,0,0
.long 5283840,5286400,9707520,9818112,1065353216,20620544,20661376,17870848,20683264,256000,2498436611,32,1474560,4087808,4087808,4087808,6778880,6781440,6784000,16275456,16282112,11403520,11513856,11514112,11403264,18702336,20627488,20629376,20676608,20611328,128,16,16253184,16293888,16294144,16252928,18978816,20660224,20603008,1311104,61440,46080,30720,0,736,0,0,0
.long 5283840,5286400,9711616,9822208,1065353216,20620552,20661384,18628608,67108864,256000,2498436611,33,1475584,4090880,4090880,4090880,6786560,6789120,6791680,16316416,16323072,11542528,11542784,11431936,11432192,18774016,20628000,20629384,20678144,20611328,128,17,16304128,16304384,16263168,16263424,19004416,20660736,20603072,1331584,0,66560,51200,20480,736,0,0,0
.long 5288960,5291520,9928704,10039296,1065353216,20620560,20661392,19386368,67108864,266240,2498436643,34,1476608,4093952,4093952,4093952,6794240,6796800,6799360,16357376,16364032,11571456,11460608,11460864,11571200,18845696,20628512,20629392,20679680,20611328,128,18,16314624,16273408,16273664,16314368,19030016,20661248,20603264,1352064,20480,5120,71680,40960,736,0,0,0
.long 5288960,5291520,9932800,10043392,1065353216,20620568,20661400,20144128,67108864,266240,2498436643,35,1477632,4097024,4097024,4097024,6801920,6804480,6807040,16398336,16404992,11487232,11487488,11597824,11598080,18912256,20628768,20629400,20681216,20611328,128,19,16283648,16283904,16324608,16324864,19055616,20661760,20603328,1372544,40960,25600,10240,61440,736,0,0,0
.long 5365760,5368320,13246464,13357056,1065353216,20636928,20661632,17875968,20683392,307200,2498436611,32,1802240,4415488,4415488,4415488,7106560,7109120,7111680,16279552,16283136,11403520,11513856,11514112,11403264,20217856,20627488,20629376,20676608,20611456,0,48,16253184,16293888,16294144,16252928,20494336,20660224,20603008,1311616,61440,46080,30720,0,352,0,0,0
.long 5365760,5368320,13250560,13361152,1065353216,20636936,20661640,18633728,67108864,307200,2498436611,33,1803264,4418560,4418560,4418560,7114240,7116800,7119360,16320512,16324096,11542528,11542784,11431936,11432192,20289536,20628000,20629384,20678144,20611456,0,49,16304128,16304384,16263168,16263424,20519936,20660736,20603072,1332096,0,66560,51200,20480,352,0,0,0
.long 5370880,5373440,13467648,13578240,1065353216,20636944,20661648,19391488,67108864,317440,2498436643,34,1804288,4421632,4421632,4421632,7121920,7124480,7127040,16361472,16365056,11571456,11460608,11460864,11571200,20361216,20628512,20629392,20679680,20611456,0,50,16314624,16273408,16273664,16314368,20545536,20661248,20603264,1352576,20480,5120,71680,40960,352,0,0,0
.long 5370880,5373440,13471744,13582336,1065353216,20636952,20661656,20149248,67108864,317440,2498436643,35,1805312,4424704,4424704,4424704,7129600,7132160,7134720,16402432,16406016,11487232,11487488,11597824,11598080,20427776,20628768,20629400,20681216,20611456,0,51,16283648,16283904,16324608,16324864,20571136,20661760,20603328,1373056,40960,25600,10240,61440,352,0,0,0
.long 5263360,5265920,8855552,8966144,1065353216,20616960,20661888,17891328,20683520,409600,3572211203,32,2129920,4743168,4743168,4743168,7434240,7436800,7439360,16285696,16292352,13172992,13283328,13283584,13172736,18702336,20635680,20629376,20676608,20611584,0,8,16908544,16949248,16949504,16908288,18978816,20668416,20607104,1966464,61440,46080,30720,0,736,0,0,0
.long 5263360,5265920,67108864,67108864,1065353216,20616968,20661896,18649088,67108864,409600,3572211203,33,2130944,4746240,4746240,4746240,7441920,7444480,7447040,16326656,16333312,13312000,13312256,13201408,13201664,18774016,20636192,20629384,20678144,20611584,0,9,16959488,16959744,16918528,16918784,19004416,20668928,20607168,1986944,0,66560,51200,20480,736,0,0,0
.long 5268480,5271040,9076736,9187328,1065353216,20616976,20661904,19406848,67108864,419840,3572211235,34,2131968,4749312,4749312,4749312,7449600,7452160,7454720,16367616,16374272,13340928,13230080,13230336,13340672,18845696,20636704,20629392,20679680,20611584,0,10,16969984,16928768,16929024,16969728,19030016,20669440,20607360,2007424,20480,5120,71680,40960,736,0,0,0
.long 5268480,5271040,67108864,67108864,1065353216,20616984,20661912,20164608,67108864,419840,3572211235,35,2132992,4752384,4752384,4752384,7457280,7459840,7462400,16408576,16415232,13256704,13256960,13367296,13367552,18912256,20636960,20629400,20681216,20611584,0,11,16939008,16939264,16979968,16980224,19055616,20669952,20607424,2027904,40960,25600,10240,61440,736,0,0,0
.long 5345280,5347840,12394496,12505088,1065353216,20633344,20662144,17896448,20683648,460800,3572211203,32,2457600,5070848,5070848,5070848,7761920,7764480,7767040,16289792,16293376,13172992,13283328,13283584,13172736,20217856,20635680,20629376,20676608,20611584,0,40,16908544,16949248,16949504,16908288,20494336,20668416,20607104,1966976,61440,46080,30720,0,352,0,0,0
.long 5345280,5347840,67108864,67108864,1065353216,20633352,20662152,18654208,67108864,460800,3572211203,33,2458624,5073920,5073920,5073920,7769600,7772160,7774720,16330752,16334336,13312000,13312256,13201408,13201664,20289536,20636192,20629384,20678144,20611584,0,41,16959488,16959744,16918528,16918784,20519936,20668928,20607168,1987456,0,66560,51200,20480,352,0,0,0
.long 5350400,5352960,12615680,12726272,1065353216,20633360,20662160,19411968,67108864,471040,3572211235,34,2459648,5076992,5076992,5076992,7777280,7779840,7782400,16371712,16375296,13340928,13230080,13230336,13340672,20361216,20636704,20629392,20679680,20611584,0,42,16969984,16928768,16929024,16969728,20545536,20669440,20607360,2007936,20480,5120,71680,40960,352,0,0,0
.long 5350400,5352960,67108864,67108864,1065353216,20633368,20662168,20169728,67108864,471040,3572211235,35,2460672,5080064,5080064,5080064,7784960,7787520,7790080,16412672,16416256,13256704,13256960,13367296,13367552,20427776,20636960,20629400,20681216,20611584,0,43,16939008,16939264,16979968,16980224,20571136,20669952,20607424,2028416,40960,25600,10240,61440,352,0,0,0
.long 1576960,1577984,8331264,8441856,1051011932,20613504,20662400,17840384,20682760,5120,887758403,36,167936,2781184,2781184,2781184,5478400,5480960,5483520,16418816,16425472,8085760,8196096,8196352,8085504,18702336,20611120,20631424,20676608,20611072,0,4,15024384,15065088,15065344,15024128,18978816,20643856,20595328,82304,61440,46080,30720,0,736,0,0,0
.long 1839104,1840128,8335360,8445952,1051011932,20613512,20662408,18598144,67108864,5120,887758403,37,168960,2784256,2784256,2784256,5486080,5488640,5491200,16459776,16466432,8224768,8225024,8114176,8114432,18774016,20611632,20631432,20678144,20611072,0,5,15075328,15075584,15034368,15034624,19004416,20644368,20595392,102784,0,66560,51200,20480,736,0,0,0
.long 1579008,1580032,8552448,8663040,1051011932,20613520,20662416,19355904,67108864,15360,887758435,38,169984,2787328,2787328,2787328,5493760,5496320,5498880,16500736,16507392,8253696,8142848,8143104,8253440,18845696,20612144,20631440,20679680,20611072,0,6,15085824,15044608,15044864,15085568,19030016,20644880,20595584,123264,20480,5120,71680,40960,736,0,0,0
.long 1841152,1842176,8556544,8667136,1051011932,20613528,20662424,20113664,67108864,15360,887758435,39,171008,2790400,2790400,2790400,5501440,5504000,5506560,16541696,16548352,8169472,8169728,8280064,8280320,18912256,20612400,20631448,20681216,20611072,0,7,15054848,15055104,15095808,15096064,19055616,20645392,20595648,143744,40960,25600,10240,61440,736,0,0,0
.long 1609728,1610752,11870208,11980800,1051011932,20629888,20662656,17845504,20682888,56320,887758403,36,495616,3108864,3108864,3108864,5806080,5808640,5811200,16422912,16426496,8085760,8196096,8196352,8085504,20217856,20611120,20631424,20676608,20611072,128,36,15024384,15065088,15065344,15024128,20494336,20643856,20595328,82816,61440,46080,30720,0,352,0,0,0
.long 1871872,1872896,11874304,11984896,1051011932,20629896,20662664,18603264,67108864,56320,887758403,37,496640,3111936,3111936,3111936,5813760,5816320,5818880,16463872,16467456,8224768,8225024,8114176,8114432,20289536,20611632,20631432,20678144,20611072,128,37,15075328,15075584,15034368,15034624,20519936,20644368,20595392,103296,0,66560,51200,20480,352,0,0,0
.long 1611776,1612800,12091392,12201984,1051011932,20629904,20662672,19361024,67108864,66560,887758435,38,497664,3115008,3115008,3115008,5821440,5824000,5826560,16504832,16508416,8253696,8142848,8143104,8253440,20361216,20612144,20631440,20679680,20611072,128,38,15085824,15044608,15044864,15085568,20545536,20644880,20595584,123776,20480,5120,71680,40960,352,0,0,0
.long 1873920,1874944,12095488,12206080,1051011932,20629912,20662680,20118784,67108864,66560,887758435,39,498688,3118080,3118080,3118080,5829120,5831680,5834240,16545792,16549376,8169472,8169728,8280064,8280320,20427776,20612400,20631448,20681216,20611072,128,39,15054848,15055104,15095808,15096064,20571136,20645392,20595648,144256,40960,25600,10240,61440,352,0,0,0
.long 3174400,3175424,11010048,11120640,1065353216,20626176,20662912,17850624,20683016,107520,1693097539,36,823296,3436544,3436544,3436544,6133760,6136320,6138880,16429056,16435712,9855232,9965568,9965824,9854976,18702336,20619312,20631424,20676608,20611200,0,28,15679744,15720448,15720704,15679488,18978816,20652048,20599424,737664,61440,46080,30720,0,736,0,0,0
.long 3436544,3437568,11014144,11124736,1065353216,20626184,20662920,18608384,67108864,107520,1693097539,37,824320,3439616,3439616,3439616,6141440,6144000,6146560,16470016,16476672,9994240,9994496,9883648,9883904,18774016,20619824,20631432,20678144,20611200,0,29,15730688,15730944,15689728,15689984,19004416,20652560,20599488,758144,0,66560,51200,20480,736,0,0,0
.long 3176448,3177472,11231232,11341824,1065353216,20626192,20662928,19366144,67108864,117760,1693097571,38,825344,3442688,3442688,3442688,6149120,6151680,6154240,16510976,16517632,10023168,9912320,9912576,10022912,18845696,20620336,20631440,20679680,20611200,0,30,15741184,15699968,15700224,15740928,19030016,20653072,20599680,778624,20480,5120,71680,40960,736,0,0,0
.long 3438592,3439616,11235328,11345920,1065353216,20626200,20662936,20123904,67108864,117760,1693097571,39,826368,3445760,3445760,3445760,6156800,6159360,6161920,16551936,16558592,9938944,9939200,10049536,10049792,18912256,20620592,20631448,20681216,20611200,0,31,15710208,15710464,15751168,15751424,19055616,20653584,20599744,799104,40960,25600,10240,61440,736,0,0,0
.long 3207168,3208192,14548992,14659584,1065353216,20642560,20663168,17865984,20683144,209920,1693097539,36,1150976,3764224,3764224,3764224,6461440,6464000,6466560,16433152,16436736,9855232,9965568,9965824,9854976,20217856,20619312,20631424,20676608,20611328,0,60,15679744,15720448,15720704,15679488,20494336,20652048,20599424,738176,61440,46080,30720,0,352,0,0,0
.long 3469312,3470336,14553088,14663680,1065353216,20642568,20663176,18623744,67108864,209920,1693097539,37,1152000,3767296,3767296,3767296,6469120,6471680,6474240,16474112,16477696,9994240,9994496,9883648,9883904,20289536,20619824,20631432,20678144,20611328,0,61,15730688,15730944,15689728,15689984,20519936,20652560,20599488,758656,0,66560,51200,20480,352,0,0,0
.long 3209216,3210240,14770176,14880768,1065353216,20642576,20663184,19381504,67108864,220160,1693097571,38,1153024,3770368,3770368,3770368,6476800,6479360,6481920,16515072,16518656,10023168,9912320,9912576,10022912,20361216,20620336,20631440,20679680,20611328,0,62,15741184,15699968,15700224,15740928,20545536,20653072,20599680,779136,20480,5120,71680,40960,352,0,0,0
.long 3471360,3472384,14774272,14884864,1065353216,20642584,20663192,20139264,67108864,220160,1693097571,39,1154048,3773440,3773440,3773440,6484480,6487040,6489600,16556032,16559616,9938944,9939200,10049536,10049792,20427776,20620592,20631448,20681216,20611328,0,63,15710208,15710464,15751168,15751424,20571136,20653584,20599744,799616,40960,25600,10240,61440,352,0,0,0
.long 5294080,5296640,10149888,10260480,1065353216,20622592,20663424,17871104,20683272,261120,2498436675,36,1478656,4091904,4091904,4091904,6789120,6791680,6794240,16439296,16445952,11624704,11735040,11735296,11624448,18702336,20627504,20631424,20676608,20611328,128,20,16335104,16375808,16376064,16334848,18978816,20660240,20603520,1393024,61440,46080,30720,0,736,0,0,0
.long 5294080,5296640,10153984,10264576,1065353216,20622600,20663432,18628864,67108864,261120,2498436675,37,1479680,4094976,4094976,4094976,6796800,6799360,6801920,16480256,16486912,11763712,11763968,11653120,11653376,18774016,20628016,20631432,20678144,20611328,128,21,16386048,16386304,16345088,16345344,19004416,20660752,20603584,1413504,0,66560,51200,20480,736,0,0,0
.long 5299200,5301760,10371072,10481664,1065353216,20622608,20663440,19386624,67108864,271360,2498436707,38,1480704,4098048,4098048,4098048,6804480,6807040,6809600,16521216,16527872,11792640,11681792,11682048,11792384,18845696,20628528,20631440,20679680,20611328,128,22,16396544,16355328,16355584,16396288,19030016,20661264,20603776,1433984,20480,5120,71680,40960,736,0,0,0
.long 5299200,5301760,10375168,10485760,1065353216,20622616,20663448,20144384,67108864,271360,2498436707,39,1481728,4101120,4101120,4101120,6812160,6814720,6817280,16562176,16568832,11708416,11708672,11819008,11819264,18912256,20628784,20631448,20681216,20611328,128,23,16365568,16365824,16406528,16406784,19055616,20661776,20603840,1454464,40960,25600,10240,61440,736,0,0,0
.long 5376000,5378560,13688832,13799424,1065353216,20638976,20663680,17876224,20683400,312320,2498436675,36,1806336,4419584,4419584,4419584,7116800,7119360,7121920,16443392,16446976,11624704,11735040,11735296,11624448,20217856,20627504,20631424,20676608,20611456,0,52,16335104,16375808,16376064,16334848,20494336,20660240,20603520,1393536,61440,46080,30720,0,352,0,0,0
.long 5376000,5378560,13692928,13803520,1065353216,20638984,20663688,18633984,67108864,312320,2498436675,37,1807360,4422656,4422656,4422656,7124480,7127040,7129600,16484352,16487936,11763712,11763968,11653120,11653376,20289536,20628016,20631432,20678144,20611456,0,53,16386048,16386304,16345088,16345344,20519936,20660752,20603584,1414016,0,66560,51200,20480,352,0,0,0
.long 5381120,5383680,13910016,14020608,1065353216,20638992,20663696,19391744,67108864,322560,2498436707,38,1808384,4425728,4425728,4425728,7132160,7134720,7137280,16525312,16528896,11792640,11681792,11682048,11792384,20361216,20628528,20631440,20679680,20611456,0,54,16396544,16355328,16355584,16396288,20545536,20661264,20603776,1434496,20480,5120,71680,40960,352,0,0,0
.long 5381120,5383680,13914112,14024704,1065353216,20639000,20663704,20149504,67108864,322560,2498436707,39,1809408,4428800,4428800,4428800,7139840,7142400,7144960,16566272,16569856,11708416,11708672,11819008,11819264,20427776,20628784,20631448,20681216,20611456,0,55,16365568,16365824,16406528,16406784,20571136,20661776,20603840,1454976,40960,25600,10240,61440,352,0,0,0
.long 5273600,5276160,9297920,9408512,1065353216,20619008,20663936,17891584,20683528,414720,3572211267,36,2134016,4747264,4747264,4747264,7444480,7447040,7449600,16449536,16456192,13394176,13504512,13504768,13393920,18702336,20635696,20631424,20676608,20611584,0,12,16990464,17031168,17031424,16990208,18978816,20668432,20607616,2048384,61440,46080,30720,0,736,0,0,0
.long 5273600,5276160,67108864,67108864,1065353216,20619016,20663944,18649344,67108864,414720,3572211267,37,2135040,4750336,4750336,4750336,7452160,7454720,7457280,16490496,16497152,13533184,13533440,13422592,13422848,18774016,20636208,20631432,20678144,20611584,0,13,17041408,17041664,17000448,17000704,19004416,20668944,20607680,2068864,0,66560,51200,20480,736,0,0,0
.long 5278720,5281280,9519104,9629696,1065353216,20619024,20663952,19407104,67108864,424960,3572211299,38,2136064,4753408,4753408,4753408,7459840,7462400,7464960,16531456,16538112,13562112,13451264,13451520,13561856,18845696,20636720,20631440,20679680,20611584,0,14,17051904,17010688,17010944,17051648,19030016,20669456,20607872,2089344,20480,5120,71680,40960,736,0,0,0
.long 5278720,5281280,67108864,67108864,1065353216,20619032,20663960,20164864,67108864,424960,3572211299,39,2137088,4756480,4756480,4756480,7467520,7470080,7472640,16572416,16579072,13477888,13478144,13588480,13588736,18912256,20636976,20631448,20681216,20611584,0,15,17020928,17021184,17061888,17062144,19055616,20669968,20607936,2109824,40960,25600,10240,61440,736,0,0,0
.long 5355520,5358080,12836864,12947456,1065353216,20635392,20664192,17896704,20683656,465920,3572211267,36,2461696,5074944,5074944,5074944,7772160,7774720,7777280,16453632,16457216,13394176,13504512,13504768,13393920,20217856,20635696,20631424,20676608,20611584,0,44,16990464,17031168,17031424,16990208,20494336,20668432,20607616,2048896,61440,46080,30720,0,352,0,0,0
.long 5355520,5358080,67108864,67108864,1065353216,20635400,20664200,18654464,67108864,465920,3572211267,37,2462720,5078016,5078016,5078016,7779840,7782400,7784960,16494592,16498176,13533184,13533440,13422592,13422848,20289536,20636208,20631432,20678144,20611584,0,45,17041408,17041664,17000448,17000704,20519936,20668944,20607680,2069376,0,66560,51200,20480,352,0,0,0
.long 5360640,5363200,13058048,13168640,1065353216,20635408,20664208,19412224,67108864,476160,3572211299,38,2463744,5081088,5081088,5081088,7787520,7790080,7792640,16535552,16539136,13562112,13451264,13451520,13561856,20361216,20636720,20631440,20679680,20611584,0,46,17051904,17010688,17010944,17051648,20545536,20669456,20607872,2089856,20480,5120,71680,40960,352,0,0,0
.long 5360640,5363200,67108864,67108864,1065353216,20635416,20664216,20169984,67108864,476160,3572211299,39,2464768,5084160,5084160,5084160,7795200,7797760,7800320,16576512,16580096,13477888,13478144,13588480,13588736,20427776,20636976,20631448,20681216,20611584,0,47,17020928,17021184,17061888,17062144,20571136,20669968,20607936,2110336,40960,25600,10240,61440,352,0,0,0
.long 1581056,1582080,8773632,8884224,1051011932,20615552,20664448,17840640,20682768,25600,887766531,40,172032,2785280,2785280,2785280,5488640,5491200,5493760,16582656,16589312,8306944,8417280,8417536,8306688,18702336,20613152,20633472,20676608,20611072,0,8,15106304,15147008,15147264,15106048,18978816,20645888,20595840,164224,61440,46080,30720,0,736,0,0,0
.long 1843200,1844224,8777728,8888320,1051011932,20615560,20664456,18598400,67108864,25600,887766531,41,173056,2788352,2788352,2788352,5496320,5498880,5501440,16623616,16630272,8445952,8446208,8335360,8335616,18774016,20613536,20633480,20678144,20611072,0,9,15157248,15157504,15116288,15116544,19004416,20646400,20595904,184704,0,66560,51200,20480,736,0,0,0
.long 1583104,1584128,8994816,9105408,1051011932,20615568,20664464,19356160,67108864,35840,887766563,42,174080,2791424,2791424,2791424,5504000,5506560,5509120,16664576,16671232,8474880,8364032,8364288,8474624,18845696,20614176,20633488,20679680,20611072,0,10,15167744,15126528,15126784,15167488,19030016,20646912,20596096,205184,20480,5120,71680,40960,736,0,0,0
.long 1845248,1846272,8998912,9109504,1051011932,20615576,20664472,20113920,67108864,35840,887766563,43,175104,2794496,2794496,2794496,5511680,5514240,5516800,16705536,16712192,8390656,8390912,8501248,8501504,18912256,20614432,20633496,20681216,20611072,0,11,15136768,15137024,15177728,15177984,19055616,20647424,20596160,225664,40960,25600,10240,61440,736,0,0,0
.long 1613824,1614848,12312576,12423168,1051011932,20631936,20664704,17845760,20682896,76800,887766531,40,499712,3112960,3112960,3112960,5816320,5818880,5821440,16586752,16590336,8306944,8417280,8417536,8306688,20217856,20613152,20633472,20676608,20611072,128,40,15106304,15147008,15147264,15106048,20494336,20645888,20595840,164736,61440,46080,30720,0,352,0,0,0
.long 1875968,1876992,12316672,12427264,1051011932,20631944,20664712,18603520,67108864,76800,887766531,41,500736,3116032,3116032,3116032,5824000,5826560,5829120,16627712,16631296,8445952,8446208,8335360,8335616,20289536,20613536,20633480,20678144,20611072,128,41,15157248,15157504,15116288,15116544,20519936,20646400,20595904,185216,0,66560,51200,20480,352,0,0,0
.long 1615872,1616896,12533760,12644352,1051011932,20631952,20664720,19361280,67108864,87040,887766563,42,501760,3119104,3119104,3119104,5831680,5834240,5836800,16668672,16672256,8474880,8364032,8364288,8474624,20361216,20614176,20633488,20679680,20611072,128,42,15167744,15126528,15126784,15167488,20545536,20646912,20596096,205696,20480,5120,71680,40960,352,0,0,0
.long 1878016,1879040,12537856,12648448,1051011932,20631960,20664728,20119040,67108864,87040,887766563,43,502784,3122176,3122176,3122176,5839360,5841920,5844480,16709632,16713216,8390656,8390912,8501248,8501504,20427776,20614432,20633496,20681216,20611072,128,43,15136768,15137024,15177728,15177984,20571136,20647424,20596160,226176,40960,25600,10240,61440,352,0,0,0
.long 3670016,3671040,7913472,8024064,1065353216,20611968,20664960,17850880,20683024,128000,1693105667,40,827392,3440640,3440640,3440640,6144000,6146560,6149120,16592896,16599552,10076416,10186752,10187008,10076160,18702336,20621344,20633472,20676608,20611200,0,0,15761664,15802368,15802624,15761408,18978816,20654080,20599936,819584,61440,46080,30720,0,736,0,0,0
.long 3932160,3933184,7917568,8028160,1065353216,20611976,20664968,18608640,67108864,128000,1693105667,41,828416,3443712,3443712,3443712,6151680,6154240,6156800,16633856,16640512,10215424,10215680,10104832,10105088,18774016,20621728,20633480,20678144,20611200,0,1,15812608,15812864,15771648,15771904,19004416,20654592,20600000,840064,0,66560,51200,20480,736,0,0,0
.long 3672064,3673088,8134656,8245248,1065353216,20611984,20664976,19366400,67108864,138240,1693105699,42,829440,3446784,3446784,3446784,6159360,6161920,6164480,16674816,16681472,10244352,10133504,10133760,10244096,18845696,20622368,20633488,20679680,20611200,0,2,15823104,15781888,15782144,15822848,19030016,20655104,20600192,860544,20480,5120,71680,40960,736,0,0,0
.long 3934208,3935232,8138752,8249344,1065353216,20611992,20664984,20124160,67108864,138240,1693105699,43,830464,3449856,3449856,3449856,6167040,6169600,6172160,16715776,16722432,10160128,10160384,10270720,10270976,18912256,20622624,20633496,20681216,20611200,0,3,15792128,15792384,15833088,15833344,19055616,20655616,20600256,881024,40960,25600,10240,61440,736,0,0,0
.long 3702784,3703808,11452416,11563008,1065353216,20628352,20665216,17866240,20683152,230400,1693105667,40,1155072,3768320,3768320,3768320,6471680,6474240,6476800,16596992,16600576,10076416,10186752,10187008,10076160,20217856,20621344,20633472,20676608,20611328,0,32,15761664,15802368,15802624,15761408,20494336,20654080,20599936,820096,61440,46080,30720,0,352,0,0,0
.long 3964928,3965952,11456512,11567104,1065353216,20628360,20665224,18624000,67108864,230400,1693105667,41,1156096,3771392,3771392,3771392,6479360,6481920,6484480,16637952,16641536,10215424,10215680,10104832,10105088,20289536,20621728,20633480,20678144,20611328,0,33,15812608,15812864,15771648,15771904,20519936,20654592,20600000,840576,0,66560,51200,20480,352,0,0,0
.long 3704832,3705856,11673600,11784192,1065353216,20628368,20665232,19381760,67108864,240640,1693105699,42,1157120,3774464,3774464,3774464,6487040,6489600,6492160,16678912,16682496,10244352,10133504,10133760,10244096,20361216,20622368,20633488,20679680,20611328,0,34,15823104,15781888,15782144,15822848,20545536,20655104,20600192,861056,20480,5120,71680,40960,352,0,0,0
.long 3966976,3968000,11677696,11788288,1065353216,20628376,20665240,20139520,67108864,240640,1693105699,43,1158144,3777536,3777536,3777536,6494720,6497280,6499840,16719872,16723456,10160128,10160384,10270720,10270976,20427776,20622624,20633496,20681216,20611328,0,35,15792128,15792384,15833088,15833344,20571136,20655616,20600256,881536,40960,25600,10240,61440,352,0,0,0
.long 5304320,5306880,10592256,10702848,1065353216,20624640,20665472,17871360,20683280,281600,2498444803,40,1482752,4096000,4096000,4096000,6799360,6801920,6804480,16603136,16609792,11845888,11956224,11956480,11845632,18702336,20629536,20633472,20676608,20611328,128,24,16417024,16457728,16457984,16416768,18978816,20662272,20604032,1474944,61440,46080,30720,0,736,0,0,0
.long 5304320,5306880,10596352,10706944,1065353216,20624648,20665480,18629120,67108864,281600,2498444803,41,1483776,4099072,4099072,4099072,6807040,6809600,6812160,16644096,16650752,11984896,11985152,11874304,11874560,18774016,20629920,20633480,20678144,20611328,128,25,16467968,16468224,16427008,16427264,19004416,20662784,20604096,1495424,0,66560,51200,20480,736,0,0,0
.long 5309440,5312000,10813440,10924032,1065353216,20624656,20665488,19386880,67108864,291840,2498444835,42,1484800,4102144,4102144,4102144,6814720,6817280,6819840,16685056,16691712,12013824,11902976,11903232,12013568,18845696,20630560,20633488,20679680,20611328,128,26,16478464,16437248,16437504,16478208,19030016,20663296,20604288,1515904,20480,5120,71680,40960,736,0,0,0
.long 5309440,5312000,10817536,10928128,1065353216,20624664,20665496,20144640,67108864,291840,2498444835,43,1485824,4105216,4105216,4105216,6822400,6824960,6827520,16726016,16732672,11929600,11929856,12040192,12040448,18912256,20630816,20633496,20681216,20611328,128,27,16447488,16447744,16488448,16488704,19055616,20663808,20604352,1536384,40960,25600,10240,61440,736,0,0,0
.long 5386240,5388800,14131200,14241792,1065353216,20641024,20665728,17876480,20683408,332800,2498444803,40,1810432,4423680,4423680,4423680,7127040,7129600,7132160,16607232,16610816,11845888,11956224,11956480,11845632,20217856,20629536,20633472,20676608,20611456,0,56,16417024,16457728,16457984,16416768,20494336,20662272,20604032,1475456,61440,46080,30720,0,352,0,0,0
.long 5386240,5388800,14135296,14245888,1065353216,20641032,20665736,18634240,67108864,332800,2498444803,41,1811456,4426752,4426752,4426752,7134720,7137280,7139840,16648192,16651776,11984896,11985152,11874304,11874560,20289536,20629920,20633480,20678144,20611456,0,57,16467968,16468224,16427008,16427264,20519936,20662784,20604096,1495936,0,66560,51200,20480,352,0,0,0
.long 5391360,5393920,14352384,14462976,1065353216,20641040,20665744,19392000,67108864,343040,2498444835,42,1812480,4429824,4429824,4429824,7142400,7144960,7147520,16689152,16692736,12013824,11902976,11903232,12013568,20361216,20630560,20633488,20679680,20611456,0,58,16478464,16437248,16437504,16478208,20545536,20663296,20604288,1516416,20480,5120,71680,40960,352,0,0,0
.long 5391360,5393920,14356480,14467072,1065353216,20641048,20665752,20149760,67108864,343040,2498444835,43,1813504,4432896,4432896,4432896,7150080,7152640,7155200,16730112,16733696,11929600,11929856,12040192,12040448,20427776,20630816,20633496,20681216,20611456,0,59,16447488,16447744,16488448,16488704,20571136,20663808,20604352,1536896,40960,25600,10240,61440,352,0,0,0
.long 5283840,5286400,9740288,9850880,1065353216,20621056,20665984,17891840,20683536,435200,3572219395,40,2138112,4751360,4751360,4751360,7454720,7457280,7459840,16613376,16620032,13615360,13725696,13725952,13615104,18702336,20637728,20633472,20676608,20611584,0,16,17072384,17113088,17113344,17072128,18978816,20670464,20608128,2130304,61440,46080,30720,0,736,0,0,0
.long 5283840,5286400,67108864,67108864,1065353216,20621064,20665992,18649600,67108864,435200,3572219395,41,2139136,4754432,4754432,4754432,7462400,7464960,7467520,16654336,16660992,13754368,13754624,13643776,13644032,18774016,20638112,20633480,20678144,20611584,0,17,17123328,17123584,17082368,17082624,19004416,20670976,20608192,2150784,0,66560,51200,20480,736,0,0,0
.long 5288960,5291520,9961472,10072064,1065353216,20621072,20666000,19407360,67108864,445440,3572219427,42,2140160,4757504,4757504,4757504,7470080,7472640,7475200,16695296,16701952,13783296,13672448,13672704,13783040,18845696,20638752,20633488,20679680,20611584,0,18,17133824,17092608,17092864,17133568,19030016,20671488,20608384,2171264,20480,5120,71680,40960,736,0,0,0
.long 5288960,5291520,67108864,67108864,1065353216,20621080,20666008,20165120,67108864,445440,3572219427,43,2141184,4760576,4760576,4760576,7477760,7480320,7482880,16736256,16742912,13699072,13699328,13809664,13809920,18912256,20639008,20633496,20681216,20611584,0,19,17102848,17103104,17143808,17144064,19055616,20672000,20608448,2191744,40960,25600,10240,61440,736,0,0,0
.long 5365760,5368320,13279232,13389824,1065353216,20637440,20666240,17896960,20683664,486400,3572219395,40,2465792,5079040,5079040,5079040,7782400,7784960,7787520,16617472,16621056,13615360,13725696,13725952,13615104,20217856,20637728,20633472,20676608,20611584,0,48,17072384,17113088,17113344,17072128,20494336,20670464,20608128,2130816,61440,46080,30720,0,352,0,0,0
.long 5365760,5368320,67108864,67108864,1065353216,20637448,20666248,18654720,67108864,486400,3572219395,41,2466816,5082112,5082112,5082112,7790080,7792640,7795200,16658432,16662016,13754368,13754624,13643776,13644032,20289536,20638112,20633480,20678144,20611584,0,49,17123328,17123584,17082368,17082624,20519936,20670976,20608192,2151296,0,66560,51200,20480,352,0,0,0
.long 5370880,5373440,13500416,13611008,1065353216,20637456,20666256,19412480,67108864,496640,3572219427,42,2467840,5085184,5085184,5085184,7797760,7800320,7802880,16699392,16702976,13783296,13672448,13672704,13783040,20361216,20638752,20633488,20679680,20611584,0,50,17133824,17092608,17092864,17133568,20545536,20671488,20608384,2171776,20480,5120,71680,40960,352,0,0,0
.long 5370880,5373440,67108864,67108864,1065353216,20637464,20666264,20170240,67108864,496640,3572219427,43,2468864,5088256,5088256,5088256,7805440,7808000,7810560,16740352,16743936,13699072,13699328,13809664,13809920,20427776,20639008,20633496,20681216,20611584,0,51,17102848,17103104,17143808,17144064,20571136,20672000,20608448,2192256,40960,25600,10240,61440,352,0,0,0
.long 1585152,1586176,9216000,9326592,1051011932,20617600,20666496,17840896,20682776,30720,887766595,44,176128,2789376,2789376,2789376,5498880,5501440,5504000,16746496,16753152,8528128,8638464,8638720,8527872,18702336,20613168,20635520,20676608,20611072,0,12,15188224,15228928,15229184,15187968,18978816,20645904,20596352,246144,61440,46080,30720,0,736,0,0,0
.long 1847296,1848320,9220096,9330688,1051011932,20617608,20666504,18598656,67108864,30720,887766595,45,177152,2792448,2792448,2792448,5506560,5509120,5511680,16787456,16794112,8667136,8667392,8556544,8556800,18774016,20613552,20635528,20678144,20611072,0,13,15239168,15239424,15198208,15198464,19004416,20646416,20596416,266624,0,66560,51200,20480,736,0,0,0
.long 1587200,1588224,9437184,9547776,1051011932,20617616,20666512,19356416,67108864,40960,887766627,46,178176,2795520,2795520,2795520,5514240,5516800,5519360,16828416,16835072,8696064,8585216,8585472,8695808,18845696,20614192,20635536,20679680,20611072,0,14,15249664,15208448,15208704,15249408,19030016,20646928,20596608,287104,20480,5120,71680,40960,736,0,0,0
.long 1849344,1850368,9441280,9551872,1051011932,20617624,20666520,20114176,67108864,40960,887766627,47,179200,2798592,2798592,2798592,5521920,5524480,5527040,16869376,16876032,8611840,8612096,8722432,8722688,18912256,20614448,20635544,20681216,20611072,0,15,15218688,15218944,15259648,15259904,19055616,20647440,20596672,307584,40960,25600,10240,61440,736,0,0,0
.long 1617920,1618944,12754944,12865536,1051011932,20633984,20666752,17846016,20682904,81920,887766595,44,503808,3117056,3117056,3117056,5826560,5829120,5831680,16750592,16754176,8528128,8638464,8638720,8527872,20217856,20613168,20635520,20676608,20611072,128,44,15188224,15228928,15229184,15187968,20494336,20645904,20596352,246656,61440,46080,30720,0,352,0,0,0
.long 1880064,1881088,12759040,12869632,1051011932,20633992,20666760,18603776,67108864,81920,887766595,45,504832,3120128,3120128,3120128,5834240,5836800,5839360,16791552,16795136,8667136,8667392,8556544,8556800,20289536,20613552,20635528,20678144,20611072,128,45,15239168,15239424,15198208,15198464,20519936,20646416,20596416,267136,0,66560,51200,20480,352,0,0,0
.long 1619968,1620992,12976128,13086720,1051011932,20634000,20666768,19361536,67108864,92160,887766627,46,505856,3123200,3123200,3123200,5841920,5844480,5847040,16832512,16836096,8696064,8585216,8585472,8695808,20361216,20614192,20635536,20679680,20611072,128,46,15249664,15208448,15208704,15249408,20545536,20646928,20596608,287616,20480,5120,71680,40960,352,0,0,0
.long 1882112,1883136,12980224,13090816,1051011932,20634008,20666776,20119296,67108864,92160,887766627,47,506880,3126272,3126272,3126272,5849600,5852160,5854720,16873472,16877056,8611840,8612096,8722432,8722688,20427776,20614448,20635544,20681216,20611072,128,47,15218688,15218944,15259648,15259904,20571136,20647440,20596672,308096,40960,25600,10240,61440,352,0,0,0
.long 3674112,3675136,8355840,8466432,1065353216,20614016,20667008,17851136,20683032,133120,1693105731,44,831488,3444736,3444736,3444736,6154240,6156800,6159360,16756736,16763392,10297600,10407936,10408192,10297344,18702336,20621360,20635520,20676608,20611200,0,4,15843584,15884288,15884544,15843328,18978816,20654096,20600448,901504,61440,46080,30720,0,736,0,0,0
.long 3936256,3937280,8359936,8470528,1065353216,20614024,20667016,18608896,67108864,133120,1693105731,45,832512,3447808,3447808,3447808,6161920,6164480,6167040,16797696,16804352,10436608,10436864,10326016,10326272,18774016,20621744,20635528,20678144,20611200,0,5,15894528,15894784,15853568,15853824,19004416,20654608,20600512,921984,0,66560,51200,20480,736,0,0,0
.long 3676160,3677184,8577024,8687616,1065353216,20614032,20667024,19366656,67108864,143360,1693105763,46,833536,3450880,3450880,3450880,6169600,6172160,6174720,16838656,16845312,10465536,10354688,10354944,10465280,18845696,20622384,20635536,20679680,20611200,0,6,15905024,15863808,15864064,15904768,19030016,20655120,20600704,942464,20480,5120,71680,40960,736,0,0,0
.long 3938304,3939328,8581120,8691712,1065353216,20614040,20667032,20124416,67108864,143360,1693105763,47,834560,3453952,3453952,3453952,6177280,6179840,6182400,16879616,16886272,10381312,10381568,10491904,10492160,18912256,20622640,20635544,20681216,20611200,0,7,15874048,15874304,15915008,15915264,19055616,20655632,20600768,962944,40960,25600,10240,61440,736,0,0,0
.long 3706880,3707904,11894784,12005376,1065353216,20630400,20667264,17866496,20683160,235520,1693105731,44,1159168,3772416,3772416,3772416,6481920,6484480,6487040,16760832,16764416,10297600,10407936,10408192,10297344,20217856,20621360,20635520,20676608,20611328,0,36,15843584,15884288,15884544,15843328,20494336,20654096,20600448,902016,61440,46080,30720,0,352,0,0,0
.long 3969024,3970048,11898880,12009472,1065353216,20630408,20667272,18624256,67108864,235520,1693105731,45,1160192,3775488,3775488,3775488,6489600,6492160,6494720,16801792,16805376,10436608,10436864,10326016,10326272,20289536,20621744,20635528,20678144,20611328,0,37,15894528,15894784,15853568,15853824,20519936,20654608,20600512,922496,0,66560,51200,20480,352,0,0,0
.long 3708928,3709952,12115968,12226560,1065353216,20630416,20667280,19382016,67108864,245760,1693105763,46,1161216,3778560,3778560,3778560,6497280,6499840,6502400,16842752,16846336,10465536,10354688,10354944,10465280,20361216,20622384,20635536,20679680,20611328,0,38,15905024,15863808,15864064,15904768,20545536,20655120,20600704,942976,20480,5120,71680,40960,352,0,0,0
.long 3971072,3972096,12120064,12230656,1065353216,20630424,20667288,20139776,67108864,245760,1693105763,47,1162240,3781632,3781632,3781632,6504960,6507520,6510080,16883712,16887296,10381312,10381568,10491904,10492160,20427776,20622640,20635544,20681216,20611328,0,39,15874048,15874304,15915008,15915264,20571136,20655632,20600768,963456,40960,25600,10240,61440,352,0,0,0
.long 5314560,5317120,11042816,11153408,1065353216,20626688,20667520,17871616,20683288,286720,2766880323,44,1486848,4100096,4100096,4100096,6809600,6812160,6814720,16766976,16773632,12067072,12177408,12177664,12066816,18702336,20629552,20635520,20676608,20611328,128,28,16498944,16539648,16539904,16498688,18978816,20662288,20604544,1556864,61440,46080,30720,0,736,0,0,0
.long 5314560,5317120,11046912,11157504,1065353216,20626696,20667528,18629376,67108864,286720,2766880323,45,1487872,4103168,4103168,4103168,6817280,6819840,6822400,16807936,16814592,12206080,12206336,12095488,12095744,18774016,20629936,20635528,20678144,20611328,128,29,16549888,16550144,16508928,16509184,19004416,20662800,20604608,1577344,0,66560,51200,20480,736,0,0,0
.long 5319680,5322240,11264000,11374592,1065353216,20626704,20667536,19387136,67108864,296960,2766880355,46,1488896,4106240,4106240,4106240,6824960,6827520,6830080,16848896,16855552,12235008,12124160,12124416,12234752,18845696,20630576,20635536,20679680,20611328,128,30,16560384,16519168,16519424,16560128,19030016,20663312,20604800,1597824,20480,5120,71680,40960,736,0,0,0
.long 5319680,5322240,11268096,11378688,1065353216,20626712,20667544,20144896,67108864,296960,2766880355,47,1489920,4109312,4109312,4109312,6832640,6835200,6837760,16889856,16896512,12150784,12151040,12261376,12261632,18912256,20630832,20635544,20681216,20611328,128,31,16529408,16529664,16570368,16570624,19055616,20663824,20604864,1618304,40960,25600,10240,61440,736,0,0,0
.long 5396480,5399040,14581760,14692352,1065353216,20643072,20667776,17876736,20683416,337920,2766880323,44,1814528,4427776,4427776,4427776,7137280,7139840,7142400,16771072,16774656,12067072,12177408,12177664,12066816,20217856,20629552,20635520,20676608,20611456,0,60,16498944,16539648,16539904,16498688,20494336,20662288,20604544,1557376,61440,46080,30720,0,352,0,0,0
.long 5396480,5399040,14585856,14696448,1065353216,20643080,20667784,18634496,67108864,337920,2766880323,45,1815552,4430848,4430848,4430848,7144960,7147520,7150080,16812032,16815616,12206080,12206336,12095488,12095744,20289536,20629936,20635528,20678144,20611456,0,61,16549888,16550144,16508928,16509184,20519936,20662800,20604608,1577856,0,66560,51200,20480,352,0,0,0
.long 5401600,5404160,14802944,14913536,1065353216,20643088,20667792,19392256,67108864,348160,2766880355,46,1816576,4433920,4433920,4433920,7152640,7155200,7157760,16852992,16856576,12235008,12124160,12124416,12234752,20361216,20630576,20635536,20679680,20611456,0,62,16560384,16519168,16519424,16560128,20545536,20663312,20604800,1598336,20480,5120,71680,40960,352,0,0,0
.long 5401600,5404160,14807040,14917632,1065353216,20643096,20667800,20150016,67108864,348160,2766880355,47,1817600,4436992,4436992,4436992,7160320,7162880,7165440,16893952,16897536,12150784,12151040,12261376,12261632,20427776,20630832,20635544,20681216,20611456,0,63,16529408,16529664,16570368,16570624,20571136,20663824,20604864,1618816,40960,25600,10240,61440,352,0,0,0
.long 5294080,5296640,10182656,10293248,1065353216,20623104,20668032,17892096,20683544,440320,3572219459,44,2142208,4755456,4755456,4755456,7464960,7467520,7470080,16777216,16783872,13836544,13946880,13947136,13836288,18702336,20637744,20635520,20676608,20611584,0,20,17154304,17195008,17195264,17154048,18978816,20670480,20608640,2212224,61440,46080,30720,0,736,0,0,0
.long 5294080,5296640,67108864,67108864,1065353216,20623112,20668040,18649856,67108864,440320,3572219459,45,2143232,4758528,4758528,4758528,7472640,7475200,7477760,16818176,16824832,13975552,13975808,13864960,13865216,18774016,20638128,20635528,20678144,20611584,0,21,17205248,17205504,17164288,17164544,19004416,20670992,20608704,2232704,0,66560,51200,20480,736,0,0,0
.long 5299200,5301760,10403840,10514432,1065353216,20623120,20668048,19407616,67108864,450560,3572219491,46,2144256,4761600,4761600,4761600,7480320,7482880,7485440,16859136,16865792,14004480,13893632,13893888,14004224,18845696,20638768,20635536,20679680,20611584,0,22,17215744,17174528,17174784,17215488,19030016,20671504,20608896,2253184,20480,5120,71680,40960,736,0,0,0
.long 5299200,5301760,67108864,67108864,1065353216,20623128,20668056,20165376,67108864,450560,3572219491,47,2145280,4764672,4764672,4764672,7488000,7490560,7493120,16900096,16906752,13920256,13920512,14030848,14031104,18912256,20639024,20635544,20681216,20611584,0,23,17184768,17185024,17225728,17225984,19055616,20672016,20608960,2273664,40960,25600,10240,61440,736,0,0,0
.long 5376000,5378560,13721600,13832192,1065353216,20639488,20668288,17897216,20683672,491520,3572219459,44,2469888,5083136,5083136,5083136,7792640,7795200,7797760,16781312,16784896,13836544,13946880,13947136,13836288,20217856,20637744,20635520,20676608,20611584,0,52,17154304,17195008,17195264,17154048,20494336,20670480,20608640,2212736,61440,46080,30720,0,352,0,0,0
.long 5376000,5378560,67108864,67108864,1065353216,20639496,20668296,18654976,67108864,491520,3572219459,45,2470912,5086208,5086208,5086208,7800320,7802880,7805440,16822272,16825856,13975552,13975808,13864960,13865216,20289536,20638128,20635528,20678144,20611584,0,53,17205248,17205504,17164288,17164544,20519936,20670992,20608704,2233216,0,66560,51200,20480,352,0,0,0
.long 5381120,5383680,13942784,14053376,1065353216,20639504,20668304,19412736,67108864,501760,3572219491,46,2471936,5089280,5089280,5089280,7808000,7810560,7813120,16863232,16866816,14004480,13893632,13893888,14004224,20361216,20638768,20635536,20679680,20611584,0,54,17215744,17174528,17174784,17215488,20545536,20671504,20608896,2253696,20480,5120,71680,40960,352,0,0,0
.long 5381120,5383680,67108864,67108864,1065353216,20639512,20668312,20170496,67108864,501760,3572219491,47,2472960,5092352,5092352,5092352,7815680,7818240,7820800,16904192,16907776,13920256,13920512,14030848,14031104,20427776,20639024,20635544,20681216,20611584,0,55,17184768,17185024,17225728,17225984,20571136,20672016,20608960,2274176,40960,25600,10240,61440,352,0,0,0
.long 1589248,1590272,9650176,9760768,1051011932,20619648,20668544,17901568,20683776,512000,619339267,48,180224,2793472,2793472,2793472,5509120,5511680,5514240,16910336,16916992,8749312,8859648,8859904,8749056,18702336,20615200,20637568,20676608,20611072,0,16,15270144,15310848,15311104,15269888,18978816,20647936,20596864,328064,61440,46080,30720,0,736,0,0,0
.long 1851392,1852416,9654272,9764864,1051011932,20619656,20668552,18659328,67108864,512000,619339267,49,181248,2796544,2796544,2796544,5516800,5519360,5521920,16951296,16957952,8888320,8888576,8777728,8777984,18774016,20615584,20637576,20678144,20611072,0,17,15321088,15321344,15280128,15280384,19004416,20648448,20596928,348544,0,66560,51200,20480,736,0,0,0
.long 1591296,1592320,9871360,9981952,1051011932,20619664,20668560,19417088,67108864,522240,619339299,50,182272,2799616,2799616,2799616,5524480,5527040,5529600,16992256,16998912,8917248,8806400,8806656,8916992,18845696,20616096,20637584,20679680,20611072,0,18,15331584,15290368,15290624,15331328,19030016,20648960,20597120,369024,20480,5120,71680,40960,736,0,0,0
.long 1853440,1854464,9875456,9986048,1051011932,20619672,20668568,20174848,67108864,522240,619339299,51,183296,2802688,2802688,2802688,5532160,5534720,5537280,17033216,17039872,8833024,8833280,8943616,8943872,18912256,20616480,20637592,20681216,20611072,0,19,15300608,15300864,15341568,15341824,19055616,20649472,20597184,389504,40960,25600,10240,61440,736,0,0,0
.long 1622016,1623040,13189120,13299712,1051011932,20636032,20668800,17902080,20683792,537600,619339267,48,507904,3121152,3121152,3121152,5836800,5839360,5841920,16914432,16918016,8749312,8859648,8859904,8749056,20217856,20615200,20637568,20676608,20611072,128,48,15270144,15310848,15311104,15269888,20494336,20647936,20596864,328576,61440,46080,30720,0,352,0,0,0
.long 1884160,1885184,13193216,13303808,1051011932,20636040,20668808,18659840,67108864,537600,619339267,49,508928,3124224,3124224,3124224,5844480,5847040,5849600,16955392,16958976,8888320,8888576,8777728,8777984,20289536,20615584,20637576,20678144,20611072,128,49,15321088,15321344,15280128,15280384,20519936,20648448,20596928,349056,0,66560,51200,20480,352,0,0,0
.long 1624064,1625088,13410304,13520896,1051011932,20636048,20668816,19417600,67108864,547840,619339299,50,509952,3127296,3127296,3127296,5852160,5854720,5857280,16996352,16999936,8917248,8806400,8806656,8916992,20361216,20616096,20637584,20679680,20611072,128,50,15331584,15290368,15290624,15331328,20545536,20648960,20597120,369536,20480,5120,71680,40960,352,0,0,0
.long 1886208,1887232,13414400,13524992,1051011932,20636056,20668824,20175360,67108864,547840,619339299,51,510976,3130368,3130368,3130368,5859840,5862400,5864960,17037312,17040896,8833024,8833280,8943616,8943872,20427776,20616480,20637592,20681216,20611072,128,51,15300608,15300864,15341568,15341824,20571136,20649472,20597184,390016,40960,25600,10240,61440,352,0,0,0
.long 3678208,3679232,8806400,8916992,1065353216,20616064,20669056,17916928,20683904,614400,1961549315,48,835584,3448832,3448832,3448832,6164480,6167040,6169600,16920576,16927232,10518784,10629120,10629376,10518528,18702336,20623392,20637568,20676608,20611200,0,8,15925504,15966208,15966464,15925248,18978816,20656128,20600960,983424,61440,46080,30720,0,736,0,0,0
.long 3940352,3941376,8810496,8921088,1065353216,20616072,20669064,18674688,67108864,614400,1961549315,49,836608,3451904,3451904,3451904,6172160,6174720,6177280,16961536,16968192,10657792,10658048,10547200,10547456,18774016,20623776,20637576,20678144,20611200,0,9,15976448,15976704,15935488,15935744,19004416,20656640,20601024,1003904,0,66560,51200,20480,736,0,0,0
.long 3680256,3681280,9027584,9138176,1065353216,20616080,20669072,19432448,67108864,624640,1961549347,50,837632,3454976,3454976,3454976,6179840,6182400,6184960,17002496,17009152,10686720,10575872,10576128,10686464,18845696,20624288,20637584,20679680,20611200,0,10,15986944,15945728,15945984,15986688,19030016,20657152,20601216,1024384,20480,5120,71680,40960,736,0,0,0
.long 3942400,3943424,9031680,9142272,1065353216,20616088,20669080,20190208,67108864,624640,1961549347,51,838656,3458048,3458048,3458048,6187520,6190080,6192640,17043456,17050112,10602496,10602752,10713088,10713344,18912256,20624672,20637592,20681216,20611200,0,11,15955968,15956224,15996928,15997184,19055616,20657664,20601280,1044864,40960,25600,10240,61440,736,0,0,0
.long 3710976,3712000,12345344,12455936,1065353216,20632448,20669312,17917440,20683920,640000,1961549315,48,1163264,3776512,3776512,3776512,6492160,6494720,6497280,16924672,16928256,10518784,10629120,10629376,10518528,20217856,20623392,20637568,20676608,20611328,0,40,15925504,15966208,15966464,15925248,20494336,20656128,20600960,983936,61440,46080,30720,0,352,0,0,0
.long 3973120,3974144,12349440,12460032,1065353216,20632456,20669320,18675200,67108864,640000,1961549315,49,1164288,3779584,3779584,3779584,6499840,6502400,6504960,16965632,16969216,10657792,10658048,10547200,10547456,20289536,20623776,20637576,20678144,20611328,0,41,15976448,15976704,15935488,15935744,20519936,20656640,20601024,1004416,0,66560,51200,20480,352,0,0,0
.long 3713024,3714048,12566528,12677120,1065353216,20632464,20669328,19432960,67108864,650240,1961549347,50,1165312,3782656,3782656,3782656,6507520,6510080,6512640,17006592,17010176,10686720,10575872,10576128,10686464,20361216,20624288,20637584,20679680,20611328,0,42,15986944,15945728,15945984,15986688,20545536,20657152,20601216,1024896,20480,5120,71680,40960,352,0,0,0
.long 3975168,3976192,12570624,12681216,1065353216,20632472,20669336,20190720,67108864,650240,1961549347,51,1166336,3785728,3785728,3785728,6515200,6517760,6520320,17047552,17051136,10602496,10602752,10713088,10713344,20427776,20624672,20637592,20681216,20611328,0,43,15955968,15956224,15996928,15997184,20571136,20657664,20601280,1045376,40960,25600,10240,61440,352,0,0,0
.long 5242880,5245440,7946240,8056832,1065353216,20612480,20669568,17922048,20684032,665600,2766888451,48,1490944,4104192,4104192,4104192,6819840,6822400,6824960,16930816,16937472,12288256,12398592,12398848,12288000,18702336,20631584,20637568,20676608,20611328,128,0,16580864,16621568,16621824,16580608,18978816,20664320,20605056,1638784,61440,46080,30720,0,736,0,0,0
.long 5242880,5245440,7950336,8060928,1065353216,20612488,20669576,18679808,67108864,665600,2766888451,49,1491968,4107264,4107264,4107264,6827520,6830080,6832640,16971776,16978432,12427264,12427520,12316672,12316928,18774016,20631968,20637576,20678144,20611328,128,1,16631808,16632064,16590848,16591104,19004416,20664832,20605120,1659264,0,66560,51200,20480,736,0,0,0
.long 5248000,5250560,8167424,8278016,1065353216,20612496,20669584,19437568,67108864,675840,2766888483,50,1492992,4110336,4110336,4110336,6835200,6837760,6840320,17012736,17019392,12456192,12345344,12345600,12455936,18845696,20632480,20637584,20679680,20611328,128,2,16642304,16601088,16601344,16642048,19030016,20665344,20605312,1679744,20480,5120,71680,40960,736,0,0,0
.long 5248000,5250560,8171520,8282112,1065353216,20612504,20669592,20195328,67108864,675840,2766888483,51,1494016,4113408,4113408,4113408,6842880,6845440,6848000,17053696,17060352,12371968,12372224,12482560,12482816,18912256,20632864,20637592,20681216,20611328,128,3,16611328,16611584,16652288,16652544,19055616,20665856,20605376,1700224,40960,25600,10240,61440,736,0,0,0
.long 5324800,5327360,11485184,11595776,1065353216,20628864,20669824,17922560,20684048,691200,2766888451,48,1818624,4431872,4431872,4431872,7147520,7150080,7152640,16934912,16938496,12288256,12398592,12398848,12288000,20217856,20631584,20637568,20676608,20611456,0,32,16580864,16621568,16621824,16580608,20494336,20664320,20605056,1639296,61440,46080,30720,0,352,0,0,0
.long 5324800,5327360,11489280,11599872,1065353216,20628872,20669832,18680320,67108864,691200,2766888451,49,1819648,4434944,4434944,4434944,7155200,7157760,7160320,16975872,16979456,12427264,12427520,12316672,12316928,20289536,20631968,20637576,20678144,20611456,0,33,16631808,16632064,16590848,16591104,20519936,20664832,20605120,1659776,0,66560,51200,20480,352,0,0,0
.long 5329920,5332480,11706368,11816960,1065353216,20628880,20669840,19438080,67108864,701440,2766888483,50,1820672,4438016,4438016,4438016,7162880,7165440,7168000,17016832,17020416,12456192,12345344,12345600,12455936,20361216,20632480,20637584,20679680,20611456,0,34,16642304,16601088,16601344,16642048,20545536,20665344,20605312,1680256,20480,5120,71680,40960,352,0,0,0
.long 5329920,5332480,11710464,11821056,1065353216,20628888,20669848,20195840,67108864,701440,2766888483,51,1821696,4441088,4441088,4441088,7170560,7173120,7175680,17057792,17061376,12371968,12372224,12482560,12482816,20427776,20632864,20637592,20681216,20611456,0,35,16611328,16611584,16652288,16652544,20571136,20665856,20605376,1700736,40960,25600,10240,61440,352,0,0,0
.long 5304320,5306880,10625024,10735616,1065353216,20625152,20670080,17927168,20684160,716800,3572227587,48,2146304,4759552,4759552,4759552,7475200,7477760,7480320,16941056,16947712,14057728,14168064,14168320,14057472,18702336,20639776,20637568,20676608,20611584,0,24,17236224,17276928,17277184,17235968,18978816,20672512,20609152,2294144,61440,46080,30720,0,736,0,0,0
.long 5304320,5306880,67108864,67108864,1065353216,20625160,20670088,18684928,67108864,716800,3572227587,49,2147328,4762624,4762624,4762624,7482880,7485440,7488000,16982016,16988672,14196736,14196992,14086144,14086400,18774016,20640160,20637576,20678144,20611584,0,25,17287168,17287424,17246208,17246464,19004416,20673024,20609216,2314624,0,66560,51200,20480,736,0,0,0
.long 5309440,5312000,10846208,10956800,1065353216,20625168,20670096,19442688,67108864,727040,3572227619,50,2148352,4765696,4765696,4765696,7490560,7493120,7495680,17022976,17029632,14225664,14114816,14115072,14225408,18845696,20640672,20637584,20679680,20611584,0,26,17297664,17256448,17256704,17297408,19030016,20673536,20609408,2335104,20480,5120,71680,40960,736,0,0,0
.long 5309440,5312000,67108864,67108864,1065353216,20625176,20670104,20200448,67108864,727040,3572227619,51,2149376,4768768,4768768,4768768,7498240,7500800,7503360,17063936,17070592,14141440,14141696,14252032,14252288,18912256,20641056,20637592,20681216,20611584,0,27,17266688,17266944,17307648,17307904,19055616,20674048,20609472,2355584,40960,25600,10240,61440,736,0,0,0
.long 5386240,5388800,14163968,14274560,1065353216,20641536,20670336,17927680,20684176,742400,3572227587,48,2473984,5087232,5087232,5087232,7802880,7805440,7808000,16945152,16948736,14057728,14168064,14168320,14057472,20217856,20639776,20637568,20676608,20611584,0,56,17236224,17276928,17277184,17235968,20494336,20672512,20609152,2294656,61440,46080,30720,0,352,0,0,0
.long 5386240,5388800,67108864,67108864,1065353216,20641544,20670344,18685440,67108864,742400,3572227587,49,2475008,5090304,5090304,5090304,7810560,7813120,7815680,16986112,16989696,14196736,14196992,14086144,14086400,20289536,20640160,20637576,20678144,20611584,0,57,17287168,17287424,17246208,17246464,20519936,20673024,20609216,2315136,0,66560,51200,20480,352,0,0,0
.long 5391360,5393920,14385152,14495744,1065353216,20641552,20670352,19443200,67108864,752640,3572227619,50,2476032,5093376,5093376,5093376,7818240,7820800,7823360,17027072,17030656,14225664,14114816,14115072,14225408,20361216,20640672,20637584,20679680,20611584,0,58,17297664,17256448,17256704,17297408,20545536,20673536,20609408,2335616,20480,5120,71680,40960,352,0,0,0
.long 5391360,5393920,67108864,67108864,1065353216,20641560,20670360,20200960,67108864,752640,3572227619,51,2477056,5096448,5096448,5096448,7825920,7828480,7831040,17068032,17071616,14141440,14141696,14252032,14252288,20427776,20641056,20637592,20681216,20611584,0,59,17266688,17266944,17307648,17307904,20571136,20674048,20609472,2356096,40960,25600,10240,61440,352,0,0,0
.long 1593344,1594368,10100736,10211328,1051011932,20621696,20670592,17901824,20683784,517120,887774787,52,184320,2797568,2797568,2797568,5519360,5521920,5524480,17074176,17080832,8970496,9080832,9081088,8970240,18702336,20615216,20639616,20676608,20611072,0,20,15352064,15392768,15393024,15351808,18978816,20647952,20597376,409984,61440,46080,30720,0,736,0,0,0
.long 1855488,1856512,10104832,10215424,1051011932,20621704,20670600,18659584,67108864,517120,887774787,53,185344,2800640,2800640,2800640,5527040,5529600,5532160,17115136,17121792,9109504,9109760,8998912,8999168,18774016,20615600,20639624,20678144,20611072,0,21,15403008,15403264,15362048,15362304,19004416,20648464,20597440,430464,0,66560,51200,20480,736,0,0,0
.long 1595392,1596416,10321920,10432512,1051011932,20621712,20670608,19417344,67108864,527360,887774819,54,186368,2803712,2803712,2803712,5534720,5537280,5539840,17156096,17162752,9138432,9027584,9027840,9138176,18845696,20616112,20639632,20679680,20611072,0,22,15413504,15372288,15372544,15413248,19030016,20648976,20597632,450944,20480,5120,71680,40960,736,0,0,0
.long 1857536,1858560,10326016,10436608,1051011932,20621720,20670616,20175104,67108864,527360,887774819,55,187392,2806784,2806784,2806784,5542400,5544960,5547520,17197056,17203712,9054208,9054464,9164800,9165056,18912256,20616496,20639640,20681216,20611072,0,23,15382528,15382784,15423488,15423744,19055616,20649488,20597696,471424,40960,25600,10240,61440,736,0,0,0
.long 1626112,1627136,13639680,13750272,1051011932,20638080,20670848,17902336,20683800,542720,887774787,52,512000,3125248,3125248,3125248,5847040,5849600,5852160,17078272,17081856,8970496,9080832,9081088,8970240,20217856,20615216,20639616,20676608,20611072,128,52,15352064,15392768,15393024,15351808,20494336,20647952,20597376,410496,61440,46080,30720,0,352,0,0,0
.long 1888256,1889280,13643776,13754368,1051011932,20638088,20670856,18660096,67108864,542720,887774787,53,513024,3128320,3128320,3128320,5854720,5857280,5859840,17119232,17122816,9109504,9109760,8998912,8999168,20289536,20615600,20639624,20678144,20611072,128,53,15403008,15403264,15362048,15362304,20519936,20648464,20597440,430976,0,66560,51200,20480,352,0,0,0
.long 1628160,1629184,13860864,13971456,1051011932,20638096,20670864,19417856,67108864,552960,887774819,54,514048,3131392,3131392,3131392,5862400,5864960,5867520,17160192,17163776,9138432,9027584,9027840,9138176,20361216,20616112,20639632,20679680,20611072,128,54,15413504,15372288,15372544,15413248,20545536,20648976,20597632,451456,20480,5120,71680,40960,352,0,0,0
.long 1890304,1891328,13864960,13975552,1051011932,20638104,20670872,20175616,67108864,552960,887774819,55,515072,3134464,3134464,3134464,5870080,5872640,5875200,17201152,17204736,9054208,9054464,9164800,9165056,20427776,20616496,20639640,20681216,20611072,128,55,15382528,15382784,15423488,15423744,20571136,20649488,20597696,471936,40960,25600,10240,61440,352,0,0,0
.long 3682304,3683328,9248768,9359360,1065353216,20618112,20671104,17917184,20683912,619520,1961549379,52,839680,3452928,3452928,3452928,6174720,6177280,6179840,17084416,17091072,10739968,10850304,10850560,10739712,18702336,20623408,20639616,20676608,20611200,0,12,16007424,16048128,16048384,16007168,18978816,20656144,20601472,1065344,61440,46080,30720,0,736,0,0,0
.long 3944448,3945472,9252864,9363456,1065353216,20618120,20671112,18674944,67108864,619520,1961549379,53,840704,3456000,3456000,3456000,6182400,6184960,6187520,17125376,17132032,10878976,10879232,10768384,10768640,18774016,20623792,20639624,20678144,20611200,0,13,16058368,16058624,16017408,16017664,19004416,20656656,20601536,1085824,0,66560,51200,20480,736,0,0,0
.long 3684352,3685376,9469952,9580544,1065353216,20618128,20671120,19432704,67108864,629760,1961549411,54,841728,3459072,3459072,3459072,6190080,6192640,6195200,17166336,17172992,10907904,10797056,10797312,10907648,18845696,20624304,20639632,20679680,20611200,0,14,16068864,16027648,16027904,16068608,19030016,20657168,20601728,1106304,20480,5120,71680,40960,736,0,0,0
.long 3946496,3947520,9474048,9584640,1065353216,20618136,20671128,20190464,67108864,629760,1961549411,55,842752,3462144,3462144,3462144,6197760,6200320,6202880,17207296,17213952,10823680,10823936,10934272,10934528,18912256,20624688,20639640,20681216,20611200,0,15,16037888,16038144,16078848,16079104,19055616,20657680,20601792,1126784,40960,25600,10240,61440,736,0,0,0
.long 3715072,3716096,12787712,12898304,1065353216,20634496,20671360,17917696,20683928,645120,1961549379,52,1167360,3780608,3780608,3780608,6502400,6504960,6507520,17088512,17092096,10739968,10850304,10850560,10739712,20217856,20623408,20639616,20676608,20611328,0,44,16007424,16048128,16048384,16007168,20494336,20656144,20601472,1065856,61440,46080,30720,0,352,0,0,0
.long 3977216,3978240,12791808,12902400,1065353216,20634504,20671368,18675456,67108864,645120,1961549379,53,1168384,3783680,3783680,3783680,6510080,6512640,6515200,17129472,17133056,10878976,10879232,10768384,10768640,20289536,20623792,20639624,20678144,20611328,0,45,16058368,16058624,16017408,16017664,20519936,20656656,20601536,1086336,0,66560,51200,20480,352,0,0,0
.long 3717120,3718144,13008896,13119488,1065353216,20634512,20671376,19433216,67108864,655360,1961549411,54,1169408,3786752,3786752,3786752,6517760,6520320,6522880,17170432,17174016,10907904,10797056,10797312,10907648,20361216,20624304,20639632,20679680,20611328,0,46,16068864,16027648,16027904,16068608,20545536,20657168,20601728,1106816,20480,5120,71680,40960,352,0,0,0
.long 3979264,3980288,13012992,13123584,1065353216,20634520,20671384,20190976,67108864,655360,1961549411,55,1170432,3789824,3789824,3789824,6525440,6528000,6530560,17211392,17214976,10823680,10823936,10934272,10934528,20427776,20624688,20639640,20681216,20611328,0,47,16037888,16038144,16078848,16079104,20571136,20657680,20601792,1127296,40960,25600,10240,61440,352,0,0,0
.long 5253120,5255680,8388608,8499200,1065353216,20614528,20671616,17922304,20684040,670720,2766888515,52,1495040,4108288,4108288,4108288,6830080,6832640,6835200,17094656,17101312,12509440,12619776,12620032,12509184,18702336,20631600,20639616,20676608,20611328,128,4,16662784,16703488,16703744,16662528,18978816,20664336,20605568,1720704,61440,46080,30720,0,736,0,0,0
.long 5253120,5255680,8392704,8503296,1065353216,20614536,20671624,18680064,67108864,670720,2766888515,53,1496064,4111360,4111360,4111360,6837760,6840320,6842880,17135616,17142272,12648448,12648704,12537856,12538112,18774016,20631984,20639624,20678144,20611328,128,5,16713728,16713984,16672768,16673024,19004416,20664848,20605632,1741184,0,66560,51200,20480,736,0,0,0
.long 5258240,5260800,8609792,8720384,1065353216,20614544,20671632,19437824,67108864,680960,2766888547,54,1497088,4114432,4114432,4114432,6845440,6848000,6850560,17176576,17183232,12677376,12566528,12566784,12677120,18845696,20632496,20639632,20679680,20611328,128,6,16724224,16683008,16683264,16723968,19030016,20665360,20605824,1761664,20480,5120,71680,40960,736,0,0,0
.long 5258240,5260800,8613888,8724480,1065353216,20614552,20671640,20195584,67108864,680960,2766888547,55,1498112,4117504,4117504,4117504,6853120,6855680,6858240,17217536,17224192,12593152,12593408,12703744,12704000,18912256,20632880,20639640,20681216,20611328,128,7,16693248,16693504,16734208,16734464,19055616,20665872,20605888,1782144,40960,25600,10240,61440,736,0,0,0
.long 5335040,5337600,11927552,12038144,1065353216,20630912,20671872,17922816,20684056,696320,2766888515,52,1822720,4435968,4435968,4435968,7157760,7160320,7162880,17098752,17102336,12509440,12619776,12620032,12509184,20217856,20631600,20639616,20676608,20611456,0,36,16662784,16703488,16703744,16662528,20494336,20664336,20605568,1721216,61440,46080,30720,0,352,0,0,0
.long 5335040,5337600,11931648,12042240,1065353216,20630920,20671880,18680576,67108864,696320,2766888515,53,1823744,4439040,4439040,4439040,7165440,7168000,7170560,17139712,17143296,12648448,12648704,12537856,12538112,20289536,20631984,20639624,20678144,20611456,0,37,16713728,16713984,16672768,16673024,20519936,20664848,20605632,1741696,0,66560,51200,20480,352,0,0,0
.long 5340160,5342720,12148736,12259328,1065353216,20630928,20671888,19438336,67108864,706560,2766888547,54,1824768,4442112,4442112,4442112,7173120,7175680,7178240,17180672,17184256,12677376,12566528,12566784,12677120,20361216,20632496,20639632,20679680,20611456,0,38,16724224,16683008,16683264,16723968,20545536,20665360,20605824,1762176,20480,5120,71680,40960,352,0,0,0
.long 5340160,5342720,12152832,12263424,1065353216,20630936,20671896,20196096,67108864,706560,2766888547,55,1825792,4445184,4445184,4445184,7180800,7183360,7185920,17221632,17225216,12593152,12593408,12703744,12704000,20427776,20632880,20639640,20681216,20611456,0,39,16693248,16693504,16734208,16734464,20571136,20665872,20605888,1782656,40960,25600,10240,61440,352,0,0,0
.long 5314560,5317120,11067392,11177984,1065353216,20627200,20672128,17927424,20684168,721920,3572227651,52,2150400,4763648,4763648,4763648,7485440,7488000,7490560,17104896,17111552,14278912,14389248,14389504,14278656,18702336,20639792,20639616,20676608,20611584,0,28,17318144,17358848,17359104,17317888,18978816,20672528,20609664,2376064,61440,46080,30720,0,736,0,0,0
.long 5314560,5317120,67108864,67108864,1065353216,20627208,20672136,18685184,67108864,721920,3572227651,53,2151424,4766720,4766720,4766720,7493120,7495680,7498240,17145856,17152512,14417920,14418176,14307328,14307584,18774016,20640176,20639624,20678144,20611584,0,29,17369088,17369344,17328128,17328384,19004416,20673040,20609728,2396544,0,66560,51200,20480,736,0,0,0
.long 5319680,5322240,11288576,11399168,1065353216,20627216,20672144,19442944,67108864,732160,3572227683,54,2152448,4769792,4769792,4769792,7500800,7503360,7505920,17186816,17193472,14446848,14336000,14336256,14446592,18845696,20640688,20639632,20679680,20611584,0,30,17379584,17338368,17338624,17379328,19030016,20673552,20609920,2417024,20480,5120,71680,40960,736,0,0,0
.long 5319680,5322240,67108864,67108864,1065353216,20627224,20672152,20200704,67108864,732160,3572227683,55,2153472,4772864,4772864,4772864,7508480,7511040,7513600,17227776,17234432,14362624,14362880,14473216,14473472,18912256,20641072,20639640,20681216,20611584,0,31,17348608,17348864,17389568,17389824,19055616,20674064,20609984,2437504,40960,25600,10240,61440,736,0,0,0
.long 5396480,5399040,14606336,14716928,1065353216,20643584,20672384,17927936,20684184,747520,3572227651,52,2478080,5091328,5091328,5091328,7813120,7815680,7818240,17108992,17112576,14278912,14389248,14389504,14278656,20217856,20639792,20639616,20676608,20611584,0,60,17318144,17358848,17359104,17317888,20494336,20672528,20609664,2376576,61440,46080,30720,0,352,0,0,0
.long 5396480,5399040,67108864,67108864,1065353216,20643592,20672392,18685696,67108864,747520,3572227651,53,2479104,5094400,5094400,5094400,7820800,7823360,7825920,17149952,17153536,14417920,14418176,14307328,14307584,20289536,20640176,20639624,20678144,20611584,0,61,17369088,17369344,17328128,17328384,20519936,20673040,20609728,2397056,0,66560,51200,20480,352,0,0,0
.long 5401600,5404160,14827520,14938112,1065353216,20643600,20672400,19443456,67108864,757760,3572227683,54,2480128,5097472,5097472,5097472,7828480,7831040,7833600,17190912,17194496,14446848,14336000,14336256,14446592,20361216,20640688,20639632,20679680,20611584,0,62,17379584,17338368,17338624,17379328,20545536,20673552,20609920,2417536,20480,5120,71680,40960,352,0,0,0
.long 5401600,5404160,67108864,67108864,1065353216,20643608,20672408,20201216,67108864,757760,3572227683,55,2481152,5100544,5100544,5100544,7836160,7838720,7841280,17231872,17235456,14362624,14362880,14473216,14473472,20427776,20641072,20639640,20681216,20611584,0,63,17348608,17348864,17389568,17389824,20571136,20674064,20609984,2438016,40960,25600,10240,61440,352,0,0,0
.long 1638400,358400,17768448,17881088,768000,17932288,20672640,17625088,20684288,491520,4109008385,56,188416,2801664,2801664,2801664,5529600,5532160,5534720,17238016,17244672,9191680,9302016,9302272,9191424,18702336,20617248,20641664,20676608,20611072,0,12,15433984,15474688,15474944,15433728,18978816,20649984,20597888,491904,61440,46080,30720,0,736,0,0,0
.long 1638400,358400,18526208,18638848,768000,18690048,20672648,18382848,67108864,491520,4109008385,57,189440,2804736,2804736,2804736,5537280,5539840,5542400,17278976,17285632,9330688,9330944,9220096,9220352,18774016,20617632,20641672,20678144,20611072,0,12,15484928,15485184,15443968,15444224,19004416,20650496,20597952,512384,0,66560,51200,20480,736,0,0,0
.long 1648640,368640,19283968,19396608,778240,19447808,20672656,19140608,67108864,501760,4109008417,58,190464,2807808,2807808,2807808,5544960,5547520,5550080,17319936,17326592,9359616,9248768,9249024,9359360,18845696,20618144,20641680,20679680,20611072,0,12,15495424,15454208,15454464,15495168,19030016,20651008,20598144,532864,20480,5120,71680,40960,736,0,0,0
.long 1648640,368640,20041728,20154368,778240,20205568,20672664,19898368,67108864,501760,4109008417,59,191488,2810880,2810880,2810880,5552640,5555200,5557760,17360896,17367552,9275392,9275648,9385984,9386240,18912256,20618528,20641688,20681216,20611072,0,12,15464448,15464704,15505408,15505664,19055616,20651520,20598208,553344,40960,25600,10240,61440,736,0,0,0
.long 1643520,363520,17768704,17881344,773120,17932544,20672896,17625344,20684296,496640,4109008385,56,516096,3129344,3129344,3129344,5857280,5859840,5862400,17242112,17245696,9191680,9302016,9302272,9191424,20217856,20617248,20641664,20676608,20611072,128,12,15433984,15474688,15474944,15433728,20494336,20649984,20597888,492416,61440,46080,30720,0,352,0,0,0
.long 1643520,363520,18526464,18639104,773120,18690304,20672904,18383104,67108864,496640,4109008385,57,517120,3132416,3132416,3132416,5864960,5867520,5870080,17283072,17286656,9330688,9330944,9220096,9220352,20289536,20617632,20641672,20678144,20611072,128,12,15484928,15485184,15443968,15444224,20519936,20650496,20597952,512896,0,66560,51200,20480,352,0,0,0
.long 1653760,373760,19284224,19396864,783360,19448064,20672912,19140864,67108864,506880,4109008417,58,518144,3135488,3135488,3135488,5872640,5875200,5877760,17324032,17327616,9359616,9248768,9249024,9359360,20361216,20618144,20641680,20679680,20611072,128,12,15495424,15454208,15454464,15495168,20545536,20651008,20598144,533376,20480,5120,71680,40960,352,0,0,0
.long 1653760,373760,20041984,20154624,783360,20205824,20672920,19898624,67108864,506880,4109008417,59,519168,3138560,3138560,3138560,5880320,5882880,5885440,17364992,17368576,9275392,9275648,9385984,9386240,20427776,20618528,20641688,20681216,20611072,128,12,15464448,15464704,15505408,15505664,20571136,20651520,20598208,553856,40960,25600,10240,61440,352,0,0,0
.long 1658880,384000,17768960,17881600,793600,17932800,20673152,17625600,20684304,512000,4109041153,56,843776,3457024,3457024,3457024,6184960,6187520,6190080,17248256,17254912,10961152,11071488,11071744,10960896,18702336,20625440,20641664,20676608,20611200,0,12,16089344,16130048,16130304,16089088,18978816,20658176,20601984,1147264,61440,46080,30720,0,736,0,0,0
.long 1658880,384000,18526720,18639360,793600,18690560,20673160,18383360,67108864,512000,4109041153,57,844800,3460096,3460096,3460096,6192640,6195200,6197760,17289216,17295872,11100160,11100416,10989568,10989824,18774016,20625824,20641672,20678144,20611200,0,12,16140288,16140544,16099328,16099584,19004416,20658688,20602048,1167744,0,66560,51200,20480,736,0,0,0
.long 1669120,394240,19284480,19397120,803840,19448320,20673168,19141120,67108864,522240,4109041185,58,845824,3463168,3463168,3463168,6200320,6202880,6205440,17330176,17336832,11129088,11018240,11018496,11128832,18845696,20626336,20641680,20679680,20611200,0,12,16150784,16109568,16109824,16150528,19030016,20659200,20602240,1188224,20480,5120,71680,40960,736,0,0,0
.long 1669120,394240,20042240,20154880,803840,20206080,20673176,19898880,67108864,522240,4109041185,59,846848,3466240,3466240,3466240,6208000,6210560,6213120,17371136,17377792,11044864,11045120,11155456,11155712,18912256,20626720,20641688,20681216,20611200,0,12,16119808,16120064,16160768,16161024,19055616,20659712,20602304,1208704,40960,25600,10240,61440,736,0,0,0
.long 1664000,389120,17769216,17881856,798720,17933056,20673408,17625856,20684312,517120,4109041153,56,1171456,3784704,3784704,3784704,6512640,6515200,6517760,17252352,17255936,10961152,11071488,11071744,10960896,20217856,20625440,20641664,20676608,20611328,0,12,16089344,16130048,16130304,16089088,20494336,20658176,20601984,1147776,61440,46080,30720,0,352,0,0,0
.long 1664000,389120,18526976,18639616,798720,18690816,20673416,18383616,67108864,517120,4109041153,57,1172480,3787776,3787776,3787776,6520320,6522880,6525440,17293312,17296896,11100160,11100416,10989568,10989824,20289536,20625824,20641672,20678144,20611328,0,12,16140288,16140544,16099328,16099584,20519936,20658688,20602048,1168256,0,66560,51200,20480,352,0,0,0
.long 1674240,399360,19284736,19397376,808960,19448576,20673424,19141376,67108864,527360,4109041185,58,1173504,3790848,3790848,3790848,6528000,6530560,6533120,17334272,17337856,11129088,11018240,11018496,11128832,20361216,20626336,20641680,20679680,20611328,0,12,16150784,16109568,16109824,16150528,20545536,20659200,20602240,1188736,20480,5120,71680,40960,352,0,0,0
.long 1674240,399360,20042496,20155136,808960,20206336,20673432,19899136,67108864,527360,4109041185,59,1174528,3793920,3793920,3793920,6535680,6538240,6540800,17375232,17378816,11044864,11045120,11155456,11155712,20427776,20626720,20641688,20681216,20611328,0,12,16119808,16120064,16160768,16161024,20571136,20659712,20602304,1209216,40960,25600,10240,61440,352,0,0,0
.long 2170880,225280,17835008,17886208,634880,17937408,20673664,17630208,20684416,532480,4109073921,56,1499136,4112384,4112384,4112384,6840320,6842880,6845440,17258496,17265152,12730624,12840960,12841216,12730368,18702336,20633632,20641664,20676608,20611328,128,12,16744704,16785408,16785664,16744448,18978816,20666368,20606080,1802624,61440,46080,30720,0,736,0,0,0
.long 2170880,225280,18592768,18643968,634880,18695168,20673672,18387968,67108864,532480,4109073921,57,1500160,4115456,4115456,4115456,6848000,6850560,6853120,17299456,17306112,12869632,12869888,12759040,12759296,18774016,20634016,20641672,20678144,20611328,128,12,16795648,16795904,16754688,16754944,19004416,20666880,20606144,1823104,0,66560,51200,20480,736,0,0,0
.long 2181120,250880,19350528,19401728,660480,19452928,20673680,19145728,67108864,542720,4109073953,58,1501184,4118528,4118528,4118528,6855680,6858240,6860800,17340416,17347072,12898560,12787712,12787968,12898304,18845696,20634528,20641680,20679680,20611328,128,12,16806144,16764928,16765184,16805888,19030016,20667392,20606336,1843584,20480,5120,71680,40960,736,0,0,0
.long 2181120,250880,20108288,20159488,660480,20210688,20673688,19903488,67108864,542720,4109073953,59,1502208,4121600,4121600,4121600,6863360,6865920,6868480,17381376,17388032,12814336,12814592,12924928,12925184,18912256,20634912,20641688,20681216,20611328,128,12,16775168,16775424,16816128,16816384,19055616,20667904,20606400,1864064,40960,25600,10240,61440,736,0,0,0
.long 2176000,276480,17835264,17886464,686080,17937664,20673920,17630464,20684424,537600,4109073921,56,1826816,4440064,4440064,4440064,7168000,7170560,7173120,17262592,17266176,12730624,12840960,12841216,12730368,20217856,20633632,20641664,20676608,20611456,0,12,16744704,16785408,16785664,16744448,20494336,20666368,20606080,1803136,61440,46080,30720,0,352,0,0,0
.long 2176000,276480,18593024,18644224,686080,18695424,20673928,18388224,67108864,537600,4109073921,57,1827840,4443136,4443136,4443136,7175680,7178240,7180800,17303552,17307136,12869632,12869888,12759040,12759296,20289536,20634016,20641672,20678144,20611456,0,12,16795648,16795904,16754688,16754944,20519936,20666880,20606144,1823616,0,66560,51200,20480,352,0,0,0
.long 2186240,302080,19350784,19401984,711680,19453184,20673936,19145984,67108864,547840,4109073953,58,1828864,4446208,4446208,4446208,7183360,7185920,7188480,17344512,17348096,12898560,12787712,12787968,12898304,20361216,20634528,20641680,20679680,20611456,0,12,16806144,16764928,16765184,16805888,20545536,20667392,20606336,1844096,20480,5120,71680,40960,352,0,0,0
.long 2186240,302080,20108544,20159744,711680,20210944,20673944,19903744,67108864,547840,4109073953,59,1829888,4449280,4449280,4449280,7191040,7193600,7196160,17385472,17389056,12814336,12814592,12924928,12925184,20427776,20634912,20641688,20681216,20611456,0,12,16775168,16775424,16816128,16816384,20571136,20667904,20606400,1864576,40960,25600,10240,61440,352,0,0,0
.long 2191360,327680,17835520,17886720,737280,17937920,20674176,17630720,20684432,552960,4109106689,56,2154496,4767744,4767744,4767744,7495680,7498240,7500800,17268736,17275392,14500096,14610432,14610688,14499840,18702336,20641824,20641664,20676608,20611584,0,12,17400064,17440768,17441024,17399808,18978816,20674560,20610176,2457984,61440,46080,30720,0,736,0,0,0
.long 2191360,327680,18593280,18644480,737280,18695680,20674184,18388480,67108864,552960,4109106689,57,2155520,4770816,4770816,4770816,7503360,7505920,7508480,17309696,17316352,14639104,14639360,14528512,14528768,18774016,20642208,20641672,20678144,20611584,0,12,17451008,17451264,17410048,17410304,19004416,20675072,20610240,2478464,0,66560,51200,20480,736,0,0,0
.long 2201600,353280,19351040,19402240,762880,19453440,20674192,19146240,67108864,563200,4109106721,58,2156544,4773888,4773888,4773888,7511040,7513600,7516160,17350656,17357312,14668032,14557184,14557440,14667776,18845696,20642720,20641680,20679680,20611584,0,12,17461504,17420288,17420544,17461248,19030016,20675584,20610432,2498944,20480,5120,71680,40960,736,0,0,0
.long 2201600,353280,20108800,20160000,762880,20211200,20674200,19904000,67108864,563200,4109106721,59,2157568,4776960,4776960,4776960,7518720,7521280,7523840,17391616,17398272,14583808,14584064,14694400,14694656,18912256,20643104,20641688,20681216,20611584,0,12,17430528,17430784,17471488,17471744,19055616,20676096,20610496,2519424,40960,25600,10240,61440,736,0,0,0
.long 2196480,378880,17835776,17886976,788480,17938176,20674432,17630976,20684440,558080,4109106689,56,2482176,5095424,5095424,5095424,7823360,7825920,7828480,17272832,17276416,14500096,14610432,14610688,14499840,20217856,20641824,20641664,20676608,20611584,0,12,17400064,17440768,17441024,17399808,20494336,20674560,20610176,2458496,61440,46080,30720,0,352,0,0,0
.long 2196480,378880,18593536,18644736,788480,18695936,20674440,18388736,67108864,558080,4109106689,57,2483200,5098496,5098496,5098496,7831040,7833600,7836160,17313792,17317376,14639104,14639360,14528512,14528768,20289536,20642208,20641672,20678144,20611584,0,12,17451008,17451264,17410048,17410304,20519936,20675072,20610240,2478976,0,66560,51200,20480,352,0,0,0
.long 2206720,404480,19351296,19402496,814080,19453696,20674448,19146496,67108864,568320,4109106721,58,2484224,5101568,5101568,5101568,7838720,7841280,7843840,17354752,17358336,14668032,14557184,14557440,14667776,20361216,20642720,20641680,20679680,20611584,0,12,17461504,17420288,17420544,17461248,20545536,20675584,20610432,2499456,20480,5120,71680,40960,352,0,0,0
.long 2206720,404480,20109056,20160256,814080,20211456,20674456,19904256,67108864,568320,4109106721,59,2485248,5104640,5104640,5104640,7846400,7848960,7851520,17395712,17399296,14583808,14584064,14694400,14694656,20427776,20643104,20641688,20681216,20611584,0,12,17430528,17430784,17471488,17471744,20571136,20676096,20610496,2519936,40960,25600,10240,61440,352,0,0,0
.long 153600,563200,17855488,17906688,0,67108864,20674688,17696768,20684544,1064960,4109008449,60,192512,2805760,2805760,2805760,5539840,5542400,5544960,17401856,17408512,9412864,9523200,9523456,9412608,18702336,20617264,20643712,20676608,20611072,0,6,15515904,15556608,15556864,15515648,18978816,20650000,20598400,573824,61440,46080,30720,0,736,0,0,0
.long 153600,563200,18613248,18664448,0,67108864,20674696,18454528,67108864,1064960,4109008449,61,193536,2808832,2808832,2808832,5547520,5550080,5552640,17442816,17449472,9551872,9552128,9441280,9441536,18774016,20617648,20643720,20678144,20611072,0,6,15566848,15567104,15525888,15526144,19004416,20650512,20598464,594304,0,66560,51200,20480,736,0,0,0
.long 163840,573440,19371008,19422208,0,67108864,20674704,19212288,67108864,1075200,4109008481,62,194560,2811904,2811904,2811904,5555200,5557760,5560320,17483776,17490432,9580800,9469952,9470208,9580544,18845696,20618160,20643728,20679680,20611072,0,6,15577344,15536128,15536384,15577088,19030016,20651024,20598656,614784,20480,5120,71680,40960,736,0,0,0
.long 163840,573440,20128768,20179968,0,67108864,20674712,19970048,67108864,1075200,4109008481,63,195584,2814976,2814976,2814976,5562880,5565440,5568000,17524736,17531392,9496576,9496832,9607168,9607424,18912256,20618544,20643736,20681216,20611072,0,6,15546368,15546624,15587328,15587584,19055616,20651536,20598720,635264,40960,25600,10240,61440,736,0,0,0
.long 158720,568320,17855744,17906944,0,67108864,20674944,17697024,20684552,1070080,4109008449,60,520192,3133440,3133440,3133440,5867520,5870080,5872640,17405952,17409536,9412864,9523200,9523456,9412608,20217856,20617264,20643712,20676608,20611072,128,6,15515904,15556608,15556864,15515648,20494336,20650000,20598400,574336,61440,46080,30720,0,352,0,0,0
.long 158720,568320,18613504,18664704,0,67108864,20674952,18454784,67108864,1070080,4109008449,61,521216,3136512,3136512,3136512,5875200,5877760,5880320,17446912,17450496,9551872,9552128,9441280,9441536,20289536,20617648,20643720,20678144,20611072,128,6,15566848,15567104,15525888,15526144,20519936,20650512,20598464,594816,0,66560,51200,20480,352,0,0,0
.long 168960,578560,19371264,19422464,0,67108864,20674960,19212544,67108864,1080320,4109008481,62,522240,3139584,3139584,3139584,5882880,5885440,5888000,17487872,17491456,9580800,9469952,9470208,9580544,20361216,20618160,20643728,20679680,20611072,128,6,15577344,15536128,15536384,15577088,20545536,20651024,20598656,615296,20480,5120,71680,40960,352,0,0,0
.long 168960,578560,20129024,20180224,0,67108864,20674968,19970304,67108864,1080320,4109008481,63,523264,3142656,3142656,3142656,5890560,5893120,5895680,17528832,17532416,9496576,9496832,9607168,9607424,20427776,20618544,20643736,20681216,20611072,128,6,15546368,15546624,15587328,15587584,20571136,20651536,20598720,635776,40960,25600,10240,61440,352,0,0,0
.long 179200,588800,17856000,17907200,0,67108864,20675200,17697280,20684560,1085440,4109041217,60,847872,3461120,3461120,3461120,6195200,6197760,6200320,17412096,17418752,11182336,11292672,11292928,11182080,18702336,20625456,20643712,20676608,20611200,0,6,16171264,16211968,16212224,16171008,18978816,20658192,20602496,1229184,61440,46080,30720,0,736,0,0,0
.long 179200,588800,18613760,18664960,0,67108864,20675208,18455040,67108864,1085440,4109041217,61,848896,3464192,3464192,3464192,6202880,6205440,6208000,17453056,17459712,11321344,11321600,11210752,11211008,18774016,20625840,20643720,20678144,20611200,0,6,16222208,16222464,16181248,16181504,19004416,20658704,20602560,1249664,0,66560,51200,20480,736,0,0,0
.long 189440,599040,19371520,19422720,0,67108864,20675216,19212800,67108864,1095680,4109041249,62,849920,3467264,3467264,3467264,6210560,6213120,6215680,17494016,17500672,11350272,11239424,11239680,11350016,18845696,20626352,20643728,20679680,20611200,0,6,16232704,16191488,16191744,16232448,19030016,20659216,20602752,1270144,20480,5120,71680,40960,736,0,0,0
.long 189440,599040,20129280,20180480,0,67108864,20675224,19970560,67108864,1095680,4109041249,63,850944,3470336,3470336,3470336,6218240,6220800,6223360,17534976,17541632,11266048,11266304,11376640,11376896,18912256,20626736,20643736,20681216,20611200,0,6,16201728,16201984,16242688,16242944,19055616,20659728,20602816,1290624,40960,25600,10240,61440,736,0,0,0
.long 184320,593920,17856256,17907456,0,67108864,20675456,17697536,20684568,1090560,4109041217,60,1175552,3788800,3788800,3788800,6522880,6525440,6528000,17416192,17419776,11182336,11292672,11292928,11182080,20217856,20625456,20643712,20676608,20611328,0,6,16171264,16211968,16212224,16171008,20494336,20658192,20602496,1229696,61440,46080,30720,0,352,0,0,0
.long 184320,593920,18614016,18665216,0,67108864,20675464,18455296,67108864,1090560,4109041217,61,1176576,3791872,3791872,3791872,6530560,6533120,6535680,17457152,17460736,11321344,11321600,11210752,11211008,20289536,20625840,20643720,20678144,20611328,0,6,16222208,16222464,16181248,16181504,20519936,20658704,20602560,1250176,0,66560,51200,20480,352,0,0,0
.long 194560,604160,19371776,19422976,0,67108864,20675472,19213056,67108864,1100800,4109041249,62,1177600,3794944,3794944,3794944,6538240,6540800,6543360,17498112,17501696,11350272,11239424,11239680,11350016,20361216,20626352,20643728,20679680,20611328,0,6,16232704,16191488,16191744,16232448,20545536,20659216,20602752,1270656,20480,5120,71680,40960,352,0,0,0
.long 194560,604160,20129536,20180736,0,67108864,20675480,19970816,67108864,1100800,4109041249,63,1178624,3798016,3798016,3798016,6545920,6548480,6551040,17539072,17542656,11266048,11266304,11376640,11376896,20427776,20626736,20643736,20681216,20611328,0,6,16201728,16201984,16242688,16242944,20571136,20659728,20602816,1291136,40960,25600,10240,61440,352,0,0,0
.long 20480,430080,17860608,17911808,0,67108864,20675712,17701888,20684672,1105920,4109073985,60,1503232,4116480,4116480,4116480,6850560,6853120,6855680,17422336,17428992,12951808,13062144,13062400,12951552,18702336,20633648,20643712,20676608,20611328,128,6,16826624,16867328,16867584,16826368,18978816,20666384,20606592,1884544,61440,46080,30720,0,736,0,0,0
.long 20480,430080,18618368,18669568,0,67108864,20675720,18459648,67108864,1105920,4109073985,61,1504256,4119552,4119552,4119552,6858240,6860800,6863360,17463296,17469952,13090816,13091072,12980224,12980480,18774016,20634032,20643720,20678144,20611328,128,6,16877568,16877824,16836608,16836864,19004416,20666896,20606656,1905024,0,66560,51200,20480,736,0,0,0
.long 46080,455680,19376128,19427328,0,67108864,20675728,19217408,67108864,1116160,4109074017,62,1505280,4122624,4122624,4122624,6865920,6868480,6871040,17504256,17510912,13119744,13008896,13009152,13119488,18845696,20634544,20643728,20679680,20611328,128,6,16888064,16846848,16847104,16887808,19030016,20667408,20606848,1925504,20480,5120,71680,40960,736,0,0,0
.long 46080,455680,20133888,20185088,0,67108864,20675736,19975168,67108864,1116160,4109074017,63,1506304,4125696,4125696,4125696,6873600,6876160,6878720,17545216,17551872,13035520,13035776,13146112,13146368,18912256,20634928,20643736,20681216,20611328,128,6,16857088,16857344,16898048,16898304,19055616,20667920,20606912,1945984,40960,25600,10240,61440,736,0,0,0
.long 71680,481280,17860864,17912064,0,67108864,20675968,17702144,20684680,1111040,4109073985,60,1830912,4444160,4444160,4444160,7178240,7180800,7183360,17426432,17430016,12951808,13062144,13062400,12951552,20217856,20633648,20643712,20676608,20611456,0,6,16826624,16867328,16867584,16826368,20494336,20666384,20606592,1885056,61440,46080,30720,0,352,0,0,0
.long 71680,481280,18618624,18669824,0,67108864,20675976,18459904,67108864,1111040,4109073985,61,1831936,4447232,4447232,4447232,7185920,7188480,7191040,17467392,17470976,13090816,13091072,12980224,12980480,20289536,20634032,20643720,20678144,20611456,0,6,16877568,16877824,16836608,16836864,20519936,20666896,20606656,1905536,0,66560,51200,20480,352,0,0,0
.long 97280,506880,19376384,19427584,0,67108864,20675984,19217664,67108864,1121280,4109074017,62,1832960,4450304,4450304,4450304,7193600,7196160,7198720,17508352,17511936,13119744,13008896,13009152,13119488,20361216,20634544,20643728,20679680,20611456,0,6,16888064,16846848,16847104,16887808,20545536,20667408,20606848,1926016,20480,5120,71680,40960,352,0,0,0
.long 97280,506880,20134144,20185344,0,67108864,20675992,19975424,67108864,1121280,4109074017,63,1833984,4453376,4453376,4453376,7201280,7203840,7206400,17549312,17552896,13035520,13035776,13146112,13146368,20427776,20634928,20643736,20681216,20611456,0,6,16857088,16857344,16898048,16898304,20571136,20667920,20606912,1946496,40960,25600,10240,61440,352,0,0,0
.long 122880,532480,17861120,17912320,0,67108864,20676224,17702400,20684688,1126400,4109106753,60,2158592,4771840,4771840,4771840,7505920,7508480,7511040,17432576,17439232,14721280,14831616,14831872,14721024,18702336,20641840,20643712,20676608,20611584,0,6,17481984,17522688,17522944,17481728,18978816,20674576,20610688,2539904,61440,46080,30720,0,736,0,0,0
.long 122880,532480,18618880,18670080,0,67108864,20676232,18460160,67108864,1126400,4109106753,61,2159616,4774912,4774912,4774912,7513600,7516160,7518720,17473536,17480192,14860288,14860544,14749696,14749952,18774016,20642224,20643720,20678144,20611584,0,6,17532928,17533184,17491968,17492224,19004416,20675088,20610752,2560384,0,66560,51200,20480,736,0,0,0
.long 148480,558080,19376640,19427840,0,67108864,20676240,19217920,67108864,1136640,4109106785,62,2160640,4777984,4777984,4777984,7521280,7523840,7526400,17514496,17521152,14889216,14778368,14778624,14888960,18845696,20642736,20643728,20679680,20611584,0,6,17543424,17502208,17502464,17543168,19030016,20675600,20610944,2580864,20480,5120,71680,40960,736,0,0,0
.long 148480,558080,20134400,20185600,0,67108864,20676248,19975680,67108864,1136640,4109106785,63,2161664,4781056,4781056,4781056,7528960,7531520,7534080,17555456,17562112,14804992,14805248,14915584,14915840,18912256,20643120,20643736,20681216,20611584,0,6,17512448,17512704,17553408,17553664,19055616,20676112,20611008,2601344,40960,25600,10240,61440,736,0,0,0
.long 174080,583680,17861376,17912576,0,67108864,20676480,17702656,20684696,1131520,4109106753,60,2486272,5099520,5099520,5099520,7833600,7836160,7838720,17436672,17440256,14721280,14831616,14831872,14721024,20217856,20641840,20643712,20676608,20611584,0,6,17481984,17522688,17522944,17481728,20494336,20674576,20610688,2540416,61440,46080,30720,0,352,0,0,0
.long 174080,583680,18619136,18670336,0,67108864,20676488,18460416,67108864,1131520,4109106753,61,2487296,5102592,5102592,5102592,7841280,7843840,7846400,17477632,17481216,14860288,14860544,14749696,14749952,20289536,20642224,20643720,20678144,20611584,0,6,17532928,17533184,17491968,17492224,20519936,20675088,20610752,2560896,0,66560,51200,20480,352,0,0,0
.long 199680,609280,19376896,19428096,0,67108864,20676496,19218176,67108864,1141760,4109106785,62,2488320,5105664,5105664,5105664,7848960,7851520,7854080,17518592,17522176,14889216,14778368,14778624,14888960,20361216,20642736,20643728,20679680,20611584,0,6,17543424,17502208,17502464,17543168,20545536,20675600,20610944,2581376,20480,5120,71680,40960,352,0,0,0
.long 199680,609280,20134656,20185856,0,67108864,20676504,19975936,67108864,1141760,4109106785,63,2489344,5108736,5108736,5108736,7856640,7859200,7861760,17559552,17563136,14804992,14805248,14915584,14915840,20427776,20643120,20643736,20681216,20611584,0,6,17512448,17512704,17553408,17553664,20571136,20676112,20611008,2601856,40960,25600,10240,61440,352,0,0,0
```
